```python
import torch

def _softmax(x, axis=-1):
    return torch.softmax(x, dim=axis)
def _gelu(x):
    return torch.nn.functional.gelu(x, approximate="tanh")
def _silu(x):
    return torch.nn.functional.silu(x)
def _sigmoid(x):
    return torch.sigmoid(x)
def _layernorm(x, axis=-1, eps=1e-5):
    m = x.mean(dim=axis, keepdim=True)
    v = x.var(dim=axis, keepdim=True, unbiased=False)
    return (x - m) / torch.sqrt(v + eps)
def _scatter_add(tgt, idx, src, axis=0):
    return tgt.clone().index_add_(axis, idx, src)
def _segment_sum(src, seg, n):
    out = torch.zeros((n,) + src.shape[1:], dtype=src.dtype)
    return out.index_add_(0, seg, src)
def _pad(x, pw):
    flat = tuple(v for pair in reversed(pw) for v in pair)
    return torch.nn.functional.pad(x, flat)

kernel_name = 'sequential_preLN__linear_attn_block__mixer_token_mlp__prompt'

def setup_inputs():

    _w = (lambda a: (lambda t: t.to(torch.bfloat16) if t.is_floating_point() else t)(torch.as_tensor(a)))
    def _A_setup():
        B, S, D = 1, 2048, 576
        return {
            "x": _w((lambda *s: torch.randn(*s, dtype=torch.bfloat16) * 0.05)(B, S, D)),
            "wqkv": _w((lambda *s: torch.randn(*s, dtype=torch.bfloat16) * 0.05)(D, 3 * D)),
            "wo": _w((lambda *s: torch.randn(*s, dtype=torch.bfloat16) * 0.05)(D, D)),
        }
    _A_in = _A_setup()

    def _B_setup():
        B, S, D, F = 1, 2048, 576, 4608
        return {
            "x": _w((lambda *s: torch.randn(*s, dtype=torch.bfloat16) * 0.05)(B, S, D)),
            "w1": _w((lambda *s: torch.randn(*s, dtype=torch.bfloat16) * 0.2)(S, F) * (S ** -0.5)),
            "b1": _w((lambda *s: torch.randn(*s, dtype=torch.bfloat16) * 3.2)(F) * 0.02),
            "w2": _w((lambda *s: torch.randn(*s, dtype=torch.bfloat16) * 0.2)(F, S) * (F ** -0.5)),
            "b2": _w((lambda *s: torch.randn(*s, dtype=torch.bfloat16) * 0.4)(S) * 0.02),
        }
    _B_in = _B_setup()

    return {
        "A_x": _A_in["x"],
        "A_wqkv": _A_in["wqkv"],
        "A_wo": _A_in["wo"],
        "B_x": _B_in["x"],
        "B_w1": _B_in["w1"],
        "B_b1": _B_in["b1"],
        "B_w2": _B_in["w2"],
        "B_b2": _B_in["b2"],
    }

def reference(A_x, A_wqkv, A_wo, B_x, B_w1, B_b1, B_w2, B_b2):
    def _A_ref(x, wqkv, wo):
        B, S, D = x.shape
        H = 32; Dh = D // H
        qkv = (lambda x, *d: x.permute(*d))((x @ wqkv).reshape(B, S, 3, H, Dh), 2, 0, 3, 1, 4)
        q, k, v = qkv[0], qkv[1], qkv[2]
        phi = lambda t: torch.where(t > 0, t + 1, torch.exp(t)) + 1e-6
        pq, pk = phi(q), phi(k)
        kv = torch.einsum("bhsd,bhse->bhde", pk, v)
        z = torch.einsum("bhsd->bhd", pk)
        num = torch.einsum("bhqd,bhde->bhqe", pq, kv)
        den = torch.einsum("bhqd,bhd->bhq", pq, z)[..., None] + 1e-6
        o = num / den
        return (lambda x, *d: x.permute(*d))(o, 0, 2, 1, 3).reshape(B, S, D) @ wo

    def _B_ref(x, w1, b1, w2, b2):
        B, S, D = x.shape
        h = _layernorm(x, axis=-1)
        u = torch.einsum("bsd,sf->bdf", h, w1) + b1
        u = _gelu(u)
        y = torch.einsum("bdf,fs->bds", u, w2) + b2
        return (lambda x, *d: x.permute(*d))(y, 0, 2, 1)

    x = A_x
    h = x + _A_ref(_layernorm(x, axis=-1), A_wqkv, A_wo)
    h2 = h + _B_ref(_layernorm(h, axis=-1), B_w1, B_b1, B_w2, B_b2)
    return h2
```

```asm
; @launch grid=(256,1,1) block=(512,1,1) lds=159744
.amdgcn_target "amdgcn-amd-amdhsa--gfx950"
.text
.globl sequential_preLN__linear_attn_block__mixer_token_mlp__prompt_kernel
.p2align 8
.type sequential_preLN__linear_attn_block__mixer_token_mlp__prompt_kernel,@function
sequential_preLN__linear_attn_block__mixer_token_mlp__prompt_kernel:
    s_cmp_ge_u32 s2, 256
    s_cbranch_scc1 Lk1_end4
    s_load_dwordx4 s[4:7], s[0:1], 0
    s_load_dwordx4 s[28:31], s[0:1], 72
    v_readfirstlane_b32 s3, v0
    v_and_b32 v1, 63, v0
    s_and_b32 s33, s2, 7
    s_lshr_b32 s34, s2, 3
    s_lshr_b32 s3, s3, 6
    s_and_b32 s32, s33, 1
    s_cmp_lt_u32 s34, 8
    s_cbranch_scc1 Lk1_spare5
    s_sub_u32 s34, s34, 8
    s_lshr_b32 s35, s34, 2
    s_and_b32 s36, s34, 3
    s_lshr_b32 s37, s33, 1
    s_lshl_b32 s37, s37, 2
    s_add_u32 s36, s36, s37
    s_cmp_lt_u32 s3, 4
    s_cbranch_scc1 Lk1_comp6
    s_cmp_gt_u32 s3, 4
    s_cbranch_scc1 Lk1_help1
    v_lshrrev_b32 v20, 4, v1
    v_lshrrev_b32 v21, 3, v1
    s_movk_i32 s38, 1152
    v_mul_u32_u24 v21, s38, v21
    v_mul_u32_u24 v43, s38, v1
    v_and_b32 v22, 7, v1
    v_xor_b32 v22, v22, v20
    v_xor_b32 v23, 4, v22
    v_lshl_add_u32 v2, v22, 4, v21
    v_lshl_add_u32 v3, v23, 4, v21
    v_add_u32 v4, 16384, v2
    v_add_u32 v3, 8192, v3
    v_add_u32 v5, 16384, v3
    s_mul_i32 s40, s36, 147456
    s_add_u32 s41, s40, 36864
    s_add_u32 s42, s40, 73728
    s_add_u32 s43, s40, 110592
    s_lshl_b32 s38, s32, 2
    s_add_u32 s38, s38, s35
    s_mul_i32 s38, s38, 144
    s_add_u32 s38, s38, 1152
    s_lshl_b32 s39, s32, 1
    s_add_u32 s39, s39, s35
    s_sub_u32 s39, s39, 4
    s_mul_i32 s39, s39, 288
    s_cmp_lt_u32 s35, 4
    s_cselect_b32 s44, s38, s39
    s_cselect_b32 s45, 1008, 0
    s_movk_i32 s46, 3641
    s_movk_i32 s47, 3456
    v_mov_b32 v24, s45
    s_lshl_b32 s38, s32, 5
    s_add_u32 s38, s38, s35
    s_lshl_b32 s53, s38, 2
    v_mov_b32 v34, s53
    s_waitcnt lgkmcnt(0)
    s_mov_b32 s12, s4
    s_mov_b32 s13, s5
    s_mov_b32 s14, 2359296
    s_mov_b32 s15, 0x20000
    s_mov_b32 s16, s6
    s_mov_b32 s17, s7
    s_mov_b32 s18, 1990656
    s_mov_b32 s19, 0x20000
    s_mul_i32 s50, s34, 2850
    s_lshr_b32 s50, s50, 16
    s_mul_i32 s51, s50, 23
    s_sub_u32 s51, s34, s51
    s_cmp_ge_u32 s51, 15
    s_cbranch_scc1 Lk1_sx7
    s_lshl_b32 s51, s51, 6
    s_movk_i32 s52, 4370
    v_add_u32 v40, s51, v1
    v_mul_u32_u24 v41, s52, v40
    s_movk_i32 s52, 1536
    v_lshrrev_b32 v41, 16, v41
    v_mul_u32_u24 v42, 15, v41
    v_mul_u32_u24 v41, s52, v41
    v_sub_u32 v42, v40, v42
    v_mul_u32_u24 v42, 52, v42
    v_lshl_add_u32 v40, v40, 7, v41
    v_lshrrev_b32 v42, 8, v42
    s_mul_i32 s50, s50, 221184
    s_lshl_b32 s52, s32, 9
    v_lshl_add_u32 v40, v42, 9, v40
    s_add_u32 s50, s50, s52
    buffer_load_dword v8, v40, s[16:19], s50 offen
    s_branch Lk1_sn8
Lk1_sx7:
    s_lshr_b32 s52, s33, 1
    s_lshl_b32 s52, s52, 3
    s_add_u32 s51, s51, s52
    s_sub_u32 s51, s51, 15
    s_mul_i32 s51, s51, 73728
    s_lshl_b32 s50, s50, 7
    s_add_u32 s50, s50, s51
    buffer_load_dword v8, v43, s[12:15], s50 offen
Lk1_sn8:
    s_mov_b32 m0, 73728
    s_nop 0
    buffer_load_dwordx4 v2, s[12:15], s40 offen offset:0 lds
    v_add_u32 v25, 0, v1
    v_mul_u32_u24 v26, s46, v25
    v_lshrrev_b32 v26, 16, v26
    v_mul_u32_u24 v27, 18, v26
    v_lshrrev_b32 v28, 1, v26
    v_sub_u32 v27, v25, v27
    v_xor_b32 v28, v28, v26
    v_cmp_lt_u32 vcc, 8, v27
    v_and_b32 v28, 4, v28
    v_lshlrev_b32 v27, 4, v27
    v_mul_u32_u24 v28, 3, v28
    v_cndmask_b32 v29, 0, v24, vcc
    v_xor_b32 v26, v26, v28
    v_mad_u32_u24 v27, v26, s47, v27
    v_add3_u32 v10, v27, v29, 0
    buffer_load_dwordx4 v3, s[12:15], s40 offen offset:1024 lds
    v_add_u32 v25, 64, v1
    v_mul_u32_u24 v26, s46, v25
    v_lshrrev_b32 v26, 16, v26
    v_mul_u32_u24 v27, 18, v26
    v_lshrrev_b32 v28, 1, v26
    v_sub_u32 v27, v25, v27
    v_xor_b32 v28, v28, v26
    v_cmp_lt_u32 vcc, 8, v27
    v_and_b32 v28, 4, v28
    v_lshlrev_b32 v27, 4, v27
    v_mul_u32_u24 v28, 3, v28
    v_cndmask_b32 v29, 0, v24, vcc
    v_xor_b32 v26, v26, v28
    v_mad_u32_u24 v27, v26, s47, v27
    v_add_u32 v27, v27, v29
    v_subrev_u32 v11, 1024, v27
    buffer_load_dwordx4 v4, s[12:15], s40 offen offset:2048 lds
    v_add_u32 v25, 128, v1
    v_mul_u32_u24 v26, s46, v25
    v_lshrrev_b32 v26, 16, v26
    v_mul_u32_u24 v27, 18, v26
    v_lshrrev_b32 v28, 1, v26
    v_sub_u32 v27, v25, v27
    v_xor_b32 v28, v28, v26
    v_cmp_lt_u32 vcc, 8, v27
    v_and_b32 v28, 4, v28
    v_lshlrev_b32 v27, 4, v27
    v_mul_u32_u24 v28, 3, v28
    v_cndmask_b32 v29, 0, v24, vcc
    v_xor_b32 v26, v26, v28
    v_mad_u32_u24 v27, v26, s47, v27
    v_add_u32 v27, v27, v29
    v_subrev_u32 v12, 2048, v27
    buffer_load_dwordx4 v5, s[12:15], s40 offen offset:3072 lds
    s_add_u32 s40, s40, 128
    v_add_u32 v25, 192, v1
    v_mul_u32_u24 v26, s46, v25
    v_lshrrev_b32 v26, 16, v26
    v_mul_u32_u24 v27, 18, v26
    v_lshrrev_b32 v28, 1, v26
    v_sub_u32 v27, v25, v27
    v_xor_b32 v28, v28, v26
    v_cmp_lt_u32 vcc, 8, v27
    v_and_b32 v28, 4, v28
    v_lshlrev_b32 v27, 4, v27
    v_mul_u32_u24 v28, 3, v28
    v_cndmask_b32 v29, 0, v24, vcc
    v_xor_b32 v26, v26, v28
    v_mad_u32_u24 v27, v26, s47, v27
    v_add_u32 v27, v27, v29
    v_subrev_u32 v13, 3072, v27
    s_mov_b32 m0, 77824
    s_nop 0
    buffer_load_dwordx4 v2, s[12:15], s41 offen offset:0 lds
    v_add_u32 v25, 256, v1
    v_mul_u32_u24 v26, s46, v25
    v_lshrrev_b32 v26, 16, v26
    v_mul_u32_u24 v27, 18, v26
    v_lshrrev_b32 v28, 1, v26
    v_sub_u32 v27, v25, v27
    v_xor_b32 v28, v28, v26
    v_cmp_lt_u32 vcc, 8, v27
    v_and_b32 v28, 4, v28
    v_lshlrev_b32 v27, 4, v27
    v_mul_u32_u24 v28, 3, v28
    v_cndmask_b32 v29, 0, v24, vcc
    v_xor_b32 v26, v26, v28
    v_mad_u32_u24 v27, v26, s47, v27
    v_add3_u32 v14, v27, v29, 0
    buffer_load_dwordx4 v3, s[12:15], s41 offen offset:1024 lds
    v_add_u32 v25, 320, v1
    v_mul_u32_u24 v26, s46, v25
    v_lshrrev_b32 v26, 16, v26
    v_mul_u32_u24 v27, 18, v26
    v_lshrrev_b32 v28, 1, v26
    v_sub_u32 v27, v25, v27
    v_xor_b32 v28, v28, v26
    v_cmp_lt_u32 vcc, 8, v27
    v_and_b32 v28, 4, v28
    v_lshlrev_b32 v27, 4, v27
    v_mul_u32_u24 v28, 3, v28
    v_cndmask_b32 v29, 0, v24, vcc
    v_xor_b32 v26, v26, v28
    v_mad_u32_u24 v27, v26, s47, v27
    v_add_u32 v27, v27, v29
    v_subrev_u32 v15, 1024, v27
    buffer_load_dwordx4 v4, s[12:15], s41 offen offset:2048 lds
    v_add_u32 v25, 384, v1
    v_mul_u32_u24 v26, s46, v25
    v_lshrrev_b32 v26, 16, v26
    v_mul_u32_u24 v27, 18, v26
    v_lshrrev_b32 v28, 1, v26
    v_sub_u32 v27, v25, v27
    v_xor_b32 v28, v28, v26
    v_cmp_lt_u32 vcc, 8, v27
    v_and_b32 v28, 4, v28
    v_lshlrev_b32 v27, 4, v27
    v_mul_u32_u24 v28, 3, v28
    v_cndmask_b32 v29, 0, v24, vcc
    v_xor_b32 v26, v26, v28
    v_mad_u32_u24 v27, v26, s47, v27
    v_add_u32 v27, v27, v29
    v_subrev_u32 v16, 2048, v27
    buffer_load_dwordx4 v5, s[12:15], s41 offen offset:3072 lds
    s_add_u32 s41, s41, 128
    v_add_u32 v25, 448, v1
    v_mul_u32_u24 v26, s46, v25
    v_lshrrev_b32 v26, 16, v26
    v_mul_u32_u24 v27, 18, v26
    v_lshrrev_b32 v28, 1, v26
    v_sub_u32 v27, v25, v27
    v_xor_b32 v28, v28, v26
    v_cmp_lt_u32 vcc, 8, v27
    v_and_b32 v28, 4, v28
    v_lshlrev_b32 v27, 4, v27
    v_mul_u32_u24 v28, 3, v28
    v_cndmask_b32 v29, 0, v24, vcc
    v_xor_b32 v26, v26, v28
    v_mad_u32_u24 v27, v26, s47, v27
    v_add_u32 v27, v27, v29
    v_subrev_u32 v17, 3072, v27
    s_mov_b32 m0, 81920
    s_nop 0
    buffer_load_dwordx4 v2, s[12:15], s42 offen offset:0 lds
    v_add_u32 v25, 512, v1
    v_mul_u32_u24 v26, s46, v25
    v_lshrrev_b32 v26, 16, v26
    v_mul_u32_u24 v27, 18, v26
    v_lshrrev_b32 v28, 1, v26
    v_sub_u32 v27, v25, v27
    v_xor_b32 v28, v28, v26
    v_cmp_lt_u32 vcc, 8, v27
    v_and_b32 v28, 4, v28
    v_lshlrev_b32 v27, 4, v27
    v_mul_u32_u24 v28, 3, v28
    v_cndmask_b32 v29, 0, v24, vcc
    v_xor_b32 v26, v26, v28
    v_mad_u32_u24 v27, v26, s47, v27
    v_add3_u32 v18, v27, v29, 0
    buffer_load_dwordx4 v3, s[12:15], s42 offen offset:1024 lds
    buffer_load_dwordx4 v4, s[12:15], s42 offen offset:2048 lds
    buffer_load_dwordx4 v5, s[12:15], s42 offen offset:3072 lds
    s_add_u32 s42, s42, 128
    s_mov_b32 m0, 86016
    s_nop 0
    buffer_load_dwordx4 v2, s[12:15], s43 offen offset:0 lds
    buffer_load_dwordx4 v3, s[12:15], s43 offen offset:1024 lds
    buffer_load_dwordx4 v4, s[12:15], s43 offen offset:2048 lds
    buffer_load_dwordx4 v5, s[12:15], s43 offen offset:3072 lds
    s_add_u32 s43, s43, 128
    s_mov_b32 m0, 0
    s_nop 0
    buffer_load_dwordx4 v10, s[16:19], s44 offen offset:0 lds
    buffer_load_dwordx4 v11, s[16:19], s44 offen offset:1024 lds
    buffer_load_dwordx4 v12, s[16:19], s44 offen offset:2048 lds
    buffer_load_dwordx4 v13, s[16:19], s44 offen offset:3072 lds
    s_mov_b32 m0, 4096
    s_nop 0
    buffer_load_dwordx4 v14, s[16:19], s44 offen offset:0 lds
    buffer_load_dwordx4 v15, s[16:19], s44 offen offset:1024 lds
    buffer_load_dwordx4 v16, s[16:19], s44 offen offset:2048 lds
    buffer_load_dwordx4 v17, s[16:19], s44 offen offset:3072 lds
    s_mov_b32 m0, 8192
    s_nop 0
    buffer_load_dwordx4 v18, s[16:19], s44 offen offset:0 lds
    s_add_u32 s44, s44, 110592
    s_mov_b32 m0, 9216
    s_nop 0
    buffer_load_dwordx4 v10, s[16:19], s44 offen offset:0 lds
    buffer_load_dwordx4 v11, s[16:19], s44 offen offset:1024 lds
    buffer_load_dwordx4 v12, s[16:19], s44 offen offset:2048 lds
    buffer_load_dwordx4 v13, s[16:19], s44 offen offset:3072 lds
    s_mov_b32 m0, 13312
    s_nop 0
    buffer_load_dwordx4 v14, s[16:19], s44 offen offset:0 lds
    buffer_load_dwordx4 v15, s[16:19], s44 offen offset:1024 lds
    buffer_load_dwordx4 v16, s[16:19], s44 offen offset:2048 lds
    buffer_load_dwordx4 v17, s[16:19], s44 offen offset:3072 lds
    s_mov_b32 m0, 17408
    s_nop 0
    buffer_load_dwordx4 v18, s[16:19], s44 offen offset:0 lds
    s_add_u32 s44, s44, 110592
    s_mov_b32 m0, 18432
    s_nop 0
    buffer_load_dwordx4 v10, s[16:19], s44 offen offset:0 lds
    buffer_load_dwordx4 v11, s[16:19], s44 offen offset:1024 lds
    buffer_load_dwordx4 v12, s[16:19], s44 offen offset:2048 lds
    buffer_load_dwordx4 v13, s[16:19], s44 offen offset:3072 lds
    s_mov_b32 m0, 22528
    s_nop 0
    buffer_load_dwordx4 v14, s[16:19], s44 offen offset:0 lds
    buffer_load_dwordx4 v15, s[16:19], s44 offen offset:1024 lds
    buffer_load_dwordx4 v16, s[16:19], s44 offen offset:2048 lds
    buffer_load_dwordx4 v17, s[16:19], s44 offen offset:3072 lds
    s_mov_b32 m0, 26624
    s_nop 0
    buffer_load_dwordx4 v18, s[16:19], s44 offen offset:0 lds
    s_add_u32 s44, s44, 110592
    s_mov_b32 m0, 27648
    s_nop 0
    buffer_load_dwordx4 v10, s[16:19], s44 offen offset:0 lds
    buffer_load_dwordx4 v11, s[16:19], s44 offen offset:1024 lds
    buffer_load_dwordx4 v12, s[16:19], s44 offen offset:2048 lds
    buffer_load_dwordx4 v13, s[16:19], s44 offen offset:3072 lds
    s_mov_b32 m0, 31744
    s_nop 0
    buffer_load_dwordx4 v14, s[16:19], s44 offen offset:0 lds
    buffer_load_dwordx4 v15, s[16:19], s44 offen offset:1024 lds
    buffer_load_dwordx4 v16, s[16:19], s44 offen offset:2048 lds
    buffer_load_dwordx4 v17, s[16:19], s44 offen offset:3072 lds
    s_mov_b32 m0, 35840
    s_nop 0
    buffer_load_dwordx4 v18, s[16:19], s44 offen offset:0 lds
    s_add_u32 s44, s44, 110592
    s_mov_b32 m0, 90112
    s_nop 0
    buffer_load_dwordx4 v2, s[12:15], s40 offen offset:0 lds
    buffer_load_dwordx4 v3, s[12:15], s40 offen offset:1024 lds
    buffer_load_dwordx4 v4, s[12:15], s40 offen offset:2048 lds
    buffer_load_dwordx4 v5, s[12:15], s40 offen offset:3072 lds
    s_add_u32 s40, s40, 128
    s_mov_b32 m0, 94208
    s_nop 0
    buffer_load_dwordx4 v2, s[12:15], s41 offen offset:0 lds
    buffer_load_dwordx4 v3, s[12:15], s41 offen offset:1024 lds
    buffer_load_dwordx4 v4, s[12:15], s41 offen offset:2048 lds
    buffer_load_dwordx4 v5, s[12:15], s41 offen offset:3072 lds
    s_add_u32 s41, s41, 128
    s_mov_b32 m0, 98304
    s_nop 0
    buffer_load_dwordx4 v2, s[12:15], s42 offen offset:0 lds
    buffer_load_dwordx4 v3, s[12:15], s42 offen offset:1024 lds
    buffer_load_dwordx4 v4, s[12:15], s42 offen offset:2048 lds
    buffer_load_dwordx4 v5, s[12:15], s42 offen offset:3072 lds
    s_add_u32 s42, s42, 128
    s_mov_b32 m0, 102400
    s_nop 0
    buffer_load_dwordx4 v2, s[12:15], s43 offen offset:0 lds
    buffer_load_dwordx4 v3, s[12:15], s43 offen offset:1024 lds
    buffer_load_dwordx4 v4, s[12:15], s43 offen offset:2048 lds
    buffer_load_dwordx4 v5, s[12:15], s43 offen offset:3072 lds
    s_add_u32 s43, s43, 128
    s_waitcnt vmcnt(34)
    s_barrier
    s_mov_b32 m0, 36864
    s_nop 0
    buffer_load_dwordx4 v10, s[16:19], s44 offen offset:0 lds
    buffer_load_dwordx4 v11, s[16:19], s44 offen offset:1024 lds
    buffer_load_dwordx4 v12, s[16:19], s44 offen offset:2048 lds
    buffer_load_dwordx4 v13, s[16:19], s44 offen offset:3072 lds
    s_mov_b32 m0, 40960
    s_nop 0
    buffer_load_dwordx4 v14, s[16:19], s44 offen offset:0 lds
    buffer_load_dwordx4 v15, s[16:19], s44 offen offset:1024 lds
    buffer_load_dwordx4 v16, s[16:19], s44 offen offset:2048 lds
    buffer_load_dwordx4 v17, s[16:19], s44 offen offset:3072 lds
    s_mov_b32 m0, 45056
    s_nop 0
    buffer_load_dwordx4 v18, s[16:19], s44 offen offset:0 lds
    s_add_u32 s44, s44, 110592
    s_mov_b32 m0, 46080
    s_nop 0
    buffer_load_dwordx4 v10, s[16:19], s44 offen offset:0 lds
    buffer_load_dwordx4 v11, s[16:19], s44 offen offset:1024 lds
    buffer_load_dwordx4 v12, s[16:19], s44 offen offset:2048 lds
    buffer_load_dwordx4 v13, s[16:19], s44 offen offset:3072 lds
    s_mov_b32 m0, 50176
    s_nop 0
    buffer_load_dwordx4 v14, s[16:19], s44 offen offset:0 lds
    buffer_load_dwordx4 v15, s[16:19], s44 offen offset:1024 lds
    buffer_load_dwordx4 v16, s[16:19], s44 offen offset:2048 lds
    buffer_load_dwordx4 v17, s[16:19], s44 offen offset:3072 lds
    s_mov_b32 m0, 54272
    s_nop 0
    buffer_load_dwordx4 v18, s[16:19], s44 offen offset:0 lds
    s_add_u32 s44, s44, 110592
    s_mov_b32 m0, 106496
    s_nop 0
    buffer_load_dwordx4 v2, s[12:15], s40 offen offset:0 lds
    buffer_load_dwordx4 v3, s[12:15], s40 offen offset:1024 lds
    buffer_load_dwordx4 v4, s[12:15], s40 offen offset:2048 lds
    buffer_load_dwordx4 v5, s[12:15], s40 offen offset:3072 lds
    s_add_u32 s40, s40, 128
    s_mov_b32 m0, 110592
    s_nop 0
    buffer_load_dwordx4 v2, s[12:15], s41 offen offset:0 lds
    buffer_load_dwordx4 v3, s[12:15], s41 offen offset:1024 lds
    buffer_load_dwordx4 v4, s[12:15], s41 offen offset:2048 lds
    buffer_load_dwordx4 v5, s[12:15], s41 offen offset:3072 lds
    s_add_u32 s41, s41, 128
    s_mov_b32 m0, 114688
    s_nop 0
    buffer_load_dwordx4 v2, s[12:15], s42 offen offset:0 lds
    buffer_load_dwordx4 v3, s[12:15], s42 offen offset:1024 lds
    buffer_load_dwordx4 v4, s[12:15], s42 offen offset:2048 lds
    buffer_load_dwordx4 v5, s[12:15], s42 offen offset:3072 lds
    s_add_u32 s42, s42, 128
    s_mov_b32 m0, 118784
    s_nop 0
    buffer_load_dwordx4 v2, s[12:15], s43 offen offset:0 lds
    buffer_load_dwordx4 v3, s[12:15], s43 offen offset:1024 lds
    buffer_load_dwordx4 v4, s[12:15], s43 offen offset:2048 lds
    buffer_load_dwordx4 v5, s[12:15], s43 offen offset:3072 lds
    s_add_u32 s43, s43, 128
    s_waitcnt vmcnt(34)
    s_barrier
    s_mov_b32 m0, 55296
    s_nop 0
    buffer_load_dwordx4 v10, s[16:19], s44 offen offset:0 lds
    buffer_load_dwordx4 v11, s[16:19], s44 offen offset:1024 lds
    buffer_load_dwordx4 v12, s[16:19], s44 offen offset:2048 lds
    buffer_load_dwordx4 v13, s[16:19], s44 offen offset:3072 lds
    s_mov_b32 m0, 59392
    s_nop 0
    buffer_load_dwordx4 v14, s[16:19], s44 offen offset:0 lds
    buffer_load_dwordx4 v15, s[16:19], s44 offen offset:1024 lds
    buffer_load_dwordx4 v16, s[16:19], s44 offen offset:2048 lds
    buffer_load_dwordx4 v17, s[16:19], s44 offen offset:3072 lds
    s_mov_b32 m0, 63488
    s_nop 0
    buffer_load_dwordx4 v18, s[16:19], s44 offen offset:0 lds
    s_add_u32 s44, s44, 110592
    s_mov_b32 m0, 64512
    s_nop 0
    buffer_load_dwordx4 v10, s[16:19], s44 offen offset:0 lds
    buffer_load_dwordx4 v11, s[16:19], s44 offen offset:1024 lds
    buffer_load_dwordx4 v12, s[16:19], s44 offen offset:2048 lds
    buffer_load_dwordx4 v13, s[16:19], s44 offen offset:3072 lds
    s_mov_b32 m0, 68608
    s_nop 0
    buffer_load_dwordx4 v14, s[16:19], s44 offen offset:0 lds
    buffer_load_dwordx4 v15, s[16:19], s44 offen offset:1024 lds
    buffer_load_dwordx4 v16, s[16:19], s44 offen offset:2048 lds
    buffer_load_dwordx4 v17, s[16:19], s44 offen offset:3072 lds
    s_mov_b32 m0, 72704
    s_nop 0
    buffer_load_dwordx4 v18, s[16:19], s44 offen offset:0 lds
    s_add_u32 s44, s44, 110592
    s_mov_b32 m0, 122880
    s_nop 0
    buffer_load_dwordx4 v2, s[12:15], s40 offen offset:0 lds
    buffer_load_dwordx4 v3, s[12:15], s40 offen offset:1024 lds
    buffer_load_dwordx4 v4, s[12:15], s40 offen offset:2048 lds
    buffer_load_dwordx4 v5, s[12:15], s40 offen offset:3072 lds
    s_add_u32 s40, s40, 128
    s_mov_b32 m0, 126976
    s_nop 0
    buffer_load_dwordx4 v2, s[12:15], s41 offen offset:0 lds
    buffer_load_dwordx4 v3, s[12:15], s41 offen offset:1024 lds
    buffer_load_dwordx4 v4, s[12:15], s41 offen offset:2048 lds
    buffer_load_dwordx4 v5, s[12:15], s41 offen offset:3072 lds
    s_add_u32 s41, s41, 128
    s_mov_b32 m0, 131072
    s_nop 0
    buffer_load_dwordx4 v2, s[12:15], s42 offen offset:0 lds
    buffer_load_dwordx4 v3, s[12:15], s42 offen offset:1024 lds
    buffer_load_dwordx4 v4, s[12:15], s42 offen offset:2048 lds
    buffer_load_dwordx4 v5, s[12:15], s42 offen offset:3072 lds
    s_add_u32 s42, s42, 128
    s_mov_b32 m0, 135168
    s_nop 0
    buffer_load_dwordx4 v2, s[12:15], s43 offen offset:0 lds
    buffer_load_dwordx4 v3, s[12:15], s43 offen offset:1024 lds
    buffer_load_dwordx4 v4, s[12:15], s43 offen offset:2048 lds
    buffer_load_dwordx4 v5, s[12:15], s43 offen offset:3072 lds
    s_add_u32 s43, s43, 128
    s_waitcnt vmcnt(34)
    s_barrier
    s_mov_b32 m0, 0
    s_nop 0
    buffer_load_dwordx4 v10, s[16:19], s44 offen offset:0 lds
    buffer_load_dwordx4 v11, s[16:19], s44 offen offset:1024 lds
    buffer_load_dwordx4 v12, s[16:19], s44 offen offset:2048 lds
    buffer_load_dwordx4 v13, s[16:19], s44 offen offset:3072 lds
    s_mov_b32 m0, 4096
    s_nop 0
    buffer_load_dwordx4 v14, s[16:19], s44 offen offset:0 lds
    buffer_load_dwordx4 v15, s[16:19], s44 offen offset:1024 lds
    buffer_load_dwordx4 v16, s[16:19], s44 offen offset:2048 lds
    buffer_load_dwordx4 v17, s[16:19], s44 offen offset:3072 lds
    s_mov_b32 m0, 8192
    s_nop 0
    buffer_load_dwordx4 v18, s[16:19], s44 offen offset:0 lds
    s_add_u32 s44, s44, 110592
    s_mov_b32 m0, 9216
    s_nop 0
    buffer_load_dwordx4 v10, s[16:19], s44 offen offset:0 lds
    buffer_load_dwordx4 v11, s[16:19], s44 offen offset:1024 lds
    buffer_load_dwordx4 v12, s[16:19], s44 offen offset:2048 lds
    buffer_load_dwordx4 v13, s[16:19], s44 offen offset:3072 lds
    s_mov_b32 m0, 13312
    s_nop 0
    buffer_load_dwordx4 v14, s[16:19], s44 offen offset:0 lds
    buffer_load_dwordx4 v15, s[16:19], s44 offen offset:1024 lds
    buffer_load_dwordx4 v16, s[16:19], s44 offen offset:2048 lds
    buffer_load_dwordx4 v17, s[16:19], s44 offen offset:3072 lds
    s_mov_b32 m0, 17408
    s_nop 0
    buffer_load_dwordx4 v18, s[16:19], s44 offen offset:0 lds
    s_add_u32 s44, s44, 110592
    s_mov_b32 m0, 73728
    s_nop 0
    buffer_load_dwordx4 v2, s[12:15], s40 offen offset:0 lds
    buffer_load_dwordx4 v3, s[12:15], s40 offen offset:1024 lds
    buffer_load_dwordx4 v4, s[12:15], s40 offen offset:2048 lds
    buffer_load_dwordx4 v5, s[12:15], s40 offen offset:3072 lds
    s_add_u32 s40, s40, 128
    s_mov_b32 m0, 77824
    s_nop 0
    buffer_load_dwordx4 v2, s[12:15], s41 offen offset:0 lds
    buffer_load_dwordx4 v3, s[12:15], s41 offen offset:1024 lds
    buffer_load_dwordx4 v4, s[12:15], s41 offen offset:2048 lds
    buffer_load_dwordx4 v5, s[12:15], s41 offen offset:3072 lds
    s_add_u32 s41, s41, 128
    s_mov_b32 m0, 81920
    s_nop 0
    buffer_load_dwordx4 v2, s[12:15], s42 offen offset:0 lds
    buffer_load_dwordx4 v3, s[12:15], s42 offen offset:1024 lds
    buffer_load_dwordx4 v4, s[12:15], s42 offen offset:2048 lds
    buffer_load_dwordx4 v5, s[12:15], s42 offen offset:3072 lds
    s_add_u32 s42, s42, 128
    s_mov_b32 m0, 86016
    s_nop 0
    buffer_load_dwordx4 v2, s[12:15], s43 offen offset:0 lds
    buffer_load_dwordx4 v3, s[12:15], s43 offen offset:1024 lds
    buffer_load_dwordx4 v4, s[12:15], s43 offen offset:2048 lds
    buffer_load_dwordx4 v5, s[12:15], s43 offen offset:3072 lds
    s_add_u32 s43, s43, 128
    s_waitcnt vmcnt(34)
    s_barrier
    s_mov_b32 m0, 18432
    s_nop 0
    buffer_load_dwordx4 v10, s[16:19], s44 offen offset:0 lds
    buffer_load_dwordx4 v11, s[16:19], s44 offen offset:1024 lds
    buffer_load_dwordx4 v12, s[16:19], s44 offen offset:2048 lds
    buffer_load_dwordx4 v13, s[16:19], s44 offen offset:3072 lds
    s_mov_b32 m0, 22528
    s_nop 0
    buffer_load_dwordx4 v14, s[16:19], s44 offen offset:0 lds
    buffer_load_dwordx4 v15, s[16:19], s44 offen offset:1024 lds
    buffer_load_dwordx4 v16, s[16:19], s44 offen offset:2048 lds
    buffer_load_dwordx4 v17, s[16:19], s44 offen offset:3072 lds
    s_mov_b32 m0, 26624
    s_nop 0
    buffer_load_dwordx4 v18, s[16:19], s44 offen offset:0 lds
    s_add_u32 s44, s44, 110592
    s_mov_b32 m0, 27648
    s_nop 0
    buffer_load_dwordx4 v10, s[16:19], s44 offen offset:0 lds
    buffer_load_dwordx4 v11, s[16:19], s44 offen offset:1024 lds
    buffer_load_dwordx4 v12, s[16:19], s44 offen offset:2048 lds
    buffer_load_dwordx4 v13, s[16:19], s44 offen offset:3072 lds
    s_mov_b32 m0, 31744
    s_nop 0
    buffer_load_dwordx4 v14, s[16:19], s44 offen offset:0 lds
    buffer_load_dwordx4 v15, s[16:19], s44 offen offset:1024 lds
    buffer_load_dwordx4 v16, s[16:19], s44 offen offset:2048 lds
    buffer_load_dwordx4 v17, s[16:19], s44 offen offset:3072 lds
    s_mov_b32 m0, 35840
    s_nop 0
    buffer_load_dwordx4 v18, s[16:19], s44 offen offset:0 lds
    s_add_u32 s44, s44, 110592
    s_mov_b32 m0, 90112
    s_nop 0
    buffer_load_dwordx4 v2, s[12:15], s40 offen offset:0 lds
    buffer_load_dwordx4 v3, s[12:15], s40 offen offset:1024 lds
    buffer_load_dwordx4 v4, s[12:15], s40 offen offset:2048 lds
    buffer_load_dwordx4 v5, s[12:15], s40 offen offset:3072 lds
    s_add_u32 s40, s40, 128
    s_mov_b32 m0, 94208
    s_nop 0
    buffer_load_dwordx4 v2, s[12:15], s41 offen offset:0 lds
    buffer_load_dwordx4 v3, s[12:15], s41 offen offset:1024 lds
    buffer_load_dwordx4 v4, s[12:15], s41 offen offset:2048 lds
    buffer_load_dwordx4 v5, s[12:15], s41 offen offset:3072 lds
    s_add_u32 s41, s41, 128
    s_mov_b32 m0, 98304
    s_nop 0
    buffer_load_dwordx4 v2, s[12:15], s42 offen offset:0 lds
    buffer_load_dwordx4 v3, s[12:15], s42 offen offset:1024 lds
    buffer_load_dwordx4 v4, s[12:15], s42 offen offset:2048 lds
    buffer_load_dwordx4 v5, s[12:15], s42 offen offset:3072 lds
    s_add_u32 s42, s42, 128
    s_mov_b32 m0, 102400
    s_nop 0
    buffer_load_dwordx4 v2, s[12:15], s43 offen offset:0 lds
    buffer_load_dwordx4 v3, s[12:15], s43 offen offset:1024 lds
    buffer_load_dwordx4 v4, s[12:15], s43 offen offset:2048 lds
    buffer_load_dwordx4 v5, s[12:15], s43 offen offset:3072 lds
    s_add_u32 s43, s43, 128
    s_waitcnt vmcnt(34)
    s_barrier
    s_mov_b32 m0, 36864
    s_nop 0
    buffer_load_dwordx4 v10, s[16:19], s44 offen offset:0 lds
    buffer_load_dwordx4 v11, s[16:19], s44 offen offset:1024 lds
    buffer_load_dwordx4 v12, s[16:19], s44 offen offset:2048 lds
    buffer_load_dwordx4 v13, s[16:19], s44 offen offset:3072 lds
    s_mov_b32 m0, 40960
    s_nop 0
    buffer_load_dwordx4 v14, s[16:19], s44 offen offset:0 lds
    buffer_load_dwordx4 v15, s[16:19], s44 offen offset:1024 lds
    buffer_load_dwordx4 v16, s[16:19], s44 offen offset:2048 lds
    buffer_load_dwordx4 v17, s[16:19], s44 offen offset:3072 lds
    s_mov_b32 m0, 45056
    s_nop 0
    buffer_load_dwordx4 v18, s[16:19], s44 offen offset:0 lds
    s_add_u32 s44, s44, 110592
    s_mov_b32 m0, 46080
    s_nop 0
    buffer_load_dwordx4 v10, s[16:19], s44 offen offset:0 lds
    buffer_load_dwordx4 v11, s[16:19], s44 offen offset:1024 lds
    buffer_load_dwordx4 v12, s[16:19], s44 offen offset:2048 lds
    buffer_load_dwordx4 v13, s[16:19], s44 offen offset:3072 lds
    s_mov_b32 m0, 50176
    s_nop 0
    buffer_load_dwordx4 v14, s[16:19], s44 offen offset:0 lds
    buffer_load_dwordx4 v15, s[16:19], s44 offen offset:1024 lds
    buffer_load_dwordx4 v16, s[16:19], s44 offen offset:2048 lds
    buffer_load_dwordx4 v17, s[16:19], s44 offen offset:3072 lds
    s_mov_b32 m0, 54272
    s_nop 0
    buffer_load_dwordx4 v18, s[16:19], s44 offen offset:0 lds
    s_add_u32 s44, s44, 110592
    s_mov_b32 m0, 106496
    s_nop 0
    buffer_load_dwordx4 v2, s[12:15], s40 offen offset:0 lds
    buffer_load_dwordx4 v3, s[12:15], s40 offen offset:1024 lds
    buffer_load_dwordx4 v4, s[12:15], s40 offen offset:2048 lds
    buffer_load_dwordx4 v5, s[12:15], s40 offen offset:3072 lds
    s_add_u32 s40, s40, 128
    s_mov_b32 m0, 110592
    s_nop 0
    buffer_load_dwordx4 v2, s[12:15], s41 offen offset:0 lds
    buffer_load_dwordx4 v3, s[12:15], s41 offen offset:1024 lds
    buffer_load_dwordx4 v4, s[12:15], s41 offen offset:2048 lds
    buffer_load_dwordx4 v5, s[12:15], s41 offen offset:3072 lds
    s_add_u32 s41, s41, 128
    s_mov_b32 m0, 114688
    s_nop 0
    buffer_load_dwordx4 v2, s[12:15], s42 offen offset:0 lds
    buffer_load_dwordx4 v3, s[12:15], s42 offen offset:1024 lds
    buffer_load_dwordx4 v4, s[12:15], s42 offen offset:2048 lds
    buffer_load_dwordx4 v5, s[12:15], s42 offen offset:3072 lds
    s_add_u32 s42, s42, 128
    s_mov_b32 m0, 118784
    s_nop 0
    buffer_load_dwordx4 v2, s[12:15], s43 offen offset:0 lds
    buffer_load_dwordx4 v3, s[12:15], s43 offen offset:1024 lds
    buffer_load_dwordx4 v4, s[12:15], s43 offen offset:2048 lds
    buffer_load_dwordx4 v5, s[12:15], s43 offen offset:3072 lds
    s_add_u32 s43, s43, 128
    s_waitcnt vmcnt(34)
    s_barrier
    s_mov_b32 m0, 55296
    s_nop 0
    buffer_load_dwordx4 v10, s[16:19], s44 offen offset:0 lds
    buffer_load_dwordx4 v11, s[16:19], s44 offen offset:1024 lds
    buffer_load_dwordx4 v12, s[16:19], s44 offen offset:2048 lds
    buffer_load_dwordx4 v13, s[16:19], s44 offen offset:3072 lds
    s_mov_b32 m0, 59392
    s_nop 0
    buffer_load_dwordx4 v14, s[16:19], s44 offen offset:0 lds
    buffer_load_dwordx4 v15, s[16:19], s44 offen offset:1024 lds
    buffer_load_dwordx4 v16, s[16:19], s44 offen offset:2048 lds
    buffer_load_dwordx4 v17, s[16:19], s44 offen offset:3072 lds
    s_mov_b32 m0, 63488
    s_nop 0
    buffer_load_dwordx4 v18, s[16:19], s44 offen offset:0 lds
    s_add_u32 s44, s44, 110592
    s_mov_b32 m0, 64512
    s_nop 0
    buffer_load_dwordx4 v10, s[16:19], s44 offen offset:0 lds
    buffer_load_dwordx4 v11, s[16:19], s44 offen offset:1024 lds
    buffer_load_dwordx4 v12, s[16:19], s44 offen offset:2048 lds
    buffer_load_dwordx4 v13, s[16:19], s44 offen offset:3072 lds
    s_mov_b32 m0, 68608
    s_nop 0
    buffer_load_dwordx4 v14, s[16:19], s44 offen offset:0 lds
    buffer_load_dwordx4 v15, s[16:19], s44 offen offset:1024 lds
    buffer_load_dwordx4 v16, s[16:19], s44 offen offset:2048 lds
    buffer_load_dwordx4 v17, s[16:19], s44 offen offset:3072 lds
    s_mov_b32 m0, 72704
    s_nop 0
    buffer_load_dwordx4 v18, s[16:19], s44 offen offset:0 lds
    s_add_u32 s44, s44, 110592
    s_mov_b32 m0, 122880
    s_nop 0
    buffer_load_dwordx4 v2, s[12:15], s40 offen offset:0 lds
    buffer_load_dwordx4 v3, s[12:15], s40 offen offset:1024 lds
    buffer_load_dwordx4 v4, s[12:15], s40 offen offset:2048 lds
    buffer_load_dwordx4 v5, s[12:15], s40 offen offset:3072 lds
    s_add_u32 s40, s40, 128
    s_mov_b32 m0, 126976
    s_nop 0
    buffer_load_dwordx4 v2, s[12:15], s41 offen offset:0 lds
    buffer_load_dwordx4 v3, s[12:15], s41 offen offset:1024 lds
    buffer_load_dwordx4 v4, s[12:15], s41 offen offset:2048 lds
    buffer_load_dwordx4 v5, s[12:15], s41 offen offset:3072 lds
    s_add_u32 s41, s41, 128
    s_mov_b32 m0, 131072
    s_nop 0
    buffer_load_dwordx4 v2, s[12:15], s42 offen offset:0 lds
    buffer_load_dwordx4 v3, s[12:15], s42 offen offset:1024 lds
    buffer_load_dwordx4 v4, s[12:15], s42 offen offset:2048 lds
    buffer_load_dwordx4 v5, s[12:15], s42 offen offset:3072 lds
    s_add_u32 s42, s42, 128
    s_mov_b32 m0, 135168
    s_nop 0
    buffer_load_dwordx4 v2, s[12:15], s43 offen offset:0 lds
    buffer_load_dwordx4 v3, s[12:15], s43 offen offset:1024 lds
    buffer_load_dwordx4 v4, s[12:15], s43 offen offset:2048 lds
    buffer_load_dwordx4 v5, s[12:15], s43 offen offset:3072 lds
    s_add_u32 s43, s43, 128
    s_waitcnt vmcnt(34)
    s_barrier
    s_mov_b32 m0, 0
    s_nop 0
    buffer_load_dwordx4 v10, s[16:19], s44 offen offset:0 lds
    buffer_load_dwordx4 v11, s[16:19], s44 offen offset:1024 lds
    buffer_load_dwordx4 v12, s[16:19], s44 offen offset:2048 lds
    buffer_load_dwordx4 v13, s[16:19], s44 offen offset:3072 lds
    s_mov_b32 m0, 4096
    s_nop 0
    buffer_load_dwordx4 v14, s[16:19], s44 offen offset:0 lds
    buffer_load_dwordx4 v15, s[16:19], s44 offen offset:1024 lds
    buffer_load_dwordx4 v16, s[16:19], s44 offen offset:2048 lds
    buffer_load_dwordx4 v17, s[16:19], s44 offen offset:3072 lds
    s_mov_b32 m0, 8192
    s_nop 0
    buffer_load_dwordx4 v18, s[16:19], s44 offen offset:0 lds
    s_add_u32 s44, s44, 110592
    s_mov_b32 m0, 9216
    s_nop 0
    buffer_load_dwordx4 v10, s[16:19], s44 offen offset:0 lds
    buffer_load_dwordx4 v11, s[16:19], s44 offen offset:1024 lds
    buffer_load_dwordx4 v12, s[16:19], s44 offen offset:2048 lds
    buffer_load_dwordx4 v13, s[16:19], s44 offen offset:3072 lds
    s_mov_b32 m0, 13312
    s_nop 0
    buffer_load_dwordx4 v14, s[16:19], s44 offen offset:0 lds
    buffer_load_dwordx4 v15, s[16:19], s44 offen offset:1024 lds
    buffer_load_dwordx4 v16, s[16:19], s44 offen offset:2048 lds
    buffer_load_dwordx4 v17, s[16:19], s44 offen offset:3072 lds
    s_mov_b32 m0, 17408
    s_nop 0
    buffer_load_dwordx4 v18, s[16:19], s44 offen offset:0 lds
    s_add_u32 s44, s44, 110592
    s_mov_b32 m0, 73728
    s_nop 0
    buffer_load_dwordx4 v2, s[12:15], s40 offen offset:0 lds
    buffer_load_dwordx4 v3, s[12:15], s40 offen offset:1024 lds
    buffer_load_dwordx4 v4, s[12:15], s40 offen offset:2048 lds
    buffer_load_dwordx4 v5, s[12:15], s40 offen offset:3072 lds
    s_add_u32 s40, s40, 128
    s_mov_b32 m0, 77824
    s_nop 0
    buffer_load_dwordx4 v2, s[12:15], s41 offen offset:0 lds
    buffer_load_dwordx4 v3, s[12:15], s41 offen offset:1024 lds
    buffer_load_dwordx4 v4, s[12:15], s41 offen offset:2048 lds
    buffer_load_dwordx4 v5, s[12:15], s41 offen offset:3072 lds
    s_add_u32 s41, s41, 128
    s_mov_b32 m0, 81920
    s_nop 0
    buffer_load_dwordx4 v2, s[12:15], s42 offen offset:0 lds
    buffer_load_dwordx4 v3, s[12:15], s42 offen offset:1024 lds
    buffer_load_dwordx4 v4, s[12:15], s42 offen offset:2048 lds
    buffer_load_dwordx4 v5, s[12:15], s42 offen offset:3072 lds
    s_add_u32 s42, s42, 128
    s_mov_b32 m0, 86016
    s_nop 0
    buffer_load_dwordx4 v2, s[12:15], s43 offen offset:0 lds
    buffer_load_dwordx4 v3, s[12:15], s43 offen offset:1024 lds
    buffer_load_dwordx4 v4, s[12:15], s43 offen offset:2048 lds
    buffer_load_dwordx4 v5, s[12:15], s43 offen offset:3072 lds
    s_add_u32 s43, s43, 128
    s_waitcnt vmcnt(34)
    s_barrier
    s_cmp_lt_u32 s35, 4
    s_cselect_b32 s68, 3, 2
    s_add_u32 s2, s2, 192
    s_and_b32 s2, s2, 255
    s_branch Lk2_entry
Lk1_help1:
    s_load_dwordx2 s[8:9], s[0:1], 16
    s_cmp_lt_u32 s35, 4
    s_cselect_b32 s68, 1, 0
    s_movk_i32 s69, 3
    v_lshlrev_b32 v9, 4, v1
    s_waitcnt lgkmcnt(0)
    s_cbranch_scc1 Lk1_hb11
    s_mov_b32 s20, s8
    s_mov_b32 s21, s9
    s_mov_b32 s22, 663552
    s_mov_b32 s23, 0x20000
    s_add_u32 s24, s30, 12582912
    s_addc_u32 s25, s31, 0
    s_mov_b32 s26, 3670016
    s_mov_b32 s27, 0x20000
    s_sub_u32 s63, s2, 192
    s_mul_i32 s45, s63, 3
    s_add_u32 s45, s45, s3
    s_sub_u32 s45, s45, 5
    s_cmp_ge_u32 s63, 60
    s_cbranch_scc1 Lk1_nt12
    s_mul_i32 s46, s45, 57
    s_lshr_b32 s46, s46, 9
    s_mul_i32 s47, s46, 9
    s_sub_u32 s47, s45, s47
    s_mul_i32 s48, s46, 52
    s_lshr_b32 s48, s48, 8
    s_mul_i32 s49, s48, 5
    s_sub_u32 s49, s46, s49
    v_lshrrev_b32 v24, 3, v1
    v_lshrrev_b32 v25, 1, v24
    v_mul_u32_u24 v25, 18, v25
    v_and_b32 v26, 1, v24
    v_add3_u32 v25, v25, v26, 16
    s_mov_b32 s54, 8192
    s_mov_b32 s55, 18688
    s_mov_b32 s56, 26880
    s_cmp_eq_u32 s49, 4
    s_cselect_b64 vcc, -1, 0
    s_cmov_b32 s54, 81920
    s_cselect_b32 s57, 0, s49
    v_cndmask_b32 v24, v24, v25, vcc
    s_movk_i32 s58, 1152
    v_mul_u32_u24 v24, s58, v24
    v_and_b32 v25, 7, v1
    v_lshl_add_u32 v24, v25, 4, v24
    s_mul_i32 s58, s48, 144
    s_mul_i32 s57, s57, 36
    s_add_u32 s58, s58, s57
    s_mul_i32 s58, s58, 1152
    s_lshl_b32 s57, s47, 7
    s_add_u32 s58, s58, s57
    s_add_u32 s54, s54, s58
    s_add_u32 s55, s55, s58
    s_add_u32 s56, s56, s58
    s_lshl_b32 s59, s3, 12
    s_add_u32 s59, s59, 126976
    s_mov_b32 m0, s59
    v_bfe_u32 v22, v1, 2, 4
    buffer_load_dwordx4 v24, s[20:23], s58 offen offset:0 lds
    buffer_load_dwordx4 v24, s[20:23], s54 offen offset:1024 lds
    buffer_load_dwordx4 v24, s[20:23], s55 offen offset:2048 lds
    buffer_load_dwordx4 v24, s[20:23], s56 offen offset:3072 lds
    v_and_b32 v23, 3, v1
    v_lshlrev_b32 v23, 3, v23
    v_lshl_add_u32 v22, v22, 7, v23
    v_add_u32 v22, s59, v22
    s_lshl_b32 s53, s48, 2
    s_add_u32 s53, s53, s49
    s_mul_i32 s53, s53, 3072
    s_lshr_b32 s54, s48, 1
    s_add_u32 s54, s54, 16
    s_mul_i32 s54, s54, 3072
    s_and_b32 s38, s48, 1
    s_lshl_b32 s38, s38, 3
    s_add_u32 s54, s54, s38
    s_cmp_eq_u32 s49, 4
    s_cselect_b32 s53, s54, s53
    s_add_u32 s53, s53, 262144
    s_lshl_b32 s38, s47, 2
    s_add_u32 s38, s38, 0
    s_mul_i32 s54, s38, 43
    s_lshr_b32 s54, s54, 7
    s_mul_i32 s54, s54, 51
    s_add_u32 s38, s38, s54
    s_lshl_b32 s38, s38, 10
    s_add_u32 s64, s38, s53
    s_lshl_b32 s38, s47, 2
    s_add_u32 s38, s38, 1
    s_mul_i32 s54, s38, 43
    s_lshr_b32 s54, s54, 7
    s_mul_i32 s54, s54, 51
    s_add_u32 s38, s38, s54
    s_lshl_b32 s38, s38, 10
    s_add_u32 s65, s38, s53
    s_lshl_b32 s38, s47, 2
    s_add_u32 s38, s38, 2
    s_mul_i32 s54, s38, 43
    s_lshr_b32 s54, s54, 7
    s_mul_i32 s54, s54, 51
    s_add_u32 s38, s38, s54
    s_lshl_b32 s38, s38, 10
    s_add_u32 s66, s38, s53
    s_lshl_b32 s38, s47, 2
    s_add_u32 s38, s38, 3
    s_mul_i32 s54, s38, 43
    s_lshr_b32 s54, s54, 7
    s_mul_i32 s54, s54, 51
    s_add_u32 s38, s38, s54
    s_lshl_b32 s38, s38, 10
    s_add_u32 s67, s38, s53
Lk1_nt12:
    s_cmp_ge_u32 s63, 60
    s_barrier
    s_cbranch_scc1 Lk1_ts15
    s_waitcnt vmcnt(0)
    ds_read_b64_tr_b16 v[44:45], v22 offset:0
    ds_read_b64_tr_b16 v[46:47], v22 offset:2048
    ds_read_b64_tr_b16 v[48:49], v22 offset:32
    ds_read_b64_tr_b16 v[50:51], v22 offset:2080
    ds_read_b64_tr_b16 v[52:53], v22 offset:64
    ds_read_b64_tr_b16 v[54:55], v22 offset:2112
    ds_read_b64_tr_b16 v[56:57], v22 offset:96
    ds_read_b64_tr_b16 v[58:59], v22 offset:2144
    s_waitcnt lgkmcnt(0)
    s_cmp_eq_u32 s49, 4
    s_cbranch_scc1 Lk1_left16
    buffer_store_dwordx4 v[44:47], v9, s[24:27], s64 offen sc1
    buffer_store_dwordx4 v[48:51], v9, s[24:27], s65 offen sc1
    buffer_store_dwordx4 v[52:55], v9, s[24:27], s66 offen sc1
    buffer_store_dwordx4 v[56:59], v9, s[24:27], s67 offen sc1
    s_branch Lk1_ts15
Lk1_left16:
    buffer_store_dwordx2 v[44:45], v9, s[24:27], s64 offen sc1
    buffer_store_dwordx2 v[48:49], v9, s[24:27], s65 offen sc1
    buffer_store_dwordx2 v[52:53], v9, s[24:27], s66 offen sc1
    buffer_store_dwordx2 v[56:57], v9, s[24:27], s67 offen sc1
Lk1_ts15:
    s_cmp_lg_u32 s3, 7
    s_cbranch_scc1 Lk1_nc13
    v_mov_b32 v12, -1
    v_mov_b32 v13, -1
    v_mov_b32 v14, -1
    v_mov_b32 v15, -1
    s_mul_i32 s42, s63, 3072
    s_add_u32 s42, s42, 65536
    s_lshl_b32 s43, s63, 9
    s_add_u32 s43, s43, 1048576
    v_lshrrev_b32 v16, 3, v1
    s_movk_i32 s42, 128
    v_mul_u32_u24 v16, s42, v16
    v_and_b32 v17, 0x70, v9
    s_mul_i32 s42, s63, 512
    v_add_u32 v16, v16, v17
    s_add_u32 s42, s42, 2097152
    s_mov_b32 exec_hi, 0
    buffer_store_dwordx4 v[12:15], v9, s[24:27], s43 offen sc1
    buffer_store_dwordx4 v[12:15], v16, s[24:27], s42 offen sc1
    s_add_u32 s43, s43, 524288
    buffer_store_dwordx4 v[12:15], v9, s[24:27], s43 offen sc1
    s_add_u32 s43, s43, 32768
    buffer_store_dwordx4 v[12:15], v9, s[24:27], s43 offen sc1
    s_mov_b32 exec_hi, -1
    v_mov_b32 v4, 0
    v_mov_b32 v5, 0
    v_mov_b32 v6, 0
    v_mov_b32 v7, 0
    s_lshl_b32 s42, s63, 10
    s_nop 0
    buffer_store_dwordx4 v[4:7], v9, s[24:27], s42 offen sc1
Lk1_nc13:
    s_add_u32 s16, s30, 2367488
    s_addc_u32 s17, s31, 0
    s_mov_b32 s18, 2359296
    s_mov_b32 s19, 0x20000
    v_mov_b32 v12, -1
    v_mov_b32 v13, -1
    v_mov_b32 v14, -1
    v_mov_b32 v15, -1
    s_mul_i32 s42, s45, 3072
    buffer_store_dwordx4 v[12:15], v9, s[16:19], s42 offen offset:0 sc1
    buffer_store_dwordx4 v[12:15], v9, s[16:19], s42 offen offset:1024 sc1
    buffer_store_dwordx4 v[12:15], v9, s[16:19], s42 offen offset:2048 sc1
    s_lshl_b32 s38, s63, 2
    v_mov_b32 v16, s38
    v_mov_b32 v17, 1
    s_barrier
    s_waitcnt vmcnt(0)
    s_cmp_lg_u32 s3, 5
    s_barrier
    s_cbranch_scc1 Lk1_mark14
    s_mov_b64 exec, 1
    global_store_dword v16, v17, s[28:29] sc1
    s_mov_b64 exec, -1
Lk1_mark14:
    s_cmp_lg_u32 s3, 6
    s_cbranch_scc1 Lk1_lx17
    s_lshl_b32 s63, s36, 1
    s_add_u32 s63, s63, s32
    s_lshl_b32 s63, s63, 1
    s_add_u32 s63, s63, s35
    s_sub_u32 s63, s63, 4
    v_mov_b32 v12, -1
    v_mov_b32 v13, -1
    v_mov_b32 v14, -1
    v_mov_b32 v15, -1
    s_mul_i32 s42, s63, 3072
    s_add_u32 s42, s42, 65536
    s_lshl_b32 s43, s63, 9
    s_add_u32 s43, s43, 1048576
    buffer_store_dwordx4 v[12:15], v9, s[24:27], s42 offen sc1
    buffer_store_dwordx4 v[12:15], v9, s[24:27], s42 offen offset:1024 sc1
    buffer_store_dwordx4 v[12:15], v9, s[24:27], s42 offen offset:2048 sc1
    s_add_u32 s42, s42, 1048576
    buffer_store_dwordx4 v[12:15], v9, s[24:27], s42 offen sc1
    buffer_store_dwordx4 v[12:15], v9, s[24:27], s42 offen offset:1024 sc1
    buffer_store_dwordx4 v[12:15], v9, s[24:27], s42 offen offset:2048 sc1
Lk1_lx17:
    s_add_u32 s2, s2, 192
    s_and_b32 s2, s2, 255
    s_branch Lk2_entry
Lk1_hb11:
    s_sub_u32 s69, s69, 1
    s_cmp_lg_u32 s69, 0
    s_barrier
    s_cbranch_scc1 Lk1_hb11
    s_add_u32 s2, s2, 192
    s_and_b32 s2, s2, 255
    s_branch Lk2_entry
Lk1_spare5:
    s_cmp_gt_u32 s3, 4
    s_cbranch_scc1 Lk1_out3
    s_load_dwordx2 s[8:9], s[0:1], 16
    s_load_dwordx2 s[10:11], s[0:1], 48
    s_cmp_lg_u32 s3, 4
    s_cbranch_scc1 Lk1_nc18
    s_getpc_b64 s[44:45]
Lk1_pc19:
    s_add_u32 s44, s44, sequential_preLN__linear_attn_block__mixer_token_mlp__prompt_kernel-Lk1_pc19
    s_addc_u32 s45, s45, -1
    s_lshr_b32 s46, s2, 3
    s_movk_i32 s47, 8
    v_mov_b32 v18, s46
    v_mad_u32_u24 v18, v1, s47, v18
    v_lshlrev_b32 v18, 7, v18
    v_cmp_gt_u32 vcc, Lcode_end-sequential_preLN__linear_attn_block__mixer_token_mlp__prompt_kernel, v18
    v_mov_b32 v19, 0
    v_mov_b32 v16, s44
    v_mov_b32 v17, s45
    v_lshl_add_u64 v[16:17], v[18:19], 0, v[16:17]
    s_and_saveexec_b64 s[46:47], vcc
    global_load_dword v8, v[16:17], off
    s_mov_b64 exec, s[46:47]
Lk1_nc18:
    s_movk_i32 s38, 1152
    v_mul_u32_u24 v43, s38, v1
    v_lshlrev_b32 v9, 4, v1
    s_mul_i32 s39, s34, 5
    s_add_u32 s39, s39, s3
    s_add_u32 s40, s39, 24
    s_waitcnt lgkmcnt(0)
    s_mov_b32 s12, s4
    s_mov_b32 s13, s5
    s_mov_b32 s14, 2359296
    s_mov_b32 s15, 0x20000
    s_mov_b32 s16, s6
    s_mov_b32 s17, s7
    s_mov_b32 s18, 1990656
    s_mov_b32 s19, 0x20000
    s_add_u32 s24, s30, 12582912
    s_addc_u32 s25, s31, 0
    s_mov_b32 s26, 3670016
    s_mov_b32 s27, 0x20000
    s_mov_b32 s56, 1360015489
    s_mov_b32 s57, 27412568
    s_mov_b32 s58, 609253587
    s_mov_b32 s59, 160863570
    s_mov_b32 s60, 10586583
    s_mov_b32 s61, 0
    s_mov_b32 s40, s39
    s_lshr_b32 s45, s33, 1
    s_lshl_b32 s45, s45, 2
    s_lshl_b32 s46, s32, 2
Lk1_sp20:
    s_lshr_b32 s47, s40, 3
    s_and_b32 s48, s40, 7
    s_cmp_ge_u32 s47, 10
    s_cselect_b64 s[62:63], s[58:59], s[56:57]
    s_cselect_b32 s49, 10, 0
    s_cmp_ge_u32 s47, 20
    s_cselect_b64 s[62:63], s[60:61], s[62:63]
    s_cselect_b32 s49, 20, s49
    s_sub_u32 s47, s47, s49
    s_mul_i32 s47, s47, 6
    s_lshr_b64 s[62:63], s[62:63], s47
    s_and_b32 s47, s62, 15
    s_bfe_u32 s49, s62, 0x20004
    s_mul_i32 s47, s47, 23
    s_cmp_eq_u32 s49, 0
    s_cbranch_scc1 Lk1_oa22
    s_lshl_b32 s49, s49, 3
    s_add_u32 s48, s48, s49
    s_sub_u32 s48, s48, 4
    s_xor_b32 s49, s46, 4
    s_sub_u32 s49, s49, 16
    s_cmp_ge_u32 s48, 16
    s_branch Lk1_ob23
Lk1_oa22:
    s_sub_u32 s49, s46, 4
    s_cmp_ge_u32 s48, 4
Lk1_ob23:
    s_cbranch_scc1 Lk1_oc24
    s_add_u32 s48, s48, s45
    s_and_b32 s48, s48, 15
    s_add_u32 s47, s47, s48
    s_cmp_eq_u32 s48, 15
    s_cbranch_scc1 Lk1_od25
    s_branch Lk1_oc24x
Lk1_oc24:
    s_add_u32 s48, s48, s49
    s_add_u32 s47, s47, s48
    s_add_u32 s47, s47, 15
Lk1_oc24x:
    s_mul_i32 s50, s47, 2850
    s_lshr_b32 s50, s50, 16
    s_mul_i32 s51, s50, 23
    s_sub_u32 s51, s47, s51
    s_cmp_ge_u32 s51, 15
    s_cbranch_scc1 Lk1_sx26
    s_lshl_b32 s51, s51, 6
    s_movk_i32 s52, 4370
    v_add_u32 v40, s51, v1
    v_mul_u32_u24 v41, s52, v40
    s_movk_i32 s52, 1536
    v_lshrrev_b32 v41, 16, v41
    v_mul_u32_u24 v42, 15, v41
    v_mul_u32_u24 v41, s52, v41
    v_sub_u32 v42, v40, v42
    v_mul_u32_u24 v42, 52, v42
    v_lshl_add_u32 v40, v40, 7, v41
    v_lshrrev_b32 v42, 8, v42
    s_mul_i32 s50, s50, 221184
    s_lshl_b32 s52, s32, 9
    v_lshl_add_u32 v40, v42, 9, v40
    s_add_u32 s50, s50, s52
    buffer_load_dword v8, v40, s[16:19], s50 offen
    s_branch Lk1_sn27
Lk1_sx26:
    s_lshr_b32 s52, s33, 1
    s_lshl_b32 s52, s52, 3
    s_add_u32 s51, s51, s52
    s_sub_u32 s51, s51, 15
    s_mul_i32 s51, s51, 73728
    s_lshl_b32 s50, s50, 7
    s_add_u32 s50, s50, s51
    buffer_load_dword v8, v43, s[12:15], s50 offen
Lk1_sn27:
Lk1_od25:
    s_add_u32 s40, s40, 40
    s_waitcnt vmcnt(63)
    s_cmp_lt_u32 s40, 192
    s_cbranch_scc1 Lk1_sp20
    s_mov_b32 s12, s10
    s_mov_b32 s13, s11
    s_mov_b32 s14, 18874368
    s_mov_b32 s15, 0x20000
    v_lshlrev_b32 v6, 7, v1
    s_lshr_b32 s97, s33, 1
    s_mul_i32 s97, s97, 4718592
    s_and_b32 s42, s33, 1
    s_lshl_b32 s42, s42, 13
    s_add_u32 s42, s42, s97
    s_lshl_b32 s38, s39, 14
    s_add_u32 s42, s42, s38
Lk1_w228:
    buffer_load_dword v8, v6, s[12:15], s42 offen
    s_add_u32 s39, s39, 40
    s_add_u32 s42, s42, 655360
    s_waitcnt vmcnt(1)
    s_cmp_lt_u32 s39, 112
    s_cbranch_scc1 Lk1_w228
    s_cmp_lg_u32 s3, 4
    s_cbranch_scc1 Lk1_nd29
    s_getpc_b64 s[44:45]
Lk1_pc30:
    s_add_u32 s44, s44, Lk2_entry-Lk1_pc30
    s_addc_u32 s45, s45, 0
    s_lshr_b32 s46, s2, 3
    s_movk_i32 s47, 8
    v_mov_b32 v18, s46
    v_mad_u32_u24 v18, v1, s47, v18
    v_lshlrev_b32 v18, 7, v18
    v_cmp_gt_u32 vcc, Lk3_entry-Lk2_entry, v18
    v_mov_b32 v19, 0
    v_mov_b32 v16, s44
    v_mov_b32 v17, s45
    v_lshl_add_u64 v[16:17], v[18:19], 0, v[16:17]
    s_and_saveexec_b64 s[46:47], vcc
    global_load_dword v8, v[16:17], off
    s_mov_b64 exec, s[46:47]
Lk1_nd29:
    s_cmp_lg_u32 s3, 4
    s_cbranch_scc1 Lk1_out3
    s_mov_b32 s38, 0
    v_lshlrev_b32 v34, 2, v1
Lk1_spin31:
    global_load_dword v35, v34, s[28:29] sc1
    s_add_u32 s38, s38, 1
    s_waitcnt vmcnt(0)
    v_cmp_eq_u32 vcc, 0, v35
    s_cmp_ge_u32 s38, 0x40000
    s_cbranch_scc1 Lk1_out3
    s_cbranch_vccnz Lk1_spin31
Lk1_out3:
    s_waitcnt lgkmcnt(0)
    s_add_u32 s2, s2, 192
    s_and_b32 s2, s2, 255
    s_branch Lk2_entry
Lk1_comp6:
    v_lshrrev_b32 v196, 4, v1
    v_and_b32 v197, 15, v1
    s_and_b32 s37, s3, 1
    v_lshrrev_b32 v198, 1, v197
    v_xor_b32 v198, v198, v196
    s_lshl_b32 s38, s37, 2
    v_xor_b32 v198, s38, v198
    v_lshlrev_b32 v198, 4, v198
    v_lshl_add_u32 v198, v197, 7, v198
    s_lshl_b32 s38, s3, 12
    s_add_u32 s38, s38, 73728
    v_add_u32 v2, s38, v198
    v_xor_b32 v3, 64, v2
    v_bfe_u32 v198, v1, 2, 3
    v_lshrrev_b32 v199, 5, v1
    v_lshl_add_u32 v199, v199, 4, v198
    s_movk_i32 s38, 288
    v_mul_u32_u24 v199, s38, v199
    v_and_b32 v200, 3, v1
    v_lshl_add_u32 v199, v200, 3, v199
    s_mul_i32 s38, s37, 9216
    s_sub_u32 s39, 9216, s38
    v_add_u32 v4, s38, v199
    v_add_u32 v5, s39, v199
    v_mov_b32 v28, 0x3f803f80
    v_mov_b32 v29, 0x3f803f80
    v_mov_b32 v30, 0x3f803f80
    v_mov_b32 v31, 0x3f803f80
    s_lshl_b32 s38, s3, 10
    s_add_u32 s38, s38, 139264
    v_lshl_add_u32 v6, v197, 2, s38
    v_and_b32 v198, 48, v1
    v_lshl_add_u32 v198, v196, 2, v198
    v_lshlrev_b32 v7, 2, v198
    s_lshl_b32 s40, s32, 2
    s_add_u32 s40, s40, s35
    v_cmp_gt_u32 s[60:61], 8, v197
    v_mov_b32 v201, 897988541
    s_lshl_b32 s41, s40, 2
    s_add_u32 s41, s41, s3
    v_cndmask_b32 v10, 0, v201, s[60:61]
    s_mul_i32 s41, s41, 1520
    s_lshl_b32 s38, s36, 2
    s_add_u32 s38, s38, s3
    s_mul_i32 s38, s38, 576
    s_lshl_b32 s39, s32, 1
    s_add_u32 s39, s39, s35
    s_sub_u32 s39, s39, 4
    s_mul_i32 s39, s39, 144
    s_add_u32 s38, s38, s39
    s_lshl_b32 s42, s38, 6
    s_add_u32 s43, s42, 4096
    s_add_u32 s44, s42, 8192
    v_lshlrev_b32 v198, 6, v197
    v_lshl_add_u32 v12, v196, 4, v198
    v_lshlrev_b32 v198, 4, v1
    s_mul_i32 s38, s3, 9216
    v_add_u32 v13, s38, v198
    s_lshl_b32 s38, s3, 10
    v_add_u32 v14, s38, v198
    s_lshl_b32 s45, s3, 13
    s_add_u32 s45, s45, 73728
    s_movk_i32 s38, 144
    v_mul_u32_u24 v198, s38, v197
    v_lshl_add_u32 v198, v196, 4, v198
    v_add_u32 v15, s45, v198
    s_mul_i32 s39, s3, 288
    s_add_u32 s46, s39, s45
    s_add_u32 s46, s46, 3744
    v_lshl_add_u32 v11, v196, 4, s46
    s_mul_i32 s39, s3, 296
    s_add_u32 s45, s45, s39
    s_add_u32 s45, s45, 1152
    s_movk_i32 s38, 3277
    s_movk_i32 s39, 380
    v_mov_b32 v199, 0x40000000
    v_add_u32 v200, 0, v1
    v_mul_u32_u24 v201, s38, v200
    v_cmp_gt_u32 s[54:55], s39, v200
    v_lshrrev_b32 v201, 16, v201
    v_mul_u32_u24 v202, 20, v201
    v_lshlrev_b32 v203, 2, v200
    v_sub_u32 v202, v200, v202
    v_cmp_gt_u32 vcc, 18, v202
    v_lshl_add_u32 v201, v201, 6, s45
    s_and_b64 vcc, vcc, s[54:55]
    v_add_u32 v16, v201, v203
    v_cndmask_b32 v22, v199, v203, vcc
    v_add_u32 v200, 64, v1
    v_mul_u32_u24 v201, s38, v200
    v_cmp_gt_u32 s[54:55], s39, v200
    v_lshrrev_b32 v201, 16, v201
    v_mul_u32_u24 v202, 20, v201
    v_lshlrev_b32 v203, 2, v200
    v_sub_u32 v202, v200, v202
    v_cmp_gt_u32 vcc, 18, v202
    v_lshl_add_u32 v201, v201, 6, s45
    s_and_b64 vcc, vcc, s[54:55]
    v_add_u32 v17, v201, v203
    v_cndmask_b32 v23, v199, v203, vcc
    v_add_u32 v200, 128, v1
    v_mul_u32_u24 v201, s38, v200
    v_cmp_gt_u32 s[54:55], s39, v200
    v_lshrrev_b32 v201, 16, v201
    v_mul_u32_u24 v202, 20, v201
    v_lshlrev_b32 v203, 2, v200
    v_sub_u32 v202, v200, v202
    v_cmp_gt_u32 vcc, 18, v202
    v_lshl_add_u32 v201, v201, 6, s45
    s_and_b64 vcc, vcc, s[54:55]
    v_add_u32 v18, v201, v203
    v_cndmask_b32 v24, v199, v203, vcc
    v_add_u32 v200, 192, v1
    v_mul_u32_u24 v201, s38, v200
    v_cmp_gt_u32 s[54:55], s39, v200
    v_lshrrev_b32 v201, 16, v201
    v_mul_u32_u24 v202, 20, v201
    v_lshlrev_b32 v203, 2, v200
    v_sub_u32 v202, v200, v202
    v_cmp_gt_u32 vcc, 18, v202
    v_lshl_add_u32 v201, v201, 6, s45
    s_and_b64 vcc, vcc, s[54:55]
    v_add_u32 v19, v201, v203
    v_cndmask_b32 v25, v199, v203, vcc
    v_add_u32 v200, 256, v1
    v_mul_u32_u24 v201, s38, v200
    v_cmp_gt_u32 s[54:55], s39, v200
    v_lshrrev_b32 v201, 16, v201
    v_mul_u32_u24 v202, 20, v201
    v_lshlrev_b32 v203, 2, v200
    v_sub_u32 v202, v200, v202
    v_cmp_gt_u32 vcc, 18, v202
    v_lshl_add_u32 v201, v201, 6, s45
    s_and_b64 vcc, vcc, s[54:55]
    v_add_u32 v20, v201, v203
    v_cndmask_b32 v26, v199, v203, vcc
    v_add_u32 v200, 320, v1
    v_mul_u32_u24 v201, s38, v200
    v_cmp_gt_u32 s[54:55], s39, v200
    v_lshrrev_b32 v201, 16, v201
    v_mul_u32_u24 v202, 20, v201
    v_lshlrev_b32 v203, 2, v200
    v_sub_u32 v202, v200, v202
    v_cmp_gt_u32 vcc, 18, v202
    v_lshl_add_u32 v201, v201, 6, s45
    s_and_b64 vcc, vcc, s[54:55]
    v_add_u32 v21, v201, v203
    v_cndmask_b32 v27, v199, v203, vcc
    s_waitcnt lgkmcnt(0)
    s_add_u32 s12, s30, 4096
    s_addc_u32 s13, s31, 0
    s_mov_b32 s14, 2359296
    s_mov_b32 s15, 0x20000
    s_add_u32 s20, s30, 12582912
    s_addc_u32 s21, s31, 0
    s_mov_b32 s22, 48640
    s_mov_b32 s23, 0x20000
    s_barrier
    ds_read_b128 v[156:159], v2 offset:0
    ds_read_b128 v[160:163], v2 offset:2048
    ds_read_b64_tr_b16 v[172:173], v4 offset:0
    ds_read_b64_tr_b16 v[174:175], v4 offset:2304
    ds_read_b64_tr_b16 v[176:177], v4 offset:32
    ds_read_b64_tr_b16 v[178:179], v4 offset:2336
    ds_read_b64_tr_b16 v[180:181], v4 offset:64
    ds_read_b64_tr_b16 v[182:183], v4 offset:2368
    ds_read_b64_tr_b16 v[184:185], v4 offset:96
    ds_read_b64_tr_b16 v[186:187], v4 offset:2400
    s_waitcnt lgkmcnt(6)
    v_mfma_f32_16x16x32_bf16 v[32:35], v[156:159], v[172:175], 0
    ds_read_b64_tr_b16 v[188:189], v4 offset:128
    v_mfma_f32_16x16x32_bf16 v[36:39], v[160:163], v[172:175], 0
    ds_read_b64_tr_b16 v[190:191], v4 offset:2432
    v_mfma_f32_16x16x32_bf16 v[120:123], v[28:31], v[172:175], 0
    s_waitcnt lgkmcnt(6)
    v_mfma_f32_16x16x32_bf16 v[40:43], v[156:159], v[176:179], 0
    ds_read_b64_tr_b16 v[192:193], v4 offset:160
    v_mfma_f32_16x16x32_bf16 v[44:47], v[160:163], v[176:179], 0
    ds_read_b64_tr_b16 v[194:195], v4 offset:2464
    v_mfma_f32_16x16x32_bf16 v[124:127], v[28:31], v[176:179], 0
    v_mfma_f32_16x16x32_bf16 v[104:107], v[156:159], v[156:159], 0
    s_waitcnt lgkmcnt(6)
    v_mfma_f32_16x16x32_bf16 v[48:51], v[156:159], v[180:183], 0
    ds_read_b64_tr_b16 v[172:173], v4 offset:192
    v_mfma_f32_16x16x32_bf16 v[52:55], v[160:163], v[180:183], 0
    ds_read_b64_tr_b16 v[174:175], v4 offset:2496
    v_mfma_f32_16x16x32_bf16 v[128:131], v[28:31], v[180:183], 0
    v_mfma_f32_16x16x32_bf16 v[108:111], v[160:163], v[160:163], 0
    s_waitcnt lgkmcnt(6)
    v_mfma_f32_16x16x32_bf16 v[56:59], v[156:159], v[184:187], 0
    ds_read_b64_tr_b16 v[176:177], v4 offset:224
    v_mfma_f32_16x16x32_bf16 v[60:63], v[160:163], v[184:187], 0
    ds_read_b64_tr_b16 v[178:179], v4 offset:2528
    v_mfma_f32_16x16x32_bf16 v[132:135], v[28:31], v[184:187], 0
    v_mfma_f32_16x16x32_bf16 v[112:115], v[156:159], v[28:31], 0
    s_waitcnt lgkmcnt(6)
    v_mfma_f32_16x16x32_bf16 v[64:67], v[156:159], v[188:191], 0
    ds_read_b64_tr_b16 v[180:181], v4 offset:256
    v_mfma_f32_16x16x32_bf16 v[68:71], v[160:163], v[188:191], 0
    ds_read_b64_tr_b16 v[182:183], v4 offset:2560
    v_mfma_f32_16x16x32_bf16 v[136:139], v[28:31], v[188:191], 0
    v_mfma_f32_16x16x32_bf16 v[116:119], v[160:163], v[28:31], 0
    s_waitcnt lgkmcnt(6)
    v_mfma_f32_16x16x32_bf16 v[72:75], v[156:159], v[192:195], 0
    ds_read_b128 v[164:167], v3 offset:0
    ds_read_b128 v[168:171], v3 offset:2048
    v_mfma_f32_16x16x32_bf16 v[76:79], v[160:163], v[192:195], 0
    ds_read_b64_tr_b16 v[184:185], v5 offset:0
    ds_read_b64_tr_b16 v[186:187], v5 offset:2304
    v_mfma_f32_16x16x32_bf16 v[140:143], v[28:31], v[192:195], 0
    s_waitcnt lgkmcnt(8)
    v_mfma_f32_16x16x32_bf16 v[80:83], v[156:159], v[172:175], 0
    ds_read_b64_tr_b16 v[188:189], v5 offset:32
    v_mfma_f32_16x16x32_bf16 v[84:87], v[160:163], v[172:175], 0
    ds_read_b64_tr_b16 v[190:191], v5 offset:2336
    v_mfma_f32_16x16x32_bf16 v[144:147], v[28:31], v[172:175], 0
    s_waitcnt lgkmcnt(8)
    v_mfma_f32_16x16x32_bf16 v[88:91], v[156:159], v[176:179], 0
    ds_read_b64_tr_b16 v[192:193], v5 offset:64
    v_mfma_f32_16x16x32_bf16 v[92:95], v[160:163], v[176:179], 0
    ds_read_b64_tr_b16 v[194:195], v5 offset:2368
    v_mfma_f32_16x16x32_bf16 v[148:151], v[28:31], v[176:179], 0
    s_waitcnt lgkmcnt(8)
    v_mfma_f32_16x16x32_bf16 v[96:99], v[156:159], v[180:183], 0
    ds_read_b64_tr_b16 v[172:173], v5 offset:96
    v_mfma_f32_16x16x32_bf16 v[100:103], v[160:163], v[180:183], 0
    ds_read_b64_tr_b16 v[174:175], v5 offset:2400
    v_mfma_f32_16x16x32_bf16 v[152:155], v[28:31], v[180:183], 0
    s_waitcnt lgkmcnt(6)
    v_mfma_f32_16x16x32_bf16 v[32:35], v[164:167], v[184:187], v[32:35]
    ds_read_b64_tr_b16 v[176:177], v5 offset:128
    v_mfma_f32_16x16x32_bf16 v[36:39], v[168:171], v[184:187], v[36:39]
    ds_read_b64_tr_b16 v[178:179], v5 offset:2432
    s_waitcnt lgkmcnt(6)
    v_mfma_f32_16x16x32_bf16 v[40:43], v[164:167], v[188:191], v[40:43]
    ds_read_b64_tr_b16 v[180:181], v5 offset:160
    v_mfma_f32_16x16x32_bf16 v[44:47], v[168:171], v[188:191], v[44:47]
    ds_read_b64_tr_b16 v[182:183], v5 offset:2464
    v_mfma_f32_16x16x32_bf16 v[104:107], v[164:167], v[164:167], v[104:107]
    s_waitcnt lgkmcnt(6)
    v_mfma_f32_16x16x32_bf16 v[48:51], v[164:167], v[192:195], v[48:51]
    ds_read_b64_tr_b16 v[184:185], v5 offset:192
    v_mfma_f32_16x16x32_bf16 v[52:55], v[168:171], v[192:195], v[52:55]
    ds_read_b64_tr_b16 v[186:187], v5 offset:2496
    v_mfma_f32_16x16x32_bf16 v[108:111], v[168:171], v[168:171], v[108:111]
    s_waitcnt lgkmcnt(6)
    v_mfma_f32_16x16x32_bf16 v[56:59], v[164:167], v[172:175], v[56:59]
    ds_read_b64_tr_b16 v[188:189], v5 offset:224
    v_mfma_f32_16x16x32_bf16 v[60:63], v[168:171], v[172:175], v[60:63]
    ds_read_b64_tr_b16 v[190:191], v5 offset:2528
    v_mfma_f32_16x16x32_bf16 v[112:115], v[164:167], v[28:31], v[112:115]
    s_waitcnt lgkmcnt(6)
    v_mfma_f32_16x16x32_bf16 v[64:67], v[164:167], v[176:179], v[64:67]
    ds_read_b64_tr_b16 v[192:193], v5 offset:256
    v_mfma_f32_16x16x32_bf16 v[68:71], v[168:171], v[176:179], v[68:71]
    ds_read_b64_tr_b16 v[194:195], v5 offset:2560
    v_mfma_f32_16x16x32_bf16 v[116:119], v[168:171], v[28:31], v[116:119]
    s_waitcnt lgkmcnt(6)
    v_mfma_f32_16x16x32_bf16 v[72:75], v[164:167], v[180:183], v[72:75]
    s_barrier
    ds_read_b128 v[156:159], v2 offset:16384
    ds_read_b128 v[160:163], v2 offset:18432
    v_mfma_f32_16x16x32_bf16 v[76:79], v[168:171], v[180:183], v[76:79]
    ds_read_b64_tr_b16 v[172:173], v4 offset:18432
    ds_read_b64_tr_b16 v[174:175], v4 offset:20736
    s_waitcnt lgkmcnt(8)
    v_mfma_f32_16x16x32_bf16 v[80:83], v[164:167], v[184:187], v[80:83]
    ds_read_b64_tr_b16 v[176:177], v4 offset:18464
    v_mfma_f32_16x16x32_bf16 v[84:87], v[168:171], v[184:187], v[84:87]
    ds_read_b64_tr_b16 v[178:179], v4 offset:20768
    s_waitcnt lgkmcnt(8)
    v_mfma_f32_16x16x32_bf16 v[88:91], v[164:167], v[188:191], v[88:91]
    ds_read_b64_tr_b16 v[180:181], v4 offset:18496
    v_mfma_f32_16x16x32_bf16 v[92:95], v[168:171], v[188:191], v[92:95]
    ds_read_b64_tr_b16 v[182:183], v4 offset:20800
    s_waitcnt lgkmcnt(8)
    v_mfma_f32_16x16x32_bf16 v[96:99], v[164:167], v[192:195], v[96:99]
    ds_read_b64_tr_b16 v[184:185], v4 offset:18528
    v_mfma_f32_16x16x32_bf16 v[100:103], v[168:171], v[192:195], v[100:103]
    ds_read_b64_tr_b16 v[186:187], v4 offset:20832
    s_waitcnt lgkmcnt(6)
    v_mfma_f32_16x16x32_bf16 v[32:35], v[156:159], v[172:175], v[32:35]
    ds_read_b64_tr_b16 v[188:189], v4 offset:18560
    v_mfma_f32_16x16x32_bf16 v[36:39], v[160:163], v[172:175], v[36:39]
    ds_read_b64_tr_b16 v[190:191], v4 offset:20864
    v_mfma_f32_16x16x32_bf16 v[120:123], v[28:31], v[172:175], v[120:123]
    s_waitcnt lgkmcnt(6)
    v_mfma_f32_16x16x32_bf16 v[40:43], v[156:159], v[176:179], v[40:43]
    ds_read_b64_tr_b16 v[192:193], v4 offset:18592
    v_mfma_f32_16x16x32_bf16 v[44:47], v[160:163], v[176:179], v[44:47]
    ds_read_b64_tr_b16 v[194:195], v4 offset:20896
    v_mfma_f32_16x16x32_bf16 v[124:127], v[28:31], v[176:179], v[124:127]
    v_mfma_f32_16x16x32_bf16 v[104:107], v[156:159], v[156:159], v[104:107]
    s_waitcnt lgkmcnt(6)
    v_mfma_f32_16x16x32_bf16 v[48:51], v[156:159], v[180:183], v[48:51]
    ds_read_b64_tr_b16 v[172:173], v4 offset:18624
    v_mfma_f32_16x16x32_bf16 v[52:55], v[160:163], v[180:183], v[52:55]
    ds_read_b64_tr_b16 v[174:175], v4 offset:20928
    v_mfma_f32_16x16x32_bf16 v[128:131], v[28:31], v[180:183], v[128:131]
    v_mfma_f32_16x16x32_bf16 v[108:111], v[160:163], v[160:163], v[108:111]
    s_waitcnt lgkmcnt(6)
    v_mfma_f32_16x16x32_bf16 v[56:59], v[156:159], v[184:187], v[56:59]
    ds_read_b64_tr_b16 v[176:177], v4 offset:18656
    v_mfma_f32_16x16x32_bf16 v[60:63], v[160:163], v[184:187], v[60:63]
    ds_read_b64_tr_b16 v[178:179], v4 offset:20960
    v_mfma_f32_16x16x32_bf16 v[132:135], v[28:31], v[184:187], v[132:135]
    v_mfma_f32_16x16x32_bf16 v[112:115], v[156:159], v[28:31], v[112:115]
    s_waitcnt lgkmcnt(6)
    v_mfma_f32_16x16x32_bf16 v[64:67], v[156:159], v[188:191], v[64:67]
    ds_read_b64_tr_b16 v[180:181], v4 offset:18688
    v_mfma_f32_16x16x32_bf16 v[68:71], v[160:163], v[188:191], v[68:71]
    ds_read_b64_tr_b16 v[182:183], v4 offset:20992
    v_mfma_f32_16x16x32_bf16 v[136:139], v[28:31], v[188:191], v[136:139]
    v_mfma_f32_16x16x32_bf16 v[116:119], v[160:163], v[28:31], v[116:119]
    s_waitcnt lgkmcnt(6)
    v_mfma_f32_16x16x32_bf16 v[72:75], v[156:159], v[192:195], v[72:75]
    ds_read_b128 v[164:167], v3 offset:16384
    ds_read_b128 v[168:171], v3 offset:18432
    v_mfma_f32_16x16x32_bf16 v[76:79], v[160:163], v[192:195], v[76:79]
    ds_read_b64_tr_b16 v[184:185], v5 offset:18432
    ds_read_b64_tr_b16 v[186:187], v5 offset:20736
    v_mfma_f32_16x16x32_bf16 v[140:143], v[28:31], v[192:195], v[140:143]
    s_waitcnt lgkmcnt(8)
    v_mfma_f32_16x16x32_bf16 v[80:83], v[156:159], v[172:175], v[80:83]
    ds_read_b64_tr_b16 v[188:189], v5 offset:18464
    v_mfma_f32_16x16x32_bf16 v[84:87], v[160:163], v[172:175], v[84:87]
    ds_read_b64_tr_b16 v[190:191], v5 offset:20768
    v_mfma_f32_16x16x32_bf16 v[144:147], v[28:31], v[172:175], v[144:147]
    s_waitcnt lgkmcnt(8)
    v_mfma_f32_16x16x32_bf16 v[88:91], v[156:159], v[176:179], v[88:91]
    ds_read_b64_tr_b16 v[192:193], v5 offset:18496
    v_mfma_f32_16x16x32_bf16 v[92:95], v[160:163], v[176:179], v[92:95]
    ds_read_b64_tr_b16 v[194:195], v5 offset:20800
    v_mfma_f32_16x16x32_bf16 v[148:151], v[28:31], v[176:179], v[148:151]
    s_waitcnt lgkmcnt(8)
    v_mfma_f32_16x16x32_bf16 v[96:99], v[156:159], v[180:183], v[96:99]
    ds_read_b64_tr_b16 v[172:173], v5 offset:18528
    v_mfma_f32_16x16x32_bf16 v[100:103], v[160:163], v[180:183], v[100:103]
    ds_read_b64_tr_b16 v[174:175], v5 offset:20832
    v_mfma_f32_16x16x32_bf16 v[152:155], v[28:31], v[180:183], v[152:155]
    s_waitcnt lgkmcnt(6)
    v_mfma_f32_16x16x32_bf16 v[32:35], v[164:167], v[184:187], v[32:35]
    ds_read_b64_tr_b16 v[176:177], v5 offset:18560
    v_mfma_f32_16x16x32_bf16 v[36:39], v[168:171], v[184:187], v[36:39]
    ds_read_b64_tr_b16 v[178:179], v5 offset:20864
    s_waitcnt lgkmcnt(6)
    v_mfma_f32_16x16x32_bf16 v[40:43], v[164:167], v[188:191], v[40:43]
    ds_read_b64_tr_b16 v[180:181], v5 offset:18592
    v_mfma_f32_16x16x32_bf16 v[44:47], v[168:171], v[188:191], v[44:47]
    ds_read_b64_tr_b16 v[182:183], v5 offset:20896
    v_mfma_f32_16x16x32_bf16 v[104:107], v[164:167], v[164:167], v[104:107]
    s_waitcnt lgkmcnt(6)
    v_mfma_f32_16x16x32_bf16 v[48:51], v[164:167], v[192:195], v[48:51]
    ds_read_b64_tr_b16 v[184:185], v5 offset:18624
    v_mfma_f32_16x16x32_bf16 v[52:55], v[168:171], v[192:195], v[52:55]
    ds_read_b64_tr_b16 v[186:187], v5 offset:20928
    v_mfma_f32_16x16x32_bf16 v[108:111], v[168:171], v[168:171], v[108:111]
    s_waitcnt lgkmcnt(6)
    v_mfma_f32_16x16x32_bf16 v[56:59], v[164:167], v[172:175], v[56:59]
    ds_read_b64_tr_b16 v[188:189], v5 offset:18656
    v_mfma_f32_16x16x32_bf16 v[60:63], v[168:171], v[172:175], v[60:63]
    ds_read_b64_tr_b16 v[190:191], v5 offset:20960
    v_mfma_f32_16x16x32_bf16 v[112:115], v[164:167], v[28:31], v[112:115]
    s_waitcnt lgkmcnt(6)
    v_mfma_f32_16x16x32_bf16 v[64:67], v[164:167], v[176:179], v[64:67]
    ds_read_b64_tr_b16 v[192:193], v5 offset:18688
    v_mfma_f32_16x16x32_bf16 v[68:71], v[168:171], v[176:179], v[68:71]
    ds_read_b64_tr_b16 v[194:195], v5 offset:20992
    v_mfma_f32_16x16x32_bf16 v[116:119], v[168:171], v[28:31], v[116:119]
    s_waitcnt lgkmcnt(6)
    v_mfma_f32_16x16x32_bf16 v[72:75], v[164:167], v[180:183], v[72:75]
    s_barrier
    ds_read_b128 v[156:159], v2 offset:32768
    ds_read_b128 v[160:163], v2 offset:34816
    v_mfma_f32_16x16x32_bf16 v[76:79], v[168:171], v[180:183], v[76:79]
    ds_read_b64_tr_b16 v[172:173], v4 offset:36864
    ds_read_b64_tr_b16 v[174:175], v4 offset:39168
    s_waitcnt lgkmcnt(8)
    v_mfma_f32_16x16x32_bf16 v[80:83], v[164:167], v[184:187], v[80:83]
    ds_read_b64_tr_b16 v[176:177], v4 offset:36896
    v_mfma_f32_16x16x32_bf16 v[84:87], v[168:171], v[184:187], v[84:87]
    ds_read_b64_tr_b16 v[178:179], v4 offset:39200
    s_waitcnt lgkmcnt(8)
    v_mfma_f32_16x16x32_bf16 v[88:91], v[164:167], v[188:191], v[88:91]
    ds_read_b64_tr_b16 v[180:181], v4 offset:36928
    v_mfma_f32_16x16x32_bf16 v[92:95], v[168:171], v[188:191], v[92:95]
    ds_read_b64_tr_b16 v[182:183], v4 offset:39232
    s_waitcnt lgkmcnt(8)
    v_mfma_f32_16x16x32_bf16 v[96:99], v[164:167], v[192:195], v[96:99]
    ds_read_b64_tr_b16 v[184:185], v4 offset:36960
    v_mfma_f32_16x16x32_bf16 v[100:103], v[168:171], v[192:195], v[100:103]
    ds_read_b64_tr_b16 v[186:187], v4 offset:39264
    s_waitcnt lgkmcnt(6)
    v_mfma_f32_16x16x32_bf16 v[32:35], v[156:159], v[172:175], v[32:35]
    ds_read_b64_tr_b16 v[188:189], v4 offset:36992
    v_mfma_f32_16x16x32_bf16 v[36:39], v[160:163], v[172:175], v[36:39]
    ds_read_b64_tr_b16 v[190:191], v4 offset:39296
    v_mfma_f32_16x16x32_bf16 v[120:123], v[28:31], v[172:175], v[120:123]
    s_waitcnt lgkmcnt(6)
    v_mfma_f32_16x16x32_bf16 v[40:43], v[156:159], v[176:179], v[40:43]
    ds_read_b64_tr_b16 v[192:193], v4 offset:37024
    v_mfma_f32_16x16x32_bf16 v[44:47], v[160:163], v[176:179], v[44:47]
    ds_read_b64_tr_b16 v[194:195], v4 offset:39328
    v_mfma_f32_16x16x32_bf16 v[124:127], v[28:31], v[176:179], v[124:127]
    v_mfma_f32_16x16x32_bf16 v[104:107], v[156:159], v[156:159], v[104:107]
    s_waitcnt lgkmcnt(6)
    v_mfma_f32_16x16x32_bf16 v[48:51], v[156:159], v[180:183], v[48:51]
    ds_read_b64_tr_b16 v[172:173], v4 offset:37056
    v_mfma_f32_16x16x32_bf16 v[52:55], v[160:163], v[180:183], v[52:55]
    ds_read_b64_tr_b16 v[174:175], v4 offset:39360
    v_mfma_f32_16x16x32_bf16 v[128:131], v[28:31], v[180:183], v[128:131]
    v_mfma_f32_16x16x32_bf16 v[108:111], v[160:163], v[160:163], v[108:111]
    s_waitcnt lgkmcnt(6)
    v_mfma_f32_16x16x32_bf16 v[56:59], v[156:159], v[184:187], v[56:59]
    ds_read_b64_tr_b16 v[176:177], v4 offset:37088
    v_mfma_f32_16x16x32_bf16 v[60:63], v[160:163], v[184:187], v[60:63]
    ds_read_b64_tr_b16 v[178:179], v4 offset:39392
    v_mfma_f32_16x16x32_bf16 v[132:135], v[28:31], v[184:187], v[132:135]
    v_mfma_f32_16x16x32_bf16 v[112:115], v[156:159], v[28:31], v[112:115]
    s_waitcnt lgkmcnt(6)
    v_mfma_f32_16x16x32_bf16 v[64:67], v[156:159], v[188:191], v[64:67]
    ds_read_b64_tr_b16 v[180:181], v4 offset:37120
    v_mfma_f32_16x16x32_bf16 v[68:71], v[160:163], v[188:191], v[68:71]
    ds_read_b64_tr_b16 v[182:183], v4 offset:39424
    v_mfma_f32_16x16x32_bf16 v[136:139], v[28:31], v[188:191], v[136:139]
    v_mfma_f32_16x16x32_bf16 v[116:119], v[160:163], v[28:31], v[116:119]
    s_waitcnt lgkmcnt(6)
    v_mfma_f32_16x16x32_bf16 v[72:75], v[156:159], v[192:195], v[72:75]
    ds_read_b128 v[164:167], v3 offset:32768
    ds_read_b128 v[168:171], v3 offset:34816
    v_mfma_f32_16x16x32_bf16 v[76:79], v[160:163], v[192:195], v[76:79]
    ds_read_b64_tr_b16 v[184:185], v5 offset:36864
    ds_read_b64_tr_b16 v[186:187], v5 offset:39168
    v_mfma_f32_16x16x32_bf16 v[140:143], v[28:31], v[192:195], v[140:143]
    s_waitcnt lgkmcnt(8)
    v_mfma_f32_16x16x32_bf16 v[80:83], v[156:159], v[172:175], v[80:83]
    ds_read_b64_tr_b16 v[188:189], v5 offset:36896
    v_mfma_f32_16x16x32_bf16 v[84:87], v[160:163], v[172:175], v[84:87]
    ds_read_b64_tr_b16 v[190:191], v5 offset:39200
    v_mfma_f32_16x16x32_bf16 v[144:147], v[28:31], v[172:175], v[144:147]
    s_waitcnt lgkmcnt(8)
    v_mfma_f32_16x16x32_bf16 v[88:91], v[156:159], v[176:179], v[88:91]
    ds_read_b64_tr_b16 v[192:193], v5 offset:36928
    v_mfma_f32_16x16x32_bf16 v[92:95], v[160:163], v[176:179], v[92:95]
    ds_read_b64_tr_b16 v[194:195], v5 offset:39232
    v_mfma_f32_16x16x32_bf16 v[148:151], v[28:31], v[176:179], v[148:151]
    s_waitcnt lgkmcnt(8)
    v_mfma_f32_16x16x32_bf16 v[96:99], v[156:159], v[180:183], v[96:99]
    ds_read_b64_tr_b16 v[172:173], v5 offset:36960
    v_mfma_f32_16x16x32_bf16 v[100:103], v[160:163], v[180:183], v[100:103]
    ds_read_b64_tr_b16 v[174:175], v5 offset:39264
    v_mfma_f32_16x16x32_bf16 v[152:155], v[28:31], v[180:183], v[152:155]
    s_waitcnt lgkmcnt(6)
    v_mfma_f32_16x16x32_bf16 v[32:35], v[164:167], v[184:187], v[32:35]
    ds_read_b64_tr_b16 v[176:177], v5 offset:36992
    v_mfma_f32_16x16x32_bf16 v[36:39], v[168:171], v[184:187], v[36:39]
    ds_read_b64_tr_b16 v[178:179], v5 offset:39296
    s_waitcnt lgkmcnt(6)
    v_mfma_f32_16x16x32_bf16 v[40:43], v[164:167], v[188:191], v[40:43]
    ds_read_b64_tr_b16 v[180:181], v5 offset:37024
    v_mfma_f32_16x16x32_bf16 v[44:47], v[168:171], v[188:191], v[44:47]
    ds_read_b64_tr_b16 v[182:183], v5 offset:39328
    v_mfma_f32_16x16x32_bf16 v[104:107], v[164:167], v[164:167], v[104:107]
    s_waitcnt lgkmcnt(6)
    v_mfma_f32_16x16x32_bf16 v[48:51], v[164:167], v[192:195], v[48:51]
    ds_read_b64_tr_b16 v[184:185], v5 offset:37056
    v_mfma_f32_16x16x32_bf16 v[52:55], v[168:171], v[192:195], v[52:55]
    ds_read_b64_tr_b16 v[186:187], v5 offset:39360
    v_mfma_f32_16x16x32_bf16 v[108:111], v[168:171], v[168:171], v[108:111]
    s_waitcnt lgkmcnt(6)
    v_mfma_f32_16x16x32_bf16 v[56:59], v[164:167], v[172:175], v[56:59]
    ds_read_b64_tr_b16 v[188:189], v5 offset:37088
    v_mfma_f32_16x16x32_bf16 v[60:63], v[168:171], v[172:175], v[60:63]
    ds_read_b64_tr_b16 v[190:191], v5 offset:39392
    v_mfma_f32_16x16x32_bf16 v[112:115], v[164:167], v[28:31], v[112:115]
    s_waitcnt lgkmcnt(6)
    v_mfma_f32_16x16x32_bf16 v[64:67], v[164:167], v[176:179], v[64:67]
    ds_read_b64_tr_b16 v[192:193], v5 offset:37120
    v_mfma_f32_16x16x32_bf16 v[68:71], v[168:171], v[176:179], v[68:71]
    ds_read_b64_tr_b16 v[194:195], v5 offset:39424
    v_mfma_f32_16x16x32_bf16 v[116:119], v[168:171], v[28:31], v[116:119]
    s_waitcnt lgkmcnt(6)
    v_mfma_f32_16x16x32_bf16 v[72:75], v[164:167], v[180:183], v[72:75]
    s_barrier
    ds_read_b128 v[156:159], v2 offset:49152
    ds_read_b128 v[160:163], v2 offset:51200
    v_mfma_f32_16x16x32_bf16 v[76:79], v[168:171], v[180:183], v[76:79]
    ds_read_b64_tr_b16 v[172:173], v4 offset:55296
    ds_read_b64_tr_b16 v[174:175], v4 offset:57600
    s_waitcnt lgkmcnt(8)
    v_mfma_f32_16x16x32_bf16 v[80:83], v[164:167], v[184:187], v[80:83]
    ds_read_b64_tr_b16 v[176:177], v4 offset:55328
    v_mfma_f32_16x16x32_bf16 v[84:87], v[168:171], v[184:187], v[84:87]
    ds_read_b64_tr_b16 v[178:179], v4 offset:57632
    s_waitcnt lgkmcnt(8)
    v_mfma_f32_16x16x32_bf16 v[88:91], v[164:167], v[188:191], v[88:91]
    ds_read_b64_tr_b16 v[180:181], v4 offset:55360
    v_mfma_f32_16x16x32_bf16 v[92:95], v[168:171], v[188:191], v[92:95]
    ds_read_b64_tr_b16 v[182:183], v4 offset:57664
    s_waitcnt lgkmcnt(8)
    v_mfma_f32_16x16x32_bf16 v[96:99], v[164:167], v[192:195], v[96:99]
    ds_read_b64_tr_b16 v[184:185], v4 offset:55392
    v_mfma_f32_16x16x32_bf16 v[100:103], v[168:171], v[192:195], v[100:103]
    ds_read_b64_tr_b16 v[186:187], v4 offset:57696
    s_waitcnt lgkmcnt(6)
    v_mfma_f32_16x16x32_bf16 v[32:35], v[156:159], v[172:175], v[32:35]
    ds_read_b64_tr_b16 v[188:189], v4 offset:55424
    v_mfma_f32_16x16x32_bf16 v[36:39], v[160:163], v[172:175], v[36:39]
    ds_read_b64_tr_b16 v[190:191], v4 offset:57728
    v_mfma_f32_16x16x32_bf16 v[120:123], v[28:31], v[172:175], v[120:123]
    s_waitcnt lgkmcnt(6)
    v_mfma_f32_16x16x32_bf16 v[40:43], v[156:159], v[176:179], v[40:43]
    ds_read_b64_tr_b16 v[192:193], v4 offset:55456
    v_mfma_f32_16x16x32_bf16 v[44:47], v[160:163], v[176:179], v[44:47]
    ds_read_b64_tr_b16 v[194:195], v4 offset:57760
    v_mfma_f32_16x16x32_bf16 v[124:127], v[28:31], v[176:179], v[124:127]
    v_mfma_f32_16x16x32_bf16 v[104:107], v[156:159], v[156:159], v[104:107]
    s_waitcnt lgkmcnt(6)
    v_mfma_f32_16x16x32_bf16 v[48:51], v[156:159], v[180:183], v[48:51]
    ds_read_b64_tr_b16 v[172:173], v4 offset:55488
    v_mfma_f32_16x16x32_bf16 v[52:55], v[160:163], v[180:183], v[52:55]
    ds_read_b64_tr_b16 v[174:175], v4 offset:57792
    v_mfma_f32_16x16x32_bf16 v[128:131], v[28:31], v[180:183], v[128:131]
    v_mfma_f32_16x16x32_bf16 v[108:111], v[160:163], v[160:163], v[108:111]
    s_waitcnt lgkmcnt(6)
    v_mfma_f32_16x16x32_bf16 v[56:59], v[156:159], v[184:187], v[56:59]
    ds_read_b64_tr_b16 v[176:177], v4 offset:55520
    v_mfma_f32_16x16x32_bf16 v[60:63], v[160:163], v[184:187], v[60:63]
    ds_read_b64_tr_b16 v[178:179], v4 offset:57824
    v_mfma_f32_16x16x32_bf16 v[132:135], v[28:31], v[184:187], v[132:135]
    v_mfma_f32_16x16x32_bf16 v[112:115], v[156:159], v[28:31], v[112:115]
    s_waitcnt lgkmcnt(6)
    v_mfma_f32_16x16x32_bf16 v[64:67], v[156:159], v[188:191], v[64:67]
    ds_read_b64_tr_b16 v[180:181], v4 offset:55552
    v_mfma_f32_16x16x32_bf16 v[68:71], v[160:163], v[188:191], v[68:71]
    ds_read_b64_tr_b16 v[182:183], v4 offset:57856
    v_mfma_f32_16x16x32_bf16 v[136:139], v[28:31], v[188:191], v[136:139]
    v_mfma_f32_16x16x32_bf16 v[116:119], v[160:163], v[28:31], v[116:119]
    s_waitcnt lgkmcnt(6)
    v_mfma_f32_16x16x32_bf16 v[72:75], v[156:159], v[192:195], v[72:75]
    ds_read_b128 v[164:167], v3 offset:49152
    ds_read_b128 v[168:171], v3 offset:51200
    v_mfma_f32_16x16x32_bf16 v[76:79], v[160:163], v[192:195], v[76:79]
    ds_read_b64_tr_b16 v[184:185], v5 offset:55296
    ds_read_b64_tr_b16 v[186:187], v5 offset:57600
    v_mfma_f32_16x16x32_bf16 v[140:143], v[28:31], v[192:195], v[140:143]
    s_waitcnt lgkmcnt(8)
    v_mfma_f32_16x16x32_bf16 v[80:83], v[156:159], v[172:175], v[80:83]
    ds_read_b64_tr_b16 v[188:189], v5 offset:55328
    v_mfma_f32_16x16x32_bf16 v[84:87], v[160:163], v[172:175], v[84:87]
    ds_read_b64_tr_b16 v[190:191], v5 offset:57632
    v_mfma_f32_16x16x32_bf16 v[144:147], v[28:31], v[172:175], v[144:147]
    s_waitcnt lgkmcnt(8)
    v_mfma_f32_16x16x32_bf16 v[88:91], v[156:159], v[176:179], v[88:91]
    ds_read_b64_tr_b16 v[192:193], v5 offset:55360
    v_mfma_f32_16x16x32_bf16 v[92:95], v[160:163], v[176:179], v[92:95]
    ds_read_b64_tr_b16 v[194:195], v5 offset:57664
    v_mfma_f32_16x16x32_bf16 v[148:151], v[28:31], v[176:179], v[148:151]
    s_waitcnt lgkmcnt(8)
    v_mfma_f32_16x16x32_bf16 v[96:99], v[156:159], v[180:183], v[96:99]
    ds_read_b64_tr_b16 v[172:173], v5 offset:55392
    v_mfma_f32_16x16x32_bf16 v[100:103], v[160:163], v[180:183], v[100:103]
    ds_read_b64_tr_b16 v[174:175], v5 offset:57696
    v_mfma_f32_16x16x32_bf16 v[152:155], v[28:31], v[180:183], v[152:155]
    s_waitcnt lgkmcnt(6)
    v_mfma_f32_16x16x32_bf16 v[32:35], v[164:167], v[184:187], v[32:35]
    ds_read_b64_tr_b16 v[176:177], v5 offset:55424
    v_mfma_f32_16x16x32_bf16 v[36:39], v[168:171], v[184:187], v[36:39]
    ds_read_b64_tr_b16 v[178:179], v5 offset:57728
    s_waitcnt lgkmcnt(6)
    v_mfma_f32_16x16x32_bf16 v[40:43], v[164:167], v[188:191], v[40:43]
    ds_read_b64_tr_b16 v[180:181], v5 offset:55456
    v_mfma_f32_16x16x32_bf16 v[44:47], v[168:171], v[188:191], v[44:47]
    ds_read_b64_tr_b16 v[182:183], v5 offset:57760
    v_mfma_f32_16x16x32_bf16 v[104:107], v[164:167], v[164:167], v[104:107]
    s_waitcnt lgkmcnt(6)
    v_mfma_f32_16x16x32_bf16 v[48:51], v[164:167], v[192:195], v[48:51]
    ds_read_b64_tr_b16 v[184:185], v5 offset:55488
    v_mfma_f32_16x16x32_bf16 v[52:55], v[168:171], v[192:195], v[52:55]
    ds_read_b64_tr_b16 v[186:187], v5 offset:57792
    v_mfma_f32_16x16x32_bf16 v[108:111], v[168:171], v[168:171], v[108:111]
    s_waitcnt lgkmcnt(6)
    v_mfma_f32_16x16x32_bf16 v[56:59], v[164:167], v[172:175], v[56:59]
    ds_read_b64_tr_b16 v[188:189], v5 offset:55520
    v_mfma_f32_16x16x32_bf16 v[60:63], v[168:171], v[172:175], v[60:63]
    ds_read_b64_tr_b16 v[190:191], v5 offset:57824
    v_mfma_f32_16x16x32_bf16 v[112:115], v[164:167], v[28:31], v[112:115]
    s_waitcnt lgkmcnt(6)
    v_mfma_f32_16x16x32_bf16 v[64:67], v[164:167], v[176:179], v[64:67]
    ds_read_b64_tr_b16 v[192:193], v5 offset:55552
    v_mfma_f32_16x16x32_bf16 v[68:71], v[168:171], v[176:179], v[68:71]
    ds_read_b64_tr_b16 v[194:195], v5 offset:57856
    v_mfma_f32_16x16x32_bf16 v[116:119], v[168:171], v[28:31], v[116:119]
    s_waitcnt lgkmcnt(6)
    v_mfma_f32_16x16x32_bf16 v[72:75], v[164:167], v[180:183], v[72:75]
    s_barrier
    ds_read_b128 v[156:159], v2 offset:0
    ds_read_b128 v[160:163], v2 offset:2048
    v_mfma_f32_16x16x32_bf16 v[76:79], v[168:171], v[180:183], v[76:79]
    ds_read_b64_tr_b16 v[172:173], v4 offset:0
    ds_read_b64_tr_b16 v[174:175], v4 offset:2304
    s_waitcnt lgkmcnt(8)
    v_mfma_f32_16x16x32_bf16 v[80:83], v[164:167], v[184:187], v[80:83]
    ds_read_b64_tr_b16 v[176:177], v4 offset:32
    v_mfma_f32_16x16x32_bf16 v[84:87], v[168:171], v[184:187], v[84:87]
    ds_read_b64_tr_b16 v[178:179], v4 offset:2336
    s_waitcnt lgkmcnt(8)
    v_mfma_f32_16x16x32_bf16 v[88:91], v[164:167], v[188:191], v[88:91]
    ds_read_b64_tr_b16 v[180:181], v4 offset:64
    v_mfma_f32_16x16x32_bf16 v[92:95], v[168:171], v[188:191], v[92:95]
    ds_read_b64_tr_b16 v[182:183], v4 offset:2368
    s_waitcnt lgkmcnt(8)
    v_mfma_f32_16x16x32_bf16 v[96:99], v[164:167], v[192:195], v[96:99]
    ds_read_b64_tr_b16 v[184:185], v4 offset:96
    v_mfma_f32_16x16x32_bf16 v[100:103], v[168:171], v[192:195], v[100:103]
    ds_read_b64_tr_b16 v[186:187], v4 offset:2400
    s_waitcnt lgkmcnt(6)
    v_mfma_f32_16x16x32_bf16 v[32:35], v[156:159], v[172:175], v[32:35]
    ds_read_b64_tr_b16 v[188:189], v4 offset:128
    v_mfma_f32_16x16x32_bf16 v[36:39], v[160:163], v[172:175], v[36:39]
    ds_read_b64_tr_b16 v[190:191], v4 offset:2432
    v_mfma_f32_16x16x32_bf16 v[120:123], v[28:31], v[172:175], v[120:123]
    s_waitcnt lgkmcnt(6)
    v_mfma_f32_16x16x32_bf16 v[40:43], v[156:159], v[176:179], v[40:43]
    ds_read_b64_tr_b16 v[192:193], v4 offset:160
    v_mfma_f32_16x16x32_bf16 v[44:47], v[160:163], v[176:179], v[44:47]
    ds_read_b64_tr_b16 v[194:195], v4 offset:2464
    v_mfma_f32_16x16x32_bf16 v[124:127], v[28:31], v[176:179], v[124:127]
    v_mfma_f32_16x16x32_bf16 v[104:107], v[156:159], v[156:159], v[104:107]
    s_waitcnt lgkmcnt(6)
    v_mfma_f32_16x16x32_bf16 v[48:51], v[156:159], v[180:183], v[48:51]
    ds_read_b64_tr_b16 v[172:173], v4 offset:192
    v_mfma_f32_16x16x32_bf16 v[52:55], v[160:163], v[180:183], v[52:55]
    ds_read_b64_tr_b16 v[174:175], v4 offset:2496
    v_mfma_f32_16x16x32_bf16 v[128:131], v[28:31], v[180:183], v[128:131]
    v_mfma_f32_16x16x32_bf16 v[108:111], v[160:163], v[160:163], v[108:111]
    s_waitcnt lgkmcnt(6)
    v_mfma_f32_16x16x32_bf16 v[56:59], v[156:159], v[184:187], v[56:59]
    ds_read_b64_tr_b16 v[176:177], v4 offset:224
    v_mfma_f32_16x16x32_bf16 v[60:63], v[160:163], v[184:187], v[60:63]
    ds_read_b64_tr_b16 v[178:179], v4 offset:2528
    v_mfma_f32_16x16x32_bf16 v[132:135], v[28:31], v[184:187], v[132:135]
    v_mfma_f32_16x16x32_bf16 v[112:115], v[156:159], v[28:31], v[112:115]
    s_waitcnt lgkmcnt(6)
    v_mfma_f32_16x16x32_bf16 v[64:67], v[156:159], v[188:191], v[64:67]
    ds_read_b64_tr_b16 v[180:181], v4 offset:256
    v_mfma_f32_16x16x32_bf16 v[68:71], v[160:163], v[188:191], v[68:71]
    ds_read_b64_tr_b16 v[182:183], v4 offset:2560
    v_mfma_f32_16x16x32_bf16 v[136:139], v[28:31], v[188:191], v[136:139]
    v_mfma_f32_16x16x32_bf16 v[116:119], v[160:163], v[28:31], v[116:119]
    s_waitcnt lgkmcnt(6)
    v_mfma_f32_16x16x32_bf16 v[72:75], v[156:159], v[192:195], v[72:75]
    ds_read_b128 v[164:167], v3 offset:0
    ds_read_b128 v[168:171], v3 offset:2048
    v_mfma_f32_16x16x32_bf16 v[76:79], v[160:163], v[192:195], v[76:79]
    ds_read_b64_tr_b16 v[184:185], v5 offset:0
    ds_read_b64_tr_b16 v[186:187], v5 offset:2304
    v_mfma_f32_16x16x32_bf16 v[140:143], v[28:31], v[192:195], v[140:143]
    s_waitcnt lgkmcnt(8)
    v_mfma_f32_16x16x32_bf16 v[80:83], v[156:159], v[172:175], v[80:83]
    ds_read_b64_tr_b16 v[188:189], v5 offset:32
    v_mfma_f32_16x16x32_bf16 v[84:87], v[160:163], v[172:175], v[84:87]
    ds_read_b64_tr_b16 v[190:191], v5 offset:2336
    v_mfma_f32_16x16x32_bf16 v[144:147], v[28:31], v[172:175], v[144:147]
    s_waitcnt lgkmcnt(8)
    v_mfma_f32_16x16x32_bf16 v[88:91], v[156:159], v[176:179], v[88:91]
    ds_read_b64_tr_b16 v[192:193], v5 offset:64
    v_mfma_f32_16x16x32_bf16 v[92:95], v[160:163], v[176:179], v[92:95]
    ds_read_b64_tr_b16 v[194:195], v5 offset:2368
    v_mfma_f32_16x16x32_bf16 v[148:151], v[28:31], v[176:179], v[148:151]
    s_waitcnt lgkmcnt(8)
    v_mfma_f32_16x16x32_bf16 v[96:99], v[156:159], v[180:183], v[96:99]
    ds_read_b64_tr_b16 v[172:173], v5 offset:96
    v_mfma_f32_16x16x32_bf16 v[100:103], v[160:163], v[180:183], v[100:103]
    ds_read_b64_tr_b16 v[174:175], v5 offset:2400
    v_mfma_f32_16x16x32_bf16 v[152:155], v[28:31], v[180:183], v[152:155]
    s_waitcnt lgkmcnt(6)
    v_mfma_f32_16x16x32_bf16 v[32:35], v[164:167], v[184:187], v[32:35]
    ds_read_b64_tr_b16 v[176:177], v5 offset:128
    v_mfma_f32_16x16x32_bf16 v[36:39], v[168:171], v[184:187], v[36:39]
    ds_read_b64_tr_b16 v[178:179], v5 offset:2432
    s_waitcnt lgkmcnt(6)
    v_mfma_f32_16x16x32_bf16 v[40:43], v[164:167], v[188:191], v[40:43]
    ds_read_b64_tr_b16 v[180:181], v5 offset:160
    v_mfma_f32_16x16x32_bf16 v[44:47], v[168:171], v[188:191], v[44:47]
    ds_read_b64_tr_b16 v[182:183], v5 offset:2464
    v_mfma_f32_16x16x32_bf16 v[104:107], v[164:167], v[164:167], v[104:107]
    s_waitcnt lgkmcnt(6)
    v_mfma_f32_16x16x32_bf16 v[48:51], v[164:167], v[192:195], v[48:51]
    ds_read_b64_tr_b16 v[184:185], v5 offset:192
    v_mfma_f32_16x16x32_bf16 v[52:55], v[168:171], v[192:195], v[52:55]
    ds_read_b64_tr_b16 v[186:187], v5 offset:2496
    v_mfma_f32_16x16x32_bf16 v[108:111], v[168:171], v[168:171], v[108:111]
    s_waitcnt lgkmcnt(6)
    v_mfma_f32_16x16x32_bf16 v[56:59], v[164:167], v[172:175], v[56:59]
    ds_read_b64_tr_b16 v[188:189], v5 offset:224
    v_mfma_f32_16x16x32_bf16 v[60:63], v[168:171], v[172:175], v[60:63]
    ds_read_b64_tr_b16 v[190:191], v5 offset:2528
    v_mfma_f32_16x16x32_bf16 v[112:115], v[164:167], v[28:31], v[112:115]
    s_waitcnt lgkmcnt(6)
    v_mfma_f32_16x16x32_bf16 v[64:67], v[164:167], v[176:179], v[64:67]
    ds_read_b64_tr_b16 v[192:193], v5 offset:256
    v_mfma_f32_16x16x32_bf16 v[68:71], v[168:171], v[176:179], v[68:71]
    ds_read_b64_tr_b16 v[194:195], v5 offset:2560
    v_mfma_f32_16x16x32_bf16 v[116:119], v[168:171], v[28:31], v[116:119]
    s_waitcnt lgkmcnt(6)
    v_mfma_f32_16x16x32_bf16 v[72:75], v[164:167], v[180:183], v[72:75]
    s_barrier
    ds_read_b128 v[156:159], v2 offset:16384
    ds_read_b128 v[160:163], v2 offset:18432
    v_mfma_f32_16x16x32_bf16 v[76:79], v[168:171], v[180:183], v[76:79]
    ds_read_b64_tr_b16 v[172:173], v4 offset:18432
    ds_read_b64_tr_b16 v[174:175], v4 offset:20736
    s_waitcnt lgkmcnt(8)
    v_mfma_f32_16x16x32_bf16 v[80:83], v[164:167], v[184:187], v[80:83]
    ds_read_b64_tr_b16 v[176:177], v4 offset:18464
    v_mfma_f32_16x16x32_bf16 v[84:87], v[168:171], v[184:187], v[84:87]
    ds_read_b64_tr_b16 v[178:179], v4 offset:20768
    s_waitcnt lgkmcnt(8)
    v_mfma_f32_16x16x32_bf16 v[88:91], v[164:167], v[188:191], v[88:91]
    ds_read_b64_tr_b16 v[180:181], v4 offset:18496
    v_mfma_f32_16x16x32_bf16 v[92:95], v[168:171], v[188:191], v[92:95]
    ds_read_b64_tr_b16 v[182:183], v4 offset:20800
    s_waitcnt lgkmcnt(8)
    v_mfma_f32_16x16x32_bf16 v[96:99], v[164:167], v[192:195], v[96:99]
    ds_read_b64_tr_b16 v[184:185], v4 offset:18528
    v_mfma_f32_16x16x32_bf16 v[100:103], v[168:171], v[192:195], v[100:103]
    ds_read_b64_tr_b16 v[186:187], v4 offset:20832
    s_waitcnt lgkmcnt(6)
    v_mfma_f32_16x16x32_bf16 v[32:35], v[156:159], v[172:175], v[32:35]
    ds_read_b64_tr_b16 v[188:189], v4 offset:18560
    v_mfma_f32_16x16x32_bf16 v[36:39], v[160:163], v[172:175], v[36:39]
    ds_read_b64_tr_b16 v[190:191], v4 offset:20864
    v_mfma_f32_16x16x32_bf16 v[120:123], v[28:31], v[172:175], v[120:123]
    s_waitcnt lgkmcnt(6)
    v_mfma_f32_16x16x32_bf16 v[40:43], v[156:159], v[176:179], v[40:43]
    ds_read_b64_tr_b16 v[192:193], v4 offset:18592
    v_mfma_f32_16x16x32_bf16 v[44:47], v[160:163], v[176:179], v[44:47]
    ds_read_b64_tr_b16 v[194:195], v4 offset:20896
    v_mfma_f32_16x16x32_bf16 v[124:127], v[28:31], v[176:179], v[124:127]
    v_mfma_f32_16x16x32_bf16 v[104:107], v[156:159], v[156:159], v[104:107]
    s_waitcnt lgkmcnt(6)
    v_mfma_f32_16x16x32_bf16 v[48:51], v[156:159], v[180:183], v[48:51]
    ds_read_b64_tr_b16 v[172:173], v4 offset:18624
    v_mfma_f32_16x16x32_bf16 v[52:55], v[160:163], v[180:183], v[52:55]
    ds_read_b64_tr_b16 v[174:175], v4 offset:20928
    v_mfma_f32_16x16x32_bf16 v[128:131], v[28:31], v[180:183], v[128:131]
    v_mfma_f32_16x16x32_bf16 v[108:111], v[160:163], v[160:163], v[108:111]
    s_waitcnt lgkmcnt(6)
    v_mfma_f32_16x16x32_bf16 v[56:59], v[156:159], v[184:187], v[56:59]
    ds_read_b64_tr_b16 v[176:177], v4 offset:18656
    v_mfma_f32_16x16x32_bf16 v[60:63], v[160:163], v[184:187], v[60:63]
    ds_read_b64_tr_b16 v[178:179], v4 offset:20960
    v_mfma_f32_16x16x32_bf16 v[132:135], v[28:31], v[184:187], v[132:135]
    v_mfma_f32_16x16x32_bf16 v[112:115], v[156:159], v[28:31], v[112:115]
    s_waitcnt lgkmcnt(6)
    v_mfma_f32_16x16x32_bf16 v[64:67], v[156:159], v[188:191], v[64:67]
    ds_read_b64_tr_b16 v[180:181], v4 offset:18688
    v_mfma_f32_16x16x32_bf16 v[68:71], v[160:163], v[188:191], v[68:71]
    ds_read_b64_tr_b16 v[182:183], v4 offset:20992
    v_mfma_f32_16x16x32_bf16 v[136:139], v[28:31], v[188:191], v[136:139]
    v_mfma_f32_16x16x32_bf16 v[116:119], v[160:163], v[28:31], v[116:119]
    s_waitcnt lgkmcnt(6)
    v_mfma_f32_16x16x32_bf16 v[72:75], v[156:159], v[192:195], v[72:75]
    ds_read_b128 v[164:167], v3 offset:16384
    ds_read_b128 v[168:171], v3 offset:18432
    v_mfma_f32_16x16x32_bf16 v[76:79], v[160:163], v[192:195], v[76:79]
    ds_read_b64_tr_b16 v[184:185], v5 offset:18432
    ds_read_b64_tr_b16 v[186:187], v5 offset:20736
    v_mfma_f32_16x16x32_bf16 v[140:143], v[28:31], v[192:195], v[140:143]
    s_waitcnt lgkmcnt(8)
    v_mfma_f32_16x16x32_bf16 v[80:83], v[156:159], v[172:175], v[80:83]
    ds_read_b64_tr_b16 v[188:189], v5 offset:18464
    v_mfma_f32_16x16x32_bf16 v[84:87], v[160:163], v[172:175], v[84:87]
    ds_read_b64_tr_b16 v[190:191], v5 offset:20768
    v_mfma_f32_16x16x32_bf16 v[144:147], v[28:31], v[172:175], v[144:147]
    s_waitcnt lgkmcnt(8)
    v_mfma_f32_16x16x32_bf16 v[88:91], v[156:159], v[176:179], v[88:91]
    ds_read_b64_tr_b16 v[192:193], v5 offset:18496
    v_mfma_f32_16x16x32_bf16 v[92:95], v[160:163], v[176:179], v[92:95]
    ds_read_b64_tr_b16 v[194:195], v5 offset:20800
    v_mfma_f32_16x16x32_bf16 v[148:151], v[28:31], v[176:179], v[148:151]
    s_waitcnt lgkmcnt(8)
    v_mfma_f32_16x16x32_bf16 v[96:99], v[156:159], v[180:183], v[96:99]
    ds_read_b64_tr_b16 v[172:173], v5 offset:18528
    v_mfma_f32_16x16x32_bf16 v[100:103], v[160:163], v[180:183], v[100:103]
    ds_read_b64_tr_b16 v[174:175], v5 offset:20832
    v_mfma_f32_16x16x32_bf16 v[152:155], v[28:31], v[180:183], v[152:155]
    s_waitcnt lgkmcnt(6)
    v_mfma_f32_16x16x32_bf16 v[32:35], v[164:167], v[184:187], v[32:35]
    ds_read_b64_tr_b16 v[176:177], v5 offset:18560
    v_mfma_f32_16x16x32_bf16 v[36:39], v[168:171], v[184:187], v[36:39]
    ds_read_b64_tr_b16 v[178:179], v5 offset:20864
    s_waitcnt lgkmcnt(6)
    v_mfma_f32_16x16x32_bf16 v[40:43], v[164:167], v[188:191], v[40:43]
    ds_read_b64_tr_b16 v[180:181], v5 offset:18592
    v_mfma_f32_16x16x32_bf16 v[44:47], v[168:171], v[188:191], v[44:47]
    ds_read_b64_tr_b16 v[182:183], v5 offset:20896
    v_mfma_f32_16x16x32_bf16 v[104:107], v[164:167], v[164:167], v[104:107]
    s_waitcnt lgkmcnt(6)
    v_mfma_f32_16x16x32_bf16 v[48:51], v[164:167], v[192:195], v[48:51]
    ds_read_b64_tr_b16 v[184:185], v5 offset:18624
    v_mfma_f32_16x16x32_bf16 v[52:55], v[168:171], v[192:195], v[52:55]
    ds_read_b64_tr_b16 v[186:187], v5 offset:20928
    v_mfma_f32_16x16x32_bf16 v[108:111], v[168:171], v[168:171], v[108:111]
    s_waitcnt lgkmcnt(6)
    v_mfma_f32_16x16x32_bf16 v[56:59], v[164:167], v[172:175], v[56:59]
    ds_read_b64_tr_b16 v[188:189], v5 offset:18656
    v_mfma_f32_16x16x32_bf16 v[60:63], v[168:171], v[172:175], v[60:63]
    ds_read_b64_tr_b16 v[190:191], v5 offset:20960
    v_mfma_f32_16x16x32_bf16 v[112:115], v[164:167], v[28:31], v[112:115]
    s_waitcnt lgkmcnt(6)
    v_mfma_f32_16x16x32_bf16 v[64:67], v[164:167], v[176:179], v[64:67]
    ds_read_b64_tr_b16 v[192:193], v5 offset:18688
    v_mfma_f32_16x16x32_bf16 v[68:71], v[168:171], v[176:179], v[68:71]
    ds_read_b64_tr_b16 v[194:195], v5 offset:20992
    v_mfma_f32_16x16x32_bf16 v[116:119], v[168:171], v[28:31], v[116:119]
    s_waitcnt lgkmcnt(6)
    v_mfma_f32_16x16x32_bf16 v[72:75], v[164:167], v[180:183], v[72:75]
    s_barrier
    ds_read_b128 v[156:159], v2 offset:32768
    ds_read_b128 v[160:163], v2 offset:34816
    v_mfma_f32_16x16x32_bf16 v[76:79], v[168:171], v[180:183], v[76:79]
    ds_read_b64_tr_b16 v[172:173], v4 offset:36864
    ds_read_b64_tr_b16 v[174:175], v4 offset:39168
    s_waitcnt lgkmcnt(8)
    v_mfma_f32_16x16x32_bf16 v[80:83], v[164:167], v[184:187], v[80:83]
    ds_read_b64_tr_b16 v[176:177], v4 offset:36896
    v_mfma_f32_16x16x32_bf16 v[84:87], v[168:171], v[184:187], v[84:87]
    ds_read_b64_tr_b16 v[178:179], v4 offset:39200
    s_waitcnt lgkmcnt(8)
    v_mfma_f32_16x16x32_bf16 v[88:91], v[164:167], v[188:191], v[88:91]
    ds_read_b64_tr_b16 v[180:181], v4 offset:36928
    v_mfma_f32_16x16x32_bf16 v[92:95], v[168:171], v[188:191], v[92:95]
    ds_read_b64_tr_b16 v[182:183], v4 offset:39232
    s_waitcnt lgkmcnt(8)
    v_mfma_f32_16x16x32_bf16 v[96:99], v[164:167], v[192:195], v[96:99]
    ds_read_b64_tr_b16 v[184:185], v4 offset:36960
    v_mfma_f32_16x16x32_bf16 v[100:103], v[168:171], v[192:195], v[100:103]
    ds_read_b64_tr_b16 v[186:187], v4 offset:39264
    s_waitcnt lgkmcnt(6)
    v_mfma_f32_16x16x32_bf16 v[32:35], v[156:159], v[172:175], v[32:35]
    ds_read_b64_tr_b16 v[188:189], v4 offset:36992
    v_mfma_f32_16x16x32_bf16 v[36:39], v[160:163], v[172:175], v[36:39]
    ds_read_b64_tr_b16 v[190:191], v4 offset:39296
    v_mfma_f32_16x16x32_bf16 v[120:123], v[28:31], v[172:175], v[120:123]
    s_waitcnt lgkmcnt(6)
    v_mfma_f32_16x16x32_bf16 v[40:43], v[156:159], v[176:179], v[40:43]
    ds_read_b64_tr_b16 v[192:193], v4 offset:37024
    v_mfma_f32_16x16x32_bf16 v[44:47], v[160:163], v[176:179], v[44:47]
    ds_read_b64_tr_b16 v[194:195], v4 offset:39328
    v_mfma_f32_16x16x32_bf16 v[124:127], v[28:31], v[176:179], v[124:127]
    v_mfma_f32_16x16x32_bf16 v[104:107], v[156:159], v[156:159], v[104:107]
    s_waitcnt lgkmcnt(6)
    v_mfma_f32_16x16x32_bf16 v[48:51], v[156:159], v[180:183], v[48:51]
    ds_read_b64_tr_b16 v[172:173], v4 offset:37056
    v_mfma_f32_16x16x32_bf16 v[52:55], v[160:163], v[180:183], v[52:55]
    ds_read_b64_tr_b16 v[174:175], v4 offset:39360
    v_mfma_f32_16x16x32_bf16 v[128:131], v[28:31], v[180:183], v[128:131]
    v_mfma_f32_16x16x32_bf16 v[108:111], v[160:163], v[160:163], v[108:111]
    s_waitcnt lgkmcnt(6)
    v_mfma_f32_16x16x32_bf16 v[56:59], v[156:159], v[184:187], v[56:59]
    ds_read_b64_tr_b16 v[176:177], v4 offset:37088
    v_mfma_f32_16x16x32_bf16 v[60:63], v[160:163], v[184:187], v[60:63]
    ds_read_b64_tr_b16 v[178:179], v4 offset:39392
    v_mfma_f32_16x16x32_bf16 v[132:135], v[28:31], v[184:187], v[132:135]
    v_mfma_f32_16x16x32_bf16 v[112:115], v[156:159], v[28:31], v[112:115]
    s_waitcnt lgkmcnt(6)
    v_mfma_f32_16x16x32_bf16 v[64:67], v[156:159], v[188:191], v[64:67]
    ds_read_b64_tr_b16 v[180:181], v4 offset:37120
    v_mfma_f32_16x16x32_bf16 v[68:71], v[160:163], v[188:191], v[68:71]
    ds_read_b64_tr_b16 v[182:183], v4 offset:39424
    v_mfma_f32_16x16x32_bf16 v[136:139], v[28:31], v[188:191], v[136:139]
    v_mfma_f32_16x16x32_bf16 v[116:119], v[160:163], v[28:31], v[116:119]
    s_waitcnt lgkmcnt(6)
    v_mfma_f32_16x16x32_bf16 v[72:75], v[156:159], v[192:195], v[72:75]
    ds_read_b128 v[164:167], v3 offset:32768
    ds_read_b128 v[168:171], v3 offset:34816
    v_mfma_f32_16x16x32_bf16 v[76:79], v[160:163], v[192:195], v[76:79]
    ds_read_b64_tr_b16 v[184:185], v5 offset:36864
    ds_read_b64_tr_b16 v[186:187], v5 offset:39168
    v_mfma_f32_16x16x32_bf16 v[140:143], v[28:31], v[192:195], v[140:143]
    s_waitcnt lgkmcnt(8)
    v_mfma_f32_16x16x32_bf16 v[80:83], v[156:159], v[172:175], v[80:83]
    ds_read_b64_tr_b16 v[188:189], v5 offset:36896
    v_mfma_f32_16x16x32_bf16 v[84:87], v[160:163], v[172:175], v[84:87]
    ds_read_b64_tr_b16 v[190:191], v5 offset:39200
    v_mfma_f32_16x16x32_bf16 v[144:147], v[28:31], v[172:175], v[144:147]
    s_waitcnt lgkmcnt(8)
    v_mfma_f32_16x16x32_bf16 v[88:91], v[156:159], v[176:179], v[88:91]
    ds_read_b64_tr_b16 v[192:193], v5 offset:36928
    v_mfma_f32_16x16x32_bf16 v[92:95], v[160:163], v[176:179], v[92:95]
    ds_read_b64_tr_b16 v[194:195], v5 offset:39232
    v_mfma_f32_16x16x32_bf16 v[148:151], v[28:31], v[176:179], v[148:151]
    s_waitcnt lgkmcnt(8)
    v_mfma_f32_16x16x32_bf16 v[96:99], v[156:159], v[180:183], v[96:99]
    ds_read_b64_tr_b16 v[172:173], v5 offset:36960
    v_mfma_f32_16x16x32_bf16 v[100:103], v[160:163], v[180:183], v[100:103]
    ds_read_b64_tr_b16 v[174:175], v5 offset:39264
    v_mfma_f32_16x16x32_bf16 v[152:155], v[28:31], v[180:183], v[152:155]
    s_waitcnt lgkmcnt(6)
    v_mfma_f32_16x16x32_bf16 v[32:35], v[164:167], v[184:187], v[32:35]
    ds_read_b64_tr_b16 v[176:177], v5 offset:36992
    v_mfma_f32_16x16x32_bf16 v[36:39], v[168:171], v[184:187], v[36:39]
    ds_read_b64_tr_b16 v[178:179], v5 offset:39296
    s_waitcnt lgkmcnt(6)
    v_mfma_f32_16x16x32_bf16 v[40:43], v[164:167], v[188:191], v[40:43]
    ds_read_b64_tr_b16 v[180:181], v5 offset:37024
    v_mfma_f32_16x16x32_bf16 v[44:47], v[168:171], v[188:191], v[44:47]
    ds_read_b64_tr_b16 v[182:183], v5 offset:39328
    v_mfma_f32_16x16x32_bf16 v[104:107], v[164:167], v[164:167], v[104:107]
    s_waitcnt lgkmcnt(6)
    v_mfma_f32_16x16x32_bf16 v[48:51], v[164:167], v[192:195], v[48:51]
    ds_read_b64_tr_b16 v[184:185], v5 offset:37056
    v_mfma_f32_16x16x32_bf16 v[52:55], v[168:171], v[192:195], v[52:55]
    ds_read_b64_tr_b16 v[186:187], v5 offset:39360
    v_mfma_f32_16x16x32_bf16 v[108:111], v[168:171], v[168:171], v[108:111]
    s_waitcnt lgkmcnt(6)
    v_mfma_f32_16x16x32_bf16 v[56:59], v[164:167], v[172:175], v[56:59]
    ds_read_b64_tr_b16 v[188:189], v5 offset:37088
    v_mfma_f32_16x16x32_bf16 v[60:63], v[168:171], v[172:175], v[60:63]
    ds_read_b64_tr_b16 v[190:191], v5 offset:39392
    v_mfma_f32_16x16x32_bf16 v[112:115], v[164:167], v[28:31], v[112:115]
    s_waitcnt lgkmcnt(6)
    v_mfma_f32_16x16x32_bf16 v[64:67], v[164:167], v[176:179], v[64:67]
    ds_read_b64_tr_b16 v[192:193], v5 offset:37120
    v_mfma_f32_16x16x32_bf16 v[68:71], v[168:171], v[176:179], v[68:71]
    ds_read_b64_tr_b16 v[194:195], v5 offset:39424
    v_mfma_f32_16x16x32_bf16 v[116:119], v[168:171], v[28:31], v[116:119]
    s_waitcnt lgkmcnt(6)
    v_mfma_f32_16x16x32_bf16 v[72:75], v[164:167], v[180:183], v[72:75]
    s_barrier
    ds_read_b128 v[156:159], v2 offset:49152
    ds_read_b128 v[160:163], v2 offset:51200
    v_mfma_f32_16x16x32_bf16 v[76:79], v[168:171], v[180:183], v[76:79]
    ds_read_b64_tr_b16 v[172:173], v4 offset:55296
    ds_read_b64_tr_b16 v[174:175], v4 offset:57600
    s_waitcnt lgkmcnt(8)
    v_mfma_f32_16x16x32_bf16 v[80:83], v[164:167], v[184:187], v[80:83]
    ds_read_b64_tr_b16 v[176:177], v4 offset:55328
    v_mfma_f32_16x16x32_bf16 v[84:87], v[168:171], v[184:187], v[84:87]
    ds_read_b64_tr_b16 v[178:179], v4 offset:57632
    s_waitcnt lgkmcnt(8)
    v_mfma_f32_16x16x32_bf16 v[88:91], v[164:167], v[188:191], v[88:91]
    ds_read_b64_tr_b16 v[180:181], v4 offset:55360
    v_mfma_f32_16x16x32_bf16 v[92:95], v[168:171], v[188:191], v[92:95]
    ds_read_b64_tr_b16 v[182:183], v4 offset:57664
    s_waitcnt lgkmcnt(8)
    v_mfma_f32_16x16x32_bf16 v[96:99], v[164:167], v[192:195], v[96:99]
    ds_read_b64_tr_b16 v[184:185], v4 offset:55392
    v_mfma_f32_16x16x32_bf16 v[100:103], v[168:171], v[192:195], v[100:103]
    ds_read_b64_tr_b16 v[186:187], v4 offset:57696
    s_waitcnt lgkmcnt(6)
    v_mfma_f32_16x16x32_bf16 v[32:35], v[156:159], v[172:175], v[32:35]
    ds_read_b64_tr_b16 v[188:189], v4 offset:55424
    v_mfma_f32_16x16x32_bf16 v[36:39], v[160:163], v[172:175], v[36:39]
    ds_read_b64_tr_b16 v[190:191], v4 offset:57728
    v_mfma_f32_16x16x32_bf16 v[120:123], v[28:31], v[172:175], v[120:123]
    s_waitcnt lgkmcnt(6)
    v_mfma_f32_16x16x32_bf16 v[40:43], v[156:159], v[176:179], v[40:43]
    ds_read_b64_tr_b16 v[192:193], v4 offset:55456
    v_mfma_f32_16x16x32_bf16 v[44:47], v[160:163], v[176:179], v[44:47]
    ds_read_b64_tr_b16 v[194:195], v4 offset:57760
    v_mfma_f32_16x16x32_bf16 v[124:127], v[28:31], v[176:179], v[124:127]
    v_mfma_f32_16x16x32_bf16 v[104:107], v[156:159], v[156:159], v[104:107]
    s_waitcnt lgkmcnt(6)
    v_mfma_f32_16x16x32_bf16 v[48:51], v[156:159], v[180:183], v[48:51]
    ds_read_b64_tr_b16 v[172:173], v4 offset:55488
    v_mfma_f32_16x16x32_bf16 v[52:55], v[160:163], v[180:183], v[52:55]
    ds_read_b64_tr_b16 v[174:175], v4 offset:57792
    v_mfma_f32_16x16x32_bf16 v[128:131], v[28:31], v[180:183], v[128:131]
    v_mfma_f32_16x16x32_bf16 v[108:111], v[160:163], v[160:163], v[108:111]
    s_waitcnt lgkmcnt(6)
    v_mfma_f32_16x16x32_bf16 v[56:59], v[156:159], v[184:187], v[56:59]
    ds_read_b64_tr_b16 v[176:177], v4 offset:55520
    v_mfma_f32_16x16x32_bf16 v[60:63], v[160:163], v[184:187], v[60:63]
    ds_read_b64_tr_b16 v[178:179], v4 offset:57824
    v_mfma_f32_16x16x32_bf16 v[132:135], v[28:31], v[184:187], v[132:135]
    v_mfma_f32_16x16x32_bf16 v[112:115], v[156:159], v[28:31], v[112:115]
    s_waitcnt lgkmcnt(6)
    v_mfma_f32_16x16x32_bf16 v[64:67], v[156:159], v[188:191], v[64:67]
    ds_read_b64_tr_b16 v[180:181], v4 offset:55552
    v_mfma_f32_16x16x32_bf16 v[68:71], v[160:163], v[188:191], v[68:71]
    ds_read_b64_tr_b16 v[182:183], v4 offset:57856
    v_mfma_f32_16x16x32_bf16 v[136:139], v[28:31], v[188:191], v[136:139]
    v_mfma_f32_16x16x32_bf16 v[116:119], v[160:163], v[28:31], v[116:119]
    s_waitcnt lgkmcnt(6)
    v_mfma_f32_16x16x32_bf16 v[72:75], v[156:159], v[192:195], v[72:75]
    ds_read_b128 v[164:167], v3 offset:49152
    ds_read_b128 v[168:171], v3 offset:51200
    v_mfma_f32_16x16x32_bf16 v[76:79], v[160:163], v[192:195], v[76:79]
    ds_read_b64_tr_b16 v[184:185], v5 offset:55296
    ds_read_b64_tr_b16 v[186:187], v5 offset:57600
    v_mfma_f32_16x16x32_bf16 v[140:143], v[28:31], v[192:195], v[140:143]
    s_waitcnt lgkmcnt(8)
    v_mfma_f32_16x16x32_bf16 v[80:83], v[156:159], v[172:175], v[80:83]
    ds_read_b64_tr_b16 v[188:189], v5 offset:55328
    v_mfma_f32_16x16x32_bf16 v[84:87], v[160:163], v[172:175], v[84:87]
    ds_read_b64_tr_b16 v[190:191], v5 offset:57632
    v_mfma_f32_16x16x32_bf16 v[144:147], v[28:31], v[172:175], v[144:147]
    s_waitcnt lgkmcnt(8)
    v_mfma_f32_16x16x32_bf16 v[88:91], v[156:159], v[176:179], v[88:91]
    ds_read_b64_tr_b16 v[192:193], v5 offset:55360
    v_mfma_f32_16x16x32_bf16 v[92:95], v[160:163], v[176:179], v[92:95]
    ds_read_b64_tr_b16 v[194:195], v5 offset:57664
    v_mfma_f32_16x16x32_bf16 v[148:151], v[28:31], v[176:179], v[148:151]
    s_waitcnt lgkmcnt(8)
    v_mfma_f32_16x16x32_bf16 v[96:99], v[156:159], v[180:183], v[96:99]
    ds_read_b64_tr_b16 v[172:173], v5 offset:55392
    v_mfma_f32_16x16x32_bf16 v[100:103], v[160:163], v[180:183], v[100:103]
    ds_read_b64_tr_b16 v[174:175], v5 offset:57696
    v_mfma_f32_16x16x32_bf16 v[152:155], v[28:31], v[180:183], v[152:155]
    s_waitcnt lgkmcnt(6)
    v_mfma_f32_16x16x32_bf16 v[32:35], v[164:167], v[184:187], v[32:35]
    ds_read_b64_tr_b16 v[176:177], v5 offset:55424
    v_mfma_f32_16x16x32_bf16 v[36:39], v[168:171], v[184:187], v[36:39]
    ds_read_b64_tr_b16 v[178:179], v5 offset:57728
    s_waitcnt lgkmcnt(6)
    v_mfma_f32_16x16x32_bf16 v[40:43], v[164:167], v[188:191], v[40:43]
    ds_read_b64_tr_b16 v[180:181], v5 offset:55456
    v_mfma_f32_16x16x32_bf16 v[44:47], v[168:171], v[188:191], v[44:47]
    ds_read_b64_tr_b16 v[182:183], v5 offset:57760
    v_mfma_f32_16x16x32_bf16 v[104:107], v[164:167], v[164:167], v[104:107]
    s_waitcnt lgkmcnt(6)
    v_mfma_f32_16x16x32_bf16 v[48:51], v[164:167], v[192:195], v[48:51]
    ds_read_b64_tr_b16 v[184:185], v5 offset:55488
    v_mfma_f32_16x16x32_bf16 v[52:55], v[168:171], v[192:195], v[52:55]
    ds_read_b64_tr_b16 v[186:187], v5 offset:57792
    v_mfma_f32_16x16x32_bf16 v[108:111], v[168:171], v[168:171], v[108:111]
    s_waitcnt lgkmcnt(6)
    v_mfma_f32_16x16x32_bf16 v[56:59], v[164:167], v[172:175], v[56:59]
    ds_read_b64_tr_b16 v[188:189], v5 offset:55520
    v_mfma_f32_16x16x32_bf16 v[60:63], v[168:171], v[172:175], v[60:63]
    ds_read_b64_tr_b16 v[190:191], v5 offset:57824
    v_mfma_f32_16x16x32_bf16 v[112:115], v[164:167], v[28:31], v[112:115]
    s_waitcnt lgkmcnt(6)
    v_mfma_f32_16x16x32_bf16 v[64:67], v[164:167], v[176:179], v[64:67]
    ds_read_b64_tr_b16 v[192:193], v5 offset:55552
    v_mfma_f32_16x16x32_bf16 v[68:71], v[168:171], v[176:179], v[68:71]
    ds_read_b64_tr_b16 v[194:195], v5 offset:57856
    v_mfma_f32_16x16x32_bf16 v[116:119], v[168:171], v[28:31], v[116:119]
    s_waitcnt lgkmcnt(6)
    v_mfma_f32_16x16x32_bf16 v[72:75], v[164:167], v[180:183], v[72:75]
    s_barrier
    ds_read_b128 v[156:159], v2 offset:0
    ds_read_b128 v[160:163], v2 offset:2048
    v_mfma_f32_16x16x32_bf16 v[76:79], v[168:171], v[180:183], v[76:79]
    ds_read_b64_tr_b16 v[172:173], v4 offset:0
    ds_read_b64_tr_b16 v[174:175], v4 offset:2304
    s_waitcnt lgkmcnt(8)
    v_mfma_f32_16x16x32_bf16 v[80:83], v[164:167], v[184:187], v[80:83]
    ds_read_b64_tr_b16 v[176:177], v4 offset:32
    v_mfma_f32_16x16x32_bf16 v[84:87], v[168:171], v[184:187], v[84:87]
    ds_read_b64_tr_b16 v[178:179], v4 offset:2336
    s_waitcnt lgkmcnt(8)
    v_mfma_f32_16x16x32_bf16 v[88:91], v[164:167], v[188:191], v[88:91]
    ds_read_b64_tr_b16 v[180:181], v4 offset:64
    v_mfma_f32_16x16x32_bf16 v[92:95], v[168:171], v[188:191], v[92:95]
    ds_read_b64_tr_b16 v[182:183], v4 offset:2368
    s_waitcnt lgkmcnt(8)
    v_mfma_f32_16x16x32_bf16 v[96:99], v[164:167], v[192:195], v[96:99]
    ds_read_b64_tr_b16 v[184:185], v4 offset:96
    v_mfma_f32_16x16x32_bf16 v[100:103], v[168:171], v[192:195], v[100:103]
    ds_read_b64_tr_b16 v[186:187], v4 offset:2400
    s_waitcnt lgkmcnt(6)
    v_mfma_f32_16x16x32_bf16 v[32:35], v[156:159], v[172:175], v[32:35]
    ds_read_b64_tr_b16 v[188:189], v4 offset:128
    v_mfma_f32_16x16x32_bf16 v[36:39], v[160:163], v[172:175], v[36:39]
    ds_read_b64_tr_b16 v[190:191], v4 offset:2432
    v_mfma_f32_16x16x32_bf16 v[120:123], v[28:31], v[172:175], v[120:123]
    s_waitcnt lgkmcnt(6)
    v_mfma_f32_16x16x32_bf16 v[40:43], v[156:159], v[176:179], v[40:43]
    ds_read_b64_tr_b16 v[192:193], v4 offset:160
    v_mfma_f32_16x16x32_bf16 v[44:47], v[160:163], v[176:179], v[44:47]
    ds_read_b64_tr_b16 v[194:195], v4 offset:2464
    v_mfma_f32_16x16x32_bf16 v[124:127], v[28:31], v[176:179], v[124:127]
    v_mfma_f32_16x16x32_bf16 v[104:107], v[156:159], v[156:159], v[104:107]
    s_waitcnt lgkmcnt(6)
    v_mfma_f32_16x16x32_bf16 v[48:51], v[156:159], v[180:183], v[48:51]
    ds_read_b64_tr_b16 v[172:173], v4 offset:192
    v_mfma_f32_16x16x32_bf16 v[52:55], v[160:163], v[180:183], v[52:55]
    ds_read_b64_tr_b16 v[174:175], v4 offset:2496
    v_mfma_f32_16x16x32_bf16 v[128:131], v[28:31], v[180:183], v[128:131]
    v_mfma_f32_16x16x32_bf16 v[108:111], v[160:163], v[160:163], v[108:111]
    s_waitcnt lgkmcnt(6)
    v_mfma_f32_16x16x32_bf16 v[56:59], v[156:159], v[184:187], v[56:59]
    ds_read_b64_tr_b16 v[176:177], v4 offset:224
    v_mfma_f32_16x16x32_bf16 v[60:63], v[160:163], v[184:187], v[60:63]
    ds_read_b64_tr_b16 v[178:179], v4 offset:2528
    v_mfma_f32_16x16x32_bf16 v[132:135], v[28:31], v[184:187], v[132:135]
    v_mfma_f32_16x16x32_bf16 v[112:115], v[156:159], v[28:31], v[112:115]
    s_waitcnt lgkmcnt(6)
    v_mfma_f32_16x16x32_bf16 v[64:67], v[156:159], v[188:191], v[64:67]
    ds_read_b64_tr_b16 v[180:181], v4 offset:256
    v_mfma_f32_16x16x32_bf16 v[68:71], v[160:163], v[188:191], v[68:71]
    ds_read_b64_tr_b16 v[182:183], v4 offset:2560
    v_mfma_f32_16x16x32_bf16 v[136:139], v[28:31], v[188:191], v[136:139]
    v_mfma_f32_16x16x32_bf16 v[116:119], v[160:163], v[28:31], v[116:119]
    s_waitcnt lgkmcnt(6)
    v_mfma_f32_16x16x32_bf16 v[72:75], v[156:159], v[192:195], v[72:75]
    ds_read_b128 v[164:167], v3 offset:0
    ds_read_b128 v[168:171], v3 offset:2048
    v_mfma_f32_16x16x32_bf16 v[76:79], v[160:163], v[192:195], v[76:79]
    ds_read_b64_tr_b16 v[184:185], v5 offset:0
    ds_read_b64_tr_b16 v[186:187], v5 offset:2304
    v_mfma_f32_16x16x32_bf16 v[140:143], v[28:31], v[192:195], v[140:143]
    s_waitcnt lgkmcnt(8)
    v_mfma_f32_16x16x32_bf16 v[80:83], v[156:159], v[172:175], v[80:83]
    ds_read_b64_tr_b16 v[188:189], v5 offset:32
    v_mfma_f32_16x16x32_bf16 v[84:87], v[160:163], v[172:175], v[84:87]
    ds_read_b64_tr_b16 v[190:191], v5 offset:2336
    v_mfma_f32_16x16x32_bf16 v[144:147], v[28:31], v[172:175], v[144:147]
    s_waitcnt lgkmcnt(8)
    v_mfma_f32_16x16x32_bf16 v[88:91], v[156:159], v[176:179], v[88:91]
    ds_read_b64_tr_b16 v[192:193], v5 offset:64
    v_mfma_f32_16x16x32_bf16 v[92:95], v[160:163], v[176:179], v[92:95]
    ds_read_b64_tr_b16 v[194:195], v5 offset:2368
    v_mfma_f32_16x16x32_bf16 v[148:151], v[28:31], v[176:179], v[148:151]
    s_waitcnt lgkmcnt(8)
    v_mfma_f32_16x16x32_bf16 v[96:99], v[156:159], v[180:183], v[96:99]
    ds_read_b64_tr_b16 v[172:173], v5 offset:96
    v_mfma_f32_16x16x32_bf16 v[100:103], v[160:163], v[180:183], v[100:103]
    ds_read_b64_tr_b16 v[174:175], v5 offset:2400
    v_mfma_f32_16x16x32_bf16 v[152:155], v[28:31], v[180:183], v[152:155]
    s_waitcnt lgkmcnt(6)
    v_mfma_f32_16x16x32_bf16 v[32:35], v[164:167], v[184:187], v[32:35]
    ds_read_b64_tr_b16 v[176:177], v5 offset:128
    v_mfma_f32_16x16x32_bf16 v[36:39], v[168:171], v[184:187], v[36:39]
    ds_read_b64_tr_b16 v[178:179], v5 offset:2432
    s_waitcnt lgkmcnt(6)
    v_mfma_f32_16x16x32_bf16 v[40:43], v[164:167], v[188:191], v[40:43]
    ds_read_b64_tr_b16 v[180:181], v5 offset:160
    v_mfma_f32_16x16x32_bf16 v[44:47], v[168:171], v[188:191], v[44:47]
    ds_read_b64_tr_b16 v[182:183], v5 offset:2464
    v_mfma_f32_16x16x32_bf16 v[104:107], v[164:167], v[164:167], v[104:107]
    s_waitcnt lgkmcnt(6)
    v_mfma_f32_16x16x32_bf16 v[48:51], v[164:167], v[192:195], v[48:51]
    ds_read_b64_tr_b16 v[184:185], v5 offset:192
    v_mfma_f32_16x16x32_bf16 v[52:55], v[168:171], v[192:195], v[52:55]
    ds_read_b64_tr_b16 v[186:187], v5 offset:2496
    v_mfma_f32_16x16x32_bf16 v[108:111], v[168:171], v[168:171], v[108:111]
    s_waitcnt lgkmcnt(6)
    v_mfma_f32_16x16x32_bf16 v[56:59], v[164:167], v[172:175], v[56:59]
    ds_read_b64_tr_b16 v[188:189], v5 offset:224
    v_mfma_f32_16x16x32_bf16 v[60:63], v[168:171], v[172:175], v[60:63]
    ds_read_b64_tr_b16 v[190:191], v5 offset:2528
    v_mfma_f32_16x16x32_bf16 v[112:115], v[164:167], v[28:31], v[112:115]
    s_waitcnt lgkmcnt(6)
    v_mfma_f32_16x16x32_bf16 v[64:67], v[164:167], v[176:179], v[64:67]
    ds_read_b64_tr_b16 v[192:193], v5 offset:256
    v_mfma_f32_16x16x32_bf16 v[68:71], v[168:171], v[176:179], v[68:71]
    ds_read_b64_tr_b16 v[194:195], v5 offset:2560
    v_mfma_f32_16x16x32_bf16 v[116:119], v[168:171], v[28:31], v[116:119]
    ds_write_b32 v6, v120 offset:0
    s_waitcnt lgkmcnt(7)
    v_mfma_f32_16x16x32_bf16 v[72:75], v[164:167], v[180:183], v[72:75]
    ds_write_b32 v6, v124 offset:64
    v_mfma_f32_16x16x32_bf16 v[76:79], v[168:171], v[180:183], v[76:79]
    ds_write_b32 v6, v128 offset:128
    s_waitcnt lgkmcnt(7)
    v_mfma_f32_16x16x32_bf16 v[80:83], v[164:167], v[184:187], v[80:83]
    ds_write_b32 v6, v132 offset:192
    v_mfma_f32_16x16x32_bf16 v[84:87], v[168:171], v[184:187], v[84:87]
    ds_write_b32 v6, v136 offset:256
    s_waitcnt lgkmcnt(7)
    v_mfma_f32_16x16x32_bf16 v[88:91], v[164:167], v[188:191], v[88:91]
    ds_write_b32 v6, v140 offset:320
    v_mfma_f32_16x16x32_bf16 v[92:95], v[168:171], v[188:191], v[92:95]
    ds_write_b32 v6, v144 offset:384
    s_waitcnt lgkmcnt(7)
    v_mfma_f32_16x16x32_bf16 v[96:99], v[164:167], v[192:195], v[96:99]
    ds_write_b32 v6, v148 offset:448
    v_mfma_f32_16x16x32_bf16 v[100:103], v[168:171], v[192:195], v[100:103]
    ds_write_b32 v6, v152 offset:512
    s_waitcnt lgkmcnt(0)
    s_barrier
    v_xor_b32 v6, 1024, v6
    ds_bpermute_b32 v222, v7, v104 offset:0
    ds_bpermute_b32 v223, v7, v105 offset:4
    ds_bpermute_b32 v224, v7, v106 offset:8
    ds_bpermute_b32 v225, v7, v107 offset:12
    ds_bpermute_b32 v226, v7, v108 offset:0
    ds_bpermute_b32 v227, v7, v109 offset:4
    ds_bpermute_b32 v228, v7, v110 offset:8
    ds_bpermute_b32 v229, v7, v111 offset:12
    ds_read_b32 v196, v6 offset:0
    ds_read_b32 v197, v6 offset:64
    ds_read_b32 v198, v6 offset:128
    ds_read_b32 v199, v6 offset:192
    ds_read_b32 v200, v6 offset:256
    ds_read_b32 v201, v6 offset:320
    ds_read_b32 v202, v6 offset:384
    ds_read_b32 v203, v6 offset:448
    ds_read_b32 v204, v6 offset:512
    s_mov_b32 s38, 987991609
    s_mov_b32 s39, 925353388
    s_mov_b32 s62, 1069066811
    s_mov_b32 s63, 1069066811
    s_mov_b32 s64, 897988541
    s_mov_b32 s65, 897988541
    v_mov_b32 v232, 3049366176
    v_mul_f32 v112, s38, v112
    v_mul_f32 v113, s38, v113
    v_mul_f32 v114, s38, v114
    v_mul_f32 v115, s38, v115
    v_mul_f32 v116, s38, v116
    v_mul_f32 v117, s38, v117
    v_mul_f32 v118, s38, v118
    v_mul_f32 v119, s38, v119
    v_fma_f32 v214, -v112, v112, s39
    v_fma_f32 v215, -v113, v113, s39
    v_fma_f32 v216, -v114, v114, s39
    v_fma_f32 v217, -v115, v115, s39
    v_fma_f32 v218, -v116, v116, s39
    v_fma_f32 v219, -v117, v117, s39
    v_fma_f32 v220, -v118, v118, s39
    v_fma_f32 v221, -v119, v119, s39
    s_waitcnt lgkmcnt(9)
    v_fma_f32 v222, v222, s38, v214
    v_fma_f32 v223, v223, s38, v215
    v_fma_f32 v224, v224, s38, v216
    v_fma_f32 v225, v225, s38, v217
    v_fma_f32 v226, v226, s38, v218
    v_fma_f32 v227, v227, s38, v219
    v_fma_f32 v228, v228, s38, v220
    v_fma_f32 v229, v229, s38, v221
    v_max_f32 v222, s39, v222
    v_max_f32 v223, s39, v223
    v_max_f32 v224, s39, v224
    v_max_f32 v225, s39, v225
    v_max_f32 v226, s39, v226
    v_max_f32 v227, s39, v227
    v_max_f32 v228, s39, v228
    v_max_f32 v229, s39, v229
    v_rsq_f32 v206, v222
    v_rsq_f32 v207, v223
    v_rsq_f32 v208, v224
    v_rsq_f32 v209, v225
    v_rsq_f32 v210, v226
    v_rsq_f32 v211, v227
    v_rsq_f32 v212, v228
    v_rsq_f32 v213, v229
    s_waitcnt lgkmcnt(0)
    v_add_f32 v196, v196, v120
    v_add_f32 v197, v197, v124
    v_add_f32 v198, v198, v128
    v_add_f32 v199, v199, v132
    v_add_f32 v200, v200, v136
    v_add_f32 v201, v201, v140
    v_add_f32 v202, v202, v144
    v_add_f32 v203, v203, v148
    v_add_f32 v204, v204, v152
    v_mul_f32 v214, v206, v112
    v_mul_f32 v215, v207, v113
    v_mul_f32 v216, v208, v114
    v_mul_f32 v217, v209, v115
    v_mul_f32 v218, v210, v116
    v_mul_f32 v219, v211, v117
    v_mul_f32 v220, v212, v118
    v_mul_f32 v221, v213, v119
    s_lshl_b32 s68, s40, 4
    s_add_u32 s68, s68, s36
    s_lshl_b32 s69, s36, 1
    s_add_u32 s69, s69, s32
    s_lshl_b32 s69, s69, 1
    s_add_u32 s69, s69, s35
    s_add_u32 s69, s69, 124
    s_cmp_lt_u32 s35, 4
    s_cselect_b32 s69, s68, s69
    s_lshl_b32 s69, s69, 7
    s_add_u32 s69, s69, 1605632
    s_cmp_lt_u32 s35, 4
    s_cbranch_scc1 Lk1_typea34
    v_pk_fma_f32 v[32:33], v[32:33], v[206:207], s[64:65]
    v_pk_fma_f32 v[34:35], v[34:35], v[208:209], s[64:65]
    v_pk_fma_f32 v[36:37], v[36:37], v[210:211], s[64:65]
    v_pk_fma_f32 v[38:39], v[38:39], v[212:213], s[64:65]
    v_pk_fma_f32 v[32:33], v[214:215], v[196:197], v[32:33] op_sel:[0,0,0] op_sel_hi:[1,0,1] neg_lo:[1,0,0] neg_hi:[1,0,0]
    v_pk_fma_f32 v[34:35], v[216:217], v[196:197], v[34:35] op_sel:[0,0,0] op_sel_hi:[1,0,1] neg_lo:[1,0,0] neg_hi:[1,0,0]
    v_pk_fma_f32 v[36:37], v[218:219], v[196:197], v[36:37] op_sel:[0,0,0] op_sel_hi:[1,0,1] neg_lo:[1,0,0] neg_hi:[1,0,0]
    v_pk_fma_f32 v[38:39], v[220:221], v[196:197], v[38:39] op_sel:[0,0,0] op_sel_hi:[1,0,1] neg_lo:[1,0,0] neg_hi:[1,0,0]
    v_pk_fma_f32 v[156:157], v[32:33], s[62:63], v[232:233] op_sel_hi:[1,1,0]
    v_pk_fma_f32 v[158:159], v[34:35], s[62:63], v[232:233] op_sel_hi:[1,1,0]
    v_pk_fma_f32 v[160:161], v[36:37], s[62:63], v[232:233] op_sel_hi:[1,1,0]
    v_pk_fma_f32 v[162:163], v[38:39], s[62:63], v[232:233] op_sel_hi:[1,1,0]
    v_exp_f32_e64 v156, v156 clamp
    v_exp_f32_e64 v157, v157 clamp
    v_exp_f32_e64 v158, v158 clamp
    v_exp_f32_e64 v159, v159 clamp
    v_exp_f32_e64 v160, v160 clamp
    v_exp_f32_e64 v161, v161 clamp
    v_exp_f32_e64 v162, v162 clamp
    v_exp_f32_e64 v163, v163 clamp
    v_max_f32 v32, s64, v32
    v_max_f32 v33, s64, v33
    v_max_f32 v34, s64, v34
    v_max_f32 v35, s64, v35
    v_max_f32 v36, s64, v36
    v_max_f32 v37, s64, v37
    v_max_f32 v38, s64, v38
    v_max_f32 v39, s64, v39
    v_pk_add_f32 v[32:33], v[32:33], v[156:157]
    v_pk_add_f32 v[34:35], v[34:35], v[158:159]
    v_pk_add_f32 v[36:37], v[36:37], v[160:161]
    v_pk_add_f32 v[38:39], v[38:39], v[162:163]
    v_cvt_pk_bf16_f32 v120, v32, v33
    v_cvt_pk_bf16_f32 v121, v34, v35
    v_cvt_pk_bf16_f32 v122, v36, v37
    v_cvt_pk_bf16_f32 v123, v38, v39
    buffer_store_dwordx4 v[120:123], v12, s[12:15], s42 offen offset:0 sc1
    v_pk_fma_f32 v[40:41], v[40:41], v[206:207], s[64:65]
    v_pk_fma_f32 v[42:43], v[42:43], v[208:209], s[64:65]
    v_pk_fma_f32 v[44:45], v[44:45], v[210:211], s[64:65]
    v_pk_fma_f32 v[46:47], v[46:47], v[212:213], s[64:65]
    v_pk_fma_f32 v[40:41], v[214:215], v[196:197], v[40:41] op_sel:[0,1,0] op_sel_hi:[1,1,1] neg_lo:[1,0,0] neg_hi:[1,0,0]
    v_pk_fma_f32 v[42:43], v[216:217], v[196:197], v[42:43] op_sel:[0,1,0] op_sel_hi:[1,1,1] neg_lo:[1,0,0] neg_hi:[1,0,0]
    v_pk_fma_f32 v[44:45], v[218:219], v[196:197], v[44:45] op_sel:[0,1,0] op_sel_hi:[1,1,1] neg_lo:[1,0,0] neg_hi:[1,0,0]
    v_pk_fma_f32 v[46:47], v[220:221], v[196:197], v[46:47] op_sel:[0,1,0] op_sel_hi:[1,1,1] neg_lo:[1,0,0] neg_hi:[1,0,0]
    v_pk_fma_f32 v[156:157], v[40:41], s[62:63], v[232:233] op_sel_hi:[1,1,0]
    v_pk_fma_f32 v[158:159], v[42:43], s[62:63], v[232:233] op_sel_hi:[1,1,0]
    v_pk_fma_f32 v[160:161], v[44:45], s[62:63], v[232:233] op_sel_hi:[1,1,0]
    v_pk_fma_f32 v[162:163], v[46:47], s[62:63], v[232:233] op_sel_hi:[1,1,0]
    v_exp_f32_e64 v156, v156 clamp
    v_exp_f32_e64 v157, v157 clamp
    v_exp_f32_e64 v158, v158 clamp
    v_exp_f32_e64 v159, v159 clamp
    v_exp_f32_e64 v160, v160 clamp
    v_exp_f32_e64 v161, v161 clamp
    v_exp_f32_e64 v162, v162 clamp
    v_exp_f32_e64 v163, v163 clamp
    v_max_f32 v40, s64, v40
    v_max_f32 v41, s64, v41
    v_max_f32 v42, s64, v42
    v_max_f32 v43, s64, v43
    v_max_f32 v44, s64, v44
    v_max_f32 v45, s64, v45
    v_max_f32 v46, s64, v46
    v_max_f32 v47, s64, v47
    v_pk_add_f32 v[40:41], v[40:41], v[156:157]
    v_pk_add_f32 v[42:43], v[42:43], v[158:159]
    v_pk_add_f32 v[44:45], v[44:45], v[160:161]
    v_pk_add_f32 v[46:47], v[46:47], v[162:163]
    v_cvt_pk_bf16_f32 v124, v40, v41
    v_cvt_pk_bf16_f32 v125, v42, v43
    v_cvt_pk_bf16_f32 v126, v44, v45
    v_cvt_pk_bf16_f32 v127, v46, v47
    buffer_store_dwordx4 v[124:127], v12, s[12:15], s42 offen offset:1024 sc1
    v_pk_fma_f32 v[48:49], v[48:49], v[206:207], s[64:65]
    v_pk_fma_f32 v[50:51], v[50:51], v[208:209], s[64:65]
    v_pk_fma_f32 v[52:53], v[52:53], v[210:211], s[64:65]
    v_pk_fma_f32 v[54:55], v[54:55], v[212:213], s[64:65]
    v_pk_fma_f32 v[48:49], v[214:215], v[198:199], v[48:49] op_sel:[0,0,0] op_sel_hi:[1,0,1] neg_lo:[1,0,0] neg_hi:[1,0,0]
    v_pk_fma_f32 v[50:51], v[216:217], v[198:199], v[50:51] op_sel:[0,0,0] op_sel_hi:[1,0,1] neg_lo:[1,0,0] neg_hi:[1,0,0]
    v_pk_fma_f32 v[52:53], v[218:219], v[198:199], v[52:53] op_sel:[0,0,0] op_sel_hi:[1,0,1] neg_lo:[1,0,0] neg_hi:[1,0,0]
    v_pk_fma_f32 v[54:55], v[220:221], v[198:199], v[54:55] op_sel:[0,0,0] op_sel_hi:[1,0,1] neg_lo:[1,0,0] neg_hi:[1,0,0]
    v_pk_fma_f32 v[156:157], v[48:49], s[62:63], v[232:233] op_sel_hi:[1,1,0]
    v_pk_fma_f32 v[158:159], v[50:51], s[62:63], v[232:233] op_sel_hi:[1,1,0]
    v_pk_fma_f32 v[160:161], v[52:53], s[62:63], v[232:233] op_sel_hi:[1,1,0]
    v_pk_fma_f32 v[162:163], v[54:55], s[62:63], v[232:233] op_sel_hi:[1,1,0]
    v_exp_f32_e64 v156, v156 clamp
    v_exp_f32_e64 v157, v157 clamp
    v_exp_f32_e64 v158, v158 clamp
    v_exp_f32_e64 v159, v159 clamp
    v_exp_f32_e64 v160, v160 clamp
    v_exp_f32_e64 v161, v161 clamp
    v_exp_f32_e64 v162, v162 clamp
    v_exp_f32_e64 v163, v163 clamp
    v_max_f32 v48, s64, v48
    v_max_f32 v49, s64, v49
    v_max_f32 v50, s64, v50
    v_max_f32 v51, s64, v51
    v_max_f32 v52, s64, v52
    v_max_f32 v53, s64, v53
    v_max_f32 v54, s64, v54
    v_max_f32 v55, s64, v55
    v_pk_add_f32 v[48:49], v[48:49], v[156:157]
    v_pk_add_f32 v[50:51], v[50:51], v[158:159]
    v_pk_add_f32 v[52:53], v[52:53], v[160:161]
    v_pk_add_f32 v[54:55], v[54:55], v[162:163]
    v_cvt_pk_bf16_f32 v128, v48, v49
    v_cvt_pk_bf16_f32 v129, v50, v51
    v_cvt_pk_bf16_f32 v130, v52, v53
    v_cvt_pk_bf16_f32 v131, v54, v55
    buffer_store_dwordx4 v[128:131], v12, s[12:15], s42 offen offset:2048 sc1
    v_pk_fma_f32 v[56:57], v[56:57], v[206:207], s[64:65]
    v_pk_fma_f32 v[58:59], v[58:59], v[208:209], s[64:65]
    v_pk_fma_f32 v[60:61], v[60:61], v[210:211], s[64:65]
    v_pk_fma_f32 v[62:63], v[62:63], v[212:213], s[64:65]
    v_pk_fma_f32 v[56:57], v[214:215], v[198:199], v[56:57] op_sel:[0,1,0] op_sel_hi:[1,1,1] neg_lo:[1,0,0] neg_hi:[1,0,0]
    v_pk_fma_f32 v[58:59], v[216:217], v[198:199], v[58:59] op_sel:[0,1,0] op_sel_hi:[1,1,1] neg_lo:[1,0,0] neg_hi:[1,0,0]
    v_pk_fma_f32 v[60:61], v[218:219], v[198:199], v[60:61] op_sel:[0,1,0] op_sel_hi:[1,1,1] neg_lo:[1,0,0] neg_hi:[1,0,0]
    v_pk_fma_f32 v[62:63], v[220:221], v[198:199], v[62:63] op_sel:[0,1,0] op_sel_hi:[1,1,1] neg_lo:[1,0,0] neg_hi:[1,0,0]
    v_pk_fma_f32 v[156:157], v[56:57], s[62:63], v[232:233] op_sel_hi:[1,1,0]
    v_pk_fma_f32 v[158:159], v[58:59], s[62:63], v[232:233] op_sel_hi:[1,1,0]
    v_pk_fma_f32 v[160:161], v[60:61], s[62:63], v[232:233] op_sel_hi:[1,1,0]
    v_pk_fma_f32 v[162:163], v[62:63], s[62:63], v[232:233] op_sel_hi:[1,1,0]
    v_exp_f32_e64 v156, v156 clamp
    v_exp_f32_e64 v157, v157 clamp
    v_exp_f32_e64 v158, v158 clamp
    v_exp_f32_e64 v159, v159 clamp
    v_exp_f32_e64 v160, v160 clamp
    v_exp_f32_e64 v161, v161 clamp
    v_exp_f32_e64 v162, v162 clamp
    v_exp_f32_e64 v163, v163 clamp
    v_max_f32 v56, s64, v56
    v_max_f32 v57, s64, v57
    v_max_f32 v58, s64, v58
    v_max_f32 v59, s64, v59
    v_max_f32 v60, s64, v60
    v_max_f32 v61, s64, v61
    v_max_f32 v62, s64, v62
    v_max_f32 v63, s64, v63
    v_pk_add_f32 v[56:57], v[56:57], v[156:157]
    v_pk_add_f32 v[58:59], v[58:59], v[158:159]
    v_pk_add_f32 v[60:61], v[60:61], v[160:161]
    v_pk_add_f32 v[62:63], v[62:63], v[162:163]
    v_cvt_pk_bf16_f32 v132, v56, v57
    v_cvt_pk_bf16_f32 v133, v58, v59
    v_cvt_pk_bf16_f32 v134, v60, v61
    v_cvt_pk_bf16_f32 v135, v62, v63
    buffer_store_dwordx4 v[132:135], v12, s[12:15], s42 offen offset:3072 sc1
    v_pk_fma_f32 v[64:65], v[64:65], v[206:207], s[64:65]
    v_pk_fma_f32 v[66:67], v[66:67], v[208:209], s[64:65]
    v_pk_fma_f32 v[68:69], v[68:69], v[210:211], s[64:65]
    v_pk_fma_f32 v[70:71], v[70:71], v[212:213], s[64:65]
    v_pk_fma_f32 v[64:65], v[214:215], v[200:201], v[64:65] op_sel:[0,0,0] op_sel_hi:[1,0,1] neg_lo:[1,0,0] neg_hi:[1,0,0]
    v_pk_fma_f32 v[66:67], v[216:217], v[200:201], v[66:67] op_sel:[0,0,0] op_sel_hi:[1,0,1] neg_lo:[1,0,0] neg_hi:[1,0,0]
    v_pk_fma_f32 v[68:69], v[218:219], v[200:201], v[68:69] op_sel:[0,0,0] op_sel_hi:[1,0,1] neg_lo:[1,0,0] neg_hi:[1,0,0]
    v_pk_fma_f32 v[70:71], v[220:221], v[200:201], v[70:71] op_sel:[0,0,0] op_sel_hi:[1,0,1] neg_lo:[1,0,0] neg_hi:[1,0,0]
    v_pk_fma_f32 v[156:157], v[64:65], s[62:63], v[232:233] op_sel_hi:[1,1,0]
    v_pk_fma_f32 v[158:159], v[66:67], s[62:63], v[232:233] op_sel_hi:[1,1,0]
    v_pk_fma_f32 v[160:161], v[68:69], s[62:63], v[232:233] op_sel_hi:[1,1,0]
    v_pk_fma_f32 v[162:163], v[70:71], s[62:63], v[232:233] op_sel_hi:[1,1,0]
    v_exp_f32_e64 v156, v156 clamp
    v_exp_f32_e64 v157, v157 clamp
    v_exp_f32_e64 v158, v158 clamp
    v_exp_f32_e64 v159, v159 clamp
    v_exp_f32_e64 v160, v160 clamp
    v_exp_f32_e64 v161, v161 clamp
    v_exp_f32_e64 v162, v162 clamp
    v_exp_f32_e64 v163, v163 clamp
    v_max_f32 v64, s64, v64
    v_max_f32 v65, s64, v65
    v_max_f32 v66, s64, v66
    v_max_f32 v67, s64, v67
    v_max_f32 v68, s64, v68
    v_max_f32 v69, s64, v69
    v_max_f32 v70, s64, v70
    v_max_f32 v71, s64, v71
    v_pk_add_f32 v[64:65], v[64:65], v[156:157]
    v_pk_add_f32 v[66:67], v[66:67], v[158:159]
    v_pk_add_f32 v[68:69], v[68:69], v[160:161]
    v_pk_add_f32 v[70:71], v[70:71], v[162:163]
    v_cvt_pk_bf16_f32 v136, v64, v65
    v_cvt_pk_bf16_f32 v137, v66, v67
    v_cvt_pk_bf16_f32 v138, v68, v69
    v_cvt_pk_bf16_f32 v139, v70, v71
    buffer_store_dwordx4 v[136:139], v12, s[12:15], s43 offen offset:0 sc1
    v_pk_fma_f32 v[72:73], v[72:73], v[206:207], s[64:65]
    v_pk_fma_f32 v[74:75], v[74:75], v[208:209], s[64:65]
    v_pk_fma_f32 v[76:77], v[76:77], v[210:211], s[64:65]
    v_pk_fma_f32 v[78:79], v[78:79], v[212:213], s[64:65]
    v_pk_fma_f32 v[72:73], v[214:215], v[200:201], v[72:73] op_sel:[0,1,0] op_sel_hi:[1,1,1] neg_lo:[1,0,0] neg_hi:[1,0,0]
    v_pk_fma_f32 v[74:75], v[216:217], v[200:201], v[74:75] op_sel:[0,1,0] op_sel_hi:[1,1,1] neg_lo:[1,0,0] neg_hi:[1,0,0]
    v_pk_fma_f32 v[76:77], v[218:219], v[200:201], v[76:77] op_sel:[0,1,0] op_sel_hi:[1,1,1] neg_lo:[1,0,0] neg_hi:[1,0,0]
    v_pk_fma_f32 v[78:79], v[220:221], v[200:201], v[78:79] op_sel:[0,1,0] op_sel_hi:[1,1,1] neg_lo:[1,0,0] neg_hi:[1,0,0]
    v_pk_fma_f32 v[156:157], v[72:73], s[62:63], v[232:233] op_sel_hi:[1,1,0]
    v_pk_fma_f32 v[158:159], v[74:75], s[62:63], v[232:233] op_sel_hi:[1,1,0]
    v_pk_fma_f32 v[160:161], v[76:77], s[62:63], v[232:233] op_sel_hi:[1,1,0]
    v_pk_fma_f32 v[162:163], v[78:79], s[62:63], v[232:233] op_sel_hi:[1,1,0]
    v_exp_f32_e64 v156, v156 clamp
    v_exp_f32_e64 v157, v157 clamp
    v_exp_f32_e64 v158, v158 clamp
    v_exp_f32_e64 v159, v159 clamp
    v_exp_f32_e64 v160, v160 clamp
    v_exp_f32_e64 v161, v161 clamp
    v_exp_f32_e64 v162, v162 clamp
    v_exp_f32_e64 v163, v163 clamp
    v_max_f32 v72, s64, v72
    v_max_f32 v73, s64, v73
    v_max_f32 v74, s64, v74
    v_max_f32 v75, s64, v75
    v_max_f32 v76, s64, v76
    v_max_f32 v77, s64, v77
    v_max_f32 v78, s64, v78
    v_max_f32 v79, s64, v79
    v_pk_add_f32 v[72:73], v[72:73], v[156:157]
    v_pk_add_f32 v[74:75], v[74:75], v[158:159]
    v_pk_add_f32 v[76:77], v[76:77], v[160:161]
    v_pk_add_f32 v[78:79], v[78:79], v[162:163]
    v_cvt_pk_bf16_f32 v140, v72, v73
    v_cvt_pk_bf16_f32 v141, v74, v75
    v_cvt_pk_bf16_f32 v142, v76, v77
    v_cvt_pk_bf16_f32 v143, v78, v79
    buffer_store_dwordx4 v[140:143], v12, s[12:15], s43 offen offset:1024 sc1
    v_pk_fma_f32 v[80:81], v[80:81], v[206:207], s[64:65]
    v_pk_fma_f32 v[82:83], v[82:83], v[208:209], s[64:65]
    v_pk_fma_f32 v[84:85], v[84:85], v[210:211], s[64:65]
    v_pk_fma_f32 v[86:87], v[86:87], v[212:213], s[64:65]
    v_pk_fma_f32 v[80:81], v[214:215], v[202:203], v[80:81] op_sel:[0,0,0] op_sel_hi:[1,0,1] neg_lo:[1,0,0] neg_hi:[1,0,0]
    v_pk_fma_f32 v[82:83], v[216:217], v[202:203], v[82:83] op_sel:[0,0,0] op_sel_hi:[1,0,1] neg_lo:[1,0,0] neg_hi:[1,0,0]
    v_pk_fma_f32 v[84:85], v[218:219], v[202:203], v[84:85] op_sel:[0,0,0] op_sel_hi:[1,0,1] neg_lo:[1,0,0] neg_hi:[1,0,0]
    v_pk_fma_f32 v[86:87], v[220:221], v[202:203], v[86:87] op_sel:[0,0,0] op_sel_hi:[1,0,1] neg_lo:[1,0,0] neg_hi:[1,0,0]
    v_pk_fma_f32 v[156:157], v[80:81], s[62:63], v[232:233] op_sel_hi:[1,1,0]
    v_pk_fma_f32 v[158:159], v[82:83], s[62:63], v[232:233] op_sel_hi:[1,1,0]
    v_pk_fma_f32 v[160:161], v[84:85], s[62:63], v[232:233] op_sel_hi:[1,1,0]
    v_pk_fma_f32 v[162:163], v[86:87], s[62:63], v[232:233] op_sel_hi:[1,1,0]
    v_exp_f32_e64 v156, v156 clamp
    v_exp_f32_e64 v157, v157 clamp
    v_exp_f32_e64 v158, v158 clamp
    v_exp_f32_e64 v159, v159 clamp
    v_exp_f32_e64 v160, v160 clamp
    v_exp_f32_e64 v161, v161 clamp
    v_exp_f32_e64 v162, v162 clamp
    v_exp_f32_e64 v163, v163 clamp
    v_max_f32 v80, s64, v80
    v_max_f32 v81, s64, v81
    v_max_f32 v82, s64, v82
    v_max_f32 v83, s64, v83
    v_max_f32 v84, s64, v84
    v_max_f32 v85, s64, v85
    v_max_f32 v86, s64, v86
    v_max_f32 v87, s64, v87
    v_pk_add_f32 v[80:81], v[80:81], v[156:157]
    v_pk_add_f32 v[82:83], v[82:83], v[158:159]
    v_pk_add_f32 v[84:85], v[84:85], v[160:161]
    v_pk_add_f32 v[86:87], v[86:87], v[162:163]
    v_cvt_pk_bf16_f32 v144, v80, v81
    v_cvt_pk_bf16_f32 v145, v82, v83
    v_cvt_pk_bf16_f32 v146, v84, v85
    v_cvt_pk_bf16_f32 v147, v86, v87
    buffer_store_dwordx4 v[144:147], v12, s[12:15], s43 offen offset:2048 sc1
    v_pk_fma_f32 v[88:89], v[88:89], v[206:207], s[64:65]
    v_pk_fma_f32 v[90:91], v[90:91], v[208:209], s[64:65]
    v_pk_fma_f32 v[92:93], v[92:93], v[210:211], s[64:65]
    v_pk_fma_f32 v[94:95], v[94:95], v[212:213], s[64:65]
    v_pk_fma_f32 v[88:89], v[214:215], v[202:203], v[88:89] op_sel:[0,1,0] op_sel_hi:[1,1,1] neg_lo:[1,0,0] neg_hi:[1,0,0]
    v_pk_fma_f32 v[90:91], v[216:217], v[202:203], v[90:91] op_sel:[0,1,0] op_sel_hi:[1,1,1] neg_lo:[1,0,0] neg_hi:[1,0,0]
    v_pk_fma_f32 v[92:93], v[218:219], v[202:203], v[92:93] op_sel:[0,1,0] op_sel_hi:[1,1,1] neg_lo:[1,0,0] neg_hi:[1,0,0]
    v_pk_fma_f32 v[94:95], v[220:221], v[202:203], v[94:95] op_sel:[0,1,0] op_sel_hi:[1,1,1] neg_lo:[1,0,0] neg_hi:[1,0,0]
    v_pk_fma_f32 v[156:157], v[88:89], s[62:63], v[232:233] op_sel_hi:[1,1,0]
    v_pk_fma_f32 v[158:159], v[90:91], s[62:63], v[232:233] op_sel_hi:[1,1,0]
    v_pk_fma_f32 v[160:161], v[92:93], s[62:63], v[232:233] op_sel_hi:[1,1,0]
    v_pk_fma_f32 v[162:163], v[94:95], s[62:63], v[232:233] op_sel_hi:[1,1,0]
    v_exp_f32_e64 v156, v156 clamp
    v_exp_f32_e64 v157, v157 clamp
    v_exp_f32_e64 v158, v158 clamp
    v_exp_f32_e64 v159, v159 clamp
    v_exp_f32_e64 v160, v160 clamp
    v_exp_f32_e64 v161, v161 clamp
    v_exp_f32_e64 v162, v162 clamp
    v_exp_f32_e64 v163, v163 clamp
    v_max_f32 v88, s64, v88
    v_max_f32 v89, s64, v89
    v_max_f32 v90, s64, v90
    v_max_f32 v91, s64, v91
    v_max_f32 v92, s64, v92
    v_max_f32 v93, s64, v93
    v_max_f32 v94, s64, v94
    v_max_f32 v95, s64, v95
    v_pk_add_f32 v[88:89], v[88:89], v[156:157]
    v_pk_add_f32 v[90:91], v[90:91], v[158:159]
    v_pk_add_f32 v[92:93], v[92:93], v[160:161]
    v_pk_add_f32 v[94:95], v[94:95], v[162:163]
    v_cvt_pk_bf16_f32 v148, v88, v89
    v_cvt_pk_bf16_f32 v149, v90, v91
    v_cvt_pk_bf16_f32 v150, v92, v93
    v_cvt_pk_bf16_f32 v151, v94, v95
    buffer_store_dwordx4 v[148:151], v12, s[12:15], s43 offen offset:3072 sc1
    v_pk_fma_f32 v[96:97], v[96:97], v[206:207], s[64:65]
    v_pk_fma_f32 v[98:99], v[98:99], v[208:209], s[64:65]
    v_pk_fma_f32 v[100:101], v[100:101], v[210:211], s[64:65]
    v_pk_fma_f32 v[102:103], v[102:103], v[212:213], s[64:65]
    v_pk_fma_f32 v[96:97], v[214:215], v[204:205], v[96:97] op_sel:[0,0,0] op_sel_hi:[1,0,1] neg_lo:[1,0,0] neg_hi:[1,0,0]
    v_pk_fma_f32 v[98:99], v[216:217], v[204:205], v[98:99] op_sel:[0,0,0] op_sel_hi:[1,0,1] neg_lo:[1,0,0] neg_hi:[1,0,0]
    v_pk_fma_f32 v[100:101], v[218:219], v[204:205], v[100:101] op_sel:[0,0,0] op_sel_hi:[1,0,1] neg_lo:[1,0,0] neg_hi:[1,0,0]
    v_pk_fma_f32 v[102:103], v[220:221], v[204:205], v[102:103] op_sel:[0,0,0] op_sel_hi:[1,0,1] neg_lo:[1,0,0] neg_hi:[1,0,0]
    v_pk_fma_f32 v[156:157], v[96:97], s[62:63], v[232:233] op_sel_hi:[1,1,0]
    v_pk_fma_f32 v[158:159], v[98:99], s[62:63], v[232:233] op_sel_hi:[1,1,0]
    v_pk_fma_f32 v[160:161], v[100:101], s[62:63], v[232:233] op_sel_hi:[1,1,0]
    v_pk_fma_f32 v[162:163], v[102:103], s[62:63], v[232:233] op_sel_hi:[1,1,0]
    v_exp_f32_e64 v156, v156 clamp
    v_exp_f32_e64 v157, v157 clamp
    v_exp_f32_e64 v158, v158 clamp
    v_exp_f32_e64 v159, v159 clamp
    v_exp_f32_e64 v160, v160 clamp
    v_exp_f32_e64 v161, v161 clamp
    v_exp_f32_e64 v162, v162 clamp
    v_exp_f32_e64 v163, v163 clamp
    v_max_f32 v96, s64, v96
    v_max_f32 v97, s64, v97
    v_max_f32 v98, s64, v98
    v_max_f32 v99, s64, v99
    v_max_f32 v100, s64, v100
    v_max_f32 v101, s64, v101
    v_max_f32 v102, s64, v102
    v_max_f32 v103, s64, v103
    v_pk_add_f32 v[96:97], v[96:97], v[156:157]
    v_pk_add_f32 v[98:99], v[98:99], v[158:159]
    v_pk_add_f32 v[100:101], v[100:101], v[160:161]
    v_pk_add_f32 v[102:103], v[102:103], v[162:163]
    v_cvt_pk_bf16_f32 v152, v96, v97
    v_cvt_pk_bf16_f32 v153, v98, v99
    v_cvt_pk_bf16_f32 v154, v100, v101
    v_cvt_pk_bf16_f32 v155, v102, v103
    buffer_store_dwordx4 v[152:155], v12, s[12:15], s44 offen offset:0 sc1
    s_add_u32 s2, s2, 192
    s_and_b32 s2, s2, 255
    s_branch Lk2_entry
Lk1_typea34:
    v_pk_fma_f32 v[32:33], v[32:33], v[206:207], s[64:65]
    v_pk_fma_f32 v[34:35], v[34:35], v[208:209], s[64:65]
    v_pk_fma_f32 v[36:37], v[36:37], v[210:211], s[64:65]
    v_pk_fma_f32 v[38:39], v[38:39], v[212:213], s[64:65]
    v_pk_fma_f32 v[32:33], v[214:215], v[196:197], v[32:33] op_sel:[0,0,0] op_sel_hi:[1,0,1] neg_lo:[1,0,0] neg_hi:[1,0,0]
    v_pk_fma_f32 v[34:35], v[216:217], v[196:197], v[34:35] op_sel:[0,0,0] op_sel_hi:[1,0,1] neg_lo:[1,0,0] neg_hi:[1,0,0]
    v_pk_fma_f32 v[36:37], v[218:219], v[196:197], v[36:37] op_sel:[0,0,0] op_sel_hi:[1,0,1] neg_lo:[1,0,0] neg_hi:[1,0,0]
    v_pk_fma_f32 v[38:39], v[220:221], v[196:197], v[38:39] op_sel:[0,0,0] op_sel_hi:[1,0,1] neg_lo:[1,0,0] neg_hi:[1,0,0]
    v_pk_fma_f32 v[156:157], v[32:33], s[62:63], v[232:233] op_sel_hi:[1,1,0]
    v_pk_fma_f32 v[158:159], v[34:35], s[62:63], v[232:233] op_sel_hi:[1,1,0]
    v_pk_fma_f32 v[160:161], v[36:37], s[62:63], v[232:233] op_sel_hi:[1,1,0]
    v_pk_fma_f32 v[162:163], v[38:39], s[62:63], v[232:233] op_sel_hi:[1,1,0]
    v_exp_f32_e64 v156, v156 clamp
    v_exp_f32_e64 v157, v157 clamp
    v_exp_f32_e64 v158, v158 clamp
    v_exp_f32_e64 v159, v159 clamp
    v_exp_f32_e64 v160, v160 clamp
    v_exp_f32_e64 v161, v161 clamp
    v_exp_f32_e64 v162, v162 clamp
    v_exp_f32_e64 v163, v163 clamp
    v_max_f32 v32, s64, v32
    v_max_f32 v33, s64, v33
    v_max_f32 v34, s64, v34
    v_max_f32 v35, s64, v35
    v_max_f32 v36, s64, v36
    v_max_f32 v37, s64, v37
    v_max_f32 v38, s64, v38
    v_max_f32 v39, s64, v39
    v_pk_add_f32 v[32:33], v[32:33], v[156:157]
    v_pk_add_f32 v[34:35], v[34:35], v[158:159]
    v_pk_add_f32 v[36:37], v[36:37], v[160:161]
    v_pk_add_f32 v[38:39], v[38:39], v[162:163]
    v_cvt_pk_bf16_f32 v120, v32, v33
    v_cvt_pk_bf16_f32 v121, v34, v35
    v_cvt_pk_bf16_f32 v122, v36, v37
    v_cvt_pk_bf16_f32 v123, v38, v39
    ds_write_b128 v13, v[120:123] offset:0
    v_pk_fma_f32 v[40:41], v[40:41], v[206:207], s[64:65]
    v_pk_fma_f32 v[42:43], v[42:43], v[208:209], s[64:65]
    v_pk_fma_f32 v[44:45], v[44:45], v[210:211], s[64:65]
    v_pk_fma_f32 v[46:47], v[46:47], v[212:213], s[64:65]
    v_pk_fma_f32 v[40:41], v[214:215], v[196:197], v[40:41] op_sel:[0,1,0] op_sel_hi:[1,1,1] neg_lo:[1,0,0] neg_hi:[1,0,0]
    v_pk_fma_f32 v[42:43], v[216:217], v[196:197], v[42:43] op_sel:[0,1,0] op_sel_hi:[1,1,1] neg_lo:[1,0,0] neg_hi:[1,0,0]
    v_pk_fma_f32 v[44:45], v[218:219], v[196:197], v[44:45] op_sel:[0,1,0] op_sel_hi:[1,1,1] neg_lo:[1,0,0] neg_hi:[1,0,0]
    v_pk_fma_f32 v[46:47], v[220:221], v[196:197], v[46:47] op_sel:[0,1,0] op_sel_hi:[1,1,1] neg_lo:[1,0,0] neg_hi:[1,0,0]
    v_pk_fma_f32 v[156:157], v[40:41], s[62:63], v[232:233] op_sel_hi:[1,1,0]
    v_pk_fma_f32 v[158:159], v[42:43], s[62:63], v[232:233] op_sel_hi:[1,1,0]
    v_pk_fma_f32 v[160:161], v[44:45], s[62:63], v[232:233] op_sel_hi:[1,1,0]
    v_pk_fma_f32 v[162:163], v[46:47], s[62:63], v[232:233] op_sel_hi:[1,1,0]
    v_exp_f32_e64 v156, v156 clamp
    v_exp_f32_e64 v157, v157 clamp
    v_exp_f32_e64 v158, v158 clamp
    v_exp_f32_e64 v159, v159 clamp
    v_exp_f32_e64 v160, v160 clamp
    v_exp_f32_e64 v161, v161 clamp
    v_exp_f32_e64 v162, v162 clamp
    v_exp_f32_e64 v163, v163 clamp
    v_max_f32 v40, s64, v40
    v_max_f32 v41, s64, v41
    v_max_f32 v42, s64, v42
    v_max_f32 v43, s64, v43
    v_max_f32 v44, s64, v44
    v_max_f32 v45, s64, v45
    v_max_f32 v46, s64, v46
    v_max_f32 v47, s64, v47
    v_pk_add_f32 v[40:41], v[40:41], v[156:157]
    v_pk_add_f32 v[42:43], v[42:43], v[158:159]
    v_pk_add_f32 v[44:45], v[44:45], v[160:161]
    v_pk_add_f32 v[46:47], v[46:47], v[162:163]
    v_cvt_pk_bf16_f32 v124, v40, v41
    v_cvt_pk_bf16_f32 v125, v42, v43
    v_cvt_pk_bf16_f32 v126, v44, v45
    v_cvt_pk_bf16_f32 v127, v46, v47
    ds_write_b128 v13, v[124:127] offset:1024
    v_pk_fma_f32 v[48:49], v[48:49], v[206:207], s[64:65]
    v_pk_fma_f32 v[50:51], v[50:51], v[208:209], s[64:65]
    v_pk_fma_f32 v[52:53], v[52:53], v[210:211], s[64:65]
    v_pk_fma_f32 v[54:55], v[54:55], v[212:213], s[64:65]
    v_pk_fma_f32 v[48:49], v[214:215], v[198:199], v[48:49] op_sel:[0,0,0] op_sel_hi:[1,0,1] neg_lo:[1,0,0] neg_hi:[1,0,0]
    v_pk_fma_f32 v[50:51], v[216:217], v[198:199], v[50:51] op_sel:[0,0,0] op_sel_hi:[1,0,1] neg_lo:[1,0,0] neg_hi:[1,0,0]
    v_pk_fma_f32 v[52:53], v[218:219], v[198:199], v[52:53] op_sel:[0,0,0] op_sel_hi:[1,0,1] neg_lo:[1,0,0] neg_hi:[1,0,0]
    v_pk_fma_f32 v[54:55], v[220:221], v[198:199], v[54:55] op_sel:[0,0,0] op_sel_hi:[1,0,1] neg_lo:[1,0,0] neg_hi:[1,0,0]
    v_pk_fma_f32 v[156:157], v[48:49], s[62:63], v[232:233] op_sel_hi:[1,1,0]
    v_pk_fma_f32 v[158:159], v[50:51], s[62:63], v[232:233] op_sel_hi:[1,1,0]
    v_pk_fma_f32 v[160:161], v[52:53], s[62:63], v[232:233] op_sel_hi:[1,1,0]
    v_pk_fma_f32 v[162:163], v[54:55], s[62:63], v[232:233] op_sel_hi:[1,1,0]
    v_exp_f32_e64 v156, v156 clamp
    v_exp_f32_e64 v157, v157 clamp
    v_exp_f32_e64 v158, v158 clamp
    v_exp_f32_e64 v159, v159 clamp
    v_exp_f32_e64 v160, v160 clamp
    v_exp_f32_e64 v161, v161 clamp
    v_exp_f32_e64 v162, v162 clamp
    v_exp_f32_e64 v163, v163 clamp
    v_max_f32 v48, s64, v48
    v_max_f32 v49, s64, v49
    v_max_f32 v50, s64, v50
    v_max_f32 v51, s64, v51
    v_max_f32 v52, s64, v52
    v_max_f32 v53, s64, v53
    v_max_f32 v54, s64, v54
    v_max_f32 v55, s64, v55
    v_pk_add_f32 v[48:49], v[48:49], v[156:157]
    v_pk_add_f32 v[50:51], v[50:51], v[158:159]
    v_pk_add_f32 v[52:53], v[52:53], v[160:161]
    v_pk_add_f32 v[54:55], v[54:55], v[162:163]
    v_cvt_pk_bf16_f32 v128, v48, v49
    v_cvt_pk_bf16_f32 v129, v50, v51
    v_cvt_pk_bf16_f32 v130, v52, v53
    v_cvt_pk_bf16_f32 v131, v54, v55
    ds_write_b128 v13, v[128:131] offset:2048
    v_pk_fma_f32 v[56:57], v[56:57], v[206:207], s[64:65]
    v_pk_fma_f32 v[58:59], v[58:59], v[208:209], s[64:65]
    v_pk_fma_f32 v[60:61], v[60:61], v[210:211], s[64:65]
    v_pk_fma_f32 v[62:63], v[62:63], v[212:213], s[64:65]
    v_pk_fma_f32 v[56:57], v[214:215], v[198:199], v[56:57] op_sel:[0,1,0] op_sel_hi:[1,1,1] neg_lo:[1,0,0] neg_hi:[1,0,0]
    v_pk_fma_f32 v[58:59], v[216:217], v[198:199], v[58:59] op_sel:[0,1,0] op_sel_hi:[1,1,1] neg_lo:[1,0,0] neg_hi:[1,0,0]
    v_pk_fma_f32 v[60:61], v[218:219], v[198:199], v[60:61] op_sel:[0,1,0] op_sel_hi:[1,1,1] neg_lo:[1,0,0] neg_hi:[1,0,0]
    v_pk_fma_f32 v[62:63], v[220:221], v[198:199], v[62:63] op_sel:[0,1,0] op_sel_hi:[1,1,1] neg_lo:[1,0,0] neg_hi:[1,0,0]
    v_pk_fma_f32 v[156:157], v[56:57], s[62:63], v[232:233] op_sel_hi:[1,1,0]
    v_pk_fma_f32 v[158:159], v[58:59], s[62:63], v[232:233] op_sel_hi:[1,1,0]
    v_pk_fma_f32 v[160:161], v[60:61], s[62:63], v[232:233] op_sel_hi:[1,1,0]
    v_pk_fma_f32 v[162:163], v[62:63], s[62:63], v[232:233] op_sel_hi:[1,1,0]
    v_exp_f32_e64 v156, v156 clamp
    v_exp_f32_e64 v157, v157 clamp
    v_exp_f32_e64 v158, v158 clamp
    v_exp_f32_e64 v159, v159 clamp
    v_exp_f32_e64 v160, v160 clamp
    v_exp_f32_e64 v161, v161 clamp
    v_exp_f32_e64 v162, v162 clamp
    v_exp_f32_e64 v163, v163 clamp
    v_max_f32 v56, s64, v56
    v_max_f32 v57, s64, v57
    v_max_f32 v58, s64, v58
    v_max_f32 v59, s64, v59
    v_max_f32 v60, s64, v60
    v_max_f32 v61, s64, v61
    v_max_f32 v62, s64, v62
    v_max_f32 v63, s64, v63
    v_pk_add_f32 v[56:57], v[56:57], v[156:157]
    v_pk_add_f32 v[58:59], v[58:59], v[158:159]
    v_pk_add_f32 v[60:61], v[60:61], v[160:161]
    v_pk_add_f32 v[62:63], v[62:63], v[162:163]
    v_cvt_pk_bf16_f32 v132, v56, v57
    v_cvt_pk_bf16_f32 v133, v58, v59
    v_cvt_pk_bf16_f32 v134, v60, v61
    v_cvt_pk_bf16_f32 v135, v62, v63
    ds_write_b128 v13, v[132:135] offset:3072
    v_pk_fma_f32 v[64:65], v[64:65], v[206:207], v[10:11] op_sel_hi:[1,1,0]
    v_pk_fma_f32 v[66:67], v[66:67], v[208:209], v[10:11] op_sel_hi:[1,1,0]
    v_pk_fma_f32 v[68:69], v[68:69], v[210:211], v[10:11] op_sel_hi:[1,1,0]
    v_pk_fma_f32 v[70:71], v[70:71], v[212:213], v[10:11] op_sel_hi:[1,1,0]
    v_pk_fma_f32 v[64:65], v[214:215], v[200:201], v[64:65] op_sel:[0,0,0] op_sel_hi:[1,0,1] neg_lo:[1,0,0] neg_hi:[1,0,0]
    v_pk_fma_f32 v[66:67], v[216:217], v[200:201], v[66:67] op_sel:[0,0,0] op_sel_hi:[1,0,1] neg_lo:[1,0,0] neg_hi:[1,0,0]
    v_pk_fma_f32 v[68:69], v[218:219], v[200:201], v[68:69] op_sel:[0,0,0] op_sel_hi:[1,0,1] neg_lo:[1,0,0] neg_hi:[1,0,0]
    v_pk_fma_f32 v[70:71], v[220:221], v[200:201], v[70:71] op_sel:[0,0,0] op_sel_hi:[1,0,1] neg_lo:[1,0,0] neg_hi:[1,0,0]
    v_pk_fma_f32 v[156:157], v[64:65], s[62:63], v[232:233] op_sel_hi:[1,1,0]
    v_pk_fma_f32 v[158:159], v[66:67], s[62:63], v[232:233] op_sel_hi:[1,1,0]
    v_pk_fma_f32 v[160:161], v[68:69], s[62:63], v[232:233] op_sel_hi:[1,1,0]
    v_pk_fma_f32 v[162:163], v[70:71], s[62:63], v[232:233] op_sel_hi:[1,1,0]
    v_exp_f32_e64 v156, v156 clamp
    v_exp_f32_e64 v157, v157 clamp
    v_exp_f32_e64 v158, v158 clamp
    v_exp_f32_e64 v159, v159 clamp
    v_exp_f32_e64 v160, v160 clamp
    v_exp_f32_e64 v161, v161 clamp
    v_exp_f32_e64 v162, v162 clamp
    v_exp_f32_e64 v163, v163 clamp
    v_max_f32 v164, s64, v64
    v_max_f32 v165, s64, v65
    v_max_f32 v166, s64, v66
    v_max_f32 v167, s64, v67
    v_max_f32 v168, s64, v68
    v_max_f32 v169, s64, v69
    v_max_f32 v170, s64, v70
    v_max_f32 v171, s64, v71
    v_pk_add_f32 v[156:157], v[164:165], v[156:157]
    v_pk_add_f32 v[158:159], v[166:167], v[158:159]
    v_pk_add_f32 v[160:161], v[168:169], v[160:161]
    v_pk_add_f32 v[162:163], v[170:171], v[162:163]
    v_cndmask_b32 v64, v64, v156, s[60:61]
    v_cndmask_b32 v65, v65, v157, s[60:61]
    v_cndmask_b32 v66, v66, v158, s[60:61]
    v_cndmask_b32 v67, v67, v159, s[60:61]
    v_cndmask_b32 v68, v68, v160, s[60:61]
    v_cndmask_b32 v69, v69, v161, s[60:61]
    v_cndmask_b32 v70, v70, v162, s[60:61]
    v_cndmask_b32 v71, v71, v163, s[60:61]
    v_cvt_pk_bf16_f32 v136, v64, v65
    v_cvt_pk_bf16_f32 v137, v66, v67
    v_cvt_pk_bf16_f32 v138, v68, v69
    v_cvt_pk_bf16_f32 v139, v70, v71
    ds_write_b128 v13, v[136:139] offset:4096
    v_pk_mul_f32 v[72:73], v[72:73], v[206:207]
    v_pk_mul_f32 v[74:75], v[74:75], v[208:209]
    v_pk_mul_f32 v[76:77], v[76:77], v[210:211]
    v_pk_mul_f32 v[78:79], v[78:79], v[212:213]
    v_pk_fma_f32 v[72:73], v[214:215], v[200:201], v[72:73] op_sel:[0,1,0] op_sel_hi:[1,1,1] neg_lo:[1,0,0] neg_hi:[1,0,0]
    v_pk_fma_f32 v[74:75], v[216:217], v[200:201], v[74:75] op_sel:[0,1,0] op_sel_hi:[1,1,1] neg_lo:[1,0,0] neg_hi:[1,0,0]
    v_pk_fma_f32 v[76:77], v[218:219], v[200:201], v[76:77] op_sel:[0,1,0] op_sel_hi:[1,1,1] neg_lo:[1,0,0] neg_hi:[1,0,0]
    v_pk_fma_f32 v[78:79], v[220:221], v[200:201], v[78:79] op_sel:[0,1,0] op_sel_hi:[1,1,1] neg_lo:[1,0,0] neg_hi:[1,0,0]
    v_cvt_pk_bf16_f32 v140, v72, v73
    v_cvt_pk_bf16_f32 v141, v74, v75
    v_cvt_pk_bf16_f32 v142, v76, v77
    v_cvt_pk_bf16_f32 v143, v78, v79
    ds_write_b128 v13, v[140:143] offset:5120
    v_pk_mul_f32 v[80:81], v[80:81], v[206:207]
    v_pk_mul_f32 v[82:83], v[82:83], v[208:209]
    v_pk_mul_f32 v[84:85], v[84:85], v[210:211]
    v_pk_mul_f32 v[86:87], v[86:87], v[212:213]
    v_pk_fma_f32 v[80:81], v[214:215], v[202:203], v[80:81] op_sel:[0,0,0] op_sel_hi:[1,0,1] neg_lo:[1,0,0] neg_hi:[1,0,0]
    v_pk_fma_f32 v[82:83], v[216:217], v[202:203], v[82:83] op_sel:[0,0,0] op_sel_hi:[1,0,1] neg_lo:[1,0,0] neg_hi:[1,0,0]
    v_pk_fma_f32 v[84:85], v[218:219], v[202:203], v[84:85] op_sel:[0,0,0] op_sel_hi:[1,0,1] neg_lo:[1,0,0] neg_hi:[1,0,0]
    v_pk_fma_f32 v[86:87], v[220:221], v[202:203], v[86:87] op_sel:[0,0,0] op_sel_hi:[1,0,1] neg_lo:[1,0,0] neg_hi:[1,0,0]
    v_cvt_pk_bf16_f32 v144, v80, v81
    v_cvt_pk_bf16_f32 v145, v82, v83
    v_cvt_pk_bf16_f32 v146, v84, v85
    v_cvt_pk_bf16_f32 v147, v86, v87
    ds_write_b128 v13, v[144:147] offset:6144
    v_pk_mul_f32 v[88:89], v[88:89], v[206:207]
    v_pk_mul_f32 v[90:91], v[90:91], v[208:209]
    v_pk_mul_f32 v[92:93], v[92:93], v[210:211]
    v_pk_mul_f32 v[94:95], v[94:95], v[212:213]
    v_pk_fma_f32 v[88:89], v[214:215], v[202:203], v[88:89] op_sel:[0,1,0] op_sel_hi:[1,1,1] neg_lo:[1,0,0] neg_hi:[1,0,0]
    v_pk_fma_f32 v[90:91], v[216:217], v[202:203], v[90:91] op_sel:[0,1,0] op_sel_hi:[1,1,1] neg_lo:[1,0,0] neg_hi:[1,0,0]
    v_pk_fma_f32 v[92:93], v[218:219], v[202:203], v[92:93] op_sel:[0,1,0] op_sel_hi:[1,1,1] neg_lo:[1,0,0] neg_hi:[1,0,0]
    v_pk_fma_f32 v[94:95], v[220:221], v[202:203], v[94:95] op_sel:[0,1,0] op_sel_hi:[1,1,1] neg_lo:[1,0,0] neg_hi:[1,0,0]
    v_cvt_pk_bf16_f32 v148, v88, v89
    v_cvt_pk_bf16_f32 v149, v90, v91
    v_cvt_pk_bf16_f32 v150, v92, v93
    v_cvt_pk_bf16_f32 v151, v94, v95
    ds_write_b128 v13, v[148:151] offset:7168
    v_pk_mul_f32 v[96:97], v[96:97], v[206:207]
    v_pk_mul_f32 v[98:99], v[98:99], v[208:209]
    v_pk_mul_f32 v[100:101], v[100:101], v[210:211]
    v_pk_mul_f32 v[102:103], v[102:103], v[212:213]
    v_pk_fma_f32 v[96:97], v[214:215], v[204:205], v[96:97] op_sel:[0,0,0] op_sel_hi:[1,0,1] neg_lo:[1,0,0] neg_hi:[1,0,0]
    v_pk_fma_f32 v[98:99], v[216:217], v[204:205], v[98:99] op_sel:[0,0,0] op_sel_hi:[1,0,1] neg_lo:[1,0,0] neg_hi:[1,0,0]
    v_pk_fma_f32 v[100:101], v[218:219], v[204:205], v[100:101] op_sel:[0,0,0] op_sel_hi:[1,0,1] neg_lo:[1,0,0] neg_hi:[1,0,0]
    v_pk_fma_f32 v[102:103], v[220:221], v[204:205], v[102:103] op_sel:[0,0,0] op_sel_hi:[1,0,1] neg_lo:[1,0,0] neg_hi:[1,0,0]
    v_cvt_pk_bf16_f32 v152, v96, v97
    v_cvt_pk_bf16_f32 v153, v98, v99
    v_cvt_pk_bf16_f32 v154, v100, v101
    v_cvt_pk_bf16_f32 v155, v102, v103
    ds_write_b128 v13, v[152:155] offset:8192
    s_waitcnt lgkmcnt(0)
    s_barrier
    ds_read_b128 v[32:35], v14 offset:0
    ds_read_b128 v[36:39], v14 offset:1024
    ds_read_b128 v[40:43], v14 offset:4096
    ds_read_b128 v[44:47], v14 offset:5120
    ds_read_b128 v[48:51], v14 offset:9216
    ds_read_b128 v[52:55], v14 offset:10240
    ds_read_b128 v[56:59], v14 offset:13312
    ds_read_b128 v[60:63], v14 offset:14336
    ds_read_b128 v[64:67], v14 offset:18432
    ds_read_b128 v[68:71], v14 offset:19456
    ds_read_b128 v[72:75], v14 offset:22528
    ds_read_b128 v[76:79], v14 offset:23552
    ds_read_b128 v[80:83], v14 offset:27648
    ds_read_b128 v[84:87], v14 offset:28672
    ds_read_b128 v[88:91], v14 offset:31744
    ds_read_b128 v[92:95], v14 offset:32768
    s_waitcnt lgkmcnt(12)
    v_mfma_f32_16x16x32_bf16 v[172:175], v[32:35], v[40:43], 0
    v_mfma_f32_16x16x32_bf16 v[176:179], v[32:35], v[44:47], 0
    v_mfma_f32_16x16x32_bf16 v[180:183], v[36:39], v[40:43], 0
    v_mfma_f32_16x16x32_bf16 v[184:187], v[36:39], v[44:47], 0
    v_mfma_f32_16x16x32_bf16 v[188:191], v[32:35], v[28:31], 0
    v_mfma_f32_16x16x32_bf16 v[192:195], v[36:39], v[28:31], 0
    s_waitcnt lgkmcnt(8)
    v_mfma_f32_16x16x32_bf16 v[172:175], v[48:51], v[56:59], v[172:175]
    v_mfma_f32_16x16x32_bf16 v[176:179], v[48:51], v[60:63], v[176:179]
    v_mfma_f32_16x16x32_bf16 v[180:183], v[52:55], v[56:59], v[180:183]
    v_mfma_f32_16x16x32_bf16 v[184:187], v[52:55], v[60:63], v[184:187]
    v_mfma_f32_16x16x32_bf16 v[188:191], v[48:51], v[28:31], v[188:191]
    v_mfma_f32_16x16x32_bf16 v[192:195], v[52:55], v[28:31], v[192:195]
    s_waitcnt lgkmcnt(4)
    v_mfma_f32_16x16x32_bf16 v[172:175], v[64:67], v[72:75], v[172:175]
    v_mfma_f32_16x16x32_bf16 v[176:179], v[64:67], v[76:79], v[176:179]
    v_mfma_f32_16x16x32_bf16 v[180:183], v[68:71], v[72:75], v[180:183]
    v_mfma_f32_16x16x32_bf16 v[184:187], v[68:71], v[76:79], v[184:187]
    v_mfma_f32_16x16x32_bf16 v[188:191], v[64:67], v[28:31], v[188:191]
    v_mfma_f32_16x16x32_bf16 v[192:195], v[68:71], v[28:31], v[192:195]
    s_waitcnt lgkmcnt(0)
    v_mfma_f32_16x16x32_bf16 v[172:175], v[80:83], v[88:91], v[172:175]
    v_mfma_f32_16x16x32_bf16 v[176:179], v[80:83], v[92:95], v[176:179]
    v_mfma_f32_16x16x32_bf16 v[180:183], v[84:87], v[88:91], v[180:183]
    v_mfma_f32_16x16x32_bf16 v[184:187], v[84:87], v[92:95], v[184:187]
    v_mfma_f32_16x16x32_bf16 v[188:191], v[80:83], v[28:31], v[188:191]
    v_mfma_f32_16x16x32_bf16 v[192:195], v[84:87], v[28:31], v[192:195]
    s_nop 3
    ds_write_b128 v15, v[172:175] offset:0
    ds_write_b128 v15, v[176:179] offset:2304
    ds_write_b128 v15, v[180:183] offset:64
    ds_write_b128 v15, v[184:187] offset:2368
    s_mov_b32 exec_lo, 0x00010001
    s_mov_b32 exec_hi, 0x00010001
    ds_write_b128 v11, v[188:191] offset:0
    ds_write_b128 v11, v[192:195] offset:64
    s_mov_b64 exec, -1
    ds_read_b32 v222, v16
    ds_read_b32 v223, v17
    ds_read_b32 v224, v18
    ds_read_b32 v225, v19
    ds_read_b32 v226, v20
    ds_read_b32 v227, v21
    s_waitcnt lgkmcnt(5)
    buffer_atomic_add_f32 v222, v22, s[20:23], s41 offen
    s_waitcnt lgkmcnt(4)
    buffer_atomic_add_f32 v223, v23, s[20:23], s41 offen
    s_waitcnt lgkmcnt(3)
    buffer_atomic_add_f32 v224, v24, s[20:23], s41 offen
    s_waitcnt lgkmcnt(2)
    buffer_atomic_add_f32 v225, v25, s[20:23], s41 offen
    s_waitcnt lgkmcnt(1)
    buffer_atomic_add_f32 v226, v26, s[20:23], s41 offen
    s_waitcnt lgkmcnt(0)
    buffer_atomic_add_f32 v227, v27, s[20:23], s41 offen
    s_add_u32 s2, s2, 192
    s_and_b32 s2, s2, 255
    s_branch Lk2_entry
Lk1_end4:
    s_endpgm
    .p2align 6
Lk2_entry:
    s_load_dwordx2 s[10:11], s[0:1], 80
    s_load_dwordx2 s[4:5], s[0:1], 0
    v_readfirstlane_b32 s3, v0
    v_and_b32 v1, 63, v0
    s_and_b32 s33, s2, 7
    s_lshr_b32 s34, s2, 3
    s_lshr_b32 s3, s3, 6
    s_cmp_ge_u32 s34, 24
    s_cbranch_scc1 Lk1_spare36
    s_mul_i32 s35, s34, 43
    s_lshr_b32 s35, s35, 7
    s_mul_i32 s36, s35, 3
    s_sub_u32 s34, s34, s36
    s_lshl_b32 s33, s33, 3
    s_add_u32 s33, s33, s35
    v_lshlrev_b32 v2, 4, v1
    s_mov_b32 s14, 1638400
    s_mov_b32 s15, 0x20000
    s_cmp_ge_u32 s3, 4
    s_cbranch_scc1 Lk1_gw37
    s_mul_i32 s35, s3, 12160
    s_mul_i32 s36, s33, 4
    s_add_u32 s36, s36, s3
    s_mul_i32 s36, s36, 9216
    s_lshl_b32 s37, s3, 14
    v_add_u32 v3, 4096, v2
    v_add_u32 v4, 8192, v2
    s_mov_b32 s18, 2359296
    s_mov_b32 s19, 0x20000
    s_waitcnt lgkmcnt(0)
    s_add_u32 s12, s10, 12582912
    s_addc_u32 s13, s11, 0
    s_add_u32 s16, s10, 4096
    s_addc_u32 s17, s11, 0
    s_and_b32 s56, s33, 0x3c
    s_add_u32 s56, s56, s3
    s_lshl_b32 s56, s56, 7
    s_add_u32 s56, s56, 1622016
    s_lshl_b32 s57, s3, 12
    s_add_u32 s57, s57, 1605632
    v_lshlrev_b32 v5, 7, v1
    s_cmp_eq_u32 s3, 0
    s_cselect_b32 s58, 0, 0x40000000
    v_mov_b32 v12, s58
    v_mov_b32 v13, 0
    s_mov_b32 s59, 0
    v_lshrrev_b32 v22, 4, v1
    v_and_b32 v23, 15, v1
    v_lshl_add_u32 v7, v1, 3, s37
    v_lshl_add_u32 v24, v22, 3, s37
    v_mad_u32_u24 v8, v23, 40, v24
    v_and_b32 v25, 3, v1
    v_min_u32 v26, 2, v25
    v_mad_u32_u24 v26, v26, 40, v24
    v_add_u32 v9, 640, v26
    v_bfe_u32 v26, v1, 2, 4
    v_lshl_add_u32 v27, v25, 4, s37
    v_add_u32 v27, 6144, v27
    v_lshl_add_u32 v10, v26, 6, v27
    v_cmp_gt_u32 vcc, 16, v1
    v_and_b32 v28, 1, v26
    v_or_b32 v28, 16, v28
    v_cndmask_b32 v28, v26, v28, vcc
    v_lshl_add_u32 v11, v28, 6, v27
    s_lshl_b32 s44, s3, 13
    s_add_u32 s44, s44, 110592
    v_add_u32 v15, s44, v2
    s_lshr_b32 s44, s3, 1
    s_lshl_b32 s44, s44, 11
    s_and_b32 s45, s3, 1
    s_lshl_b32 s45, s45, 3
    s_add_u32 s44, s44, s45
    s_add_u32 s44, s44, 143360
    v_add_u32 v16, s44, v2
    s_mov_b32 s55, 897988541
    v_mov_b32 v58, 0
    v_mov_b32 v59, 0
    v_mov_b32 v62, 0
    v_mov_b32 v63, 0
    v_mov_b32 v66, 0
    v_mov_b32 v67, 0
    v_mov_b32 v70, 0
    v_mov_b32 v71, 0
    v_mov_b32 v74, 0
    v_mov_b32 v75, 0
    v_mov_b32 v78, 0
    v_mov_b32 v79, 0
    v_mov_b32 v82, 0
    v_mov_b32 v83, 0
    v_mov_b32 v86, 0
    v_mov_b32 v87, 0
    v_mov_b32 v90, 0
    v_mov_b32 v91, 0
    v_mov_b32 v94, 0
    v_mov_b32 v95, 0
    v_mov_b32 v98, 0
    v_mov_b32 v99, 0
    v_mov_b32 v102, 0
    v_mov_b32 v103, 0
    v_mov_b32 v106, 0
    v_mov_b32 v107, 0
    v_mov_b32 v110, 0
    v_mov_b32 v111, 0
    v_mov_b32 v114, 0
    v_mov_b32 v115, 0
    v_mov_b32 v118, 0
    v_mov_b32 v119, 0
    s_mov_b64 exec, 1
    buffer_load_dword v6, v13, s[12:15], s56 offen sc1
    s_waitcnt vmcnt(0)
    s_barrier
    buffer_store_dword v13, v12, s[12:15], s69 offen sc1
    v_cmp_ne_u32 vcc, 0, v6
    s_cbranch_vccz Lk1_qg39
Lk1_qs38:
    buffer_load_dword v6, v13, s[12:15], s56 offen sc1
    s_add_u32 s59, s59, 1
    s_waitcnt vmcnt(0)
    v_cmp_ne_u32 vcc, 0, v6
    s_cmp_ge_u32 s59, 0x40000
    s_cbranch_scc1 Lk1_qg39
    s_cbranch_vccnz Lk1_qs38
Lk1_qg39:
    s_mov_b64 exec, -1
    s_add_u32 m0, s37, 6144
    s_nop 0
    buffer_load_dwordx4 v2, s[16:19], s36 offen offset:0 sc1 lds
    buffer_load_dwordx4 v2, s[16:19], s36 offen offset:1024 sc1 lds
    buffer_load_dwordx4 v2, s[16:19], s36 offen offset:2048 sc1 lds
    buffer_load_dwordx4 v2, s[16:19], s36 offen offset:3072 sc1 lds
    s_add_u32 m0, s37, 10240
    s_nop 0
    buffer_load_dwordx4 v3, s[16:19], s36 offen offset:0 sc1 lds
    buffer_load_dwordx4 v3, s[16:19], s36 offen offset:1024 sc1 lds
    buffer_load_dwordx4 v3, s[16:19], s36 offen offset:2048 sc1 lds
    buffer_load_dwordx4 v3, s[16:19], s36 offen offset:3072 sc1 lds
    s_add_u32 m0, s37, 14336
    s_nop 0
    buffer_load_dwordx4 v4, s[16:19], s36 offen offset:0 sc1 lds
    s_and_b32 s60, s33, 31
    s_lshl_b32 s60, s60, 7
    s_add_u32 s60, s60, s57
    s_mov_b64 exec, 1
Lk1_cs42:
    buffer_load_dword v6, v13, s[12:15], s60 offen sc0 sc1
    s_add_u32 s59, s59, 1
    s_waitcnt vmcnt(0)
    v_cmp_ne_u32 vcc, 0, v6
    s_cmp_ge_u32 s59, 0x40000
    s_cbranch_scc1 Lk1_cg43
    s_cbranch_vccnz Lk1_cs42
Lk1_cg43:
    s_mov_b32 exec_lo, -1
    s_mov_b32 exec_hi, 0
Lk1_as40:
    buffer_load_dword v6, v5, s[12:15], s57 offen sc0 sc1
    s_add_u32 s59, s59, 1
    s_waitcnt vmcnt(0)
    v_cmp_ne_u32 vcc, 0, v6
    s_cmp_ge_u32 s59, 0x40000
    s_cbranch_scc1 Lk1_ag41
    s_and_b64 exec, exec, vcc
    s_cbranch_scc1 Lk1_as40
Lk1_ag41:
    s_mov_b64 exec, -1
    buffer_load_dwordx4 v[120:123], v2, s[12:15], s35 offen offset:0 sc1
    buffer_load_dwordx4 v[124:127], v2, s[12:15], s35 offen offset:1024 sc1
    buffer_load_dwordx4 v[128:131], v2, s[12:15], s35 offen offset:2048 sc1
    buffer_load_dwordx4 v[132:135], v2, s[12:15], s35 offen offset:3072 sc1
    buffer_load_dwordx4 v[136:139], v3, s[12:15], s35 offen offset:0 sc1
    buffer_load_dwordx4 v[140:143], v3, s[12:15], s35 offen offset:1024 sc1
    s_barrier
    ds_read_b64_tr_b16 v[172:173], v10 offset:0
    ds_read_b64_tr_b16 v[174:175], v11 offset:0
    ds_read_b64_tr_b16 v[176:177], v10 offset:8
    ds_read_b64_tr_b16 v[178:179], v11 offset:8
    ds_read_b64_tr_b16 v[180:181], v10 offset:1152
    ds_read_b64_tr_b16 v[182:183], v11 offset:1152
    ds_read_b64_tr_b16 v[184:185], v10 offset:1160
    ds_read_b64_tr_b16 v[186:187], v11 offset:1160
    ds_read_b64_tr_b16 v[188:189], v10 offset:2304
    ds_read_b64_tr_b16 v[190:191], v11 offset:2304
    ds_read_b64_tr_b16 v[192:193], v10 offset:2312
    ds_read_b64_tr_b16 v[194:195], v11 offset:2312
    ds_read_b64_tr_b16 v[196:197], v10 offset:3456
    ds_read_b64_tr_b16 v[198:199], v11 offset:3456
    ds_read_b64_tr_b16 v[200:201], v10 offset:3464
    ds_read_b64_tr_b16 v[202:203], v11 offset:3464
    s_waitcnt vmcnt(5)
    v_cvt_pk_bf16_f32 v120, v120, v121
    v_cvt_pk_bf16_f32 v121, v122, v123
    ds_write_b64 v7, v[120:121] offset:0
    s_waitcnt vmcnt(4)
    v_cvt_pk_bf16_f32 v124, v124, v125
    v_cvt_pk_bf16_f32 v125, v126, v127
    ds_write_b64 v7, v[124:125] offset:512
    s_waitcnt vmcnt(3)
    v_cvt_pk_bf16_f32 v128, v128, v129
    v_cvt_pk_bf16_f32 v129, v130, v131
    ds_write_b64 v7, v[128:129] offset:1024
    ds_read_b64 v[56:57], v8 offset:0
    ds_read_b64 v[60:61], v9 offset:0
    s_mov_b64 exec, 0xffff
    ds_read_b64 v[58:59], v8 offset:32
    ds_read_b64 v[62:63], v9 offset:32
    s_mov_b64 exec, -1
    ds_read_b64 v[64:65], v8 offset:760
    ds_read_b64 v[68:69], v9 offset:760
    s_mov_b64 exec, 0xffff
    ds_read_b64 v[66:67], v8 offset:792
    ds_read_b64 v[70:71], v9 offset:792
    s_mov_b64 exec, -1
    s_waitcnt vmcnt(2)
    v_cvt_pk_bf16_f32 v132, v132, v133
    v_cvt_pk_bf16_f32 v133, v134, v135
    ds_write_b64 v7, v[132:133] offset:1536
    s_waitcnt vmcnt(1)
    v_cvt_pk_bf16_f32 v136, v136, v137
    v_cvt_pk_bf16_f32 v137, v138, v139
    ds_write_b64 v7, v[136:137] offset:2048
    s_waitcnt vmcnt(0)
    v_cvt_pk_bf16_f32 v140, v140, v141
    v_cvt_pk_bf16_f32 v141, v142, v143
    ds_write_b64 v7, v[140:141] offset:2560
    ds_read_b64 v[72:73], v8 offset:1520
    ds_read_b64 v[76:77], v9 offset:1520
    s_mov_b64 exec, 0xffff
    ds_read_b64 v[74:75], v8 offset:1552
    ds_read_b64 v[78:79], v9 offset:1552
    s_mov_b64 exec, -1
    ds_read_b64 v[80:81], v8 offset:2280
    ds_read_b64 v[84:85], v9 offset:2280
    s_mov_b64 exec, 0xffff
    ds_read_b64 v[82:83], v8 offset:2312
    ds_read_b64 v[86:87], v9 offset:2312
    s_mov_b64 exec, -1
    s_waitcnt lgkmcnt(15)
    v_mfma_f32_16x16x32_bf16 v[124:127], v[60:63], v[172:175], 0
    v_mfma_f32_16x16x32_bf16 v[120:123], v[56:59], v[172:175], 0
    v_mfma_f32_16x16x32_bf16 v[132:135], v[60:63], v[176:179], 0
    v_mfma_f32_16x16x32_bf16 v[128:131], v[56:59], v[176:179], 0
    s_waitcnt lgkmcnt(11)
    v_mfma_f32_16x16x32_bf16 v[140:143], v[68:71], v[180:183], 0
    v_mfma_f32_16x16x32_bf16 v[136:139], v[64:67], v[180:183], 0
    v_mfma_f32_16x16x32_bf16 v[148:151], v[68:71], v[184:187], 0
    v_mfma_f32_16x16x32_bf16 v[144:147], v[64:67], v[184:187], 0
    s_nop 4
    s_waitcnt lgkmcnt(4)
    v_mfma_f32_16x16x32_bf16 v[240:243], v[76:79], v[188:191], 0
    v_add_f32 v126, s55, v126
    v_add_f32 v134, s55, v134
    v_add_f32 v142, s55, v142
    v_add_f32 v150, s55, v150
    v_mfma_f32_16x16x32_bf16 v[236:239], v[72:75], v[188:191], 0
    v_rcp_f32 v126, v126
    v_rcp_f32 v134, v134
    v_mfma_f32_16x16x32_bf16 v[248:251], v[76:79], v[192:195], 0
    v_rcp_f32 v142, v142
    v_rcp_f32 v150, v150
    v_mfma_f32_16x16x32_bf16 v[244:247], v[72:75], v[192:195], 0
    v_mul_f32 v120, v120, v126
    v_mul_f32 v121, v121, v126
    v_mul_f32 v122, v122, v126
    s_waitcnt lgkmcnt(0)
    v_mfma_f32_16x16x32_bf16 v[32:35], v[84:87], v[196:199], 0
    v_mul_f32 v123, v123, v126
    v_mul_f32 v124, v124, v126
    v_mul_f32 v125, v125, v126
    v_mfma_f32_16x16x32_bf16 v[252:255], v[80:83], v[196:199], 0
    v_mul_f32 v128, v128, v134
    v_mul_f32 v129, v129, v134
    v_mul_f32 v130, v130, v134
    v_mfma_f32_16x16x32_bf16 v[40:43], v[84:87], v[200:203], 0
    v_mul_f32 v131, v131, v134
    v_mul_f32 v132, v132, v134
    v_mul_f32 v133, v133, v134
    v_mfma_f32_16x16x32_bf16 v[36:39], v[80:83], v[200:203], 0
    v_mul_f32 v136, v136, v142
    v_mul_f32 v137, v137, v142
    v_mul_f32 v138, v138, v142
    v_mul_f32 v139, v139, v142
    v_mul_f32 v140, v140, v142
    v_mul_f32 v141, v141, v142
    v_mul_f32 v144, v144, v150
    v_mul_f32 v145, v145, v150
    v_mul_f32 v146, v146, v150
    v_mul_f32 v147, v147, v150
    v_mul_f32 v148, v148, v150
    v_mul_f32 v149, v149, v150
    v_cvt_pk_bf16_f32 v124, v124, v125
    v_cvt_pk_bf16_f32 v132, v132, v133
    v_cvt_pk_bf16_f32 v140, v140, v141
    v_cvt_pk_bf16_f32 v148, v148, v149
    v_cvt_pk_bf16_f32 v152, v120, v121
    v_cvt_pk_bf16_f32 v153, v122, v123
    v_cvt_pk_bf16_f32 v156, v128, v129
    v_cvt_pk_bf16_f32 v157, v130, v131
    v_cvt_pk_bf16_f32 v154, v136, v137
    v_cvt_pk_bf16_f32 v155, v138, v139
    v_cvt_pk_bf16_f32 v158, v144, v145
    v_cvt_pk_bf16_f32 v159, v146, v147
    v_mov_b32_dpp v168, v124 quad_perm:[0,1,2,3] row_mask:1 bank_mask:0xf
    v_mov_b32_dpp v170, v132 quad_perm:[0,1,2,3] row_mask:1 bank_mask:0xf
    v_mov_b32_dpp v169, v140 quad_perm:[0,1,2,3] row_mask:1 bank_mask:0xf
    v_mov_b32_dpp v171, v148 quad_perm:[0,1,2,3] row_mask:1 bank_mask:0xf
    ds_write_b128 v15, v[152:155] offset:0
    ds_write_b128 v15, v[156:159] offset:1024
    s_nop 4
    v_add_f32 v242, s55, v242
    v_add_f32 v250, s55, v250
    v_add_f32 v34, s55, v34
    v_add_f32 v42, s55, v42
    v_rcp_f32 v242, v242
    v_rcp_f32 v250, v250
    v_rcp_f32 v34, v34
    v_rcp_f32 v42, v42
    v_mul_f32 v236, v236, v242
    v_mul_f32 v237, v237, v242
    v_mul_f32 v238, v238, v242
    v_mul_f32 v239, v239, v242
    v_mul_f32 v240, v240, v242
    v_mul_f32 v241, v241, v242
    v_mul_f32 v244, v244, v250
    v_mul_f32 v245, v245, v250
    v_mul_f32 v246, v246, v250
    v_mul_f32 v247, v247, v250
    v_mul_f32 v248, v248, v250
    v_mul_f32 v249, v249, v250
    v_mul_f32 v252, v252, v34
    v_mul_f32 v253, v253, v34
    v_mul_f32 v254, v254, v34
    v_mul_f32 v255, v255, v34
    v_mul_f32 v32, v32, v34
    v_mul_f32 v33, v33, v34
    v_mul_f32 v36, v36, v42
    v_mul_f32 v37, v37, v42
    v_mul_f32 v38, v38, v42
    v_mul_f32 v39, v39, v42
    v_mul_f32 v40, v40, v42
    v_mul_f32 v41, v41, v42
    v_cvt_pk_bf16_f32 v240, v240, v241
    v_cvt_pk_bf16_f32 v248, v248, v249
    v_cvt_pk_bf16_f32 v32, v32, v33
    v_cvt_pk_bf16_f32 v40, v40, v41
    v_cvt_pk_bf16_f32 v160, v236, v237
    v_cvt_pk_bf16_f32 v161, v238, v239
    v_cvt_pk_bf16_f32 v164, v244, v245
    v_cvt_pk_bf16_f32 v165, v246, v247
    v_cvt_pk_bf16_f32 v162, v252, v253
    v_cvt_pk_bf16_f32 v163, v254, v255
    v_cvt_pk_bf16_f32 v166, v36, v37
    v_cvt_pk_bf16_f32 v167, v38, v39
    v_mov_b32_dpp v168, v240 quad_perm:[0,1,2,3] row_mask:2 bank_mask:0xf
    v_mov_b32_dpp v170, v248 quad_perm:[0,1,2,3] row_mask:2 bank_mask:0xf
    v_mov_b32_dpp v169, v32 quad_perm:[0,1,2,3] row_mask:2 bank_mask:0xf
    v_mov_b32_dpp v171, v40 quad_perm:[0,1,2,3] row_mask:2 bank_mask:0xf
    ds_write_b128 v15, v[160:163] offset:2048
    ds_write_b128 v15, v[164:167] offset:3072
    s_mov_b32 exec_hi, 0
    ds_write_b64 v16, v[168:169] offset:0
    ds_write_b64 v16, v[170:171] offset:1024
    s_mov_b32 exec_hi, -1
    s_waitcnt lgkmcnt(0)
    s_barrier
    s_branch Lk3_entry
Lk1_gw37:
    s_and_b32 s3, s3, 3
    s_movk_i32 s38, 2731
    s_movk_i32 s39, 768
    s_mul_i32 s40, s33, 36864
    s_mul_i32 s41, s34, 384
    s_add_u32 s40, s40, s41
    s_mul_i32 s41, s3, 192
    s_mul_i32 s42, s3, 3072
    s_add_u32 s42, s42, 147456
    s_lshl_b32 s43, s34, 2
    s_add_u32 s43, s43, s3
    s_mul_i32 s43, s43, 55296
    s_add_u32 s43, s43, 262144
    s_mov_b32 m0, s42
    s_bitcmp1_b32 s68, 1
    s_cbranch_scc1 Lk1_hb44
    s_barrier
Lk1_hb44:
    v_add3_u32 v40, s41, v1, 0
    v_mul_u32_u24 v41, s38, v40
    v_lshrrev_b32 v41, 16, v41
    v_mul_u32_u24 v41, s39, v41
    v_lshl_add_u32 v52, v40, 4, v41
    v_add3_u32 v40, s41, v1, 64
    v_mul_u32_u24 v41, s38, v40
    v_lshrrev_b32 v41, 16, v41
    v_mul_u32_u24 v41, s39, v41
    v_lshl_add_u32 v53, v40, 4, v41
    v_subrev_u32 v53, 1024, v53
    v_add3_u32 v40, s41, v1, 64
    v_add_u32 v40, 64, v40
    v_mul_u32_u24 v41, s38, v40
    v_lshrrev_b32 v41, 16, v41
    v_mul_u32_u24 v41, s39, v41
    v_lshl_add_u32 v54, v40, 4, v41
    v_subrev_u32 v54, 2048, v54
    s_waitcnt lgkmcnt(0)
    s_add_u32 s12, s10, 12582912
    s_addc_u32 s13, s11, 0
    s_mov_b32 s20, s4
    s_mov_b32 s21, s5
    s_mov_b32 s22, 2359296
    s_mov_b32 s23, 0x20000
    s_bitcmp1_b32 s68, 1
    s_cbranch_scc1 Lk1_hb45
    s_barrier
Lk1_hb45:
    v_lshrrev_b32 v40, 4, v1
    v_and_b32 v43, 3, v1
    v_bfe_u32 v44, v1, 2, 4
    s_movk_i32 s44, 384
    v_mul_u32_u24 v44, s44, v44
    v_lshl_add_u32 v44, v43, 3, v44
    s_mul_i32 s44, s3, 96
    s_add_u32 s44, s44, 147456
    v_add_u32 v4, s44, v44
    v_add_u32 v3, 110592, v2
    v_bfe_u32 v42, v1, 3, 1
    v_bfe_u32 v44, v1, 2, 1
    v_lshlrev_b32 v45, 4, v40
    v_lshl_add_u32 v45, v44, 6, v45
    v_lshl_add_u32 v5, v42, 7, v45
    v_lshlrev_b32 v45, 4, v40
    v_lshl_add_u32 v45, v42, 6, v45
    v_lshl_add_u32 v45, v44, 7, v45
    v_lshl_add_u32 v6, v43, 8, v45
    s_mul_i32 s46, s33, 3072
    s_add_u32 s46, s46, 65536
    s_lshl_b32 s47, s34, 2
    s_add_u32 s47, s47, s3
    s_lshl_b32 s48, s47, 8
    s_add_u32 s48, s48, s46
    s_add_u32 s52, s48, 1048576
    s_add_u32 s53, s46, 1048576
    s_mul_i32 s47, s47, 3
    s_mul_i32 s49, s33, 36
    s_add_u32 s47, s47, s49
    s_lshl_b32 s47, s47, 10
    s_add_u32 s49, s47, 2363392
    s_add_u32 s47, s47, 0
    s_add_u32 s24, s10, 2367488
    s_addc_u32 s25, s11, 0
    s_mov_b32 s26, 11821056
    s_mov_b32 s27, 0x20000
    s_bitcmp1_b32 s68, 1
    s_cbranch_scc1 Lk1_gl46
    s_barrier
    v_lshlrev_b32 v34, 2, v1
    s_mov_b32 s38, 0
    global_load_dword v35, v34, s[28:29] sc1
    s_barrier
    s_waitcnt vmcnt(0)
    v_cmp_eq_u32 vcc, 0, v35
    s_cbranch_vccz Lk1_ig50
Lk1_is49:
    global_load_dword v35, v34, s[28:29] sc1
    s_add_u32 s38, s38, 1
    s_waitcnt vmcnt(0)
    v_cmp_eq_u32 vcc, 0, v35
    s_cmp_ge_u32 s38, 0x40000
    s_cbranch_scc1 Lk1_ig50
    s_cbranch_vccnz Lk1_is49
Lk1_ig50:
    buffer_load_dwordx4 v52, s[20:23], s40 offen offset:0 lds
    buffer_load_dwordx4 v53, s[20:23], s40 offen offset:1024 lds
    buffer_load_dwordx4 v54, s[20:23], s40 offen offset:2048 lds
    buffer_load_dwordx4 v[64:67], v2, s[12:15], s43 offen offset:0 sc1
    buffer_load_dwordx4 v[68:71], v2, s[12:15], s43 offen offset:1024 sc1
    s_barrier
    buffer_load_dwordx4 v[72:75], v2, s[12:15], s43 offen offset:2048 sc1
    s_add_u32 s43, s43, 3072
    buffer_load_dwordx4 v[76:79], v2, s[12:15], s43 offen offset:0 sc1
    buffer_load_dwordx4 v[80:83], v2, s[12:15], s43 offen offset:1024 sc1
    buffer_load_dwordx4 v[84:87], v2, s[12:15], s43 offen offset:2048 sc1
    s_add_u32 s43, s43, 3072
    buffer_load_dwordx4 v[88:91], v2, s[12:15], s43 offen offset:0 sc1
    buffer_load_dwordx4 v[92:95], v2, s[12:15], s43 offen offset:1024 sc1
    buffer_load_dwordx4 v[96:99], v2, s[12:15], s43 offen offset:2048 sc1
    s_add_u32 s43, s43, 3072
    buffer_load_dwordx4 v[100:103], v2, s[12:15], s43 offen offset:0 sc1
    buffer_load_dwordx4 v[104:107], v2, s[12:15], s43 offen offset:1024 sc1
    buffer_load_dwordx4 v[108:111], v2, s[12:15], s43 offen offset:2048 sc1
    s_add_u32 s43, s43, 3072
    buffer_load_dwordx4 v[112:115], v2, s[12:15], s43 offen offset:0 sc1
    buffer_load_dwordx4 v[116:119], v2, s[12:15], s43 offen offset:1024 sc1
    buffer_load_dwordx4 v[120:123], v2, s[12:15], s43 offen offset:2048 sc1
    s_add_u32 s43, s43, 3072
    buffer_load_dwordx4 v[124:127], v2, s[12:15], s43 offen offset:0 sc1
    buffer_load_dwordx4 v[128:131], v2, s[12:15], s43 offen offset:1024 sc1
    s_barrier
    buffer_load_dwordx4 v[132:135], v2, s[12:15], s43 offen offset:2048 sc1
    s_add_u32 s43, s43, 3072
    buffer_load_dwordx4 v[136:139], v2, s[12:15], s43 offen offset:0 sc1
    buffer_load_dwordx4 v[140:143], v2, s[12:15], s43 offen offset:1024 sc1
    buffer_load_dwordx4 v[144:147], v2, s[12:15], s43 offen offset:2048 sc1
    s_add_u32 s43, s43, 3072
    buffer_load_dwordx4 v[148:151], v2, s[12:15], s43 offen offset:0 sc1
    buffer_load_dwordx4 v[152:155], v2, s[12:15], s43 offen offset:1024 sc1
    buffer_load_dwordx4 v[156:159], v2, s[12:15], s43 offen offset:2048 sc1
    s_add_u32 s43, s43, 3072
    buffer_load_dwordx4 v[160:163], v2, s[12:15], s43 offen offset:0 sc1
    buffer_load_dwordx4 v[164:167], v2, s[12:15], s43 offen offset:1024 sc1
    buffer_load_dwordx4 v[168:171], v2, s[12:15], s43 offen offset:2048 sc1
    s_add_u32 s43, s43, 3072
    buffer_load_dwordx4 v[172:175], v2, s[12:15], s43 offen offset:0 sc1
    s_barrier
    buffer_load_dwordx4 v[176:179], v2, s[12:15], s43 offen offset:1024 sc1
    buffer_load_dwordx4 v[180:183], v2, s[12:15], s43 offen offset:2048 sc1
    s_add_u32 s43, s43, 3072
    buffer_load_dwordx4 v[184:187], v2, s[12:15], s43 offen offset:0 sc1
    buffer_load_dwordx4 v[188:191], v2, s[12:15], s43 offen offset:1024 sc1
    buffer_load_dwordx4 v[192:195], v2, s[12:15], s43 offen offset:2048 sc1
    s_add_u32 s43, s43, 3072
    buffer_load_dwordx4 v[196:199], v2, s[12:15], s43 offen offset:0 sc1
    buffer_load_dwordx4 v[200:203], v2, s[12:15], s43 offen offset:1024 sc1
    buffer_load_dwordx4 v[204:207], v2, s[12:15], s43 offen offset:2048 sc1
    s_add_u32 s43, s43, 3072
    buffer_load_dwordx4 v[208:211], v2, s[12:15], s43 offen offset:0 sc1
    buffer_load_dwordx4 v[212:215], v2, s[12:15], s43 offen offset:1024 sc1
    buffer_load_dwordx4 v[216:219], v2, s[12:15], s43 offen offset:2048 sc1
    s_add_u32 s43, s43, 3072
    buffer_load_dwordx4 v[220:223], v2, s[12:15], s43 offen offset:0 sc1
    buffer_load_dwordx4 v[224:227], v2, s[12:15], s43 offen offset:1024 sc1
    buffer_load_dwordx4 v[228:231], v2, s[12:15], s43 offen offset:2048 sc1
    s_add_u32 s43, s43, 3072
    buffer_load_dwordx4 v[232:235], v2, s[12:15], s43 offen offset:0 sc1
    buffer_load_dwordx4 v[236:239], v2, s[12:15], s43 offen offset:1024 sc1
    buffer_load_dwordx4 v[240:243], v2, s[12:15], s43 offen offset:2048 sc1
    s_add_u32 s43, s43, 3072
    s_barrier
    buffer_load_dwordx4 v[244:247], v2, s[12:15], s43 offen offset:0 sc1
    buffer_load_dwordx4 v[248:251], v2, s[12:15], s43 offen offset:1024 sc1
    buffer_load_dwordx4 v[252:255], v2, s[12:15], s43 offen offset:2048 sc1
    s_add_u32 s43, s43, 3072
    s_branch Lk1_gj47
Lk1_gl46:
    s_waitcnt vmcnt(0)
    s_barrier
    buffer_load_dwordx4 v52, s[20:23], s40 offen offset:0 lds
    buffer_load_dwordx4 v53, s[20:23], s40 offen offset:1024 lds
    buffer_load_dwordx4 v54, s[20:23], s40 offen offset:2048 lds
    buffer_load_dwordx4 v[64:67], v2, s[12:15], s43 offen offset:0 sc1
    buffer_load_dwordx4 v[68:71], v2, s[12:15], s43 offen offset:1024 sc1
    buffer_load_dwordx4 v[72:75], v2, s[12:15], s43 offen offset:2048 sc1
    s_add_u32 s43, s43, 3072
    buffer_load_dwordx4 v[76:79], v2, s[12:15], s43 offen offset:0 sc1
    buffer_load_dwordx4 v[80:83], v2, s[12:15], s43 offen offset:1024 sc1
    buffer_load_dwordx4 v[84:87], v2, s[12:15], s43 offen offset:2048 sc1
    s_add_u32 s43, s43, 3072
    buffer_load_dwordx4 v[88:91], v2, s[12:15], s43 offen offset:0 sc1
    buffer_load_dwordx4 v[92:95], v2, s[12:15], s43 offen offset:1024 sc1
    buffer_load_dwordx4 v[96:99], v2, s[12:15], s43 offen offset:2048 sc1
    s_add_u32 s43, s43, 3072
    s_barrier
    buffer_load_dwordx4 v[100:103], v2, s[12:15], s43 offen offset:0 sc1
    buffer_load_dwordx4 v[104:107], v2, s[12:15], s43 offen offset:1024 sc1
    buffer_load_dwordx4 v[108:111], v2, s[12:15], s43 offen offset:2048 sc1
    s_add_u32 s43, s43, 3072
    buffer_load_dwordx4 v[112:115], v2, s[12:15], s43 offen offset:0 sc1
    buffer_load_dwordx4 v[116:119], v2, s[12:15], s43 offen offset:1024 sc1
    buffer_load_dwordx4 v[120:123], v2, s[12:15], s43 offen offset:2048 sc1
    s_add_u32 s43, s43, 3072
    buffer_load_dwordx4 v[124:127], v2, s[12:15], s43 offen offset:0 sc1
    buffer_load_dwordx4 v[128:131], v2, s[12:15], s43 offen offset:1024 sc1
    buffer_load_dwordx4 v[132:135], v2, s[12:15], s43 offen offset:2048 sc1
    s_add_u32 s43, s43, 3072
    buffer_load_dwordx4 v[136:139], v2, s[12:15], s43 offen offset:0 sc1
    buffer_load_dwordx4 v[140:143], v2, s[12:15], s43 offen offset:1024 sc1
    buffer_load_dwordx4 v[144:147], v2, s[12:15], s43 offen offset:2048 sc1
    s_add_u32 s43, s43, 3072
    buffer_load_dwordx4 v[148:151], v2, s[12:15], s43 offen offset:0 sc1
    buffer_load_dwordx4 v[152:155], v2, s[12:15], s43 offen offset:1024 sc1
    buffer_load_dwordx4 v[156:159], v2, s[12:15], s43 offen offset:2048 sc1
    s_add_u32 s43, s43, 3072
    buffer_load_dwordx4 v[160:163], v2, s[12:15], s43 offen offset:0 sc1
    buffer_load_dwordx4 v[164:167], v2, s[12:15], s43 offen offset:1024 sc1
    buffer_load_dwordx4 v[168:171], v2, s[12:15], s43 offen offset:2048 sc1
    s_add_u32 s43, s43, 3072
    buffer_load_dwordx4 v[172:175], v2, s[12:15], s43 offen offset:0 sc1
    buffer_load_dwordx4 v[176:179], v2, s[12:15], s43 offen offset:1024 sc1
    buffer_load_dwordx4 v[180:183], v2, s[12:15], s43 offen offset:2048 sc1
    s_add_u32 s43, s43, 3072
    buffer_load_dwordx4 v[184:187], v2, s[12:15], s43 offen offset:0 sc1
    buffer_load_dwordx4 v[188:191], v2, s[12:15], s43 offen offset:1024 sc1
    buffer_load_dwordx4 v[192:195], v2, s[12:15], s43 offen offset:2048 sc1
    s_add_u32 s43, s43, 3072
    buffer_load_dwordx4 v[196:199], v2, s[12:15], s43 offen offset:0 sc1
    buffer_load_dwordx4 v[200:203], v2, s[12:15], s43 offen offset:1024 sc1
    buffer_load_dwordx4 v[204:207], v2, s[12:15], s43 offen offset:2048 sc1
    s_add_u32 s43, s43, 3072
    buffer_load_dwordx4 v[208:211], v2, s[12:15], s43 offen offset:0 sc1
    buffer_load_dwordx4 v[212:215], v2, s[12:15], s43 offen offset:1024 sc1
    buffer_load_dwordx4 v[216:219], v2, s[12:15], s43 offen offset:2048 sc1
    s_add_u32 s43, s43, 3072
    s_barrier
    buffer_load_dwordx4 v[220:223], v2, s[12:15], s43 offen offset:0 sc1
    buffer_load_dwordx4 v[224:227], v2, s[12:15], s43 offen offset:1024 sc1
    buffer_load_dwordx4 v[228:231], v2, s[12:15], s43 offen offset:2048 sc1
    s_add_u32 s43, s43, 3072
    buffer_load_dwordx4 v[232:235], v2, s[12:15], s43 offen offset:0 sc1
    buffer_load_dwordx4 v[236:239], v2, s[12:15], s43 offen offset:1024 sc1
    buffer_load_dwordx4 v[240:243], v2, s[12:15], s43 offen offset:2048 sc1
    s_add_u32 s43, s43, 3072
    buffer_load_dwordx4 v[244:247], v2, s[12:15], s43 offen offset:0 sc1
    buffer_load_dwordx4 v[248:251], v2, s[12:15], s43 offen offset:1024 sc1
    buffer_load_dwordx4 v[252:255], v2, s[12:15], s43 offen offset:2048 sc1
    s_add_u32 s43, s43, 3072
Lk1_gj47:
    s_waitcnt vmcnt(48)
    s_bitcmp0_b32 s68, 0
    s_cbranch_scc1 Lk1_gb48
    s_barrier
Lk1_gb48:
    s_lshl_b32 s37, s3, 14
    s_mul_i32 s35, s3, 12160
    s_add_u32 s35, s35, 6080
    s_add_u32 s36, s35, 4096
    s_mov_b32 s61, 897988541
    v_lshrrev_b32 v44, 4, v1
    v_and_b32 v45, 15, v1
    v_lshl_add_u32 v8, v1, 3, s37
    v_lshl_add_u32 v46, v44, 3, s37
    v_mad_u32_u24 v9, v45, 40, v46
    v_and_b32 v47, 3, v1
    v_min_u32 v48, 2, v47
    v_mad_u32_u24 v48, v48, 40, v46
    v_add_u32 v10, 640, v48
    v_bfe_u32 v48, v1, 2, 4
    v_lshl_add_u32 v49, v47, 4, s37
    v_add_u32 v49, 6144, v49
    v_lshl_add_u32 v11, v48, 6, v49
    v_cmp_gt_u32 vcc, 16, v1
    v_and_b32 v50, 1, v48
    v_or_b32 v50, 16, v50
    v_cndmask_b32 v50, v48, v50, vcc
    v_lshl_add_u32 v12, v50, 6, v49
    s_lshl_b32 s44, s3, 13
    s_add_u32 s44, s44, 110592
    v_add_u32 v13, s44, v2
    s_lshr_b32 s44, s3, 1
    s_lshl_b32 s44, s44, 11
    s_and_b32 s45, s3, 1
    s_lshl_b32 s45, s45, 3
    s_add_u32 s44, s44, s45
    s_add_u32 s44, s44, 143360
    v_add_u32 v14, s44, v2
    v_mov_b32 v30, 0
    v_mov_b32 v31, 0
    v_mov_b32 v34, 0
    v_mov_b32 v35, 0
    s_setprio 1
    s_barrier
    buffer_load_dwordx4 v[20:23], v2, s[12:15], s35 offen offset:0 sc1
    buffer_load_dwordx4 v[24:27], v2, s[12:15], s35 offen offset:1024 sc1
    buffer_load_dwordx4 v[44:47], v2, s[12:15], s35 offen offset:2048 sc1
    buffer_load_dwordx4 v[48:51], v2, s[12:15], s35 offen offset:3072 sc1
    buffer_load_dwordx4 v[52:55], v2, s[12:15], s36 offen offset:0 sc1
    buffer_load_dwordx4 v[56:59], v2, s[12:15], s36 offen offset:1024 sc1
    ds_read_b64_tr_b16 v[36:37], v11 offset:4608
    ds_read_b64_tr_b16 v[38:39], v12 offset:4608
    ds_read_b64_tr_b16 v[40:41], v11 offset:4616
    ds_read_b64_tr_b16 v[42:43], v12 offset:4616
    s_waitcnt vmcnt(5)
    v_cvt_pk_bf16_f32 v20, v20, v21
    v_cvt_pk_bf16_f32 v21, v22, v23
    ds_write_b64 v8, v[20:21] offset:3072
    s_waitcnt vmcnt(4)
    v_cvt_pk_bf16_f32 v24, v24, v25
    v_cvt_pk_bf16_f32 v25, v26, v27
    ds_write_b64 v8, v[24:25] offset:3584
    ds_read_b64 v[28:29], v9 offset:3072
    ds_read_b64 v[32:33], v10 offset:3072
    s_mov_b64 exec, 0xffff
    ds_read_b64 v[30:31], v9 offset:3104
    ds_read_b64 v[34:35], v10 offset:3104
    s_mov_b64 exec, -1
    s_waitcnt vmcnt(3)
    v_cvt_pk_bf16_f32 v44, v44, v45
    v_cvt_pk_bf16_f32 v45, v46, v47
    ds_write_b64 v8, v[44:45] offset:4096
    s_waitcnt vmcnt(2)
    v_cvt_pk_bf16_f32 v48, v48, v49
    v_cvt_pk_bf16_f32 v49, v50, v51
    ds_write_b64 v8, v[48:49] offset:4608
    s_waitcnt vmcnt(1)
    v_cvt_pk_bf16_f32 v52, v52, v53
    v_cvt_pk_bf16_f32 v53, v54, v55
    ds_write_b64 v8, v[52:53] offset:5120
    s_waitcnt vmcnt(0)
    v_cvt_pk_bf16_f32 v56, v56, v57
    v_cvt_pk_bf16_f32 v57, v58, v59
    ds_write_b64 v8, v[56:57] offset:5632
    s_waitcnt lgkmcnt(4)
    v_mfma_f32_16x16x32_bf16 v[48:51], v[32:35], v[36:39], 0
    v_mfma_f32_16x16x32_bf16 v[56:59], v[32:35], v[40:43], 0
    v_mfma_f32_16x16x32_bf16 v[44:47], v[28:31], v[36:39], 0
    v_mfma_f32_16x16x32_bf16 v[52:55], v[28:31], v[40:43], 0
    ds_read_b64 v[28:29], v9 offset:3832
    ds_read_b64 v[32:33], v10 offset:3832
    s_mov_b64 exec, 0xffff
    ds_read_b64 v[30:31], v9 offset:3864
    ds_read_b64 v[34:35], v10 offset:3864
    s_mov_b64 exec, -1
    ds_read_b64_tr_b16 v[36:37], v11 offset:5760
    ds_read_b64_tr_b16 v[38:39], v12 offset:5760
    ds_read_b64_tr_b16 v[40:41], v11 offset:5768
    ds_read_b64_tr_b16 v[42:43], v12 offset:5768
    v_add_f32 v50, s61, v50
    v_add_f32 v58, s61, v58
    v_rcp_f32 v50, v50
    v_rcp_f32 v58, v58
    v_pk_mul_f32 v[48:49], v[48:49], v[50:51] op_sel_hi:[1,0]
    v_pk_mul_f32 v[56:57], v[56:57], v[58:59] op_sel_hi:[1,0]
    v_pk_mul_f32 v[44:45], v[44:45], v[50:51] op_sel_hi:[1,0]
    v_pk_mul_f32 v[46:47], v[46:47], v[50:51] op_sel_hi:[1,0]
    v_pk_mul_f32 v[52:53], v[52:53], v[58:59] op_sel_hi:[1,0]
    v_pk_mul_f32 v[54:55], v[54:55], v[58:59] op_sel_hi:[1,0]
    v_cvt_pk_bf16_f32 v48, v48, v49
    v_cvt_pk_bf16_f32 v56, v56, v57
    v_cvt_pk_bf16_f32 v20, v44, v45
    v_cvt_pk_bf16_f32 v21, v46, v47
    v_cvt_pk_bf16_f32 v24, v52, v53
    v_cvt_pk_bf16_f32 v25, v54, v55
    v_mov_b32_dpp v16, v48 quad_perm:[0,1,2,3] row_mask:4 bank_mask:0xf
    v_mov_b32_dpp v18, v56 quad_perm:[0,1,2,3] row_mask:4 bank_mask:0xf
    s_waitcnt lgkmcnt(0)
    v_mfma_f32_16x16x32_bf16 v[48:51], v[32:35], v[36:39], 0
    v_mfma_f32_16x16x32_bf16 v[56:59], v[32:35], v[40:43], 0
    v_mfma_f32_16x16x32_bf16 v[44:47], v[28:31], v[36:39], 0
    v_mfma_f32_16x16x32_bf16 v[52:55], v[28:31], v[40:43], 0
    ds_read_b64 v[28:29], v9 offset:4592
    ds_read_b64 v[32:33], v10 offset:4592
    s_mov_b64 exec, 0xffff
    ds_read_b64 v[30:31], v9 offset:4624
    ds_read_b64 v[34:35], v10 offset:4624
    s_mov_b64 exec, -1
    ds_read_b64_tr_b16 v[36:37], v11 offset:6912
    ds_read_b64_tr_b16 v[38:39], v12 offset:6912
    ds_read_b64_tr_b16 v[40:41], v11 offset:6920
    ds_read_b64_tr_b16 v[42:43], v12 offset:6920
    v_add_f32 v50, s61, v50
    v_add_f32 v58, s61, v58
    v_rcp_f32 v50, v50
    v_rcp_f32 v58, v58
    v_pk_mul_f32 v[48:49], v[48:49], v[50:51] op_sel_hi:[1,0]
    v_pk_mul_f32 v[56:57], v[56:57], v[58:59] op_sel_hi:[1,0]
    v_pk_mul_f32 v[44:45], v[44:45], v[50:51] op_sel_hi:[1,0]
    v_pk_mul_f32 v[46:47], v[46:47], v[50:51] op_sel_hi:[1,0]
    v_pk_mul_f32 v[52:53], v[52:53], v[58:59] op_sel_hi:[1,0]
    v_pk_mul_f32 v[54:55], v[54:55], v[58:59] op_sel_hi:[1,0]
    v_cvt_pk_bf16_f32 v48, v48, v49
    v_cvt_pk_bf16_f32 v56, v56, v57
    v_cvt_pk_bf16_f32 v22, v44, v45
    v_cvt_pk_bf16_f32 v23, v46, v47
    v_cvt_pk_bf16_f32 v26, v52, v53
    v_cvt_pk_bf16_f32 v27, v54, v55
    v_mov_b32_dpp v17, v48 quad_perm:[0,1,2,3] row_mask:4 bank_mask:0xf
    v_mov_b32_dpp v19, v56 quad_perm:[0,1,2,3] row_mask:4 bank_mask:0xf
    ds_write_b128 v13, v[20:23] offset:4096
    ds_write_b128 v13, v[24:27] offset:5120
    s_waitcnt lgkmcnt(2)
    v_mfma_f32_16x16x32_bf16 v[48:51], v[32:35], v[36:39], 0
    v_mfma_f32_16x16x32_bf16 v[56:59], v[32:35], v[40:43], 0
    v_mfma_f32_16x16x32_bf16 v[44:47], v[28:31], v[36:39], 0
    v_mfma_f32_16x16x32_bf16 v[52:55], v[28:31], v[40:43], 0
    ds_read_b64 v[28:29], v9 offset:5352
    ds_read_b64 v[32:33], v10 offset:5352
    s_mov_b64 exec, 0xffff
    ds_read_b64 v[30:31], v9 offset:5384
    ds_read_b64 v[34:35], v10 offset:5384
    s_mov_b64 exec, -1
    ds_read_b64_tr_b16 v[36:37], v11 offset:8064
    ds_read_b64_tr_b16 v[38:39], v12 offset:8064
    ds_read_b64_tr_b16 v[40:41], v11 offset:8072
    ds_read_b64_tr_b16 v[42:43], v12 offset:8072
    v_add_f32 v50, s61, v50
    v_add_f32 v58, s61, v58
    v_rcp_f32 v50, v50
    v_rcp_f32 v58, v58
    v_pk_mul_f32 v[48:49], v[48:49], v[50:51] op_sel_hi:[1,0]
    v_pk_mul_f32 v[56:57], v[56:57], v[58:59] op_sel_hi:[1,0]
    v_pk_mul_f32 v[44:45], v[44:45], v[50:51] op_sel_hi:[1,0]
    v_pk_mul_f32 v[46:47], v[46:47], v[50:51] op_sel_hi:[1,0]
    v_pk_mul_f32 v[52:53], v[52:53], v[58:59] op_sel_hi:[1,0]
    v_pk_mul_f32 v[54:55], v[54:55], v[58:59] op_sel_hi:[1,0]
    v_cvt_pk_bf16_f32 v48, v48, v49
    v_cvt_pk_bf16_f32 v56, v56, v57
    v_cvt_pk_bf16_f32 v20, v44, v45
    v_cvt_pk_bf16_f32 v21, v46, v47
    v_cvt_pk_bf16_f32 v24, v52, v53
    v_cvt_pk_bf16_f32 v25, v54, v55
    v_mov_b32_dpp v16, v48 quad_perm:[0,1,2,3] row_mask:8 bank_mask:0xf
    v_mov_b32_dpp v18, v56 quad_perm:[0,1,2,3] row_mask:8 bank_mask:0xf
    s_waitcnt lgkmcnt(0)
    v_mfma_f32_16x16x32_bf16 v[48:51], v[32:35], v[36:39], 0
    v_mfma_f32_16x16x32_bf16 v[56:59], v[32:35], v[40:43], 0
    v_mfma_f32_16x16x32_bf16 v[44:47], v[28:31], v[36:39], 0
    v_mfma_f32_16x16x32_bf16 v[52:55], v[28:31], v[40:43], 0
    s_nop 7
    v_add_f32 v50, s61, v50
    v_add_f32 v58, s61, v58
    v_rcp_f32 v50, v50
    v_rcp_f32 v58, v58
    v_pk_mul_f32 v[48:49], v[48:49], v[50:51] op_sel_hi:[1,0]
    v_pk_mul_f32 v[56:57], v[56:57], v[58:59] op_sel_hi:[1,0]
    v_pk_mul_f32 v[44:45], v[44:45], v[50:51] op_sel_hi:[1,0]
    v_pk_mul_f32 v[46:47], v[46:47], v[50:51] op_sel_hi:[1,0]
    v_pk_mul_f32 v[52:53], v[52:53], v[58:59] op_sel_hi:[1,0]
    v_pk_mul_f32 v[54:55], v[54:55], v[58:59] op_sel_hi:[1,0]
    v_cvt_pk_bf16_f32 v48, v48, v49
    v_cvt_pk_bf16_f32 v56, v56, v57
    v_cvt_pk_bf16_f32 v22, v44, v45
    v_cvt_pk_bf16_f32 v23, v46, v47
    v_cvt_pk_bf16_f32 v26, v52, v53
    v_cvt_pk_bf16_f32 v27, v54, v55
    v_mov_b32_dpp v17, v48 quad_perm:[0,1,2,3] row_mask:8 bank_mask:0xf
    v_mov_b32_dpp v19, v56 quad_perm:[0,1,2,3] row_mask:8 bank_mask:0xf
    ds_write_b128 v13, v[20:23] offset:6144
    ds_write_b128 v13, v[24:27] offset:7168
    s_mov_b32 exec_lo, 0
    s_mov_b32 exec_hi, 0xffffffff
    ds_write_b64 v14, v[16:17] offset:0
    ds_write_b64 v14, v[18:19] offset:1024
    s_mov_b64 exec, -1
    s_setprio 0
    s_waitcnt lgkmcnt(0)
    s_barrier
    s_mul_i32 s44, s3, 768
    s_add_u32 s44, s44, s53
    v_lshlrev_b32 v7, 7, v1
    s_mov_b64 exec, 63
    buffer_load_dword v7, v7, s[12:15], s44 offen
    s_mov_b64 exec, -1
    ds_read_b128 v[32:35], v3 offset:0
    ds_read_b128 v[36:39], v3 offset:1024
    ds_read_b128 v[40:43], v3 offset:2048
    ds_read_b128 v[44:47], v3 offset:3072
    ds_read_b128 v[48:51], v3 offset:4096
    ds_read_b128 v[52:55], v3 offset:5120
    s_waitcnt lgkmcnt(4)
    v_mfma_f32_16x16x32_bf16 v[8:11], v[32:35], v[64:67], 0
    ds_read_b128 v[56:59], v3 offset:6144
    v_mfma_f32_16x16x32_bf16 v[12:15], v[36:39], v[64:67], 0
    ds_read_b128 v[60:63], v3 offset:7168
    v_mfma_f32_16x16x32_bf16 v[16:19], v[32:35], v[68:71], 0
    v_mfma_f32_16x16x32_bf16 v[20:23], v[36:39], v[68:71], 0
    v_mfma_f32_16x16x32_bf16 v[24:27], v[32:35], v[72:75], 0
    v_mfma_f32_16x16x32_bf16 v[28:31], v[36:39], v[72:75], 0
    s_waitcnt lgkmcnt(4)
    v_mfma_f32_16x16x32_bf16 v[8:11], v[40:43], v[76:79], v[8:11]
    ds_read_b128 v[32:35], v3 offset:8192
    v_mfma_f32_16x16x32_bf16 v[12:15], v[44:47], v[76:79], v[12:15]
    ds_read_b128 v[36:39], v3 offset:9216
    v_mfma_f32_16x16x32_bf16 v[16:19], v[40:43], v[80:83], v[16:19]
    v_mfma_f32_16x16x32_bf16 v[20:23], v[44:47], v[80:83], v[20:23]
    v_mfma_f32_16x16x32_bf16 v[24:27], v[40:43], v[84:87], v[24:27]
    buffer_load_dwordx4 v[64:67], v2, s[12:15], s43 offen offset:0 sc1
    buffer_load_dwordx4 v[68:71], v2, s[12:15], s43 offen offset:1024 sc1
    buffer_load_dwordx4 v[72:75], v2, s[12:15], s43 offen offset:2048 sc1
    s_add_u32 s43, s43, 3072
    v_mfma_f32_16x16x32_bf16 v[28:31], v[44:47], v[84:87], v[28:31]
    s_waitcnt lgkmcnt(4)
    v_mfma_f32_16x16x32_bf16 v[8:11], v[48:51], v[88:91], v[8:11]
    ds_read_b128 v[40:43], v3 offset:10240
    v_mfma_f32_16x16x32_bf16 v[12:15], v[52:55], v[88:91], v[12:15]
    ds_read_b128 v[44:47], v3 offset:11264
    v_mfma_f32_16x16x32_bf16 v[16:19], v[48:51], v[92:95], v[16:19]
    v_mfma_f32_16x16x32_bf16 v[20:23], v[52:55], v[92:95], v[20:23]
    v_mfma_f32_16x16x32_bf16 v[24:27], v[48:51], v[96:99], v[24:27]
    buffer_load_dwordx4 v[76:79], v2, s[12:15], s43 offen offset:0 sc1
    buffer_load_dwordx4 v[80:83], v2, s[12:15], s43 offen offset:1024 sc1
    buffer_load_dwordx4 v[84:87], v2, s[12:15], s43 offen offset:2048 sc1
    s_add_u32 s43, s43, 3072
    v_mfma_f32_16x16x32_bf16 v[28:31], v[52:55], v[96:99], v[28:31]
    s_waitcnt lgkmcnt(4)
    v_mfma_f32_16x16x32_bf16 v[8:11], v[56:59], v[100:103], v[8:11]
    ds_read_b128 v[48:51], v3 offset:12288
    v_mfma_f32_16x16x32_bf16 v[12:15], v[60:63], v[100:103], v[12:15]
    ds_read_b128 v[52:55], v3 offset:13312
    v_mfma_f32_16x16x32_bf16 v[16:19], v[56:59], v[104:107], v[16:19]
    v_mfma_f32_16x16x32_bf16 v[20:23], v[60:63], v[104:107], v[20:23]
    v_mfma_f32_16x16x32_bf16 v[24:27], v[56:59], v[108:111], v[24:27]
    v_mfma_f32_16x16x32_bf16 v[28:31], v[60:63], v[108:111], v[28:31]
    s_waitcnt lgkmcnt(4)
    v_mfma_f32_16x16x32_bf16 v[8:11], v[32:35], v[112:115], v[8:11]
    ds_read_b128 v[56:59], v3 offset:14336
    v_mfma_f32_16x16x32_bf16 v[12:15], v[36:39], v[112:115], v[12:15]
    ds_read_b128 v[60:63], v3 offset:15360
    v_mfma_f32_16x16x32_bf16 v[16:19], v[32:35], v[116:119], v[16:19]
    v_mfma_f32_16x16x32_bf16 v[20:23], v[36:39], v[116:119], v[20:23]
    ds_read_b64_tr_b16 v[88:89], v4 offset:0
    v_mfma_f32_16x16x32_bf16 v[24:27], v[32:35], v[120:123], v[24:27]
    v_mfma_f32_16x16x32_bf16 v[28:31], v[36:39], v[120:123], v[28:31]
    s_waitcnt lgkmcnt(5)
    v_mfma_f32_16x16x32_bf16 v[8:11], v[40:43], v[124:127], v[8:11]
    ds_read_b128 v[32:35], v3 offset:16384
    v_mfma_f32_16x16x32_bf16 v[12:15], v[44:47], v[124:127], v[12:15]
    ds_read_b128 v[36:39], v3 offset:17408
    v_mfma_f32_16x16x32_bf16 v[16:19], v[40:43], v[128:131], v[16:19]
    v_mfma_f32_16x16x32_bf16 v[20:23], v[44:47], v[128:131], v[20:23]
    ds_read_b64_tr_b16 v[90:91], v4 offset:6144
    v_mfma_f32_16x16x32_bf16 v[24:27], v[40:43], v[132:135], v[24:27]
    v_mfma_f32_16x16x32_bf16 v[28:31], v[44:47], v[132:135], v[28:31]
    s_waitcnt lgkmcnt(6)
    v_mfma_f32_16x16x32_bf16 v[8:11], v[48:51], v[136:139], v[8:11]
    ds_read_b128 v[40:43], v3 offset:18432
    v_mfma_f32_16x16x32_bf16 v[12:15], v[52:55], v[136:139], v[12:15]
    ds_read_b128 v[44:47], v3 offset:19456
    v_mfma_f32_16x16x32_bf16 v[16:19], v[48:51], v[140:143], v[16:19]
    v_mfma_f32_16x16x32_bf16 v[20:23], v[52:55], v[140:143], v[20:23]
    ds_read_b64_tr_b16 v[92:93], v4 offset:32
    v_mfma_f32_16x16x32_bf16 v[24:27], v[48:51], v[144:147], v[24:27]
    v_mfma_f32_16x16x32_bf16 v[28:31], v[52:55], v[144:147], v[28:31]
    s_waitcnt lgkmcnt(7)
    v_mfma_f32_16x16x32_bf16 v[8:11], v[56:59], v[148:151], v[8:11]
    ds_read_b128 v[48:51], v3 offset:20480
    v_mfma_f32_16x16x32_bf16 v[12:15], v[60:63], v[148:151], v[12:15]
    ds_read_b128 v[52:55], v3 offset:21504
    v_mfma_f32_16x16x32_bf16 v[16:19], v[56:59], v[152:155], v[16:19]
    v_mfma_f32_16x16x32_bf16 v[20:23], v[60:63], v[152:155], v[20:23]
    ds_read_b64_tr_b16 v[94:95], v4 offset:6176
    v_mfma_f32_16x16x32_bf16 v[24:27], v[56:59], v[156:159], v[24:27]
    v_mfma_f32_16x16x32_bf16 v[28:31], v[60:63], v[156:159], v[28:31]
    s_waitcnt lgkmcnt(7)
    v_mfma_f32_16x16x32_bf16 v[8:11], v[32:35], v[160:163], v[8:11]
    ds_read_b128 v[56:59], v3 offset:22528
    v_mfma_f32_16x16x32_bf16 v[12:15], v[36:39], v[160:163], v[12:15]
    ds_read_b128 v[60:63], v3 offset:23552
    v_mfma_f32_16x16x32_bf16 v[16:19], v[32:35], v[164:167], v[16:19]
    v_mfma_f32_16x16x32_bf16 v[20:23], v[36:39], v[164:167], v[20:23]
    ds_read_b64_tr_b16 v[96:97], v4 offset:64
    v_mfma_f32_16x16x32_bf16 v[24:27], v[32:35], v[168:171], v[24:27]
    v_mfma_f32_16x16x32_bf16 v[28:31], v[36:39], v[168:171], v[28:31]
    s_waitcnt lgkmcnt(7)
    v_mfma_f32_16x16x32_bf16 v[8:11], v[40:43], v[172:175], v[8:11]
    ds_read_b128 v[32:35], v3 offset:24576
    v_mfma_f32_16x16x32_bf16 v[12:15], v[44:47], v[172:175], v[12:15]
    ds_read_b128 v[36:39], v3 offset:25600
    v_mfma_f32_16x16x32_bf16 v[16:19], v[40:43], v[176:179], v[16:19]
    v_mfma_f32_16x16x32_bf16 v[20:23], v[44:47], v[176:179], v[20:23]
    ds_read_b64_tr_b16 v[98:99], v4 offset:6208
    v_mfma_f32_16x16x32_bf16 v[24:27], v[40:43], v[180:183], v[24:27]
    v_mfma_f32_16x16x32_bf16 v[28:31], v[44:47], v[180:183], v[28:31]
    s_waitcnt lgkmcnt(7)
    v_mfma_f32_16x16x32_bf16 v[8:11], v[48:51], v[184:187], v[8:11]
    ds_read_b128 v[40:43], v3 offset:26624
    v_mfma_f32_16x16x32_bf16 v[12:15], v[52:55], v[184:187], v[12:15]
    ds_read_b128 v[44:47], v3 offset:27648
    v_mfma_f32_16x16x32_bf16 v[16:19], v[48:51], v[188:191], v[16:19]
    v_mfma_f32_16x16x32_bf16 v[20:23], v[52:55], v[188:191], v[20:23]
    v_mfma_f32_16x16x32_bf16 v[24:27], v[48:51], v[192:195], v[24:27]
    v_mfma_f32_16x16x32_bf16 v[28:31], v[52:55], v[192:195], v[28:31]
    s_waitcnt lgkmcnt(6)
    v_mfma_f32_16x16x32_bf16 v[8:11], v[56:59], v[196:199], v[8:11]
    ds_read_b128 v[48:51], v3 offset:28672
    v_mfma_f32_16x16x32_bf16 v[12:15], v[60:63], v[196:199], v[12:15]
    ds_read_b128 v[52:55], v3 offset:29696
    s_waitcnt lgkmcnt(4)
    v_lshlrev_b32 v100, 16, v88
    v_and_b32 v101, 0xffff0000, v88
    v_mfma_f32_16x16x32_bf16 v[16:19], v[56:59], v[200:203], v[16:19]
    v_mfma_f32_16x16x32_bf16 v[20:23], v[60:63], v[200:203], v[20:23]
    v_lshlrev_b32 v102, 16, v89
    v_and_b32 v103, 0xffff0000, v89
    v_mfma_f32_16x16x32_bf16 v[24:27], v[56:59], v[204:207], v[24:27]
    v_mfma_f32_16x16x32_bf16 v[28:31], v[60:63], v[204:207], v[28:31]
    v_lshlrev_b32 v104, 16, v90
    v_and_b32 v105, 0xffff0000, v90
    v_mfma_f32_16x16x32_bf16 v[8:11], v[32:35], v[208:211], v[8:11]
    ds_read_b128 v[56:59], v3 offset:30720
    v_mfma_f32_16x16x32_bf16 v[12:15], v[36:39], v[208:211], v[12:15]
    ds_read_b128 v[60:63], v3 offset:31744
    v_lshlrev_b32 v106, 16, v91
    v_and_b32 v107, 0xffff0000, v91
    v_mfma_f32_16x16x32_bf16 v[16:19], v[32:35], v[212:215], v[16:19]
    v_mfma_f32_16x16x32_bf16 v[20:23], v[36:39], v[212:215], v[20:23]
    v_lshlrev_b32 v108, 16, v92
    v_and_b32 v109, 0xffff0000, v92
    v_mfma_f32_16x16x32_bf16 v[24:27], v[32:35], v[216:219], v[24:27]
    v_mfma_f32_16x16x32_bf16 v[28:31], v[36:39], v[216:219], v[28:31]
    v_lshlrev_b32 v110, 16, v93
    v_and_b32 v111, 0xffff0000, v93
    s_waitcnt lgkmcnt(4)
    v_mfma_f32_16x16x32_bf16 v[8:11], v[40:43], v[220:223], v[8:11]
    ds_read_b128 v[32:35], v3 offset:32768
    v_mfma_f32_16x16x32_bf16 v[12:15], v[44:47], v[220:223], v[12:15]
    ds_read_b128 v[36:39], v3 offset:33792
    v_lshlrev_b32 v112, 16, v94
    v_and_b32 v113, 0xffff0000, v94
    v_mfma_f32_16x16x32_bf16 v[16:19], v[40:43], v[224:227], v[16:19]
    v_mfma_f32_16x16x32_bf16 v[20:23], v[44:47], v[224:227], v[20:23]
    v_lshlrev_b32 v114, 16, v95
    v_and_b32 v115, 0xffff0000, v95
    v_mfma_f32_16x16x32_bf16 v[24:27], v[40:43], v[228:231], v[24:27]
    v_mfma_f32_16x16x32_bf16 v[28:31], v[44:47], v[228:231], v[28:31]
    v_lshlrev_b32 v116, 16, v96
    v_and_b32 v117, 0xffff0000, v96
    s_waitcnt lgkmcnt(4)
    v_mfma_f32_16x16x32_bf16 v[8:11], v[48:51], v[232:235], v[8:11]
    ds_read_b128 v[40:43], v3 offset:34816
    v_mfma_f32_16x16x32_bf16 v[12:15], v[52:55], v[232:235], v[12:15]
    ds_read_b128 v[44:47], v3 offset:35840
    v_lshlrev_b32 v118, 16, v97
    v_and_b32 v119, 0xffff0000, v97
    v_mfma_f32_16x16x32_bf16 v[16:19], v[48:51], v[236:239], v[16:19]
    v_mfma_f32_16x16x32_bf16 v[20:23], v[52:55], v[236:239], v[20:23]
    v_lshlrev_b32 v120, 16, v98
    v_and_b32 v121, 0xffff0000, v98
    v_mfma_f32_16x16x32_bf16 v[24:27], v[48:51], v[240:243], v[24:27]
    v_mfma_f32_16x16x32_bf16 v[28:31], v[52:55], v[240:243], v[28:31]
    v_lshlrev_b32 v122, 16, v99
    v_and_b32 v123, 0xffff0000, v99
    s_waitcnt lgkmcnt(4)
    v_mfma_f32_16x16x32_bf16 v[8:11], v[56:59], v[244:247], v[8:11]
    v_mfma_f32_16x16x32_bf16 v[12:15], v[60:63], v[244:247], v[12:15]
    v_mfma_f32_16x16x32_bf16 v[16:19], v[56:59], v[248:251], v[16:19]
    v_mfma_f32_16x16x32_bf16 v[20:23], v[60:63], v[248:251], v[20:23]
    v_mfma_f32_16x16x32_bf16 v[24:27], v[56:59], v[252:255], v[24:27]
    v_mfma_f32_16x16x32_bf16 v[28:31], v[60:63], v[252:255], v[28:31]
    s_waitcnt vmcnt(3)
    s_waitcnt lgkmcnt(2)
    v_mfma_f32_16x16x32_bf16 v[8:11], v[32:35], v[64:67], v[8:11]
    v_mfma_f32_16x16x32_bf16 v[12:15], v[36:39], v[64:67], v[12:15]
    v_mfma_f32_16x16x32_bf16 v[16:19], v[32:35], v[68:71], v[16:19]
    v_mfma_f32_16x16x32_bf16 v[20:23], v[36:39], v[68:71], v[20:23]
    v_mfma_f32_16x16x32_bf16 v[24:27], v[32:35], v[72:75], v[24:27]
    v_mfma_f32_16x16x32_bf16 v[28:31], v[36:39], v[72:75], v[28:31]
    s_waitcnt vmcnt(0)
    s_waitcnt lgkmcnt(0)
    v_mfma_f32_16x16x32_bf16 v[8:11], v[40:43], v[76:79], v[8:11]
    v_mfma_f32_16x16x32_bf16 v[12:15], v[44:47], v[76:79], v[12:15]
    v_mfma_f32_16x16x32_bf16 v[16:19], v[40:43], v[80:83], v[16:19]
    v_mfma_f32_16x16x32_bf16 v[20:23], v[44:47], v[80:83], v[20:23]
    v_mfma_f32_16x16x32_bf16 v[24:27], v[40:43], v[84:87], v[24:27]
    v_mfma_f32_16x16x32_bf16 v[28:31], v[44:47], v[84:87], v[28:31]
    s_nop 3
    v_pk_add_f32 v[8:9], v[8:9], v[100:101]
    v_pk_add_f32 v[10:11], v[10:11], v[102:103]
    v_pk_add_f32 v[12:13], v[12:13], v[104:105]
    v_pk_add_f32 v[14:15], v[14:15], v[106:107]
    v_pk_add_f32 v[16:17], v[16:17], v[108:109]
    v_pk_add_f32 v[18:19], v[18:19], v[110:111]
    v_pk_add_f32 v[20:21], v[20:21], v[112:113]
    v_pk_add_f32 v[22:23], v[22:23], v[114:115]
    v_pk_add_f32 v[24:25], v[24:25], v[116:117]
    v_pk_add_f32 v[26:27], v[26:27], v[118:119]
    v_pk_add_f32 v[28:29], v[28:29], v[120:121]
    v_pk_add_f32 v[30:31], v[30:31], v[122:123]
    v_pk_mul_f32 v[132:133], v[8:9], v[8:9]
    v_pk_mul_f32 v[134:135], v[10:11], v[10:11]
    v_pk_mul_f32 v[136:137], v[12:13], v[12:13]
    v_pk_mul_f32 v[138:139], v[14:15], v[14:15]
    v_pk_fma_f32 v[132:133], v[16:17], v[16:17], v[132:133]
    v_pk_fma_f32 v[134:135], v[18:19], v[18:19], v[134:135]
    v_pk_fma_f32 v[136:137], v[20:21], v[20:21], v[136:137]
    v_pk_fma_f32 v[138:139], v[22:23], v[22:23], v[138:139]
    v_pk_add_f32 v[124:125], v[16:17], v[8:9]
    v_pk_add_f32 v[126:127], v[18:19], v[10:11]
    v_pk_add_f32 v[128:129], v[20:21], v[12:13]
    v_pk_add_f32 v[130:131], v[22:23], v[14:15]
    v_pk_fma_f32 v[132:133], v[24:25], v[24:25], v[132:133]
    v_pk_fma_f32 v[134:135], v[26:27], v[26:27], v[134:135]
    v_pk_fma_f32 v[136:137], v[28:29], v[28:29], v[136:137]
    v_pk_fma_f32 v[138:139], v[30:31], v[30:31], v[138:139]
    v_pk_add_f32 v[124:125], v[24:25], v[124:125]
    v_pk_add_f32 v[126:127], v[26:27], v[126:127]
    v_pk_add_f32 v[128:129], v[28:29], v[128:129]
    v_pk_add_f32 v[130:131], v[30:31], v[130:131]
    v_add_f32_dpp v140, v132, v132 row_ror:8 row_mask:0xf bank_mask:0xc
    v_add_f32_dpp v141, v133, v133 row_ror:8 row_mask:0xf bank_mask:0xc
    v_add_f32_dpp v142, v134, v134 row_ror:8 row_mask:0xf bank_mask:0xc
    v_add_f32_dpp v143, v135, v135 row_ror:8 row_mask:0xf bank_mask:0xc
    v_add_f32_dpp v144, v136, v136 row_ror:8 row_mask:0xf bank_mask:0xc
    v_add_f32_dpp v145, v137, v137 row_ror:8 row_mask:0xf bank_mask:0xc
    v_add_f32_dpp v146, v138, v138 row_ror:8 row_mask:0xf bank_mask:0xc
    v_add_f32_dpp v147, v139, v139 row_ror:8 row_mask:0xf bank_mask:0xc
    v_add_f32_dpp v140, v124, v124 row_ror:8 row_mask:0xf bank_mask:0x3
    v_add_f32_dpp v141, v125, v125 row_ror:8 row_mask:0xf bank_mask:0x3
    v_add_f32_dpp v142, v126, v126 row_ror:8 row_mask:0xf bank_mask:0x3
    v_add_f32_dpp v143, v127, v127 row_ror:8 row_mask:0xf bank_mask:0x3
    v_add_f32_dpp v144, v128, v128 row_ror:8 row_mask:0xf bank_mask:0x3
    v_add_f32_dpp v145, v129, v129 row_ror:8 row_mask:0xf bank_mask:0x3
    v_add_f32_dpp v146, v130, v130 row_ror:8 row_mask:0xf bank_mask:0x3
    v_add_f32_dpp v147, v131, v131 row_ror:8 row_mask:0xf bank_mask:0x3
    v_add_f32_dpp v148, v140, v140 row_half_mirror row_mask:0xf bank_mask:0x5
    v_add_f32_dpp v149, v141, v141 row_half_mirror row_mask:0xf bank_mask:0x5
    v_add_f32_dpp v150, v142, v142 row_half_mirror row_mask:0xf bank_mask:0x5
    v_add_f32_dpp v151, v143, v143 row_half_mirror row_mask:0xf bank_mask:0x5
    v_add_f32_dpp v148, v144, v144 row_half_mirror row_mask:0xf bank_mask:0xa
    v_add_f32_dpp v149, v145, v145 row_half_mirror row_mask:0xf bank_mask:0xa
    v_add_f32_dpp v150, v146, v146 row_half_mirror row_mask:0xf bank_mask:0xa
    v_add_f32_dpp v151, v147, v147 row_half_mirror row_mask:0xf bank_mask:0xa
    v_add_f32_dpp v148, v148, v148 quad_perm:[1,0,3,2] row_mask:0xf bank_mask:0xf
    v_add_f32_dpp v149, v149, v149 quad_perm:[1,0,3,2] row_mask:0xf bank_mask:0xf
    v_add_f32_dpp v150, v150, v150 quad_perm:[1,0,3,2] row_mask:0xf bank_mask:0xf
    v_add_f32_dpp v151, v151, v151 quad_perm:[1,0,3,2] row_mask:0xf bank_mask:0xf
    v_add_f32_dpp v148, v148, v148 quad_perm:[2,3,0,1] row_mask:0xf bank_mask:0xf
    v_add_f32_dpp v149, v149, v149 quad_perm:[2,3,0,1] row_mask:0xf bank_mask:0xf
    v_add_f32_dpp v150, v150, v150 quad_perm:[2,3,0,1] row_mask:0xf bank_mask:0xf
    v_add_f32_dpp v151, v151, v151 quad_perm:[2,3,0,1] row_mask:0xf bank_mask:0xf
    s_mov_b32 exec_lo, 0x11111111
    s_mov_b32 exec_hi, 0x11111111
    buffer_store_dwordx4 v[148:151], v5, s[12:15], s52 offen
    s_mov_b64 exec, -1
    buffer_load_dwordx4 v[156:159], v6, s[12:15], s53 offen offset:0 sc1
    buffer_load_dwordx4 v[160:163], v6, s[12:15], s53 offen offset:1024 sc1
    buffer_load_dwordx4 v[164:167], v6, s[12:15], s53 offen offset:2048 sc1
    v_cvt_pk_bf16_f32 v196, v8, v9
    v_cvt_pk_bf16_f32 v197, v10, v11
    v_cvt_pk_bf16_f32 v198, v12, v13
    v_cvt_pk_bf16_f32 v199, v14, v15
    v_cvt_pk_bf16_f32 v200, v16, v17
    v_cvt_pk_bf16_f32 v201, v18, v19
    v_cvt_pk_bf16_f32 v202, v20, v21
    v_cvt_pk_bf16_f32 v203, v22, v23
    v_cvt_pk_bf16_f32 v204, v24, v25
    v_cvt_pk_bf16_f32 v205, v26, v27
    v_cvt_pk_bf16_f32 v206, v28, v29
    v_cvt_pk_bf16_f32 v207, v30, v31
    s_mov_b32 s50, 0
Lk1_near53:
    s_waitcnt vmcnt(0)
    v_max3_u32 v56, v156, v157, v158
    v_max3_u32 v57, v159, v160, v161
    v_max3_u32 v58, v162, v163, v164
    v_max3_u32 v59, v165, v166, v167
    v_max3_u32 v56, v56, v57, v58
    v_max_u32 v56, v56, v59
    v_cmp_eq_u32 vcc, -1, v56
    s_add_u32 s50, s50, 1
    s_cmp_eq_u64 vcc, 0
    s_cbranch_scc1 Lk1_far54
    s_cmp_ge_u32 s50, 16
    s_cbranch_scc1 Lk1_far54
    buffer_load_dwordx4 v[156:159], v6, s[12:15], s53 offen offset:0 sc1
    buffer_load_dwordx4 v[160:163], v6, s[12:15], s53 offen offset:1024 sc1
    buffer_load_dwordx4 v[164:167], v6, s[12:15], s53 offen offset:2048 sc1
    s_branch Lk1_near53
Lk1_far54:
    s_mov_b32 exec_lo, 0x11111111
    s_mov_b32 exec_hi, 0x11111111
    buffer_store_dwordx4 v[148:151], v5, s[12:15], s48 offen sc1
    s_mov_b64 exec, -1
    buffer_store_dwordx4 v[196:199], v2, s[24:27], s49 offen offset:0 sc1
    buffer_store_dwordx4 v[200:203], v2, s[24:27], s49 offen offset:1024 sc1
    buffer_store_dwordx4 v[204:207], v2, s[24:27], s49 offen offset:2048 sc1
    s_cmp_eq_u64 vcc, 0
    s_cbranch_scc1 Lk1_go52
    s_mov_b32 s50, 0
Lk1_spin51:
    buffer_load_dwordx4 v[156:159], v6, s[12:15], s46 offen offset:0 sc1
    buffer_load_dwordx4 v[160:163], v6, s[12:15], s46 offen offset:1024 sc1
    buffer_load_dwordx4 v[164:167], v6, s[12:15], s46 offen offset:2048 sc1
    s_waitcnt vmcnt(0)
    v_max3_u32 v56, v156, v157, v158
    v_max3_u32 v57, v159, v160, v161
    v_max3_u32 v58, v162, v163, v164
    v_max3_u32 v59, v165, v166, v167
    v_max3_u32 v56, v56, v57, v58
    v_max_u32 v56, v56, v59
    v_cmp_eq_u32 vcc, -1, v56
    s_add_u32 s50, s50, 1
    s_cmp_eq_u64 vcc, 0
    s_cbranch_scc1 Lk1_go52
    s_cmp_lt_u32 s50, 0x40000
    s_cbranch_scc1 Lk1_spin51
Lk1_go52:
    v_pk_add_f32 v[148:149], v[156:157], v[160:161]
    v_pk_add_f32 v[150:151], v[158:159], v[162:163]
    v_pk_add_f32 v[148:149], v[148:149], v[164:165]
    v_pk_add_f32 v[150:151], v[150:151], v[166:167]
    s_mov_b32 s50, 987991609
    s_mov_b32 s51, 925353388
    v_add_f32_dpp v148, v148, v148 quad_perm:[1,0,3,2] row_mask:0xf bank_mask:0xf
    v_add_f32_dpp v149, v149, v149 quad_perm:[1,0,3,2] row_mask:0xf bank_mask:0xf
    v_add_f32_dpp v150, v150, v150 quad_perm:[1,0,3,2] row_mask:0xf bank_mask:0xf
    v_add_f32_dpp v151, v151, v151 quad_perm:[1,0,3,2] row_mask:0xf bank_mask:0xf
    v_add_f32_dpp v148, v148, v148 quad_perm:[2,3,0,1] row_mask:0xf bank_mask:0xf
    v_add_f32_dpp v149, v149, v149 quad_perm:[2,3,0,1] row_mask:0xf bank_mask:0xf
    v_add_f32_dpp v150, v150, v150 quad_perm:[2,3,0,1] row_mask:0xf bank_mask:0xf
    v_add_f32_dpp v151, v151, v151 quad_perm:[2,3,0,1] row_mask:0xf bank_mask:0xf
    v_mul_f32 v148, s50, v148
    v_mul_f32 v149, s50, v149
    v_mul_f32 v150, s50, v150
    v_mul_f32 v151, s50, v151
    v_mov_b32_dpp v140, v148 row_ror:12 row_mask:0xf bank_mask:0xf
    v_mov_b32_dpp v141, v149 row_ror:12 row_mask:0xf bank_mask:0xf
    v_mov_b32_dpp v142, v150 row_ror:12 row_mask:0xf bank_mask:0xf
    v_mov_b32_dpp v143, v151 row_ror:12 row_mask:0xf bank_mask:0xf
    v_fma_f32 v140, -v148, v148, v140
    v_fma_f32 v141, -v149, v149, v141
    v_fma_f32 v142, -v150, v150, v142
    v_fma_f32 v143, -v151, v151, v143
    v_max_f32 v140, 0, v140
    v_max_f32 v141, 0, v141
    v_max_f32 v142, 0, v142
    v_max_f32 v143, 0, v143
    v_add_f32 v144, s51, v140
    v_add_f32 v145, s51, v141
    v_add_f32 v146, s51, v142
    v_add_f32 v147, s51, v143
    v_rsq_f32 v144, v144
    v_rsq_f32 v145, v145
    v_rsq_f32 v146, v146
    v_rsq_f32 v147, v147
    v_mul_f32 v140, v140, v144
    v_mul_f32 v141, v141, v145
    v_mul_f32 v142, v142, v146
    v_mul_f32 v143, v143, v147
    v_fma_f32 v140, v140, v144, s51
    v_fma_f32 v141, v141, v145, s51
    v_fma_f32 v142, v142, v146, s51
    v_fma_f32 v143, v143, v147, s51
    v_rsq_f32 v140, v140
    v_rsq_f32 v141, v141
    v_rsq_f32 v142, v142
    v_rsq_f32 v143, v143
    v_mul_f32 v140, v140, v144
    v_mul_f32 v141, v141, v145
    v_mul_f32 v142, v142, v146
    v_mul_f32 v143, v143, v147
    v_mul_f32 v144, v148, v140
    v_mul_f32 v145, v149, v141
    v_mul_f32 v146, v150, v142
    v_mul_f32 v147, v151, v143
    v_mov_b32_dpp v124, v140 row_newbcast:0 row_mask:0xf bank_mask:0xf
    v_mov_b32_dpp v125, v141 row_newbcast:0 row_mask:0xf bank_mask:0xf
    v_mov_b32_dpp v126, v142 row_newbcast:0 row_mask:0xf bank_mask:0xf
    v_mov_b32_dpp v127, v143 row_newbcast:0 row_mask:0xf bank_mask:0xf
    v_mov_b32_dpp v132, v144 row_newbcast:0 row_mask:0xf bank_mask:0xf
    v_mov_b32_dpp v133, v145 row_newbcast:0 row_mask:0xf bank_mask:0xf
    v_mov_b32_dpp v134, v146 row_newbcast:0 row_mask:0xf bank_mask:0xf
    v_mov_b32_dpp v135, v147 row_newbcast:0 row_mask:0xf bank_mask:0xf
    v_mov_b32_dpp v128, v140 row_newbcast:8 row_mask:0xf bank_mask:0xf
    v_mov_b32_dpp v129, v141 row_newbcast:8 row_mask:0xf bank_mask:0xf
    v_mov_b32_dpp v130, v142 row_newbcast:8 row_mask:0xf bank_mask:0xf
    v_mov_b32_dpp v131, v143 row_newbcast:8 row_mask:0xf bank_mask:0xf
    v_mov_b32_dpp v136, v144 row_newbcast:8 row_mask:0xf bank_mask:0xf
    v_mov_b32_dpp v137, v145 row_newbcast:8 row_mask:0xf bank_mask:0xf
    v_mov_b32_dpp v138, v146 row_newbcast:8 row_mask:0xf bank_mask:0xf
    v_mov_b32_dpp v139, v147 row_newbcast:8 row_mask:0xf bank_mask:0xf
    v_pk_fma_f32 v[8:9], v[8:9], v[124:125], v[132:133] neg_lo:[0,0,1] neg_hi:[0,0,1]
    v_pk_fma_f32 v[10:11], v[10:11], v[126:127], v[134:135] neg_lo:[0,0,1] neg_hi:[0,0,1]
    v_pk_fma_f32 v[12:13], v[12:13], v[128:129], v[136:137] neg_lo:[0,0,1] neg_hi:[0,0,1]
    v_pk_fma_f32 v[14:15], v[14:15], v[130:131], v[138:139] neg_lo:[0,0,1] neg_hi:[0,0,1]
    v_cvt_pk_bf16_f32 v212, v8, v9
    v_cvt_pk_bf16_f32 v213, v10, v11
    v_cvt_pk_bf16_f32 v214, v12, v13
    v_cvt_pk_bf16_f32 v215, v14, v15
    buffer_store_dwordx4 v[212:215], v2, s[24:27], s47 offen offset:0 sc1
    v_pk_fma_f32 v[16:17], v[16:17], v[124:125], v[132:133] neg_lo:[0,0,1] neg_hi:[0,0,1]
    v_pk_fma_f32 v[18:19], v[18:19], v[126:127], v[134:135] neg_lo:[0,0,1] neg_hi:[0,0,1]
    v_pk_fma_f32 v[20:21], v[20:21], v[128:129], v[136:137] neg_lo:[0,0,1] neg_hi:[0,0,1]
    v_pk_fma_f32 v[22:23], v[22:23], v[130:131], v[138:139] neg_lo:[0,0,1] neg_hi:[0,0,1]
    v_cvt_pk_bf16_f32 v216, v16, v17
    v_cvt_pk_bf16_f32 v217, v18, v19
    v_cvt_pk_bf16_f32 v218, v20, v21
    v_cvt_pk_bf16_f32 v219, v22, v23
    buffer_store_dwordx4 v[216:219], v2, s[24:27], s47 offen offset:1024 sc1
    v_pk_fma_f32 v[24:25], v[24:25], v[124:125], v[132:133] neg_lo:[0,0,1] neg_hi:[0,0,1]
    v_pk_fma_f32 v[26:27], v[26:27], v[126:127], v[134:135] neg_lo:[0,0,1] neg_hi:[0,0,1]
    v_pk_fma_f32 v[28:29], v[28:29], v[128:129], v[136:137] neg_lo:[0,0,1] neg_hi:[0,0,1]
    v_pk_fma_f32 v[30:31], v[30:31], v[130:131], v[138:139] neg_lo:[0,0,1] neg_hi:[0,0,1]
    v_cvt_pk_bf16_f32 v220, v24, v25
    v_cvt_pk_bf16_f32 v221, v26, v27
    v_cvt_pk_bf16_f32 v222, v28, v29
    v_cvt_pk_bf16_f32 v223, v30, v31
    buffer_store_dwordx4 v[220:223], v2, s[24:27], s47 offen offset:2048 sc1
    s_lshl_b32 s56, s34, 6
    s_add_u32 s56, s56, s33
    s_lshl_b32 s56, s56, 7
    s_add_u32 s56, s56, 11788288
    s_cmp_eq_u32 s3, 0
    s_cselect_b32 s57, 0, 0x40000000
    v_mov_b32 v56, s57
    v_mov_b32 v57, 0
    s_mov_b64 exec, 1
    s_waitcnt vmcnt(0)
    s_barrier
    buffer_store_dword v57, v56, s[24:27], s56 offen sc1
    s_mov_b64 exec, -1
    s_branch Lk4_entry
Lk1_end35:
    s_endpgm
Lk1_spare36:
    s_cmp_lt_u32 s3, 4
    s_cbranch_scc1 Lk1_pf55
    s_waitcnt lgkmcnt(0)
    s_barrier
    s_cmp_ge_u32 s2, 216
    s_cbranch_scc1 Lk4_entry
    s_branch Lk4_entry
Lk1_pf55:
    s_load_dwordx2 s[8:9], s[0:1], 32
    s_load_dwordx2 s[6:7], s[0:1], 48
    s_sub_u32 s34, s34, 24
    s_lshl_b32 s39, s34, 2
    s_add_u32 s39, s39, s3
    s_sub_u32 s39, 31, s39
    s_getpc_b64 s[44:45]
Lk1_pc56:
    s_add_u32 s44, s44, Lk3_entry-Lk1_pc56
    s_addc_u32 s45, s45, 0
    v_lshl_add_u32 v18, v1, 5, s34
    v_lshl_add_u32 v18, s3, 3, v18
    v_lshlrev_b32 v18, 7, v18
    v_cmp_gt_u32 vcc, Lk4_entry-Lk3_entry, v18
    v_mov_b32 v19, 0
    v_mov_b32 v16, s44
    v_mov_b32 v17, s45
    v_lshl_add_u64 v[16:17], v[18:19], 0, v[16:17]
    s_and_saveexec_b64 s[46:47], vcc
    global_load_dword v8, v[16:17], off
    s_mov_b64 exec, s[46:47]
    s_mov_b32 s98, 477218589
    s_movk_i32 s99, 8064
    s_mul_i32 s42, s33, 1152
    v_lshrrev_b32 v2, 4, v1
    v_and_b32 v3, 15, v1
    v_lshlrev_b32 v3, 7, v3
    v_lshl_add_u32 v3, v2, 12, v3
    s_waitcnt lgkmcnt(0)
    s_mov_b32 s12, s8
    s_mov_b32 s13, s9
    s_mov_b32 s14, 18874368
    s_mov_b32 s15, 0x20000
    s_mov_b32 s16, s6
    s_mov_b32 s17, s7
    s_mov_b32 s18, 18874368
    s_mov_b32 s19, 0x20000
    s_mov_b32 s98, 429496730
    s_movk_i32 s99, 7936
    s_and_b32 s97, s33, 1
    s_mul_i32 s42, s33, 9
    s_sub_u32 s42, s42, s97
    s_lshl_b32 s42, s42, 7
    s_lshr_b32 s35, s33, 1
    s_mul_i32 s35, s35, 4718592
    s_and_b32 s36, s33, 1
    s_lshl_b32 s36, s36, 11
    s_add_u32 s36, s36, s35
    s_lshl_b32 s35, s39, 14
    s_add_u32 s36, s36, s35
    s_add_u32 s36, s36, 1835008
    s_cmp_ge_u32 s39, 124
    s_cbranch_scc1 Lk1_w2d60
Lk1_w259:
    buffer_load_dword v8, v3, s[16:19], s36 offen
    s_add_u32 s36, s36, 524288
    s_add_u32 s39, s39, 32
    s_waitcnt vmcnt(1)
    s_cmp_lt_u32 s39, 124
    s_cbranch_scc1 Lk1_w259
Lk1_w2d60:
    s_cmp_ge_u32 s39, 244
    s_cbranch_scc1 Lk1_w1d58
Lk1_w157:
    s_lshl_b32 s40, s39, 6
    s_add_u32 s40, s40, 4294959360
    v_add_u32 v4, s40, v1
    v_mul_hi_u32 v5, v4, s98
    v_mul_u32_u24 v5, s99, v5
    v_lshl_add_u32 v6, v4, 7, v5
    buffer_load_dword v8, v6, s[12:15], s42 offen
    s_add_u32 s39, s39, 32
    s_waitcnt vmcnt(1)
    s_cmp_lt_u32 s39, 244
    s_cbranch_scc1 Lk1_w157
Lk1_w1d58:
    s_cmp_lt_u32 s2, 216
    s_waitcnt vmcnt(0)
    s_cbranch_scc1 Lk3_entry
    s_barrier
    s_branch Lk3_entry
    .p2align 6
Lk3_entry:
    s_cmp_ge_u32 s2, 216
    s_cbranch_scc1 Lk1_help63
    s_load_dwordx4 s[4:7], s[0:1], 32
    s_load_dwordx2 s[10:11], s[0:1], 80
    v_lshrrev_b32 v40, 6, v0
    v_and_b32 v1, 63, v0
    s_and_b32 s33, s2, 7
    v_readfirstlane_b32 s3, v40
    s_mul_i32 s33, s33, 27
    s_lshr_b32 s34, s2, 3
    s_add_u32 s33, s33, s34
    s_mul_i32 s34, s33, 171
    s_lshr_b32 s34, s34, 10
    s_mul_i32 s35, s34, 6
    s_sub_u32 s35, s33, s35
    s_lshr_b32 s36, s3, 1
    s_and_b32 s37, s3, 1
    v_lshlrev_b32 v2, 4, v1
    v_lshrrev_b32 v40, 4, v1
    v_and_b32 v41, 15, v1
    s_lshl_b32 s38, s37, 4
    v_add_u32 v42, s38, v40
    s_movk_i32 s39, 9216
    v_mul_u32_u24 v42, s39, v42
    v_lshlrev_b32 v43, 1, v40
    v_xor_b32 v43, v43, v41
    v_xor_b32 v44, 8, v43
    v_lshl_add_u32 v4, v43, 4, v42
    v_lshl_add_u32 v5, v44, 4, v42
    v_add_u32 v6, 71680, v4
    v_add_u32 v5, 35840, v5
    v_add_u32 v7, 71680, v5
    s_mul_i32 s40, s36, 36
    s_mul_i32 s41, s35, 6
    s_add_u32 s40, s40, s41
    s_mul_i32 s41, s37, 3
    s_add_u32 s40, s40, s41
    s_lshl_b32 s40, s40, 10
    s_mul_i32 s41, s36, 294912
    s_lshl_b32 s42, s34, 8
    s_add_u32 s41, s41, s42
    s_lshl_b32 s42, s36, 16
    s_lshl_b32 s43, s37, 12
    s_add_u32 s43, s43, s42
    s_waitcnt lgkmcnt(0)
    s_mov_b32 s12, s4
    s_mov_b32 s13, s5
    s_mov_b32 s14, 18874368
    s_mov_b32 s15, 0x20000
    s_add_u32 s16, s10, 2367488
    s_addc_u32 s17, s11, 0
    s_mov_b32 s18, 11821056
    s_mov_b32 s19, 0x20000
    s_mov_b32 s20, s6
    s_mov_b32 s21, s7
    s_mov_b32 s22, 9216
    s_mov_b32 s23, 0x20000
    s_add_u32 s24, s10, 7094272
    s_addc_u32 s25, s11, 0
    s_mov_b32 s26, 9158656
    s_mov_b32 s27, 0x20000
    s_lshl_b32 s44, s34, 8
    s_lshl_b32 s45, s36, 7
    s_add_u32 s44, s44, s45
    v_lshlrev_b32 v46, 3, v40
    v_bfe_u32 v42, v1, 2, 4
    v_and_b32 v43, 7, v42
    v_and_b32 v44, 3, v1
    v_lshlrev_b32 v44, 3, v44
    v_lshl_add_u32 v44, v42, 8, v44
    v_add_u32 v44, s42, v44
    s_xor_b32 s45, s36, 1
    s_lshl_b32 s45, s45, 2
    v_xor_b32 v43, s45, v43
    v_xor_b32 v45, 0, v43
    v_lshl_add_u32 v8, v45, 5, v44
    v_xor_b32 v45, 1, v43
    v_lshl_add_u32 v9, v45, 5, v44
    v_xor_b32 v45, 2, v43
    v_lshl_add_u32 v10, v45, 5, v44
    v_xor_b32 v45, 3, v43
    v_lshl_add_u32 v11, v45, 5, v44
    v_xor_b32 v45, 4, v43
    v_lshl_add_u32 v12, v45, 5, v44
    v_xor_b32 v45, 5, v43
    v_lshl_add_u32 v13, v45, 5, v44
    v_xor_b32 v45, 6, v43
    v_lshl_add_u32 v14, v45, 5, v44
    v_xor_b32 v45, 7, v43
    v_lshl_add_u32 v15, v45, 5, v44
    s_lshl_b32 s48, s34, 1
    s_add_u32 s48, s48, s36
    s_mul_i32 s48, s48, 72
    s_mul_i32 s45, s35, 6
    s_add_u32 s48, s48, s45
    s_mul_i32 s45, s37, 3
    s_add_u32 s48, s48, s45
    s_lshl_b32 s48, s48, 10
    s_mul_i32 s45, s34, 57
    s_lshr_b32 s45, s45, 9
    s_mul_i32 s45, s45, 128
    s_add_u32 s48, s48, s45
    s_add_u32 s49, s48, 36864
    s_mul_i32 s45, s37, 12288
    s_add_u32 s46, s45, s42
    s_xor_b32 s47, s46, 0x10000
    v_add_u32 v38, s46, v2
    v_add_u32 v39, s47, v2
    s_lshr_b32 s50, s35, 1
    s_lshl_b32 s50, s50, 13
    s_add_u32 s50, s50, 11788288
    s_mov_b32 s51, 0
    v_lshlrev_b32 v42, 7, v1
    s_add_u32 m0, s43, 0
    s_nop 0
    buffer_load_dwordx4 v4, s[12:15], s41 offen offset:0  lds
    buffer_load_dwordx4 v5, s[12:15], s41 offen offset:1024  lds
    buffer_load_dwordx4 v6, s[12:15], s41 offen offset:2048  lds
    buffer_load_dwordx4 v7, s[12:15], s41 offen offset:3072  lds
    s_add_u32 s41, s41, 589824
    s_add_u32 m0, s43, 8192
    s_nop 0
    buffer_load_dwordx4 v4, s[12:15], s41 offen offset:0  lds
    buffer_load_dwordx4 v5, s[12:15], s41 offen offset:1024  lds
    buffer_load_dwordx4 v6, s[12:15], s41 offen offset:2048  lds
    buffer_load_dwordx4 v7, s[12:15], s41 offen offset:3072  lds
    s_add_u32 s41, s41, 589824
    s_add_u32 m0, s43, 16384
    s_nop 0
    buffer_load_dwordx4 v4, s[12:15], s41 offen offset:0  lds
    buffer_load_dwordx4 v5, s[12:15], s41 offen offset:1024  lds
    buffer_load_dwordx4 v6, s[12:15], s41 offen offset:2048  lds
    buffer_load_dwordx4 v7, s[12:15], s41 offen offset:3072  lds
    s_add_u32 s41, s41, 589824
    buffer_load_dwordx2 v[48:49], v46, s[20:23], s44 offen offset:0
    buffer_load_dwordx2 v[50:51], v46, s[20:23], s44 offen offset:32
    buffer_load_dwordx2 v[52:53], v46, s[20:23], s44 offen offset:64
    buffer_load_dwordx2 v[54:55], v46, s[20:23], s44 offen offset:96
    s_barrier
    s_add_u32 m0, s43, 24576
    s_nop 0
    buffer_load_dwordx4 v4, s[12:15], s41 offen offset:0  lds
    buffer_load_dwordx4 v5, s[12:15], s41 offen offset:1024  lds
    buffer_load_dwordx4 v6, s[12:15], s41 offen offset:2048  lds
    buffer_load_dwordx4 v7, s[12:15], s41 offen offset:3072  lds
    s_add_u32 s41, s41, 589824
    s_cmp_lt_u32 s2, 192
    s_cbranch_scc1 Lk1_gg67
    s_lshr_b32 s52, s35, 1
    s_lshl_b32 s52, s52, 2
    s_add_u32 s52, s52, s3
    s_mul_i32 s52, s52, 3072
    s_mul_i32 s53, s37, 36864
    s_add_u32 s52, s52, s53
    s_add_u32 s52, s52, 519152
    s_mov_b32 s53, 73728
    v_mul_u32_u24 v44, s53, v1
    s_mov_b64 exec, 1
Lk1_gs66:
    buffer_load_dword v43, v44, s[16:19], s52 offen sc1
    s_add_u32 s51, s51, 1
    s_waitcnt vmcnt(0)
    v_cmp_eq_u32 vcc, -1, v43
    s_cmp_ge_u32 s51, 0x40000
    s_cbranch_scc1 Lk1_gg67
    s_and_b64 exec, exec, vcc
    s_cbranch_scc1 Lk1_gs66
Lk1_gg67:
    s_mov_b64 exec, -1
    s_mov_b32 s62, s40
    buffer_load_dwordx4 v[184:187], v2, s[16:19], s40 offen offset:0 sc1
    buffer_load_dwordx4 v[188:191], v2, s[16:19], s40 offen offset:1024 sc1
    buffer_load_dwordx4 v[192:195], v2, s[16:19], s40 offen offset:2048 sc1
    s_add_u32 s40, s40, 73728
    buffer_load_dwordx4 v[196:199], v2, s[16:19], s40 offen offset:0 sc1
    buffer_load_dwordx4 v[200:203], v2, s[16:19], s40 offen offset:1024 sc1
    buffer_load_dwordx4 v[204:207], v2, s[16:19], s40 offen offset:2048 sc1
    s_add_u32 s40, s40, 73728
    buffer_load_dwordx4 v[208:211], v2, s[16:19], s40 offen offset:0 sc1
    buffer_load_dwordx4 v[212:215], v2, s[16:19], s40 offen offset:1024 sc1
    buffer_load_dwordx4 v[216:219], v2, s[16:19], s40 offen offset:2048 sc1
    s_add_u32 s40, s40, 73728
    buffer_load_dwordx4 v[220:223], v2, s[16:19], s40 offen offset:0 sc1
    buffer_load_dwordx4 v[224:227], v2, s[16:19], s40 offen offset:1024 sc1
    buffer_load_dwordx4 v[228:231], v2, s[16:19], s40 offen offset:2048 sc1
    s_add_u32 s40, s40, 73728
    s_waitcnt vmcnt(12)
    v_lshlrev_b32 v16, 16, v48
    v_and_b32 v17, 0xffff0000, v48
    v_lshlrev_b32 v18, 16, v49
    v_and_b32 v19, 0xffff0000, v49
    v_lshlrev_b32 v20, 16, v50
    v_and_b32 v21, 0xffff0000, v50
    v_lshlrev_b32 v22, 16, v51
    v_and_b32 v23, 0xffff0000, v51
    v_lshlrev_b32 v24, 16, v52
    v_and_b32 v25, 0xffff0000, v52
    v_lshlrev_b32 v26, 16, v53
    v_and_b32 v27, 0xffff0000, v53
    v_lshlrev_b32 v28, 16, v54
    v_and_b32 v29, 0xffff0000, v54
    v_lshlrev_b32 v30, 16, v55
    v_and_b32 v31, 0xffff0000, v55
    s_waitcnt vmcnt(9)
    v_max3_u32 v40, v184, v185, v186
    v_max3_u32 v41, v187, v188, v189
    v_max3_u32 v45, v190, v191, v192
    v_max3_u32 v47, v193, v194, v195
    v_max3_u32 v40, v40, v41, v45
    v_max_u32 v40, v40, v47
    v_cmp_eq_u32 vcc, -1, v40
    s_cbranch_vccnz Lk1_hr68
Lk1_hk69:
    s_barrier
    ds_read_b64_tr_b16 v[152:153], v8 offset:0
    ds_read_b64_tr_b16 v[154:155], v8 offset:4096
    ds_read_b64_tr_b16 v[156:157], v9 offset:0
    ds_read_b64_tr_b16 v[158:159], v9 offset:4096
    ds_read_b64_tr_b16 v[160:161], v10 offset:0
    ds_read_b64_tr_b16 v[162:163], v10 offset:4096
    ds_read_b64_tr_b16 v[164:165], v11 offset:0
    ds_read_b64_tr_b16 v[166:167], v11 offset:4096
    s_waitcnt lgkmcnt(6)
    v_mfma_f32_16x16x32_bf16 v[56:59], v[152:155], v[184:187], 0
    ds_read_b64_tr_b16 v[168:169], v12 offset:0
    v_mfma_f32_16x16x32_bf16 v[60:63], v[152:155], v[188:191], 0
    ds_read_b64_tr_b16 v[170:171], v12 offset:4096
    v_mfma_f32_16x16x32_bf16 v[64:67], v[152:155], v[192:195], 0
    s_waitcnt lgkmcnt(6)
    v_mfma_f32_16x16x32_bf16 v[68:71], v[156:159], v[184:187], 0
    ds_read_b64_tr_b16 v[172:173], v13 offset:0
    v_mfma_f32_16x16x32_bf16 v[72:75], v[156:159], v[188:191], 0
    ds_read_b64_tr_b16 v[174:175], v13 offset:4096
    v_mfma_f32_16x16x32_bf16 v[76:79], v[156:159], v[192:195], 0
    s_waitcnt lgkmcnt(6)
    v_mfma_f32_16x16x32_bf16 v[80:83], v[160:163], v[184:187], 0
    ds_read_b64_tr_b16 v[176:177], v14 offset:0
    v_mfma_f32_16x16x32_bf16 v[84:87], v[160:163], v[188:191], 0
    ds_read_b64_tr_b16 v[178:179], v14 offset:4096
    v_mfma_f32_16x16x32_bf16 v[88:91], v[160:163], v[192:195], 0
    s_waitcnt lgkmcnt(6)
    v_mfma_f32_16x16x32_bf16 v[92:95], v[164:167], v[184:187], 0
    ds_read_b64_tr_b16 v[180:181], v15 offset:0
    v_mfma_f32_16x16x32_bf16 v[96:99], v[164:167], v[188:191], 0
    ds_read_b64_tr_b16 v[182:183], v15 offset:4096
    v_mfma_f32_16x16x32_bf16 v[100:103], v[164:167], v[192:195], 0
    s_waitcnt lgkmcnt(6)
    v_mfma_f32_16x16x32_bf16 v[104:107], v[168:171], v[184:187], v[16:19]
    s_waitcnt vmcnt(6)
    s_barrier
    ds_read_b64_tr_b16 v[152:153], v8 offset:8192
    s_add_u32 m0, s43, 32768
    s_nop 0
    buffer_load_dwordx4 v4, s[12:15], s41 offen offset:0  lds
    v_mfma_f32_16x16x32_bf16 v[108:111], v[168:171], v[188:191], v[16:19]
    ds_read_b64_tr_b16 v[154:155], v8 offset:12288
    v_mfma_f32_16x16x32_bf16 v[112:115], v[168:171], v[192:195], v[16:19]
    s_waitcnt lgkmcnt(6)
    v_mfma_f32_16x16x32_bf16 v[116:119], v[172:175], v[184:187], v[20:23]
    ds_read_b64_tr_b16 v[156:157], v9 offset:8192
    v_max3_u32 v40, v196, v197, v198
    buffer_load_dwordx4 v5, s[12:15], s41 offen offset:1024  lds
    v_mfma_f32_16x16x32_bf16 v[120:123], v[172:175], v[188:191], v[20:23]
    ds_read_b64_tr_b16 v[158:159], v9 offset:12288
    v_max3_u32 v41, v199, v200, v201
    v_mfma_f32_16x16x32_bf16 v[124:127], v[172:175], v[192:195], v[20:23]
    v_max3_u32 v45, v202, v203, v204
    s_waitcnt lgkmcnt(6)
    v_mfma_f32_16x16x32_bf16 v[128:131], v[176:179], v[184:187], v[24:27]
    ds_read_b64_tr_b16 v[160:161], v10 offset:8192
    v_max3_u32 v47, v205, v206, v207
    buffer_load_dwordx4 v6, s[12:15], s41 offen offset:2048  lds
    v_mfma_f32_16x16x32_bf16 v[132:135], v[176:179], v[188:191], v[24:27]
    ds_read_b64_tr_b16 v[162:163], v10 offset:12288
    v_max3_u32 v40, v40, v41, v45
    v_mfma_f32_16x16x32_bf16 v[136:139], v[176:179], v[192:195], v[24:27]
    v_max_u32 v40, v40, v47
    s_waitcnt lgkmcnt(6)
    v_mfma_f32_16x16x32_bf16 v[140:143], v[180:183], v[184:187], v[28:31]
    ds_read_b64_tr_b16 v[164:165], v11 offset:8192
    v_cmp_eq_u32 vcc, -1, v40
    buffer_load_dwordx4 v7, s[12:15], s41 offen offset:3072  lds
    s_add_u32 s41, s41, 589824
    v_mfma_f32_16x16x32_bf16 v[144:147], v[180:183], v[188:191], v[28:31]
    ds_read_b64_tr_b16 v[166:167], v11 offset:12288
    s_cbranch_vccnz Lk1_hr70
Lk1_hk71:
    v_mfma_f32_16x16x32_bf16 v[148:151], v[180:183], v[192:195], v[28:31]
    s_waitcnt lgkmcnt(6)
    v_mfma_f32_16x16x32_bf16 v[56:59], v[152:155], v[196:199], v[56:59]
    ds_read_b64_tr_b16 v[168:169], v12 offset:8192
    buffer_load_dwordx4 v[232:235], v2, s[16:19], s40 offen offset:0 sc1
    v_mfma_f32_16x16x32_bf16 v[60:63], v[152:155], v[200:203], v[60:63]
    ds_read_b64_tr_b16 v[170:171], v12 offset:12288
    v_mfma_f32_16x16x32_bf16 v[64:67], v[152:155], v[204:207], v[64:67]
    s_waitcnt lgkmcnt(6)
    v_mfma_f32_16x16x32_bf16 v[68:71], v[156:159], v[196:199], v[68:71]
    ds_read_b64_tr_b16 v[172:173], v13 offset:8192
    buffer_load_dwordx4 v[236:239], v2, s[16:19], s40 offen offset:1024 sc1
    v_mfma_f32_16x16x32_bf16 v[72:75], v[156:159], v[200:203], v[72:75]
    ds_read_b64_tr_b16 v[174:175], v13 offset:12288
    v_mfma_f32_16x16x32_bf16 v[76:79], v[156:159], v[204:207], v[76:79]
    s_waitcnt lgkmcnt(6)
    v_mfma_f32_16x16x32_bf16 v[80:83], v[160:163], v[196:199], v[80:83]
    ds_read_b64_tr_b16 v[176:177], v14 offset:8192
    buffer_load_dwordx4 v[240:243], v2, s[16:19], s40 offen offset:2048 sc1
    s_add_u32 s40, s40, 73728
    v_mfma_f32_16x16x32_bf16 v[84:87], v[160:163], v[200:203], v[84:87]
    ds_read_b64_tr_b16 v[178:179], v14 offset:12288
    v_mfma_f32_16x16x32_bf16 v[88:91], v[160:163], v[204:207], v[88:91]
    s_waitcnt lgkmcnt(6)
    v_mfma_f32_16x16x32_bf16 v[92:95], v[164:167], v[196:199], v[92:95]
    ds_read_b64_tr_b16 v[180:181], v15 offset:8192
    v_mfma_f32_16x16x32_bf16 v[96:99], v[164:167], v[200:203], v[96:99]
    ds_read_b64_tr_b16 v[182:183], v15 offset:12288
    v_mfma_f32_16x16x32_bf16 v[100:103], v[164:167], v[204:207], v[100:103]
    s_waitcnt lgkmcnt(6)
    v_mfma_f32_16x16x32_bf16 v[104:107], v[168:171], v[196:199], v[104:107]
    s_waitcnt vmcnt(10)
    s_barrier
    ds_read_b64_tr_b16 v[152:153], v8 offset:16384
    s_add_u32 m0, s43, 40960
    s_nop 0
    buffer_load_dwordx4 v4, s[12:15], s41 offen offset:0  lds
    v_mfma_f32_16x16x32_bf16 v[108:111], v[168:171], v[200:203], v[108:111]
    ds_read_b64_tr_b16 v[154:155], v8 offset:20480
    v_mfma_f32_16x16x32_bf16 v[112:115], v[168:171], v[204:207], v[112:115]
    s_waitcnt lgkmcnt(6)
    v_mfma_f32_16x16x32_bf16 v[116:119], v[172:175], v[196:199], v[116:119]
    ds_read_b64_tr_b16 v[156:157], v9 offset:16384
    v_max3_u32 v40, v208, v209, v210
    buffer_load_dwordx4 v5, s[12:15], s41 offen offset:1024  lds
    v_mfma_f32_16x16x32_bf16 v[120:123], v[172:175], v[200:203], v[120:123]
    ds_read_b64_tr_b16 v[158:159], v9 offset:20480
    v_max3_u32 v41, v211, v212, v213
    v_mfma_f32_16x16x32_bf16 v[124:127], v[172:175], v[204:207], v[124:127]
    v_max3_u32 v45, v214, v215, v216
    s_waitcnt lgkmcnt(6)
    v_mfma_f32_16x16x32_bf16 v[128:131], v[176:179], v[196:199], v[128:131]
    ds_read_b64_tr_b16 v[160:161], v10 offset:16384
    v_max3_u32 v47, v217, v218, v219
    buffer_load_dwordx4 v6, s[12:15], s41 offen offset:2048  lds
    v_mfma_f32_16x16x32_bf16 v[132:135], v[176:179], v[200:203], v[132:135]
    ds_read_b64_tr_b16 v[162:163], v10 offset:20480
    v_max3_u32 v40, v40, v41, v45
    v_mfma_f32_16x16x32_bf16 v[136:139], v[176:179], v[204:207], v[136:139]
    v_max_u32 v40, v40, v47
    s_waitcnt lgkmcnt(6)
    v_mfma_f32_16x16x32_bf16 v[140:143], v[180:183], v[196:199], v[140:143]
    ds_read_b64_tr_b16 v[164:165], v11 offset:16384
    v_cmp_eq_u32 vcc, -1, v40
    buffer_load_dwordx4 v7, s[12:15], s41 offen offset:3072  lds
    s_add_u32 s41, s41, 589824
    v_mfma_f32_16x16x32_bf16 v[144:147], v[180:183], v[200:203], v[144:147]
    ds_read_b64_tr_b16 v[166:167], v11 offset:20480
    s_cbranch_vccnz Lk1_hr73
Lk1_hk74:
    v_mfma_f32_16x16x32_bf16 v[148:151], v[180:183], v[204:207], v[148:151]
    s_waitcnt lgkmcnt(6)
    v_mfma_f32_16x16x32_bf16 v[56:59], v[152:155], v[208:211], v[56:59]
    ds_read_b64_tr_b16 v[168:169], v12 offset:16384
    buffer_load_dwordx4 v[244:247], v2, s[16:19], s40 offen offset:0 sc1
    v_mfma_f32_16x16x32_bf16 v[60:63], v[152:155], v[212:215], v[60:63]
    ds_read_b64_tr_b16 v[170:171], v12 offset:20480
    v_mfma_f32_16x16x32_bf16 v[64:67], v[152:155], v[216:219], v[64:67]
    s_waitcnt lgkmcnt(6)
    v_mfma_f32_16x16x32_bf16 v[68:71], v[156:159], v[208:211], v[68:71]
    ds_read_b64_tr_b16 v[172:173], v13 offset:16384
    buffer_load_dwordx4 v[248:251], v2, s[16:19], s40 offen offset:1024 sc1
    s_cmp_lg_u32 s3, 0
    s_cbranch_scc1 Lk1_h472
    buffer_load_dword v43, v42, s[16:19], s50 offen sc1
Lk1_h472:
    v_mfma_f32_16x16x32_bf16 v[72:75], v[156:159], v[212:215], v[72:75]
    ds_read_b64_tr_b16 v[174:175], v13 offset:20480
    v_mfma_f32_16x16x32_bf16 v[76:79], v[156:159], v[216:219], v[76:79]
    s_waitcnt lgkmcnt(6)
    v_mfma_f32_16x16x32_bf16 v[80:83], v[160:163], v[208:211], v[80:83]
    ds_read_b64_tr_b16 v[176:177], v14 offset:16384
    buffer_load_dwordx4 v[252:255], v2, s[16:19], s40 offen offset:2048 sc1
    s_add_u32 s40, s40, 73728
    v_mfma_f32_16x16x32_bf16 v[84:87], v[160:163], v[212:215], v[84:87]
    ds_read_b64_tr_b16 v[178:179], v14 offset:20480
    v_mfma_f32_16x16x32_bf16 v[88:91], v[160:163], v[216:219], v[88:91]
    s_waitcnt lgkmcnt(6)
    v_mfma_f32_16x16x32_bf16 v[92:95], v[164:167], v[208:211], v[92:95]
    ds_read_b64_tr_b16 v[180:181], v15 offset:16384
    v_mfma_f32_16x16x32_bf16 v[96:99], v[164:167], v[212:215], v[96:99]
    ds_read_b64_tr_b16 v[182:183], v15 offset:20480
    v_mfma_f32_16x16x32_bf16 v[100:103], v[164:167], v[216:219], v[100:103]
    s_waitcnt lgkmcnt(6)
    v_mfma_f32_16x16x32_bf16 v[104:107], v[168:171], v[208:211], v[104:107]
    s_waitcnt vmcnt(14)
    s_barrier
    ds_read_b64_tr_b16 v[152:153], v8 offset:24576
    s_add_u32 m0, s43, 49152
    s_nop 0
    buffer_load_dwordx4 v4, s[12:15], s41 offen offset:0  lds
    v_mfma_f32_16x16x32_bf16 v[108:111], v[168:171], v[212:215], v[108:111]
    ds_read_b64_tr_b16 v[154:155], v8 offset:28672
    v_mfma_f32_16x16x32_bf16 v[112:115], v[168:171], v[216:219], v[112:115]
    s_waitcnt lgkmcnt(6)
    v_mfma_f32_16x16x32_bf16 v[116:119], v[172:175], v[208:211], v[116:119]
    ds_read_b64_tr_b16 v[156:157], v9 offset:24576
    v_max3_u32 v40, v220, v221, v222
    buffer_load_dwordx4 v5, s[12:15], s41 offen offset:1024  lds
    v_mfma_f32_16x16x32_bf16 v[120:123], v[172:175], v[212:215], v[120:123]
    ds_read_b64_tr_b16 v[158:159], v9 offset:28672
    v_max3_u32 v41, v223, v224, v225
    v_mfma_f32_16x16x32_bf16 v[124:127], v[172:175], v[216:219], v[124:127]
    v_max3_u32 v45, v226, v227, v228
    s_waitcnt lgkmcnt(6)
    v_mfma_f32_16x16x32_bf16 v[128:131], v[176:179], v[208:211], v[128:131]
    ds_read_b64_tr_b16 v[160:161], v10 offset:24576
    v_max3_u32 v47, v229, v230, v231
    buffer_load_dwordx4 v6, s[12:15], s41 offen offset:2048  lds
    v_mfma_f32_16x16x32_bf16 v[132:135], v[176:179], v[212:215], v[132:135]
    ds_read_b64_tr_b16 v[162:163], v10 offset:28672
    v_max3_u32 v40, v40, v41, v45
    v_mfma_f32_16x16x32_bf16 v[136:139], v[176:179], v[216:219], v[136:139]
    v_max_u32 v40, v40, v47
    s_waitcnt lgkmcnt(6)
    v_mfma_f32_16x16x32_bf16 v[140:143], v[180:183], v[208:211], v[140:143]
    ds_read_b64_tr_b16 v[164:165], v11 offset:24576
    v_cmp_eq_u32 vcc, -1, v40
    buffer_load_dwordx4 v7, s[12:15], s41 offen offset:3072  lds
    s_add_u32 s41, s41, 589824
    v_mfma_f32_16x16x32_bf16 v[144:147], v[180:183], v[212:215], v[144:147]
    ds_read_b64_tr_b16 v[166:167], v11 offset:28672
    s_cbranch_vccnz Lk1_hr75
Lk1_hk76:
    v_mfma_f32_16x16x32_bf16 v[148:151], v[180:183], v[216:219], v[148:151]
    s_waitcnt lgkmcnt(6)
    v_mfma_f32_16x16x32_bf16 v[56:59], v[152:155], v[220:223], v[56:59]
    ds_read_b64_tr_b16 v[168:169], v12 offset:24576
    buffer_load_dwordx4 v[184:187], v2, s[16:19], s40 offen offset:0 sc1
    v_mfma_f32_16x16x32_bf16 v[60:63], v[152:155], v[224:227], v[60:63]
    ds_read_b64_tr_b16 v[170:171], v12 offset:28672
    v_mfma_f32_16x16x32_bf16 v[64:67], v[152:155], v[228:231], v[64:67]
    s_waitcnt lgkmcnt(6)
    v_mfma_f32_16x16x32_bf16 v[68:71], v[156:159], v[220:223], v[68:71]
    ds_read_b64_tr_b16 v[172:173], v13 offset:24576
    buffer_load_dwordx4 v[188:191], v2, s[16:19], s40 offen offset:1024 sc1
    v_mfma_f32_16x16x32_bf16 v[72:75], v[156:159], v[224:227], v[72:75]
    ds_read_b64_tr_b16 v[174:175], v13 offset:28672
    v_mfma_f32_16x16x32_bf16 v[76:79], v[156:159], v[228:231], v[76:79]
    s_waitcnt lgkmcnt(6)
    v_mfma_f32_16x16x32_bf16 v[80:83], v[160:163], v[220:223], v[80:83]
    ds_read_b64_tr_b16 v[176:177], v14 offset:24576
    buffer_load_dwordx4 v[192:195], v2, s[16:19], s40 offen offset:2048 sc1
    s_add_u32 s40, s40, 73728
    v_mfma_f32_16x16x32_bf16 v[84:87], v[160:163], v[224:227], v[84:87]
    ds_read_b64_tr_b16 v[178:179], v14 offset:28672
    v_mfma_f32_16x16x32_bf16 v[88:91], v[160:163], v[228:231], v[88:91]
    s_waitcnt lgkmcnt(6)
    v_mfma_f32_16x16x32_bf16 v[92:95], v[164:167], v[220:223], v[92:95]
    ds_read_b64_tr_b16 v[180:181], v15 offset:24576
    v_mfma_f32_16x16x32_bf16 v[96:99], v[164:167], v[224:227], v[96:99]
    ds_read_b64_tr_b16 v[182:183], v15 offset:28672
    v_mfma_f32_16x16x32_bf16 v[100:103], v[164:167], v[228:231], v[100:103]
    s_waitcnt lgkmcnt(6)
    v_mfma_f32_16x16x32_bf16 v[104:107], v[168:171], v[220:223], v[104:107]
    s_waitcnt vmcnt(14)
    s_barrier
    ds_read_b64_tr_b16 v[152:153], v8 offset:32768
    s_add_u32 m0, s43, 57344
    s_nop 0
    buffer_load_dwordx4 v4, s[12:15], s41 offen offset:0  lds
    v_mfma_f32_16x16x32_bf16 v[108:111], v[168:171], v[224:227], v[108:111]
    ds_read_b64_tr_b16 v[154:155], v8 offset:36864
    v_mfma_f32_16x16x32_bf16 v[112:115], v[168:171], v[228:231], v[112:115]
    s_waitcnt lgkmcnt(6)
    v_mfma_f32_16x16x32_bf16 v[116:119], v[172:175], v[220:223], v[116:119]
    ds_read_b64_tr_b16 v[156:157], v9 offset:32768
    v_max3_u32 v40, v232, v233, v234
    buffer_load_dwordx4 v5, s[12:15], s41 offen offset:1024  lds
    v_mfma_f32_16x16x32_bf16 v[120:123], v[172:175], v[224:227], v[120:123]
    ds_read_b64_tr_b16 v[158:159], v9 offset:36864
    v_max3_u32 v41, v235, v236, v237
    v_mfma_f32_16x16x32_bf16 v[124:127], v[172:175], v[228:231], v[124:127]
    v_max3_u32 v45, v238, v239, v240
    s_waitcnt lgkmcnt(6)
    v_mfma_f32_16x16x32_bf16 v[128:131], v[176:179], v[220:223], v[128:131]
    ds_read_b64_tr_b16 v[160:161], v10 offset:32768
    v_max3_u32 v47, v241, v242, v243
    buffer_load_dwordx4 v6, s[12:15], s41 offen offset:2048  lds
    v_mfma_f32_16x16x32_bf16 v[132:135], v[176:179], v[224:227], v[132:135]
    ds_read_b64_tr_b16 v[162:163], v10 offset:36864
    v_max3_u32 v40, v40, v41, v45
    v_mfma_f32_16x16x32_bf16 v[136:139], v[176:179], v[228:231], v[136:139]
    v_max_u32 v40, v40, v47
    s_waitcnt lgkmcnt(6)
    v_mfma_f32_16x16x32_bf16 v[140:143], v[180:183], v[220:223], v[140:143]
    ds_read_b64_tr_b16 v[164:165], v11 offset:32768
    v_cmp_eq_u32 vcc, -1, v40
    buffer_load_dwordx4 v7, s[12:15], s41 offen offset:3072  lds
    s_add_u32 s41, s41, 589824
    v_mfma_f32_16x16x32_bf16 v[144:147], v[180:183], v[224:227], v[144:147]
    ds_read_b64_tr_b16 v[166:167], v11 offset:36864
    s_cbranch_vccnz Lk1_hr77
Lk1_hk78:
    v_mfma_f32_16x16x32_bf16 v[148:151], v[180:183], v[228:231], v[148:151]
    s_waitcnt lgkmcnt(6)
    v_mfma_f32_16x16x32_bf16 v[56:59], v[152:155], v[232:235], v[56:59]
    ds_read_b64_tr_b16 v[168:169], v12 offset:32768
    buffer_load_dwordx4 v[196:199], v2, s[16:19], s40 offen offset:0 sc1
    v_mfma_f32_16x16x32_bf16 v[60:63], v[152:155], v[236:239], v[60:63]
    ds_read_b64_tr_b16 v[170:171], v12 offset:36864
    v_mfma_f32_16x16x32_bf16 v[64:67], v[152:155], v[240:243], v[64:67]
    s_waitcnt lgkmcnt(6)
    v_mfma_f32_16x16x32_bf16 v[68:71], v[156:159], v[232:235], v[68:71]
    ds_read_b64_tr_b16 v[172:173], v13 offset:32768
    buffer_load_dwordx4 v[200:203], v2, s[16:19], s40 offen offset:1024 sc1
    v_mfma_f32_16x16x32_bf16 v[72:75], v[156:159], v[236:239], v[72:75]
    ds_read_b64_tr_b16 v[174:175], v13 offset:36864
    v_mfma_f32_16x16x32_bf16 v[76:79], v[156:159], v[240:243], v[76:79]
    s_waitcnt lgkmcnt(6)
    v_mfma_f32_16x16x32_bf16 v[80:83], v[160:163], v[232:235], v[80:83]
    ds_read_b64_tr_b16 v[176:177], v14 offset:32768
    buffer_load_dwordx4 v[204:207], v2, s[16:19], s40 offen offset:2048 sc1
    s_add_u32 s40, s40, 73728
    v_mfma_f32_16x16x32_bf16 v[84:87], v[160:163], v[236:239], v[84:87]
    ds_read_b64_tr_b16 v[178:179], v14 offset:36864
    v_mfma_f32_16x16x32_bf16 v[88:91], v[160:163], v[240:243], v[88:91]
    s_waitcnt lgkmcnt(6)
    v_mfma_f32_16x16x32_bf16 v[92:95], v[164:167], v[232:235], v[92:95]
    ds_read_b64_tr_b16 v[180:181], v15 offset:32768
    v_mfma_f32_16x16x32_bf16 v[96:99], v[164:167], v[236:239], v[96:99]
    ds_read_b64_tr_b16 v[182:183], v15 offset:36864
    v_mfma_f32_16x16x32_bf16 v[100:103], v[164:167], v[240:243], v[100:103]
    s_waitcnt lgkmcnt(6)
    v_mfma_f32_16x16x32_bf16 v[104:107], v[168:171], v[232:235], v[104:107]
    s_waitcnt vmcnt(14)
    s_cmp_lg_u32 s3, 0
    s_cbranch_scc1 Lk1_h680
    v_cmp_ne_u32 vcc, 0, v43
    s_and_b64 exec, exec, vcc
    s_cbranch_scc0 Lk1_h680
Lk1_h579:
    buffer_load_dword v43, v42, s[16:19], s50 offen sc1
    s_add_u32 s51, s51, 1
    s_waitcnt vmcnt(0)
    v_cmp_ne_u32 vcc, 0, v43
    s_cmp_ge_u32 s51, 0x40000
    s_cbranch_scc1 Lk1_h680
    s_and_b64 exec, exec, vcc
    s_cbranch_scc1 Lk1_h579
Lk1_h680:
    s_mov_b64 exec, -1
    s_barrier
    ds_read_b64_tr_b16 v[152:153], v8 offset:40960
    s_add_u32 m0, s43, 0
    s_nop 0
    buffer_load_dwordx4 v4, s[12:15], s41 offen offset:0  lds
    v_mfma_f32_16x16x32_bf16 v[108:111], v[168:171], v[236:239], v[108:111]
    ds_read_b64_tr_b16 v[154:155], v8 offset:45056
    v_mfma_f32_16x16x32_bf16 v[112:115], v[168:171], v[240:243], v[112:115]
    s_waitcnt lgkmcnt(6)
    v_mfma_f32_16x16x32_bf16 v[116:119], v[172:175], v[232:235], v[116:119]
    ds_read_b64_tr_b16 v[156:157], v9 offset:40960
    v_max3_u32 v40, v244, v245, v246
    buffer_load_dwordx4 v5, s[12:15], s41 offen offset:1024  lds
    v_mfma_f32_16x16x32_bf16 v[120:123], v[172:175], v[236:239], v[120:123]
    ds_read_b64_tr_b16 v[158:159], v9 offset:45056
    v_max3_u32 v41, v247, v248, v249
    v_mfma_f32_16x16x32_bf16 v[124:127], v[172:175], v[240:243], v[124:127]
    v_max3_u32 v45, v250, v251, v252
    s_waitcnt lgkmcnt(6)
    v_mfma_f32_16x16x32_bf16 v[128:131], v[176:179], v[232:235], v[128:131]
    ds_read_b64_tr_b16 v[160:161], v10 offset:40960
    v_max3_u32 v47, v253, v254, v255
    buffer_load_dwordx4 v6, s[12:15], s41 offen offset:2048  lds
    v_mfma_f32_16x16x32_bf16 v[132:135], v[176:179], v[236:239], v[132:135]
    ds_read_b64_tr_b16 v[162:163], v10 offset:45056
    v_max3_u32 v40, v40, v41, v45
    v_mfma_f32_16x16x32_bf16 v[136:139], v[176:179], v[240:243], v[136:139]
    v_max_u32 v40, v40, v47
    s_waitcnt lgkmcnt(6)
    v_mfma_f32_16x16x32_bf16 v[140:143], v[180:183], v[232:235], v[140:143]
    ds_read_b64_tr_b16 v[164:165], v11 offset:40960
    v_cmp_eq_u32 vcc, -1, v40
    buffer_load_dwordx4 v7, s[12:15], s41 offen offset:3072  lds
    s_add_u32 s41, s41, 589824
    v_mfma_f32_16x16x32_bf16 v[144:147], v[180:183], v[236:239], v[144:147]
    ds_read_b64_tr_b16 v[166:167], v11 offset:45056
    s_cbranch_vccnz Lk1_hr81
Lk1_hk82:
    v_mfma_f32_16x16x32_bf16 v[148:151], v[180:183], v[240:243], v[148:151]
    s_waitcnt lgkmcnt(6)
    v_mfma_f32_16x16x32_bf16 v[56:59], v[152:155], v[244:247], v[56:59]
    ds_read_b64_tr_b16 v[168:169], v12 offset:40960
    buffer_load_dwordx4 v[208:211], v2, s[16:19], s40 offen offset:0 sc1
    v_mfma_f32_16x16x32_bf16 v[60:63], v[152:155], v[248:251], v[60:63]
    ds_read_b64_tr_b16 v[170:171], v12 offset:45056
    v_mfma_f32_16x16x32_bf16 v[64:67], v[152:155], v[252:255], v[64:67]
    s_waitcnt lgkmcnt(6)
    v_mfma_f32_16x16x32_bf16 v[68:71], v[156:159], v[244:247], v[68:71]
    ds_read_b64_tr_b16 v[172:173], v13 offset:40960
    buffer_load_dwordx4 v[212:215], v2, s[16:19], s40 offen offset:1024 sc1
    v_mfma_f32_16x16x32_bf16 v[72:75], v[156:159], v[248:251], v[72:75]
    ds_read_b64_tr_b16 v[174:175], v13 offset:45056
    v_mfma_f32_16x16x32_bf16 v[76:79], v[156:159], v[252:255], v[76:79]
    s_waitcnt lgkmcnt(6)
    v_mfma_f32_16x16x32_bf16 v[80:83], v[160:163], v[244:247], v[80:83]
    ds_read_b64_tr_b16 v[176:177], v14 offset:40960
    buffer_load_dwordx4 v[216:219], v2, s[16:19], s40 offen offset:2048 sc1
    s_add_u32 s40, s40, 73728
    v_mfma_f32_16x16x32_bf16 v[84:87], v[160:163], v[248:251], v[84:87]
    ds_read_b64_tr_b16 v[178:179], v14 offset:45056
    v_mfma_f32_16x16x32_bf16 v[88:91], v[160:163], v[252:255], v[88:91]
    s_waitcnt lgkmcnt(6)
    v_mfma_f32_16x16x32_bf16 v[92:95], v[164:167], v[244:247], v[92:95]
    ds_read_b64_tr_b16 v[180:181], v15 offset:40960
    v_mfma_f32_16x16x32_bf16 v[96:99], v[164:167], v[248:251], v[96:99]
    ds_read_b64_tr_b16 v[182:183], v15 offset:45056
    v_mfma_f32_16x16x32_bf16 v[100:103], v[164:167], v[252:255], v[100:103]
    s_waitcnt lgkmcnt(6)
    v_mfma_f32_16x16x32_bf16 v[104:107], v[168:171], v[244:247], v[104:107]
    s_waitcnt vmcnt(14)
    s_barrier
    ds_read_b64_tr_b16 v[152:153], v8 offset:49152
    s_add_u32 m0, s43, 8192
    s_nop 0
    buffer_load_dwordx4 v4, s[12:15], s41 offen offset:0  lds
    v_mfma_f32_16x16x32_bf16 v[108:111], v[168:171], v[248:251], v[108:111]
    ds_read_b64_tr_b16 v[154:155], v8 offset:53248
    v_mfma_f32_16x16x32_bf16 v[112:115], v[168:171], v[252:255], v[112:115]
    s_waitcnt lgkmcnt(6)
    v_mfma_f32_16x16x32_bf16 v[116:119], v[172:175], v[244:247], v[116:119]
    ds_read_b64_tr_b16 v[156:157], v9 offset:49152
    v_max3_u32 v40, v184, v185, v186
    buffer_load_dwordx4 v5, s[12:15], s41 offen offset:1024  lds
    v_mfma_f32_16x16x32_bf16 v[120:123], v[172:175], v[248:251], v[120:123]
    ds_read_b64_tr_b16 v[158:159], v9 offset:53248
    v_max3_u32 v41, v187, v188, v189
    v_mfma_f32_16x16x32_bf16 v[124:127], v[172:175], v[252:255], v[124:127]
    v_max3_u32 v45, v190, v191, v192
    s_waitcnt lgkmcnt(6)
    v_mfma_f32_16x16x32_bf16 v[128:131], v[176:179], v[244:247], v[128:131]
    ds_read_b64_tr_b16 v[160:161], v10 offset:49152
    v_max3_u32 v47, v193, v194, v195
    buffer_load_dwordx4 v6, s[12:15], s41 offen offset:2048  lds
    v_mfma_f32_16x16x32_bf16 v[132:135], v[176:179], v[248:251], v[132:135]
    ds_read_b64_tr_b16 v[162:163], v10 offset:53248
    v_max3_u32 v40, v40, v41, v45
    v_mfma_f32_16x16x32_bf16 v[136:139], v[176:179], v[252:255], v[136:139]
    v_max_u32 v40, v40, v47
    s_waitcnt lgkmcnt(6)
    v_mfma_f32_16x16x32_bf16 v[140:143], v[180:183], v[244:247], v[140:143]
    ds_read_b64_tr_b16 v[164:165], v11 offset:49152
    v_cmp_eq_u32 vcc, -1, v40
    buffer_load_dwordx4 v7, s[12:15], s41 offen offset:3072  lds
    s_add_u32 s41, s41, 589824
    v_mfma_f32_16x16x32_bf16 v[144:147], v[180:183], v[248:251], v[144:147]
    ds_read_b64_tr_b16 v[166:167], v11 offset:53248
    s_cbranch_vccnz Lk1_hr83
Lk1_hk84:
    v_mfma_f32_16x16x32_bf16 v[148:151], v[180:183], v[252:255], v[148:151]
    s_waitcnt lgkmcnt(6)
    v_mfma_f32_16x16x32_bf16 v[56:59], v[152:155], v[184:187], v[56:59]
    ds_read_b64_tr_b16 v[168:169], v12 offset:49152
    buffer_load_dwordx4 v[220:223], v2, s[16:19], s40 offen offset:0 sc1
    v_mfma_f32_16x16x32_bf16 v[60:63], v[152:155], v[188:191], v[60:63]
    ds_read_b64_tr_b16 v[170:171], v12 offset:53248
    v_mfma_f32_16x16x32_bf16 v[64:67], v[152:155], v[192:195], v[64:67]
    s_waitcnt lgkmcnt(6)
    v_mfma_f32_16x16x32_bf16 v[68:71], v[156:159], v[184:187], v[68:71]
    ds_read_b64_tr_b16 v[172:173], v13 offset:49152
    buffer_load_dwordx4 v[224:227], v2, s[16:19], s40 offen offset:1024 sc1
    v_mfma_f32_16x16x32_bf16 v[72:75], v[156:159], v[188:191], v[72:75]
    ds_read_b64_tr_b16 v[174:175], v13 offset:53248
    v_mfma_f32_16x16x32_bf16 v[76:79], v[156:159], v[192:195], v[76:79]
    s_waitcnt lgkmcnt(6)
    v_mfma_f32_16x16x32_bf16 v[80:83], v[160:163], v[184:187], v[80:83]
    ds_read_b64_tr_b16 v[176:177], v14 offset:49152
    buffer_load_dwordx4 v[228:231], v2, s[16:19], s40 offen offset:2048 sc1
    s_add_u32 s40, s40, 73728
    v_mfma_f32_16x16x32_bf16 v[84:87], v[160:163], v[188:191], v[84:87]
    ds_read_b64_tr_b16 v[178:179], v14 offset:53248
    v_mfma_f32_16x16x32_bf16 v[88:91], v[160:163], v[192:195], v[88:91]
    s_waitcnt lgkmcnt(6)
    v_mfma_f32_16x16x32_bf16 v[92:95], v[164:167], v[184:187], v[92:95]
    ds_read_b64_tr_b16 v[180:181], v15 offset:49152
    v_mfma_f32_16x16x32_bf16 v[96:99], v[164:167], v[188:191], v[96:99]
    ds_read_b64_tr_b16 v[182:183], v15 offset:53248
    v_mfma_f32_16x16x32_bf16 v[100:103], v[164:167], v[192:195], v[100:103]
    s_waitcnt lgkmcnt(6)
    v_mfma_f32_16x16x32_bf16 v[104:107], v[168:171], v[184:187], v[104:107]
    s_waitcnt vmcnt(14)
    s_barrier
    ds_read_b64_tr_b16 v[152:153], v8 offset:57344
    s_add_u32 m0, s43, 16384
    s_nop 0
    buffer_load_dwordx4 v4, s[12:15], s41 offen offset:0  lds
    v_mfma_f32_16x16x32_bf16 v[108:111], v[168:171], v[188:191], v[108:111]
    ds_read_b64_tr_b16 v[154:155], v8 offset:61440
    v_mfma_f32_16x16x32_bf16 v[112:115], v[168:171], v[192:195], v[112:115]
    s_waitcnt lgkmcnt(6)
    v_mfma_f32_16x16x32_bf16 v[116:119], v[172:175], v[184:187], v[116:119]
    ds_read_b64_tr_b16 v[156:157], v9 offset:57344
    v_max3_u32 v40, v196, v197, v198
    buffer_load_dwordx4 v5, s[12:15], s41 offen offset:1024  lds
    v_mfma_f32_16x16x32_bf16 v[120:123], v[172:175], v[188:191], v[120:123]
    ds_read_b64_tr_b16 v[158:159], v9 offset:61440
    v_max3_u32 v41, v199, v200, v201
    v_mfma_f32_16x16x32_bf16 v[124:127], v[172:175], v[192:195], v[124:127]
    v_max3_u32 v45, v202, v203, v204
    s_waitcnt lgkmcnt(6)
    v_mfma_f32_16x16x32_bf16 v[128:131], v[176:179], v[184:187], v[128:131]
    ds_read_b64_tr_b16 v[160:161], v10 offset:57344
    v_max3_u32 v47, v205, v206, v207
    buffer_load_dwordx4 v6, s[12:15], s41 offen offset:2048  lds
    v_mfma_f32_16x16x32_bf16 v[132:135], v[176:179], v[188:191], v[132:135]
    ds_read_b64_tr_b16 v[162:163], v10 offset:61440
    v_max3_u32 v40, v40, v41, v45
    v_mfma_f32_16x16x32_bf16 v[136:139], v[176:179], v[192:195], v[136:139]
    v_max_u32 v40, v40, v47
    s_waitcnt lgkmcnt(6)
    v_mfma_f32_16x16x32_bf16 v[140:143], v[180:183], v[184:187], v[140:143]
    ds_read_b64_tr_b16 v[164:165], v11 offset:57344
    v_cmp_eq_u32 vcc, -1, v40
    buffer_load_dwordx4 v7, s[12:15], s41 offen offset:3072  lds
    s_add_u32 s41, s41, 589824
    v_mfma_f32_16x16x32_bf16 v[144:147], v[180:183], v[188:191], v[144:147]
    ds_read_b64_tr_b16 v[166:167], v11 offset:61440
    s_cbranch_vccnz Lk1_hr85
Lk1_hk86:
    v_mfma_f32_16x16x32_bf16 v[148:151], v[180:183], v[192:195], v[148:151]
    s_waitcnt lgkmcnt(6)
    v_mfma_f32_16x16x32_bf16 v[56:59], v[152:155], v[196:199], v[56:59]
    ds_read_b64_tr_b16 v[168:169], v12 offset:57344
    buffer_load_dwordx4 v[232:235], v2, s[16:19], s40 offen offset:0 sc1
    v_mfma_f32_16x16x32_bf16 v[60:63], v[152:155], v[200:203], v[60:63]
    ds_read_b64_tr_b16 v[170:171], v12 offset:61440
    v_mfma_f32_16x16x32_bf16 v[64:67], v[152:155], v[204:207], v[64:67]
    s_waitcnt lgkmcnt(6)
    v_mfma_f32_16x16x32_bf16 v[68:71], v[156:159], v[196:199], v[68:71]
    ds_read_b64_tr_b16 v[172:173], v13 offset:57344
    buffer_load_dwordx4 v[236:239], v2, s[16:19], s40 offen offset:1024 sc1
    v_mfma_f32_16x16x32_bf16 v[72:75], v[156:159], v[200:203], v[72:75]
    ds_read_b64_tr_b16 v[174:175], v13 offset:61440
    v_mfma_f32_16x16x32_bf16 v[76:79], v[156:159], v[204:207], v[76:79]
    s_waitcnt lgkmcnt(6)
    v_mfma_f32_16x16x32_bf16 v[80:83], v[160:163], v[196:199], v[80:83]
    ds_read_b64_tr_b16 v[176:177], v14 offset:57344
    buffer_load_dwordx4 v[240:243], v2, s[16:19], s40 offen offset:2048 sc1
    s_add_u32 s40, s40, 73728
    v_mfma_f32_16x16x32_bf16 v[84:87], v[160:163], v[200:203], v[84:87]
    ds_read_b64_tr_b16 v[178:179], v14 offset:61440
    v_mfma_f32_16x16x32_bf16 v[88:91], v[160:163], v[204:207], v[88:91]
    s_waitcnt lgkmcnt(6)
    v_mfma_f32_16x16x32_bf16 v[92:95], v[164:167], v[196:199], v[92:95]
    ds_read_b64_tr_b16 v[180:181], v15 offset:57344
    v_mfma_f32_16x16x32_bf16 v[96:99], v[164:167], v[200:203], v[96:99]
    ds_read_b64_tr_b16 v[182:183], v15 offset:61440
    v_mfma_f32_16x16x32_bf16 v[100:103], v[164:167], v[204:207], v[100:103]
    s_waitcnt lgkmcnt(6)
    v_mfma_f32_16x16x32_bf16 v[104:107], v[168:171], v[196:199], v[104:107]
    s_waitcnt vmcnt(14)
    s_barrier
    ds_read_b64_tr_b16 v[152:153], v8 offset:0
    s_add_u32 m0, s43, 24576
    s_nop 0
    buffer_load_dwordx4 v4, s[12:15], s41 offen offset:0  lds
    v_mfma_f32_16x16x32_bf16 v[108:111], v[168:171], v[200:203], v[108:111]
    ds_read_b64_tr_b16 v[154:155], v8 offset:4096
    v_mfma_f32_16x16x32_bf16 v[112:115], v[168:171], v[204:207], v[112:115]
    s_waitcnt lgkmcnt(6)
    v_mfma_f32_16x16x32_bf16 v[116:119], v[172:175], v[196:199], v[116:119]
    ds_read_b64_tr_b16 v[156:157], v9 offset:0
    buffer_load_dwordx4 v5, s[12:15], s41 offen offset:1024  lds
    v_mfma_f32_16x16x32_bf16 v[120:123], v[172:175], v[200:203], v[120:123]
    ds_read_b64_tr_b16 v[158:159], v9 offset:4096
    v_mfma_f32_16x16x32_bf16 v[124:127], v[172:175], v[204:207], v[124:127]
    s_waitcnt lgkmcnt(6)
    v_mfma_f32_16x16x32_bf16 v[128:131], v[176:179], v[196:199], v[128:131]
    ds_read_b64_tr_b16 v[160:161], v10 offset:0
    buffer_load_dwordx4 v6, s[12:15], s41 offen offset:2048  lds
    v_mfma_f32_16x16x32_bf16 v[132:135], v[176:179], v[200:203], v[132:135]
    ds_read_b64_tr_b16 v[162:163], v10 offset:4096
    v_mfma_f32_16x16x32_bf16 v[136:139], v[176:179], v[204:207], v[136:139]
    s_waitcnt lgkmcnt(6)
    v_mfma_f32_16x16x32_bf16 v[140:143], v[180:183], v[196:199], v[140:143]
    ds_read_b64_tr_b16 v[164:165], v11 offset:0
    buffer_load_dwordx4 v7, s[12:15], s41 offen offset:3072  lds
    s_add_u32 s41, s41, 589824
    v_mfma_f32_16x16x32_bf16 v[144:147], v[180:183], v[200:203], v[144:147]
    ds_read_b64_tr_b16 v[166:167], v11 offset:4096
    v_mfma_f32_16x16x32_bf16 v[148:151], v[180:183], v[204:207], v[148:151]
    s_waitcnt lgkmcnt(6)
    v_mfma_f32_16x16x32_bf16 v[56:59], v[152:155], v[208:211], v[56:59]
    ds_read_b64_tr_b16 v[168:169], v12 offset:0
    buffer_load_dwordx4 v[244:247], v2, s[16:19], s40 offen offset:0 sc1
    v_mfma_f32_16x16x32_bf16 v[60:63], v[152:155], v[212:215], v[60:63]
    ds_read_b64_tr_b16 v[170:171], v12 offset:4096
    v_mfma_f32_16x16x32_bf16 v[64:67], v[152:155], v[216:219], v[64:67]
    s_waitcnt lgkmcnt(6)
    v_mfma_f32_16x16x32_bf16 v[68:71], v[156:159], v[208:211], v[68:71]
    ds_read_b64_tr_b16 v[172:173], v13 offset:0
    buffer_load_dwordx4 v[248:251], v2, s[16:19], s40 offen offset:1024 sc1
    v_mfma_f32_16x16x32_bf16 v[72:75], v[156:159], v[212:215], v[72:75]
    ds_read_b64_tr_b16 v[174:175], v13 offset:4096
    v_mfma_f32_16x16x32_bf16 v[76:79], v[156:159], v[216:219], v[76:79]
    s_waitcnt lgkmcnt(6)
    v_mfma_f32_16x16x32_bf16 v[80:83], v[160:163], v[208:211], v[80:83]
    ds_read_b64_tr_b16 v[176:177], v14 offset:0
    buffer_load_dwordx4 v[252:255], v2, s[16:19], s40 offen offset:2048 sc1
    s_add_u32 s40, s40, 73728
    v_mfma_f32_16x16x32_bf16 v[84:87], v[160:163], v[212:215], v[84:87]
    ds_read_b64_tr_b16 v[178:179], v14 offset:4096
    v_mfma_f32_16x16x32_bf16 v[88:91], v[160:163], v[216:219], v[88:91]
    s_waitcnt lgkmcnt(6)
    v_mfma_f32_16x16x32_bf16 v[92:95], v[164:167], v[208:211], v[92:95]
    ds_read_b64_tr_b16 v[180:181], v15 offset:0
    v_mfma_f32_16x16x32_bf16 v[96:99], v[164:167], v[212:215], v[96:99]
    ds_read_b64_tr_b16 v[182:183], v15 offset:4096
    v_mfma_f32_16x16x32_bf16 v[100:103], v[164:167], v[216:219], v[100:103]
    s_waitcnt lgkmcnt(6)
    v_mfma_f32_16x16x32_bf16 v[104:107], v[168:171], v[208:211], v[104:107]
    s_waitcnt vmcnt(14)
    s_barrier
    ds_read_b64_tr_b16 v[152:153], v8 offset:8192
    s_add_u32 m0, s43, 32768
    s_nop 0
    buffer_load_dwordx4 v4, s[12:15], s41 offen offset:0  lds
    v_mfma_f32_16x16x32_bf16 v[108:111], v[168:171], v[212:215], v[108:111]
    ds_read_b64_tr_b16 v[154:155], v8 offset:12288
    v_mfma_f32_16x16x32_bf16 v[112:115], v[168:171], v[216:219], v[112:115]
    s_waitcnt lgkmcnt(6)
    v_mfma_f32_16x16x32_bf16 v[116:119], v[172:175], v[208:211], v[116:119]
    ds_read_b64_tr_b16 v[156:157], v9 offset:8192
    buffer_load_dwordx4 v5, s[12:15], s41 offen offset:1024  lds
    v_mfma_f32_16x16x32_bf16 v[120:123], v[172:175], v[212:215], v[120:123]
    ds_read_b64_tr_b16 v[158:159], v9 offset:12288
    v_mfma_f32_16x16x32_bf16 v[124:127], v[172:175], v[216:219], v[124:127]
    s_waitcnt lgkmcnt(6)
    v_mfma_f32_16x16x32_bf16 v[128:131], v[176:179], v[208:211], v[128:131]
    ds_read_b64_tr_b16 v[160:161], v10 offset:8192
    buffer_load_dwordx4 v6, s[12:15], s41 offen offset:2048  lds
    v_mfma_f32_16x16x32_bf16 v[132:135], v[176:179], v[212:215], v[132:135]
    ds_read_b64_tr_b16 v[162:163], v10 offset:12288
    v_mfma_f32_16x16x32_bf16 v[136:139], v[176:179], v[216:219], v[136:139]
    s_waitcnt lgkmcnt(6)
    v_mfma_f32_16x16x32_bf16 v[140:143], v[180:183], v[208:211], v[140:143]
    ds_read_b64_tr_b16 v[164:165], v11 offset:8192
    buffer_load_dwordx4 v7, s[12:15], s41 offen offset:3072  lds
    s_add_u32 s41, s41, 589824
    v_mfma_f32_16x16x32_bf16 v[144:147], v[180:183], v[212:215], v[144:147]
    ds_read_b64_tr_b16 v[166:167], v11 offset:12288
    v_mfma_f32_16x16x32_bf16 v[148:151], v[180:183], v[216:219], v[148:151]
    s_waitcnt lgkmcnt(6)
    v_mfma_f32_16x16x32_bf16 v[56:59], v[152:155], v[220:223], v[56:59]
    ds_read_b64_tr_b16 v[168:169], v12 offset:8192
    buffer_load_dwordx4 v[184:187], v2, s[16:19], s40 offen offset:0 sc1
    v_mfma_f32_16x16x32_bf16 v[60:63], v[152:155], v[224:227], v[60:63]
    ds_read_b64_tr_b16 v[170:171], v12 offset:12288
    v_mfma_f32_16x16x32_bf16 v[64:67], v[152:155], v[228:231], v[64:67]
    s_waitcnt lgkmcnt(6)
    v_mfma_f32_16x16x32_bf16 v[68:71], v[156:159], v[220:223], v[68:71]
    ds_read_b64_tr_b16 v[172:173], v13 offset:8192
    buffer_load_dwordx4 v[188:191], v2, s[16:19], s40 offen offset:1024 sc1
    v_mfma_f32_16x16x32_bf16 v[72:75], v[156:159], v[224:227], v[72:75]
    ds_read_b64_tr_b16 v[174:175], v13 offset:12288
    v_mfma_f32_16x16x32_bf16 v[76:79], v[156:159], v[228:231], v[76:79]
    s_waitcnt lgkmcnt(6)
    v_mfma_f32_16x16x32_bf16 v[80:83], v[160:163], v[220:223], v[80:83]
    ds_read_b64_tr_b16 v[176:177], v14 offset:8192
    buffer_load_dwordx4 v[192:195], v2, s[16:19], s40 offen offset:2048 sc1
    s_add_u32 s40, s40, 73728
    v_mfma_f32_16x16x32_bf16 v[84:87], v[160:163], v[224:227], v[84:87]
    ds_read_b64_tr_b16 v[178:179], v14 offset:12288
    v_mfma_f32_16x16x32_bf16 v[88:91], v[160:163], v[228:231], v[88:91]
    s_waitcnt lgkmcnt(6)
    v_mfma_f32_16x16x32_bf16 v[92:95], v[164:167], v[220:223], v[92:95]
    ds_read_b64_tr_b16 v[180:181], v15 offset:8192
    v_mfma_f32_16x16x32_bf16 v[96:99], v[164:167], v[224:227], v[96:99]
    ds_read_b64_tr_b16 v[182:183], v15 offset:12288
    v_mfma_f32_16x16x32_bf16 v[100:103], v[164:167], v[228:231], v[100:103]
    s_waitcnt lgkmcnt(6)
    v_mfma_f32_16x16x32_bf16 v[104:107], v[168:171], v[220:223], v[104:107]
    s_waitcnt vmcnt(14)
    s_barrier
    ds_read_b64_tr_b16 v[152:153], v8 offset:16384
    s_add_u32 m0, s43, 40960
    s_nop 0
    buffer_load_dwordx4 v4, s[12:15], s41 offen offset:0  lds
    v_mfma_f32_16x16x32_bf16 v[108:111], v[168:171], v[224:227], v[108:111]
    ds_read_b64_tr_b16 v[154:155], v8 offset:20480
    v_mfma_f32_16x16x32_bf16 v[112:115], v[168:171], v[228:231], v[112:115]
    s_waitcnt lgkmcnt(6)
    v_mfma_f32_16x16x32_bf16 v[116:119], v[172:175], v[220:223], v[116:119]
    ds_read_b64_tr_b16 v[156:157], v9 offset:16384
    buffer_load_dwordx4 v5, s[12:15], s41 offen offset:1024  lds
    v_mfma_f32_16x16x32_bf16 v[120:123], v[172:175], v[224:227], v[120:123]
    ds_read_b64_tr_b16 v[158:159], v9 offset:20480
    v_mfma_f32_16x16x32_bf16 v[124:127], v[172:175], v[228:231], v[124:127]
    s_waitcnt lgkmcnt(6)
    v_mfma_f32_16x16x32_bf16 v[128:131], v[176:179], v[220:223], v[128:131]
    ds_read_b64_tr_b16 v[160:161], v10 offset:16384
    buffer_load_dwordx4 v6, s[12:15], s41 offen offset:2048  lds
    v_mfma_f32_16x16x32_bf16 v[132:135], v[176:179], v[224:227], v[132:135]
    ds_read_b64_tr_b16 v[162:163], v10 offset:20480
    v_mfma_f32_16x16x32_bf16 v[136:139], v[176:179], v[228:231], v[136:139]
    s_waitcnt lgkmcnt(6)
    v_mfma_f32_16x16x32_bf16 v[140:143], v[180:183], v[220:223], v[140:143]
    ds_read_b64_tr_b16 v[164:165], v11 offset:16384
    buffer_load_dwordx4 v7, s[12:15], s41 offen offset:3072  lds
    s_add_u32 s41, s41, 589824
    v_mfma_f32_16x16x32_bf16 v[144:147], v[180:183], v[224:227], v[144:147]
    ds_read_b64_tr_b16 v[166:167], v11 offset:20480
    v_mfma_f32_16x16x32_bf16 v[148:151], v[180:183], v[228:231], v[148:151]
    s_waitcnt lgkmcnt(6)
    v_mfma_f32_16x16x32_bf16 v[56:59], v[152:155], v[232:235], v[56:59]
    ds_read_b64_tr_b16 v[168:169], v12 offset:16384
    buffer_load_dwordx4 v[196:199], v2, s[16:19], s40 offen offset:0 sc1
    v_mfma_f32_16x16x32_bf16 v[60:63], v[152:155], v[236:239], v[60:63]
    ds_read_b64_tr_b16 v[170:171], v12 offset:20480
    v_mfma_f32_16x16x32_bf16 v[64:67], v[152:155], v[240:243], v[64:67]
    s_waitcnt lgkmcnt(6)
    v_mfma_f32_16x16x32_bf16 v[68:71], v[156:159], v[232:235], v[68:71]
    ds_read_b64_tr_b16 v[172:173], v13 offset:16384
    buffer_load_dwordx4 v[200:203], v2, s[16:19], s40 offen offset:1024 sc1
    v_mfma_f32_16x16x32_bf16 v[72:75], v[156:159], v[236:239], v[72:75]
    ds_read_b64_tr_b16 v[174:175], v13 offset:20480
    v_mfma_f32_16x16x32_bf16 v[76:79], v[156:159], v[240:243], v[76:79]
    s_waitcnt lgkmcnt(6)
    v_mfma_f32_16x16x32_bf16 v[80:83], v[160:163], v[232:235], v[80:83]
    ds_read_b64_tr_b16 v[176:177], v14 offset:16384
    buffer_load_dwordx4 v[204:207], v2, s[16:19], s40 offen offset:2048 sc1
    s_add_u32 s40, s40, 73728
    v_mfma_f32_16x16x32_bf16 v[84:87], v[160:163], v[236:239], v[84:87]
    ds_read_b64_tr_b16 v[178:179], v14 offset:20480
    v_mfma_f32_16x16x32_bf16 v[88:91], v[160:163], v[240:243], v[88:91]
    s_waitcnt lgkmcnt(6)
    v_mfma_f32_16x16x32_bf16 v[92:95], v[164:167], v[232:235], v[92:95]
    ds_read_b64_tr_b16 v[180:181], v15 offset:16384
    v_mfma_f32_16x16x32_bf16 v[96:99], v[164:167], v[236:239], v[96:99]
    ds_read_b64_tr_b16 v[182:183], v15 offset:20480
    v_mfma_f32_16x16x32_bf16 v[100:103], v[164:167], v[240:243], v[100:103]
    s_waitcnt lgkmcnt(6)
    v_mfma_f32_16x16x32_bf16 v[104:107], v[168:171], v[232:235], v[104:107]
    s_waitcnt vmcnt(14)
    s_barrier
    ds_read_b64_tr_b16 v[152:153], v8 offset:24576
    s_add_u32 m0, s43, 49152
    s_nop 0
    buffer_load_dwordx4 v4, s[12:15], s41 offen offset:0  lds
    v_mfma_f32_16x16x32_bf16 v[108:111], v[168:171], v[236:239], v[108:111]
    ds_read_b64_tr_b16 v[154:155], v8 offset:28672
    v_mfma_f32_16x16x32_bf16 v[112:115], v[168:171], v[240:243], v[112:115]
    s_waitcnt lgkmcnt(6)
    v_mfma_f32_16x16x32_bf16 v[116:119], v[172:175], v[232:235], v[116:119]
    ds_read_b64_tr_b16 v[156:157], v9 offset:24576
    buffer_load_dwordx4 v5, s[12:15], s41 offen offset:1024  lds
    v_mfma_f32_16x16x32_bf16 v[120:123], v[172:175], v[236:239], v[120:123]
    ds_read_b64_tr_b16 v[158:159], v9 offset:28672
    v_mfma_f32_16x16x32_bf16 v[124:127], v[172:175], v[240:243], v[124:127]
    s_waitcnt lgkmcnt(6)
    v_mfma_f32_16x16x32_bf16 v[128:131], v[176:179], v[232:235], v[128:131]
    ds_read_b64_tr_b16 v[160:161], v10 offset:24576
    buffer_load_dwordx4 v6, s[12:15], s41 offen offset:2048  lds
    v_mfma_f32_16x16x32_bf16 v[132:135], v[176:179], v[236:239], v[132:135]
    ds_read_b64_tr_b16 v[162:163], v10 offset:28672
    v_mfma_f32_16x16x32_bf16 v[136:139], v[176:179], v[240:243], v[136:139]
    s_waitcnt lgkmcnt(6)
    v_mfma_f32_16x16x32_bf16 v[140:143], v[180:183], v[232:235], v[140:143]
    ds_read_b64_tr_b16 v[164:165], v11 offset:24576
    buffer_load_dwordx4 v7, s[12:15], s41 offen offset:3072  lds
    s_add_u32 s41, s41, 589824
    v_mfma_f32_16x16x32_bf16 v[144:147], v[180:183], v[236:239], v[144:147]
    ds_read_b64_tr_b16 v[166:167], v11 offset:28672
    v_mfma_f32_16x16x32_bf16 v[148:151], v[180:183], v[240:243], v[148:151]
    s_waitcnt lgkmcnt(6)
    v_mfma_f32_16x16x32_bf16 v[56:59], v[152:155], v[244:247], v[56:59]
    ds_read_b64_tr_b16 v[168:169], v12 offset:24576
    buffer_load_dwordx4 v[208:211], v2, s[16:19], s40 offen offset:0 sc1
    v_mfma_f32_16x16x32_bf16 v[60:63], v[152:155], v[248:251], v[60:63]
    ds_read_b64_tr_b16 v[170:171], v12 offset:28672
    v_mfma_f32_16x16x32_bf16 v[64:67], v[152:155], v[252:255], v[64:67]
    s_waitcnt lgkmcnt(6)
    v_mfma_f32_16x16x32_bf16 v[68:71], v[156:159], v[244:247], v[68:71]
    ds_read_b64_tr_b16 v[172:173], v13 offset:24576
    buffer_load_dwordx4 v[212:215], v2, s[16:19], s40 offen offset:1024 sc1
    v_mfma_f32_16x16x32_bf16 v[72:75], v[156:159], v[248:251], v[72:75]
    ds_read_b64_tr_b16 v[174:175], v13 offset:28672
    v_mfma_f32_16x16x32_bf16 v[76:79], v[156:159], v[252:255], v[76:79]
    s_waitcnt lgkmcnt(6)
    v_mfma_f32_16x16x32_bf16 v[80:83], v[160:163], v[244:247], v[80:83]
    ds_read_b64_tr_b16 v[176:177], v14 offset:24576
    buffer_load_dwordx4 v[216:219], v2, s[16:19], s40 offen offset:2048 sc1
    s_add_u32 s40, s40, 73728
    v_mfma_f32_16x16x32_bf16 v[84:87], v[160:163], v[248:251], v[84:87]
    ds_read_b64_tr_b16 v[178:179], v14 offset:28672
    v_mfma_f32_16x16x32_bf16 v[88:91], v[160:163], v[252:255], v[88:91]
    s_waitcnt lgkmcnt(6)
    v_mfma_f32_16x16x32_bf16 v[92:95], v[164:167], v[244:247], v[92:95]
    ds_read_b64_tr_b16 v[180:181], v15 offset:24576
    v_mfma_f32_16x16x32_bf16 v[96:99], v[164:167], v[248:251], v[96:99]
    ds_read_b64_tr_b16 v[182:183], v15 offset:28672
    v_mfma_f32_16x16x32_bf16 v[100:103], v[164:167], v[252:255], v[100:103]
    s_waitcnt lgkmcnt(6)
    v_mfma_f32_16x16x32_bf16 v[104:107], v[168:171], v[244:247], v[104:107]
    s_waitcnt vmcnt(14)
    s_barrier
    ds_read_b64_tr_b16 v[152:153], v8 offset:32768
    s_add_u32 m0, s43, 57344
    s_nop 0
    buffer_load_dwordx4 v4, s[12:15], s41 offen offset:0  lds
    v_mfma_f32_16x16x32_bf16 v[108:111], v[168:171], v[248:251], v[108:111]
    ds_read_b64_tr_b16 v[154:155], v8 offset:36864
    v_mfma_f32_16x16x32_bf16 v[112:115], v[168:171], v[252:255], v[112:115]
    s_waitcnt lgkmcnt(6)
    v_mfma_f32_16x16x32_bf16 v[116:119], v[172:175], v[244:247], v[116:119]
    ds_read_b64_tr_b16 v[156:157], v9 offset:32768
    buffer_load_dwordx4 v5, s[12:15], s41 offen offset:1024  lds
    v_mfma_f32_16x16x32_bf16 v[120:123], v[172:175], v[248:251], v[120:123]
    ds_read_b64_tr_b16 v[158:159], v9 offset:36864
    v_mfma_f32_16x16x32_bf16 v[124:127], v[172:175], v[252:255], v[124:127]
    s_waitcnt lgkmcnt(6)
    v_mfma_f32_16x16x32_bf16 v[128:131], v[176:179], v[244:247], v[128:131]
    ds_read_b64_tr_b16 v[160:161], v10 offset:32768
    buffer_load_dwordx4 v6, s[12:15], s41 offen offset:2048  lds
    v_mfma_f32_16x16x32_bf16 v[132:135], v[176:179], v[248:251], v[132:135]
    ds_read_b64_tr_b16 v[162:163], v10 offset:36864
    v_mfma_f32_16x16x32_bf16 v[136:139], v[176:179], v[252:255], v[136:139]
    s_waitcnt lgkmcnt(6)
    v_mfma_f32_16x16x32_bf16 v[140:143], v[180:183], v[244:247], v[140:143]
    ds_read_b64_tr_b16 v[164:165], v11 offset:32768
    buffer_load_dwordx4 v7, s[12:15], s41 offen offset:3072  lds
    s_add_u32 s41, s41, 589824
    v_mfma_f32_16x16x32_bf16 v[144:147], v[180:183], v[248:251], v[144:147]
    ds_read_b64_tr_b16 v[166:167], v11 offset:36864
    v_mfma_f32_16x16x32_bf16 v[148:151], v[180:183], v[252:255], v[148:151]
    s_waitcnt lgkmcnt(6)
    v_mfma_f32_16x16x32_bf16 v[56:59], v[152:155], v[184:187], v[56:59]
    ds_read_b64_tr_b16 v[168:169], v12 offset:32768
    buffer_load_dwordx4 v[220:223], v2, s[16:19], s40 offen offset:0 sc1
    v_mfma_f32_16x16x32_bf16 v[60:63], v[152:155], v[188:191], v[60:63]
    ds_read_b64_tr_b16 v[170:171], v12 offset:36864
    v_mfma_f32_16x16x32_bf16 v[64:67], v[152:155], v[192:195], v[64:67]
    s_waitcnt lgkmcnt(6)
    v_mfma_f32_16x16x32_bf16 v[68:71], v[156:159], v[184:187], v[68:71]
    ds_read_b64_tr_b16 v[172:173], v13 offset:32768
    buffer_load_dwordx4 v[224:227], v2, s[16:19], s40 offen offset:1024 sc1
    v_mfma_f32_16x16x32_bf16 v[72:75], v[156:159], v[188:191], v[72:75]
    ds_read_b64_tr_b16 v[174:175], v13 offset:36864
    v_mfma_f32_16x16x32_bf16 v[76:79], v[156:159], v[192:195], v[76:79]
    s_waitcnt lgkmcnt(6)
    v_mfma_f32_16x16x32_bf16 v[80:83], v[160:163], v[184:187], v[80:83]
    ds_read_b64_tr_b16 v[176:177], v14 offset:32768
    buffer_load_dwordx4 v[228:231], v2, s[16:19], s40 offen offset:2048 sc1
    s_add_u32 s40, s40, 73728
    v_mfma_f32_16x16x32_bf16 v[84:87], v[160:163], v[188:191], v[84:87]
    ds_read_b64_tr_b16 v[178:179], v14 offset:36864
    v_mfma_f32_16x16x32_bf16 v[88:91], v[160:163], v[192:195], v[88:91]
    s_waitcnt lgkmcnt(6)
    v_mfma_f32_16x16x32_bf16 v[92:95], v[164:167], v[184:187], v[92:95]
    ds_read_b64_tr_b16 v[180:181], v15 offset:32768
    v_mfma_f32_16x16x32_bf16 v[96:99], v[164:167], v[188:191], v[96:99]
    ds_read_b64_tr_b16 v[182:183], v15 offset:36864
    v_mfma_f32_16x16x32_bf16 v[100:103], v[164:167], v[192:195], v[100:103]
    s_waitcnt lgkmcnt(6)
    v_mfma_f32_16x16x32_bf16 v[104:107], v[168:171], v[184:187], v[104:107]
    s_waitcnt vmcnt(14)
    s_barrier
    ds_read_b64_tr_b16 v[152:153], v8 offset:40960
    s_add_u32 m0, s43, 0
    s_nop 0
    buffer_load_dwordx4 v4, s[12:15], s41 offen offset:0  lds
    v_mfma_f32_16x16x32_bf16 v[108:111], v[168:171], v[188:191], v[108:111]
    ds_read_b64_tr_b16 v[154:155], v8 offset:45056
    v_mfma_f32_16x16x32_bf16 v[112:115], v[168:171], v[192:195], v[112:115]
    s_waitcnt lgkmcnt(6)
    v_mfma_f32_16x16x32_bf16 v[116:119], v[172:175], v[184:187], v[116:119]
    ds_read_b64_tr_b16 v[156:157], v9 offset:40960
    buffer_load_dwordx4 v5, s[12:15], s41 offen offset:1024  lds
    v_mfma_f32_16x16x32_bf16 v[120:123], v[172:175], v[188:191], v[120:123]
    ds_read_b64_tr_b16 v[158:159], v9 offset:45056
    v_mfma_f32_16x16x32_bf16 v[124:127], v[172:175], v[192:195], v[124:127]
    s_waitcnt lgkmcnt(6)
    v_mfma_f32_16x16x32_bf16 v[128:131], v[176:179], v[184:187], v[128:131]
    ds_read_b64_tr_b16 v[160:161], v10 offset:40960
    buffer_load_dwordx4 v6, s[12:15], s41 offen offset:2048  lds
    v_mfma_f32_16x16x32_bf16 v[132:135], v[176:179], v[188:191], v[132:135]
    ds_read_b64_tr_b16 v[162:163], v10 offset:45056
    v_mfma_f32_16x16x32_bf16 v[136:139], v[176:179], v[192:195], v[136:139]
    s_waitcnt lgkmcnt(6)
    v_mfma_f32_16x16x32_bf16 v[140:143], v[180:183], v[184:187], v[140:143]
    ds_read_b64_tr_b16 v[164:165], v11 offset:40960
    buffer_load_dwordx4 v7, s[12:15], s41 offen offset:3072  lds
    s_add_u32 s41, s41, 589824
    v_mfma_f32_16x16x32_bf16 v[144:147], v[180:183], v[188:191], v[144:147]
    ds_read_b64_tr_b16 v[166:167], v11 offset:45056
    v_mfma_f32_16x16x32_bf16 v[148:151], v[180:183], v[192:195], v[148:151]
    s_waitcnt lgkmcnt(6)
    v_mfma_f32_16x16x32_bf16 v[56:59], v[152:155], v[196:199], v[56:59]
    ds_read_b64_tr_b16 v[168:169], v12 offset:40960
    buffer_load_dwordx4 v[232:235], v2, s[16:19], s40 offen offset:0 sc1
    v_mfma_f32_16x16x32_bf16 v[60:63], v[152:155], v[200:203], v[60:63]
    ds_read_b64_tr_b16 v[170:171], v12 offset:45056
    v_mfma_f32_16x16x32_bf16 v[64:67], v[152:155], v[204:207], v[64:67]
    s_waitcnt lgkmcnt(6)
    v_mfma_f32_16x16x32_bf16 v[68:71], v[156:159], v[196:199], v[68:71]
    ds_read_b64_tr_b16 v[172:173], v13 offset:40960
    buffer_load_dwordx4 v[236:239], v2, s[16:19], s40 offen offset:1024 sc1
    v_mfma_f32_16x16x32_bf16 v[72:75], v[156:159], v[200:203], v[72:75]
    ds_read_b64_tr_b16 v[174:175], v13 offset:45056
    v_mfma_f32_16x16x32_bf16 v[76:79], v[156:159], v[204:207], v[76:79]
    s_waitcnt lgkmcnt(6)
    v_mfma_f32_16x16x32_bf16 v[80:83], v[160:163], v[196:199], v[80:83]
    ds_read_b64_tr_b16 v[176:177], v14 offset:40960
    buffer_load_dwordx4 v[240:243], v2, s[16:19], s40 offen offset:2048 sc1
    s_add_u32 s40, s40, 73728
    v_mfma_f32_16x16x32_bf16 v[84:87], v[160:163], v[200:203], v[84:87]
    ds_read_b64_tr_b16 v[178:179], v14 offset:45056
    v_mfma_f32_16x16x32_bf16 v[88:91], v[160:163], v[204:207], v[88:91]
    s_waitcnt lgkmcnt(6)
    v_mfma_f32_16x16x32_bf16 v[92:95], v[164:167], v[196:199], v[92:95]
    ds_read_b64_tr_b16 v[180:181], v15 offset:40960
    v_mfma_f32_16x16x32_bf16 v[96:99], v[164:167], v[200:203], v[96:99]
    ds_read_b64_tr_b16 v[182:183], v15 offset:45056
    v_mfma_f32_16x16x32_bf16 v[100:103], v[164:167], v[204:207], v[100:103]
    s_waitcnt lgkmcnt(6)
    v_mfma_f32_16x16x32_bf16 v[104:107], v[168:171], v[196:199], v[104:107]
    s_waitcnt vmcnt(14)
    s_barrier
    ds_read_b64_tr_b16 v[152:153], v8 offset:49152
    s_add_u32 m0, s43, 8192
    s_nop 0
    buffer_load_dwordx4 v4, s[12:15], s41 offen offset:0  lds
    v_mfma_f32_16x16x32_bf16 v[108:111], v[168:171], v[200:203], v[108:111]
    ds_read_b64_tr_b16 v[154:155], v8 offset:53248
    v_mfma_f32_16x16x32_bf16 v[112:115], v[168:171], v[204:207], v[112:115]
    s_waitcnt lgkmcnt(6)
    v_mfma_f32_16x16x32_bf16 v[116:119], v[172:175], v[196:199], v[116:119]
    ds_read_b64_tr_b16 v[156:157], v9 offset:49152
    buffer_load_dwordx4 v5, s[12:15], s41 offen offset:1024  lds
    v_mfma_f32_16x16x32_bf16 v[120:123], v[172:175], v[200:203], v[120:123]
    ds_read_b64_tr_b16 v[158:159], v9 offset:53248
    v_mfma_f32_16x16x32_bf16 v[124:127], v[172:175], v[204:207], v[124:127]
    s_waitcnt lgkmcnt(6)
    v_mfma_f32_16x16x32_bf16 v[128:131], v[176:179], v[196:199], v[128:131]
    ds_read_b64_tr_b16 v[160:161], v10 offset:49152
    buffer_load_dwordx4 v6, s[12:15], s41 offen offset:2048  lds
    v_mfma_f32_16x16x32_bf16 v[132:135], v[176:179], v[200:203], v[132:135]
    ds_read_b64_tr_b16 v[162:163], v10 offset:53248
    v_mfma_f32_16x16x32_bf16 v[136:139], v[176:179], v[204:207], v[136:139]
    s_waitcnt lgkmcnt(6)
    v_mfma_f32_16x16x32_bf16 v[140:143], v[180:183], v[196:199], v[140:143]
    ds_read_b64_tr_b16 v[164:165], v11 offset:49152
    buffer_load_dwordx4 v7, s[12:15], s41 offen offset:3072  lds
    s_add_u32 s41, s41, 589824
    v_mfma_f32_16x16x32_bf16 v[144:147], v[180:183], v[200:203], v[144:147]
    ds_read_b64_tr_b16 v[166:167], v11 offset:53248
    v_mfma_f32_16x16x32_bf16 v[148:151], v[180:183], v[204:207], v[148:151]
    s_waitcnt lgkmcnt(6)
    v_mfma_f32_16x16x32_bf16 v[56:59], v[152:155], v[208:211], v[56:59]
    ds_read_b64_tr_b16 v[168:169], v12 offset:49152
    buffer_load_dwordx4 v[244:247], v2, s[16:19], s40 offen offset:0 sc1
    v_mfma_f32_16x16x32_bf16 v[60:63], v[152:155], v[212:215], v[60:63]
    ds_read_b64_tr_b16 v[170:171], v12 offset:53248
    v_mfma_f32_16x16x32_bf16 v[64:67], v[152:155], v[216:219], v[64:67]
    s_waitcnt lgkmcnt(6)
    v_mfma_f32_16x16x32_bf16 v[68:71], v[156:159], v[208:211], v[68:71]
    ds_read_b64_tr_b16 v[172:173], v13 offset:49152
    buffer_load_dwordx4 v[248:251], v2, s[16:19], s40 offen offset:1024 sc1
    v_mfma_f32_16x16x32_bf16 v[72:75], v[156:159], v[212:215], v[72:75]
    ds_read_b64_tr_b16 v[174:175], v13 offset:53248
    v_mfma_f32_16x16x32_bf16 v[76:79], v[156:159], v[216:219], v[76:79]
    s_waitcnt lgkmcnt(6)
    v_mfma_f32_16x16x32_bf16 v[80:83], v[160:163], v[208:211], v[80:83]
    ds_read_b64_tr_b16 v[176:177], v14 offset:49152
    buffer_load_dwordx4 v[252:255], v2, s[16:19], s40 offen offset:2048 sc1
    s_add_u32 s40, s40, 73728
    v_mfma_f32_16x16x32_bf16 v[84:87], v[160:163], v[212:215], v[84:87]
    ds_read_b64_tr_b16 v[178:179], v14 offset:53248
    v_mfma_f32_16x16x32_bf16 v[88:91], v[160:163], v[216:219], v[88:91]
    s_waitcnt lgkmcnt(6)
    v_mfma_f32_16x16x32_bf16 v[92:95], v[164:167], v[208:211], v[92:95]
    ds_read_b64_tr_b16 v[180:181], v15 offset:49152
    v_mfma_f32_16x16x32_bf16 v[96:99], v[164:167], v[212:215], v[96:99]
    ds_read_b64_tr_b16 v[182:183], v15 offset:53248
    v_mfma_f32_16x16x32_bf16 v[100:103], v[164:167], v[216:219], v[100:103]
    s_waitcnt lgkmcnt(6)
    v_mfma_f32_16x16x32_bf16 v[104:107], v[168:171], v[208:211], v[104:107]
    s_waitcnt vmcnt(14)
    s_barrier
    ds_read_b64_tr_b16 v[152:153], v8 offset:57344
    s_add_u32 m0, s43, 16384
    s_nop 0
    buffer_load_dwordx4 v4, s[12:15], s41 offen offset:0  lds
    v_mfma_f32_16x16x32_bf16 v[108:111], v[168:171], v[212:215], v[108:111]
    ds_read_b64_tr_b16 v[154:155], v8 offset:61440
    v_mfma_f32_16x16x32_bf16 v[112:115], v[168:171], v[216:219], v[112:115]
    s_waitcnt lgkmcnt(6)
    v_mfma_f32_16x16x32_bf16 v[116:119], v[172:175], v[208:211], v[116:119]
    ds_read_b64_tr_b16 v[156:157], v9 offset:57344
    buffer_load_dwordx4 v5, s[12:15], s41 offen offset:1024  lds
    v_mfma_f32_16x16x32_bf16 v[120:123], v[172:175], v[212:215], v[120:123]
    ds_read_b64_tr_b16 v[158:159], v9 offset:61440
    v_mfma_f32_16x16x32_bf16 v[124:127], v[172:175], v[216:219], v[124:127]
    s_waitcnt lgkmcnt(6)
    v_mfma_f32_16x16x32_bf16 v[128:131], v[176:179], v[208:211], v[128:131]
    ds_read_b64_tr_b16 v[160:161], v10 offset:57344
    buffer_load_dwordx4 v6, s[12:15], s41 offen offset:2048  lds
    v_mfma_f32_16x16x32_bf16 v[132:135], v[176:179], v[212:215], v[132:135]
    ds_read_b64_tr_b16 v[162:163], v10 offset:61440
    v_mfma_f32_16x16x32_bf16 v[136:139], v[176:179], v[216:219], v[136:139]
    s_waitcnt lgkmcnt(6)
    v_mfma_f32_16x16x32_bf16 v[140:143], v[180:183], v[208:211], v[140:143]
    ds_read_b64_tr_b16 v[164:165], v11 offset:57344
    buffer_load_dwordx4 v7, s[12:15], s41 offen offset:3072  lds
    s_add_u32 s41, s41, 589824
    v_mfma_f32_16x16x32_bf16 v[144:147], v[180:183], v[212:215], v[144:147]
    ds_read_b64_tr_b16 v[166:167], v11 offset:61440
    v_mfma_f32_16x16x32_bf16 v[148:151], v[180:183], v[216:219], v[148:151]
    s_waitcnt lgkmcnt(6)
    v_mfma_f32_16x16x32_bf16 v[56:59], v[152:155], v[220:223], v[56:59]
    ds_read_b64_tr_b16 v[168:169], v12 offset:57344
    buffer_load_dwordx4 v[184:187], v2, s[16:19], s40 offen offset:0 sc1
    v_mfma_f32_16x16x32_bf16 v[60:63], v[152:155], v[224:227], v[60:63]
    ds_read_b64_tr_b16 v[170:171], v12 offset:61440
    v_mfma_f32_16x16x32_bf16 v[64:67], v[152:155], v[228:231], v[64:67]
    s_waitcnt lgkmcnt(6)
    v_mfma_f32_16x16x32_bf16 v[68:71], v[156:159], v[220:223], v[68:71]
    ds_read_b64_tr_b16 v[172:173], v13 offset:57344
    buffer_load_dwordx4 v[188:191], v2, s[16:19], s40 offen offset:1024 sc1
    v_mfma_f32_16x16x32_bf16 v[72:75], v[156:159], v[224:227], v[72:75]
    ds_read_b64_tr_b16 v[174:175], v13 offset:61440
    v_mfma_f32_16x16x32_bf16 v[76:79], v[156:159], v[228:231], v[76:79]
    s_waitcnt lgkmcnt(6)
    v_mfma_f32_16x16x32_bf16 v[80:83], v[160:163], v[220:223], v[80:83]
    ds_read_b64_tr_b16 v[176:177], v14 offset:57344
    buffer_load_dwordx4 v[192:195], v2, s[16:19], s40 offen offset:2048 sc1
    s_add_u32 s40, s40, 73728
    v_mfma_f32_16x16x32_bf16 v[84:87], v[160:163], v[224:227], v[84:87]
    ds_read_b64_tr_b16 v[178:179], v14 offset:61440
    v_mfma_f32_16x16x32_bf16 v[88:91], v[160:163], v[228:231], v[88:91]
    s_waitcnt lgkmcnt(6)
    v_mfma_f32_16x16x32_bf16 v[92:95], v[164:167], v[220:223], v[92:95]
    ds_read_b64_tr_b16 v[180:181], v15 offset:57344
    v_mfma_f32_16x16x32_bf16 v[96:99], v[164:167], v[224:227], v[96:99]
    ds_read_b64_tr_b16 v[182:183], v15 offset:61440
    v_mfma_f32_16x16x32_bf16 v[100:103], v[164:167], v[228:231], v[100:103]
    s_waitcnt lgkmcnt(6)
    v_mfma_f32_16x16x32_bf16 v[104:107], v[168:171], v[220:223], v[104:107]
    s_waitcnt vmcnt(14)
    s_barrier
    ds_read_b64_tr_b16 v[152:153], v8 offset:0
    s_add_u32 m0, s43, 24576
    s_nop 0
    buffer_load_dwordx4 v4, s[12:15], s41 offen offset:0  lds
    v_mfma_f32_16x16x32_bf16 v[108:111], v[168:171], v[224:227], v[108:111]
    ds_read_b64_tr_b16 v[154:155], v8 offset:4096
    v_mfma_f32_16x16x32_bf16 v[112:115], v[168:171], v[228:231], v[112:115]
    s_waitcnt lgkmcnt(6)
    v_mfma_f32_16x16x32_bf16 v[116:119], v[172:175], v[220:223], v[116:119]
    ds_read_b64_tr_b16 v[156:157], v9 offset:0
    buffer_load_dwordx4 v5, s[12:15], s41 offen offset:1024  lds
    v_mfma_f32_16x16x32_bf16 v[120:123], v[172:175], v[224:227], v[120:123]
    ds_read_b64_tr_b16 v[158:159], v9 offset:4096
    v_mfma_f32_16x16x32_bf16 v[124:127], v[172:175], v[228:231], v[124:127]
    s_waitcnt lgkmcnt(6)
    v_mfma_f32_16x16x32_bf16 v[128:131], v[176:179], v[220:223], v[128:131]
    ds_read_b64_tr_b16 v[160:161], v10 offset:0
    buffer_load_dwordx4 v6, s[12:15], s41 offen offset:2048  lds
    v_mfma_f32_16x16x32_bf16 v[132:135], v[176:179], v[224:227], v[132:135]
    ds_read_b64_tr_b16 v[162:163], v10 offset:4096
    v_mfma_f32_16x16x32_bf16 v[136:139], v[176:179], v[228:231], v[136:139]
    s_waitcnt lgkmcnt(6)
    v_mfma_f32_16x16x32_bf16 v[140:143], v[180:183], v[220:223], v[140:143]
    ds_read_b64_tr_b16 v[164:165], v11 offset:0
    buffer_load_dwordx4 v7, s[12:15], s41 offen offset:3072  lds
    s_add_u32 s41, s41, 589824
    v_mfma_f32_16x16x32_bf16 v[144:147], v[180:183], v[224:227], v[144:147]
    ds_read_b64_tr_b16 v[166:167], v11 offset:4096
    v_mfma_f32_16x16x32_bf16 v[148:151], v[180:183], v[228:231], v[148:151]
    s_waitcnt lgkmcnt(6)
    v_mfma_f32_16x16x32_bf16 v[56:59], v[152:155], v[232:235], v[56:59]
    ds_read_b64_tr_b16 v[168:169], v12 offset:0
    buffer_load_dwordx4 v[196:199], v2, s[16:19], s40 offen offset:0 sc1
    v_mfma_f32_16x16x32_bf16 v[60:63], v[152:155], v[236:239], v[60:63]
    ds_read_b64_tr_b16 v[170:171], v12 offset:4096
    v_mfma_f32_16x16x32_bf16 v[64:67], v[152:155], v[240:243], v[64:67]
    s_waitcnt lgkmcnt(6)
    v_mfma_f32_16x16x32_bf16 v[68:71], v[156:159], v[232:235], v[68:71]
    ds_read_b64_tr_b16 v[172:173], v13 offset:0
    buffer_load_dwordx4 v[200:203], v2, s[16:19], s40 offen offset:1024 sc1
    v_mfma_f32_16x16x32_bf16 v[72:75], v[156:159], v[236:239], v[72:75]
    ds_read_b64_tr_b16 v[174:175], v13 offset:4096
    v_mfma_f32_16x16x32_bf16 v[76:79], v[156:159], v[240:243], v[76:79]
    s_waitcnt lgkmcnt(6)
    v_mfma_f32_16x16x32_bf16 v[80:83], v[160:163], v[232:235], v[80:83]
    ds_read_b64_tr_b16 v[176:177], v14 offset:0
    buffer_load_dwordx4 v[204:207], v2, s[16:19], s40 offen offset:2048 sc1
    s_add_u32 s40, s40, 73728
    v_mfma_f32_16x16x32_bf16 v[84:87], v[160:163], v[236:239], v[84:87]
    ds_read_b64_tr_b16 v[178:179], v14 offset:4096
    v_mfma_f32_16x16x32_bf16 v[88:91], v[160:163], v[240:243], v[88:91]
    s_waitcnt lgkmcnt(6)
    v_mfma_f32_16x16x32_bf16 v[92:95], v[164:167], v[232:235], v[92:95]
    ds_read_b64_tr_b16 v[180:181], v15 offset:0
    v_mfma_f32_16x16x32_bf16 v[96:99], v[164:167], v[236:239], v[96:99]
    ds_read_b64_tr_b16 v[182:183], v15 offset:4096
    v_mfma_f32_16x16x32_bf16 v[100:103], v[164:167], v[240:243], v[100:103]
    s_waitcnt lgkmcnt(6)
    v_mfma_f32_16x16x32_bf16 v[104:107], v[168:171], v[232:235], v[104:107]
    s_waitcnt vmcnt(14)
    s_barrier
    ds_read_b64_tr_b16 v[152:153], v8 offset:8192
    s_add_u32 m0, s43, 32768
    s_nop 0
    buffer_load_dwordx4 v4, s[12:15], s41 offen offset:0  lds
    v_mfma_f32_16x16x32_bf16 v[108:111], v[168:171], v[236:239], v[108:111]
    ds_read_b64_tr_b16 v[154:155], v8 offset:12288
    v_mfma_f32_16x16x32_bf16 v[112:115], v[168:171], v[240:243], v[112:115]
    s_waitcnt lgkmcnt(6)
    v_mfma_f32_16x16x32_bf16 v[116:119], v[172:175], v[232:235], v[116:119]
    ds_read_b64_tr_b16 v[156:157], v9 offset:8192
    buffer_load_dwordx4 v5, s[12:15], s41 offen offset:1024  lds
    v_mfma_f32_16x16x32_bf16 v[120:123], v[172:175], v[236:239], v[120:123]
    ds_read_b64_tr_b16 v[158:159], v9 offset:12288
    v_mfma_f32_16x16x32_bf16 v[124:127], v[172:175], v[240:243], v[124:127]
    s_waitcnt lgkmcnt(6)
    v_mfma_f32_16x16x32_bf16 v[128:131], v[176:179], v[232:235], v[128:131]
    ds_read_b64_tr_b16 v[160:161], v10 offset:8192
    buffer_load_dwordx4 v6, s[12:15], s41 offen offset:2048  lds
    v_mfma_f32_16x16x32_bf16 v[132:135], v[176:179], v[236:239], v[132:135]
    ds_read_b64_tr_b16 v[162:163], v10 offset:12288
    v_mfma_f32_16x16x32_bf16 v[136:139], v[176:179], v[240:243], v[136:139]
    s_waitcnt lgkmcnt(6)
    v_mfma_f32_16x16x32_bf16 v[140:143], v[180:183], v[232:235], v[140:143]
    ds_read_b64_tr_b16 v[164:165], v11 offset:8192
    buffer_load_dwordx4 v7, s[12:15], s41 offen offset:3072  lds
    s_add_u32 s41, s41, 589824
    v_mfma_f32_16x16x32_bf16 v[144:147], v[180:183], v[236:239], v[144:147]
    ds_read_b64_tr_b16 v[166:167], v11 offset:12288
    v_mfma_f32_16x16x32_bf16 v[148:151], v[180:183], v[240:243], v[148:151]
    s_waitcnt lgkmcnt(6)
    v_mfma_f32_16x16x32_bf16 v[56:59], v[152:155], v[244:247], v[56:59]
    ds_read_b64_tr_b16 v[168:169], v12 offset:8192
    buffer_load_dwordx4 v[208:211], v2, s[16:19], s40 offen offset:0 sc1
    v_mfma_f32_16x16x32_bf16 v[60:63], v[152:155], v[248:251], v[60:63]
    ds_read_b64_tr_b16 v[170:171], v12 offset:12288
    v_mfma_f32_16x16x32_bf16 v[64:67], v[152:155], v[252:255], v[64:67]
    s_waitcnt lgkmcnt(6)
    v_mfma_f32_16x16x32_bf16 v[68:71], v[156:159], v[244:247], v[68:71]
    ds_read_b64_tr_b16 v[172:173], v13 offset:8192
    buffer_load_dwordx4 v[212:215], v2, s[16:19], s40 offen offset:1024 sc1
    v_mfma_f32_16x16x32_bf16 v[72:75], v[156:159], v[248:251], v[72:75]
    ds_read_b64_tr_b16 v[174:175], v13 offset:12288
    v_mfma_f32_16x16x32_bf16 v[76:79], v[156:159], v[252:255], v[76:79]
    s_waitcnt lgkmcnt(6)
    v_mfma_f32_16x16x32_bf16 v[80:83], v[160:163], v[244:247], v[80:83]
    ds_read_b64_tr_b16 v[176:177], v14 offset:8192
    buffer_load_dwordx4 v[216:219], v2, s[16:19], s40 offen offset:2048 sc1
    s_add_u32 s40, s40, 73728
    v_mfma_f32_16x16x32_bf16 v[84:87], v[160:163], v[248:251], v[84:87]
    ds_read_b64_tr_b16 v[178:179], v14 offset:12288
    v_mfma_f32_16x16x32_bf16 v[88:91], v[160:163], v[252:255], v[88:91]
    s_waitcnt lgkmcnt(6)
    v_mfma_f32_16x16x32_bf16 v[92:95], v[164:167], v[244:247], v[92:95]
    ds_read_b64_tr_b16 v[180:181], v15 offset:8192
    v_mfma_f32_16x16x32_bf16 v[96:99], v[164:167], v[248:251], v[96:99]
    ds_read_b64_tr_b16 v[182:183], v15 offset:12288
    v_mfma_f32_16x16x32_bf16 v[100:103], v[164:167], v[252:255], v[100:103]
    s_waitcnt lgkmcnt(6)
    v_mfma_f32_16x16x32_bf16 v[104:107], v[168:171], v[244:247], v[104:107]
    s_waitcnt vmcnt(14)
    s_barrier
    ds_read_b64_tr_b16 v[152:153], v8 offset:16384
    s_add_u32 m0, s43, 40960
    s_nop 0
    buffer_load_dwordx4 v4, s[12:15], s41 offen offset:0  lds
    v_mfma_f32_16x16x32_bf16 v[108:111], v[168:171], v[248:251], v[108:111]
    ds_read_b64_tr_b16 v[154:155], v8 offset:20480
    v_mfma_f32_16x16x32_bf16 v[112:115], v[168:171], v[252:255], v[112:115]
    s_waitcnt lgkmcnt(6)
    v_mfma_f32_16x16x32_bf16 v[116:119], v[172:175], v[244:247], v[116:119]
    ds_read_b64_tr_b16 v[156:157], v9 offset:16384
    buffer_load_dwordx4 v5, s[12:15], s41 offen offset:1024  lds
    v_mfma_f32_16x16x32_bf16 v[120:123], v[172:175], v[248:251], v[120:123]
    ds_read_b64_tr_b16 v[158:159], v9 offset:20480
    v_mfma_f32_16x16x32_bf16 v[124:127], v[172:175], v[252:255], v[124:127]
    s_waitcnt lgkmcnt(6)
    v_mfma_f32_16x16x32_bf16 v[128:131], v[176:179], v[244:247], v[128:131]
    ds_read_b64_tr_b16 v[160:161], v10 offset:16384
    buffer_load_dwordx4 v6, s[12:15], s41 offen offset:2048  lds
    v_mfma_f32_16x16x32_bf16 v[132:135], v[176:179], v[248:251], v[132:135]
    ds_read_b64_tr_b16 v[162:163], v10 offset:20480
    v_mfma_f32_16x16x32_bf16 v[136:139], v[176:179], v[252:255], v[136:139]
    s_waitcnt lgkmcnt(6)
    v_mfma_f32_16x16x32_bf16 v[140:143], v[180:183], v[244:247], v[140:143]
    ds_read_b64_tr_b16 v[164:165], v11 offset:16384
    buffer_load_dwordx4 v7, s[12:15], s41 offen offset:3072  lds
    s_add_u32 s41, s41, 589824
    v_mfma_f32_16x16x32_bf16 v[144:147], v[180:183], v[248:251], v[144:147]
    ds_read_b64_tr_b16 v[166:167], v11 offset:20480
    v_mfma_f32_16x16x32_bf16 v[148:151], v[180:183], v[252:255], v[148:151]
    s_waitcnt lgkmcnt(6)
    v_mfma_f32_16x16x32_bf16 v[56:59], v[152:155], v[184:187], v[56:59]
    ds_read_b64_tr_b16 v[168:169], v12 offset:16384
    buffer_load_dwordx4 v[220:223], v2, s[16:19], s40 offen offset:0 sc1
    v_mfma_f32_16x16x32_bf16 v[60:63], v[152:155], v[188:191], v[60:63]
    ds_read_b64_tr_b16 v[170:171], v12 offset:20480
    v_mfma_f32_16x16x32_bf16 v[64:67], v[152:155], v[192:195], v[64:67]
    s_waitcnt lgkmcnt(6)
    v_mfma_f32_16x16x32_bf16 v[68:71], v[156:159], v[184:187], v[68:71]
    ds_read_b64_tr_b16 v[172:173], v13 offset:16384
    buffer_load_dwordx4 v[224:227], v2, s[16:19], s40 offen offset:1024 sc1
    v_mfma_f32_16x16x32_bf16 v[72:75], v[156:159], v[188:191], v[72:75]
    ds_read_b64_tr_b16 v[174:175], v13 offset:20480
    v_mfma_f32_16x16x32_bf16 v[76:79], v[156:159], v[192:195], v[76:79]
    s_waitcnt lgkmcnt(6)
    v_mfma_f32_16x16x32_bf16 v[80:83], v[160:163], v[184:187], v[80:83]
    ds_read_b64_tr_b16 v[176:177], v14 offset:16384
    buffer_load_dwordx4 v[228:231], v2, s[16:19], s40 offen offset:2048 sc1
    s_add_u32 s40, s40, 73728
    v_mfma_f32_16x16x32_bf16 v[84:87], v[160:163], v[188:191], v[84:87]
    ds_read_b64_tr_b16 v[178:179], v14 offset:20480
    v_mfma_f32_16x16x32_bf16 v[88:91], v[160:163], v[192:195], v[88:91]
    s_waitcnt lgkmcnt(6)
    v_mfma_f32_16x16x32_bf16 v[92:95], v[164:167], v[184:187], v[92:95]
    ds_read_b64_tr_b16 v[180:181], v15 offset:16384
    v_mfma_f32_16x16x32_bf16 v[96:99], v[164:167], v[188:191], v[96:99]
    ds_read_b64_tr_b16 v[182:183], v15 offset:20480
    v_mfma_f32_16x16x32_bf16 v[100:103], v[164:167], v[192:195], v[100:103]
    s_waitcnt lgkmcnt(6)
    v_mfma_f32_16x16x32_bf16 v[104:107], v[168:171], v[184:187], v[104:107]
    s_waitcnt vmcnt(14)
    s_barrier
    ds_read_b64_tr_b16 v[152:153], v8 offset:24576
    s_add_u32 m0, s43, 49152
    s_nop 0
    buffer_load_dwordx4 v4, s[12:15], s41 offen offset:0  lds
    v_mfma_f32_16x16x32_bf16 v[108:111], v[168:171], v[188:191], v[108:111]
    ds_read_b64_tr_b16 v[154:155], v8 offset:28672
    v_mfma_f32_16x16x32_bf16 v[112:115], v[168:171], v[192:195], v[112:115]
    s_waitcnt lgkmcnt(6)
    v_mfma_f32_16x16x32_bf16 v[116:119], v[172:175], v[184:187], v[116:119]
    ds_read_b64_tr_b16 v[156:157], v9 offset:24576
    buffer_load_dwordx4 v5, s[12:15], s41 offen offset:1024  lds
    v_mfma_f32_16x16x32_bf16 v[120:123], v[172:175], v[188:191], v[120:123]
    ds_read_b64_tr_b16 v[158:159], v9 offset:28672
    v_mfma_f32_16x16x32_bf16 v[124:127], v[172:175], v[192:195], v[124:127]
    s_waitcnt lgkmcnt(6)
    v_mfma_f32_16x16x32_bf16 v[128:131], v[176:179], v[184:187], v[128:131]
    ds_read_b64_tr_b16 v[160:161], v10 offset:24576
    buffer_load_dwordx4 v6, s[12:15], s41 offen offset:2048  lds
    v_mfma_f32_16x16x32_bf16 v[132:135], v[176:179], v[188:191], v[132:135]
    ds_read_b64_tr_b16 v[162:163], v10 offset:28672
    v_mfma_f32_16x16x32_bf16 v[136:139], v[176:179], v[192:195], v[136:139]
    s_waitcnt lgkmcnt(6)
    v_mfma_f32_16x16x32_bf16 v[140:143], v[180:183], v[184:187], v[140:143]
    ds_read_b64_tr_b16 v[164:165], v11 offset:24576
    buffer_load_dwordx4 v7, s[12:15], s41 offen offset:3072  lds
    s_add_u32 s41, s41, 589824
    v_mfma_f32_16x16x32_bf16 v[144:147], v[180:183], v[188:191], v[144:147]
    ds_read_b64_tr_b16 v[166:167], v11 offset:28672
    v_mfma_f32_16x16x32_bf16 v[148:151], v[180:183], v[192:195], v[148:151]
    s_waitcnt lgkmcnt(6)
    v_mfma_f32_16x16x32_bf16 v[56:59], v[152:155], v[196:199], v[56:59]
    ds_read_b64_tr_b16 v[168:169], v12 offset:24576
    buffer_load_dwordx4 v[232:235], v2, s[16:19], s40 offen offset:0 sc1
    v_mfma_f32_16x16x32_bf16 v[60:63], v[152:155], v[200:203], v[60:63]
    ds_read_b64_tr_b16 v[170:171], v12 offset:28672
    v_mfma_f32_16x16x32_bf16 v[64:67], v[152:155], v[204:207], v[64:67]
    s_waitcnt lgkmcnt(6)
    v_mfma_f32_16x16x32_bf16 v[68:71], v[156:159], v[196:199], v[68:71]
    ds_read_b64_tr_b16 v[172:173], v13 offset:24576
    buffer_load_dwordx4 v[236:239], v2, s[16:19], s40 offen offset:1024 sc1
    v_mfma_f32_16x16x32_bf16 v[72:75], v[156:159], v[200:203], v[72:75]
    ds_read_b64_tr_b16 v[174:175], v13 offset:28672
    v_mfma_f32_16x16x32_bf16 v[76:79], v[156:159], v[204:207], v[76:79]
    s_waitcnt lgkmcnt(6)
    v_mfma_f32_16x16x32_bf16 v[80:83], v[160:163], v[196:199], v[80:83]
    ds_read_b64_tr_b16 v[176:177], v14 offset:24576
    buffer_load_dwordx4 v[240:243], v2, s[16:19], s40 offen offset:2048 sc1
    s_add_u32 s40, s40, 73728
    v_mfma_f32_16x16x32_bf16 v[84:87], v[160:163], v[200:203], v[84:87]
    ds_read_b64_tr_b16 v[178:179], v14 offset:28672
    v_mfma_f32_16x16x32_bf16 v[88:91], v[160:163], v[204:207], v[88:91]
    s_waitcnt lgkmcnt(6)
    v_mfma_f32_16x16x32_bf16 v[92:95], v[164:167], v[196:199], v[92:95]
    ds_read_b64_tr_b16 v[180:181], v15 offset:24576
    v_mfma_f32_16x16x32_bf16 v[96:99], v[164:167], v[200:203], v[96:99]
    ds_read_b64_tr_b16 v[182:183], v15 offset:28672
    v_mfma_f32_16x16x32_bf16 v[100:103], v[164:167], v[204:207], v[100:103]
    s_waitcnt lgkmcnt(6)
    v_mfma_f32_16x16x32_bf16 v[104:107], v[168:171], v[196:199], v[104:107]
    s_waitcnt vmcnt(14)
    s_barrier
    ds_read_b64_tr_b16 v[152:153], v8 offset:32768
    s_add_u32 m0, s43, 57344
    s_nop 0
    buffer_load_dwordx4 v4, s[12:15], s41 offen offset:0  lds
    v_mfma_f32_16x16x32_bf16 v[108:111], v[168:171], v[200:203], v[108:111]
    ds_read_b64_tr_b16 v[154:155], v8 offset:36864
    v_mfma_f32_16x16x32_bf16 v[112:115], v[168:171], v[204:207], v[112:115]
    s_waitcnt lgkmcnt(6)
    v_mfma_f32_16x16x32_bf16 v[116:119], v[172:175], v[196:199], v[116:119]
    ds_read_b64_tr_b16 v[156:157], v9 offset:32768
    buffer_load_dwordx4 v5, s[12:15], s41 offen offset:1024  lds
    v_mfma_f32_16x16x32_bf16 v[120:123], v[172:175], v[200:203], v[120:123]
    ds_read_b64_tr_b16 v[158:159], v9 offset:36864
    v_mfma_f32_16x16x32_bf16 v[124:127], v[172:175], v[204:207], v[124:127]
    s_waitcnt lgkmcnt(6)
    v_mfma_f32_16x16x32_bf16 v[128:131], v[176:179], v[196:199], v[128:131]
    ds_read_b64_tr_b16 v[160:161], v10 offset:32768
    buffer_load_dwordx4 v6, s[12:15], s41 offen offset:2048  lds
    v_mfma_f32_16x16x32_bf16 v[132:135], v[176:179], v[200:203], v[132:135]
    ds_read_b64_tr_b16 v[162:163], v10 offset:36864
    v_mfma_f32_16x16x32_bf16 v[136:139], v[176:179], v[204:207], v[136:139]
    s_waitcnt lgkmcnt(6)
    v_mfma_f32_16x16x32_bf16 v[140:143], v[180:183], v[196:199], v[140:143]
    ds_read_b64_tr_b16 v[164:165], v11 offset:32768
    buffer_load_dwordx4 v7, s[12:15], s41 offen offset:3072  lds
    s_add_u32 s41, s41, 589824
    v_mfma_f32_16x16x32_bf16 v[144:147], v[180:183], v[200:203], v[144:147]
    ds_read_b64_tr_b16 v[166:167], v11 offset:36864
    v_mfma_f32_16x16x32_bf16 v[148:151], v[180:183], v[204:207], v[148:151]
    s_waitcnt lgkmcnt(6)
    v_mfma_f32_16x16x32_bf16 v[56:59], v[152:155], v[208:211], v[56:59]
    ds_read_b64_tr_b16 v[168:169], v12 offset:32768
    buffer_load_dwordx4 v[244:247], v2, s[16:19], s40 offen offset:0 sc1
    v_mfma_f32_16x16x32_bf16 v[60:63], v[152:155], v[212:215], v[60:63]
    ds_read_b64_tr_b16 v[170:171], v12 offset:36864
    v_mfma_f32_16x16x32_bf16 v[64:67], v[152:155], v[216:219], v[64:67]
    s_waitcnt lgkmcnt(6)
    v_mfma_f32_16x16x32_bf16 v[68:71], v[156:159], v[208:211], v[68:71]
    ds_read_b64_tr_b16 v[172:173], v13 offset:32768
    buffer_load_dwordx4 v[248:251], v2, s[16:19], s40 offen offset:1024 sc1
    v_mfma_f32_16x16x32_bf16 v[72:75], v[156:159], v[212:215], v[72:75]
    ds_read_b64_tr_b16 v[174:175], v13 offset:36864
    v_mfma_f32_16x16x32_bf16 v[76:79], v[156:159], v[216:219], v[76:79]
    s_waitcnt lgkmcnt(6)
    v_mfma_f32_16x16x32_bf16 v[80:83], v[160:163], v[208:211], v[80:83]
    ds_read_b64_tr_b16 v[176:177], v14 offset:32768
    buffer_load_dwordx4 v[252:255], v2, s[16:19], s40 offen offset:2048 sc1
    s_add_u32 s40, s40, 73728
    v_mfma_f32_16x16x32_bf16 v[84:87], v[160:163], v[212:215], v[84:87]
    ds_read_b64_tr_b16 v[178:179], v14 offset:36864
    v_mfma_f32_16x16x32_bf16 v[88:91], v[160:163], v[216:219], v[88:91]
    s_waitcnt lgkmcnt(6)
    v_mfma_f32_16x16x32_bf16 v[92:95], v[164:167], v[208:211], v[92:95]
    ds_read_b64_tr_b16 v[180:181], v15 offset:32768
    v_mfma_f32_16x16x32_bf16 v[96:99], v[164:167], v[212:215], v[96:99]
    ds_read_b64_tr_b16 v[182:183], v15 offset:36864
    v_mfma_f32_16x16x32_bf16 v[100:103], v[164:167], v[216:219], v[100:103]
    s_waitcnt lgkmcnt(6)
    v_mfma_f32_16x16x32_bf16 v[104:107], v[168:171], v[208:211], v[104:107]
    s_waitcnt vmcnt(14)
    s_barrier
    ds_read_b64_tr_b16 v[152:153], v8 offset:40960
    s_add_u32 m0, s43, 0
    s_nop 0
    buffer_load_dwordx4 v4, s[12:15], s41 offen offset:0  lds
    v_mfma_f32_16x16x32_bf16 v[108:111], v[168:171], v[212:215], v[108:111]
    ds_read_b64_tr_b16 v[154:155], v8 offset:45056
    v_mfma_f32_16x16x32_bf16 v[112:115], v[168:171], v[216:219], v[112:115]
    s_waitcnt lgkmcnt(6)
    v_mfma_f32_16x16x32_bf16 v[116:119], v[172:175], v[208:211], v[116:119]
    ds_read_b64_tr_b16 v[156:157], v9 offset:40960
    buffer_load_dwordx4 v5, s[12:15], s41 offen offset:1024  lds
    v_mfma_f32_16x16x32_bf16 v[120:123], v[172:175], v[212:215], v[120:123]
    ds_read_b64_tr_b16 v[158:159], v9 offset:45056
    v_mfma_f32_16x16x32_bf16 v[124:127], v[172:175], v[216:219], v[124:127]
    s_waitcnt lgkmcnt(6)
    v_mfma_f32_16x16x32_bf16 v[128:131], v[176:179], v[208:211], v[128:131]
    ds_read_b64_tr_b16 v[160:161], v10 offset:40960
    buffer_load_dwordx4 v6, s[12:15], s41 offen offset:2048  lds
    v_mfma_f32_16x16x32_bf16 v[132:135], v[176:179], v[212:215], v[132:135]
    ds_read_b64_tr_b16 v[162:163], v10 offset:45056
    v_mfma_f32_16x16x32_bf16 v[136:139], v[176:179], v[216:219], v[136:139]
    s_waitcnt lgkmcnt(6)
    v_mfma_f32_16x16x32_bf16 v[140:143], v[180:183], v[208:211], v[140:143]
    ds_read_b64_tr_b16 v[164:165], v11 offset:40960
    buffer_load_dwordx4 v7, s[12:15], s41 offen offset:3072  lds
    s_add_u32 s41, s41, 589824
    v_mfma_f32_16x16x32_bf16 v[144:147], v[180:183], v[212:215], v[144:147]
    ds_read_b64_tr_b16 v[166:167], v11 offset:45056
    v_mfma_f32_16x16x32_bf16 v[148:151], v[180:183], v[216:219], v[148:151]
    s_waitcnt lgkmcnt(6)
    v_mfma_f32_16x16x32_bf16 v[56:59], v[152:155], v[220:223], v[56:59]
    ds_read_b64_tr_b16 v[168:169], v12 offset:40960
    buffer_load_dwordx4 v[184:187], v2, s[16:19], s40 offen offset:0 sc1
    v_mfma_f32_16x16x32_bf16 v[60:63], v[152:155], v[224:227], v[60:63]
    ds_read_b64_tr_b16 v[170:171], v12 offset:45056
    v_mfma_f32_16x16x32_bf16 v[64:67], v[152:155], v[228:231], v[64:67]
    s_waitcnt lgkmcnt(6)
    v_mfma_f32_16x16x32_bf16 v[68:71], v[156:159], v[220:223], v[68:71]
    ds_read_b64_tr_b16 v[172:173], v13 offset:40960
    buffer_load_dwordx4 v[188:191], v2, s[16:19], s40 offen offset:1024 sc1
    v_mfma_f32_16x16x32_bf16 v[72:75], v[156:159], v[224:227], v[72:75]
    ds_read_b64_tr_b16 v[174:175], v13 offset:45056
    v_mfma_f32_16x16x32_bf16 v[76:79], v[156:159], v[228:231], v[76:79]
    s_waitcnt lgkmcnt(6)
    v_mfma_f32_16x16x32_bf16 v[80:83], v[160:163], v[220:223], v[80:83]
    ds_read_b64_tr_b16 v[176:177], v14 offset:40960
    buffer_load_dwordx4 v[192:195], v2, s[16:19], s40 offen offset:2048 sc1
    s_add_u32 s40, s40, 73728
    v_mfma_f32_16x16x32_bf16 v[84:87], v[160:163], v[224:227], v[84:87]
    ds_read_b64_tr_b16 v[178:179], v14 offset:45056
    v_mfma_f32_16x16x32_bf16 v[88:91], v[160:163], v[228:231], v[88:91]
    s_waitcnt lgkmcnt(6)
    v_mfma_f32_16x16x32_bf16 v[92:95], v[164:167], v[220:223], v[92:95]
    ds_read_b64_tr_b16 v[180:181], v15 offset:40960
    v_mfma_f32_16x16x32_bf16 v[96:99], v[164:167], v[224:227], v[96:99]
    ds_read_b64_tr_b16 v[182:183], v15 offset:45056
    v_mfma_f32_16x16x32_bf16 v[100:103], v[164:167], v[228:231], v[100:103]
    s_waitcnt lgkmcnt(6)
    v_mfma_f32_16x16x32_bf16 v[104:107], v[168:171], v[220:223], v[104:107]
    s_waitcnt vmcnt(14)
    s_barrier
    ds_read_b64_tr_b16 v[152:153], v8 offset:49152
    s_add_u32 m0, s43, 8192
    s_nop 0
    buffer_load_dwordx4 v4, s[12:15], s41 offen offset:0  lds
    v_mfma_f32_16x16x32_bf16 v[108:111], v[168:171], v[224:227], v[108:111]
    ds_read_b64_tr_b16 v[154:155], v8 offset:53248
    v_mfma_f32_16x16x32_bf16 v[112:115], v[168:171], v[228:231], v[112:115]
    s_waitcnt lgkmcnt(6)
    v_mfma_f32_16x16x32_bf16 v[116:119], v[172:175], v[220:223], v[116:119]
    ds_read_b64_tr_b16 v[156:157], v9 offset:49152
    buffer_load_dwordx4 v5, s[12:15], s41 offen offset:1024  lds
    v_mfma_f32_16x16x32_bf16 v[120:123], v[172:175], v[224:227], v[120:123]
    ds_read_b64_tr_b16 v[158:159], v9 offset:53248
    v_mfma_f32_16x16x32_bf16 v[124:127], v[172:175], v[228:231], v[124:127]
    s_waitcnt lgkmcnt(6)
    v_mfma_f32_16x16x32_bf16 v[128:131], v[176:179], v[220:223], v[128:131]
    ds_read_b64_tr_b16 v[160:161], v10 offset:49152
    buffer_load_dwordx4 v6, s[12:15], s41 offen offset:2048  lds
    v_mfma_f32_16x16x32_bf16 v[132:135], v[176:179], v[224:227], v[132:135]
    ds_read_b64_tr_b16 v[162:163], v10 offset:53248
    v_mfma_f32_16x16x32_bf16 v[136:139], v[176:179], v[228:231], v[136:139]
    s_waitcnt lgkmcnt(6)
    v_mfma_f32_16x16x32_bf16 v[140:143], v[180:183], v[220:223], v[140:143]
    ds_read_b64_tr_b16 v[164:165], v11 offset:49152
    buffer_load_dwordx4 v7, s[12:15], s41 offen offset:3072  lds
    s_add_u32 s41, s41, 589824
    v_mfma_f32_16x16x32_bf16 v[144:147], v[180:183], v[224:227], v[144:147]
    ds_read_b64_tr_b16 v[166:167], v11 offset:53248
    v_mfma_f32_16x16x32_bf16 v[148:151], v[180:183], v[228:231], v[148:151]
    s_waitcnt lgkmcnt(6)
    v_mfma_f32_16x16x32_bf16 v[56:59], v[152:155], v[232:235], v[56:59]
    ds_read_b64_tr_b16 v[168:169], v12 offset:49152
    buffer_load_dwordx4 v[196:199], v2, s[16:19], s40 offen offset:0 sc1
    v_mfma_f32_16x16x32_bf16 v[60:63], v[152:155], v[236:239], v[60:63]
    ds_read_b64_tr_b16 v[170:171], v12 offset:53248
    v_mfma_f32_16x16x32_bf16 v[64:67], v[152:155], v[240:243], v[64:67]
    s_waitcnt lgkmcnt(6)
    v_mfma_f32_16x16x32_bf16 v[68:71], v[156:159], v[232:235], v[68:71]
    ds_read_b64_tr_b16 v[172:173], v13 offset:49152
    buffer_load_dwordx4 v[200:203], v2, s[16:19], s40 offen offset:1024 sc1
    v_mfma_f32_16x16x32_bf16 v[72:75], v[156:159], v[236:239], v[72:75]
    ds_read_b64_tr_b16 v[174:175], v13 offset:53248
    v_mfma_f32_16x16x32_bf16 v[76:79], v[156:159], v[240:243], v[76:79]
    s_waitcnt lgkmcnt(6)
    v_mfma_f32_16x16x32_bf16 v[80:83], v[160:163], v[232:235], v[80:83]
    ds_read_b64_tr_b16 v[176:177], v14 offset:49152
    buffer_load_dwordx4 v[204:207], v2, s[16:19], s40 offen offset:2048 sc1
    s_add_u32 s40, s40, 73728
    v_mfma_f32_16x16x32_bf16 v[84:87], v[160:163], v[236:239], v[84:87]
    ds_read_b64_tr_b16 v[178:179], v14 offset:53248
    v_mfma_f32_16x16x32_bf16 v[88:91], v[160:163], v[240:243], v[88:91]
    s_waitcnt lgkmcnt(6)
    v_mfma_f32_16x16x32_bf16 v[92:95], v[164:167], v[232:235], v[92:95]
    ds_read_b64_tr_b16 v[180:181], v15 offset:49152
    v_mfma_f32_16x16x32_bf16 v[96:99], v[164:167], v[236:239], v[96:99]
    ds_read_b64_tr_b16 v[182:183], v15 offset:53248
    v_mfma_f32_16x16x32_bf16 v[100:103], v[164:167], v[240:243], v[100:103]
    s_waitcnt lgkmcnt(6)
    v_mfma_f32_16x16x32_bf16 v[104:107], v[168:171], v[232:235], v[104:107]
    s_waitcnt vmcnt(14)
    s_barrier
    ds_read_b64_tr_b16 v[152:153], v8 offset:57344
    s_add_u32 m0, s43, 16384
    s_nop 0
    buffer_load_dwordx4 v4, s[12:15], s41 offen offset:0  lds
    v_mfma_f32_16x16x32_bf16 v[108:111], v[168:171], v[236:239], v[108:111]
    ds_read_b64_tr_b16 v[154:155], v8 offset:61440
    v_mfma_f32_16x16x32_bf16 v[112:115], v[168:171], v[240:243], v[112:115]
    s_waitcnt lgkmcnt(6)
    v_mfma_f32_16x16x32_bf16 v[116:119], v[172:175], v[232:235], v[116:119]
    ds_read_b64_tr_b16 v[156:157], v9 offset:57344
    buffer_load_dwordx4 v5, s[12:15], s41 offen offset:1024  lds
    v_mfma_f32_16x16x32_bf16 v[120:123], v[172:175], v[236:239], v[120:123]
    ds_read_b64_tr_b16 v[158:159], v9 offset:61440
    v_mfma_f32_16x16x32_bf16 v[124:127], v[172:175], v[240:243], v[124:127]
    s_waitcnt lgkmcnt(6)
    v_mfma_f32_16x16x32_bf16 v[128:131], v[176:179], v[232:235], v[128:131]
    ds_read_b64_tr_b16 v[160:161], v10 offset:57344
    buffer_load_dwordx4 v6, s[12:15], s41 offen offset:2048  lds
    v_mfma_f32_16x16x32_bf16 v[132:135], v[176:179], v[236:239], v[132:135]
    ds_read_b64_tr_b16 v[162:163], v10 offset:61440
    v_mfma_f32_16x16x32_bf16 v[136:139], v[176:179], v[240:243], v[136:139]
    s_waitcnt lgkmcnt(6)
    v_mfma_f32_16x16x32_bf16 v[140:143], v[180:183], v[232:235], v[140:143]
    ds_read_b64_tr_b16 v[164:165], v11 offset:57344
    buffer_load_dwordx4 v7, s[12:15], s41 offen offset:3072  lds
    s_add_u32 s41, s41, 589824
    v_mfma_f32_16x16x32_bf16 v[144:147], v[180:183], v[236:239], v[144:147]
    ds_read_b64_tr_b16 v[166:167], v11 offset:61440
    v_mfma_f32_16x16x32_bf16 v[148:151], v[180:183], v[240:243], v[148:151]
    s_waitcnt lgkmcnt(6)
    v_mfma_f32_16x16x32_bf16 v[56:59], v[152:155], v[244:247], v[56:59]
    ds_read_b64_tr_b16 v[168:169], v12 offset:57344
    buffer_load_dwordx4 v[208:211], v2, s[16:19], s40 offen offset:0 sc1
    v_mfma_f32_16x16x32_bf16 v[60:63], v[152:155], v[248:251], v[60:63]
    ds_read_b64_tr_b16 v[170:171], v12 offset:61440
    v_mfma_f32_16x16x32_bf16 v[64:67], v[152:155], v[252:255], v[64:67]
    s_waitcnt lgkmcnt(6)
    v_mfma_f32_16x16x32_bf16 v[68:71], v[156:159], v[244:247], v[68:71]
    ds_read_b64_tr_b16 v[172:173], v13 offset:57344
    buffer_load_dwordx4 v[212:215], v2, s[16:19], s40 offen offset:1024 sc1
    v_mfma_f32_16x16x32_bf16 v[72:75], v[156:159], v[248:251], v[72:75]
    ds_read_b64_tr_b16 v[174:175], v13 offset:61440
    v_mfma_f32_16x16x32_bf16 v[76:79], v[156:159], v[252:255], v[76:79]
    s_waitcnt lgkmcnt(6)
    v_mfma_f32_16x16x32_bf16 v[80:83], v[160:163], v[244:247], v[80:83]
    ds_read_b64_tr_b16 v[176:177], v14 offset:57344
    buffer_load_dwordx4 v[216:219], v2, s[16:19], s40 offen offset:2048 sc1
    s_add_u32 s40, s40, 73728
    v_mfma_f32_16x16x32_bf16 v[84:87], v[160:163], v[248:251], v[84:87]
    ds_read_b64_tr_b16 v[178:179], v14 offset:61440
    v_mfma_f32_16x16x32_bf16 v[88:91], v[160:163], v[252:255], v[88:91]
    s_waitcnt lgkmcnt(6)
    v_mfma_f32_16x16x32_bf16 v[92:95], v[164:167], v[244:247], v[92:95]
    ds_read_b64_tr_b16 v[180:181], v15 offset:57344
    v_mfma_f32_16x16x32_bf16 v[96:99], v[164:167], v[248:251], v[96:99]
    ds_read_b64_tr_b16 v[182:183], v15 offset:61440
    v_mfma_f32_16x16x32_bf16 v[100:103], v[164:167], v[252:255], v[100:103]
    s_waitcnt lgkmcnt(6)
    v_mfma_f32_16x16x32_bf16 v[104:107], v[168:171], v[244:247], v[104:107]
    s_waitcnt vmcnt(14)
    s_barrier
    ds_read_b64_tr_b16 v[152:153], v8 offset:0
    s_add_u32 m0, s43, 24576
    s_nop 0
    buffer_load_dwordx4 v4, s[12:15], s41 offen offset:0  lds
    v_mfma_f32_16x16x32_bf16 v[108:111], v[168:171], v[248:251], v[108:111]
    ds_read_b64_tr_b16 v[154:155], v8 offset:4096
    v_mfma_f32_16x16x32_bf16 v[112:115], v[168:171], v[252:255], v[112:115]
    s_waitcnt lgkmcnt(6)
    v_mfma_f32_16x16x32_bf16 v[116:119], v[172:175], v[244:247], v[116:119]
    ds_read_b64_tr_b16 v[156:157], v9 offset:0
    buffer_load_dwordx4 v5, s[12:15], s41 offen offset:1024  lds
    v_mfma_f32_16x16x32_bf16 v[120:123], v[172:175], v[248:251], v[120:123]
    ds_read_b64_tr_b16 v[158:159], v9 offset:4096
    v_mfma_f32_16x16x32_bf16 v[124:127], v[172:175], v[252:255], v[124:127]
    s_waitcnt lgkmcnt(6)
    v_mfma_f32_16x16x32_bf16 v[128:131], v[176:179], v[244:247], v[128:131]
    ds_read_b64_tr_b16 v[160:161], v10 offset:0
    buffer_load_dwordx4 v6, s[12:15], s41 offen offset:2048  lds
    v_mfma_f32_16x16x32_bf16 v[132:135], v[176:179], v[248:251], v[132:135]
    ds_read_b64_tr_b16 v[162:163], v10 offset:4096
    v_mfma_f32_16x16x32_bf16 v[136:139], v[176:179], v[252:255], v[136:139]
    s_waitcnt lgkmcnt(6)
    v_mfma_f32_16x16x32_bf16 v[140:143], v[180:183], v[244:247], v[140:143]
    ds_read_b64_tr_b16 v[164:165], v11 offset:0
    buffer_load_dwordx4 v7, s[12:15], s41 offen offset:3072  lds
    s_add_u32 s41, s41, 589824
    v_mfma_f32_16x16x32_bf16 v[144:147], v[180:183], v[248:251], v[144:147]
    ds_read_b64_tr_b16 v[166:167], v11 offset:4096
    v_mfma_f32_16x16x32_bf16 v[148:151], v[180:183], v[252:255], v[148:151]
    s_waitcnt lgkmcnt(6)
    v_mfma_f32_16x16x32_bf16 v[56:59], v[152:155], v[184:187], v[56:59]
    ds_read_b64_tr_b16 v[168:169], v12 offset:0
    buffer_load_dwordx4 v[220:223], v2, s[16:19], s40 offen offset:0 sc1
    v_mfma_f32_16x16x32_bf16 v[60:63], v[152:155], v[188:191], v[60:63]
    ds_read_b64_tr_b16 v[170:171], v12 offset:4096
    v_mfma_f32_16x16x32_bf16 v[64:67], v[152:155], v[192:195], v[64:67]
    s_waitcnt lgkmcnt(6)
    v_mfma_f32_16x16x32_bf16 v[68:71], v[156:159], v[184:187], v[68:71]
    ds_read_b64_tr_b16 v[172:173], v13 offset:0
    buffer_load_dwordx4 v[224:227], v2, s[16:19], s40 offen offset:1024 sc1
    v_mfma_f32_16x16x32_bf16 v[72:75], v[156:159], v[188:191], v[72:75]
    ds_read_b64_tr_b16 v[174:175], v13 offset:4096
    v_mfma_f32_16x16x32_bf16 v[76:79], v[156:159], v[192:195], v[76:79]
    s_waitcnt lgkmcnt(6)
    v_mfma_f32_16x16x32_bf16 v[80:83], v[160:163], v[184:187], v[80:83]
    ds_read_b64_tr_b16 v[176:177], v14 offset:0
    buffer_load_dwordx4 v[228:231], v2, s[16:19], s40 offen offset:2048 sc1
    s_add_u32 s40, s40, 73728
    v_mfma_f32_16x16x32_bf16 v[84:87], v[160:163], v[188:191], v[84:87]
    ds_read_b64_tr_b16 v[178:179], v14 offset:4096
    v_mfma_f32_16x16x32_bf16 v[88:91], v[160:163], v[192:195], v[88:91]
    s_waitcnt lgkmcnt(6)
    v_mfma_f32_16x16x32_bf16 v[92:95], v[164:167], v[184:187], v[92:95]
    ds_read_b64_tr_b16 v[180:181], v15 offset:0
    v_mfma_f32_16x16x32_bf16 v[96:99], v[164:167], v[188:191], v[96:99]
    ds_read_b64_tr_b16 v[182:183], v15 offset:4096
    v_mfma_f32_16x16x32_bf16 v[100:103], v[164:167], v[192:195], v[100:103]
    s_waitcnt lgkmcnt(6)
    v_mfma_f32_16x16x32_bf16 v[104:107], v[168:171], v[184:187], v[104:107]
    s_waitcnt vmcnt(14)
    s_barrier
    ds_read_b64_tr_b16 v[152:153], v8 offset:8192
    s_add_u32 m0, s43, 32768
    s_nop 0
    buffer_load_dwordx4 v4, s[12:15], s41 offen offset:0  lds
    v_mfma_f32_16x16x32_bf16 v[108:111], v[168:171], v[188:191], v[108:111]
    ds_read_b64_tr_b16 v[154:155], v8 offset:12288
    v_mfma_f32_16x16x32_bf16 v[112:115], v[168:171], v[192:195], v[112:115]
    s_waitcnt lgkmcnt(6)
    v_mfma_f32_16x16x32_bf16 v[116:119], v[172:175], v[184:187], v[116:119]
    ds_read_b64_tr_b16 v[156:157], v9 offset:8192
    buffer_load_dwordx4 v5, s[12:15], s41 offen offset:1024  lds
    v_mfma_f32_16x16x32_bf16 v[120:123], v[172:175], v[188:191], v[120:123]
    ds_read_b64_tr_b16 v[158:159], v9 offset:12288
    v_mfma_f32_16x16x32_bf16 v[124:127], v[172:175], v[192:195], v[124:127]
    s_waitcnt lgkmcnt(6)
    v_mfma_f32_16x16x32_bf16 v[128:131], v[176:179], v[184:187], v[128:131]
    ds_read_b64_tr_b16 v[160:161], v10 offset:8192
    buffer_load_dwordx4 v6, s[12:15], s41 offen offset:2048  lds
    v_mfma_f32_16x16x32_bf16 v[132:135], v[176:179], v[188:191], v[132:135]
    ds_read_b64_tr_b16 v[162:163], v10 offset:12288
    v_mfma_f32_16x16x32_bf16 v[136:139], v[176:179], v[192:195], v[136:139]
    s_waitcnt lgkmcnt(6)
    v_mfma_f32_16x16x32_bf16 v[140:143], v[180:183], v[184:187], v[140:143]
    ds_read_b64_tr_b16 v[164:165], v11 offset:8192
    buffer_load_dwordx4 v7, s[12:15], s41 offen offset:3072  lds
    s_add_u32 s41, s41, 589824
    v_mfma_f32_16x16x32_bf16 v[144:147], v[180:183], v[188:191], v[144:147]
    ds_read_b64_tr_b16 v[166:167], v11 offset:12288
    v_mfma_f32_16x16x32_bf16 v[148:151], v[180:183], v[192:195], v[148:151]
    s_waitcnt lgkmcnt(6)
    v_mfma_f32_16x16x32_bf16 v[56:59], v[152:155], v[196:199], v[56:59]
    ds_read_b64_tr_b16 v[168:169], v12 offset:8192
    buffer_load_dwordx4 v[232:235], v2, s[16:19], s40 offen offset:0 sc1
    v_mfma_f32_16x16x32_bf16 v[60:63], v[152:155], v[200:203], v[60:63]
    ds_read_b64_tr_b16 v[170:171], v12 offset:12288
    v_mfma_f32_16x16x32_bf16 v[64:67], v[152:155], v[204:207], v[64:67]
    s_waitcnt lgkmcnt(6)
    v_mfma_f32_16x16x32_bf16 v[68:71], v[156:159], v[196:199], v[68:71]
    ds_read_b64_tr_b16 v[172:173], v13 offset:8192
    buffer_load_dwordx4 v[236:239], v2, s[16:19], s40 offen offset:1024 sc1
    v_mfma_f32_16x16x32_bf16 v[72:75], v[156:159], v[200:203], v[72:75]
    ds_read_b64_tr_b16 v[174:175], v13 offset:12288
    v_mfma_f32_16x16x32_bf16 v[76:79], v[156:159], v[204:207], v[76:79]
    s_waitcnt lgkmcnt(6)
    v_mfma_f32_16x16x32_bf16 v[80:83], v[160:163], v[196:199], v[80:83]
    ds_read_b64_tr_b16 v[176:177], v14 offset:8192
    buffer_load_dwordx4 v[240:243], v2, s[16:19], s40 offen offset:2048 sc1
    s_add_u32 s40, s40, 73728
    v_mfma_f32_16x16x32_bf16 v[84:87], v[160:163], v[200:203], v[84:87]
    ds_read_b64_tr_b16 v[178:179], v14 offset:12288
    v_mfma_f32_16x16x32_bf16 v[88:91], v[160:163], v[204:207], v[88:91]
    s_waitcnt lgkmcnt(6)
    v_mfma_f32_16x16x32_bf16 v[92:95], v[164:167], v[196:199], v[92:95]
    ds_read_b64_tr_b16 v[180:181], v15 offset:8192
    v_mfma_f32_16x16x32_bf16 v[96:99], v[164:167], v[200:203], v[96:99]
    ds_read_b64_tr_b16 v[182:183], v15 offset:12288
    v_mfma_f32_16x16x32_bf16 v[100:103], v[164:167], v[204:207], v[100:103]
    s_waitcnt lgkmcnt(6)
    v_mfma_f32_16x16x32_bf16 v[104:107], v[168:171], v[196:199], v[104:107]
    s_waitcnt vmcnt(14)
    s_barrier
    ds_read_b64_tr_b16 v[152:153], v8 offset:16384
    s_add_u32 m0, s43, 40960
    s_nop 0
    buffer_load_dwordx4 v4, s[12:15], s41 offen offset:0  lds
    v_mfma_f32_16x16x32_bf16 v[108:111], v[168:171], v[200:203], v[108:111]
    ds_read_b64_tr_b16 v[154:155], v8 offset:20480
    v_mfma_f32_16x16x32_bf16 v[112:115], v[168:171], v[204:207], v[112:115]
    s_waitcnt lgkmcnt(6)
    v_mfma_f32_16x16x32_bf16 v[116:119], v[172:175], v[196:199], v[116:119]
    ds_read_b64_tr_b16 v[156:157], v9 offset:16384
    buffer_load_dwordx4 v5, s[12:15], s41 offen offset:1024  lds
    v_mfma_f32_16x16x32_bf16 v[120:123], v[172:175], v[200:203], v[120:123]
    ds_read_b64_tr_b16 v[158:159], v9 offset:20480
    v_mfma_f32_16x16x32_bf16 v[124:127], v[172:175], v[204:207], v[124:127]
    s_waitcnt lgkmcnt(6)
    v_mfma_f32_16x16x32_bf16 v[128:131], v[176:179], v[196:199], v[128:131]
    ds_read_b64_tr_b16 v[160:161], v10 offset:16384
    buffer_load_dwordx4 v6, s[12:15], s41 offen offset:2048  lds
    v_mfma_f32_16x16x32_bf16 v[132:135], v[176:179], v[200:203], v[132:135]
    ds_read_b64_tr_b16 v[162:163], v10 offset:20480
    v_mfma_f32_16x16x32_bf16 v[136:139], v[176:179], v[204:207], v[136:139]
    s_waitcnt lgkmcnt(6)
    v_mfma_f32_16x16x32_bf16 v[140:143], v[180:183], v[196:199], v[140:143]
    ds_read_b64_tr_b16 v[164:165], v11 offset:16384
    buffer_load_dwordx4 v7, s[12:15], s41 offen offset:3072  lds
    s_add_u32 s41, s41, 589824
    v_mfma_f32_16x16x32_bf16 v[144:147], v[180:183], v[200:203], v[144:147]
    ds_read_b64_tr_b16 v[166:167], v11 offset:20480
    v_mfma_f32_16x16x32_bf16 v[148:151], v[180:183], v[204:207], v[148:151]
    s_waitcnt lgkmcnt(6)
    v_mfma_f32_16x16x32_bf16 v[56:59], v[152:155], v[208:211], v[56:59]
    ds_read_b64_tr_b16 v[168:169], v12 offset:16384
    buffer_load_dwordx4 v[244:247], v2, s[16:19], s40 offen offset:0 sc1
    v_mfma_f32_16x16x32_bf16 v[60:63], v[152:155], v[212:215], v[60:63]
    ds_read_b64_tr_b16 v[170:171], v12 offset:20480
    v_mfma_f32_16x16x32_bf16 v[64:67], v[152:155], v[216:219], v[64:67]
    s_waitcnt lgkmcnt(6)
    v_mfma_f32_16x16x32_bf16 v[68:71], v[156:159], v[208:211], v[68:71]
    ds_read_b64_tr_b16 v[172:173], v13 offset:16384
    buffer_load_dwordx4 v[248:251], v2, s[16:19], s40 offen offset:1024 sc1
    v_mfma_f32_16x16x32_bf16 v[72:75], v[156:159], v[212:215], v[72:75]
    ds_read_b64_tr_b16 v[174:175], v13 offset:20480
    v_mfma_f32_16x16x32_bf16 v[76:79], v[156:159], v[216:219], v[76:79]
    s_waitcnt lgkmcnt(6)
    v_mfma_f32_16x16x32_bf16 v[80:83], v[160:163], v[208:211], v[80:83]
    ds_read_b64_tr_b16 v[176:177], v14 offset:16384
    buffer_load_dwordx4 v[252:255], v2, s[16:19], s40 offen offset:2048 sc1
    s_add_u32 s40, s40, 73728
    v_mfma_f32_16x16x32_bf16 v[84:87], v[160:163], v[212:215], v[84:87]
    ds_read_b64_tr_b16 v[178:179], v14 offset:20480
    v_mfma_f32_16x16x32_bf16 v[88:91], v[160:163], v[216:219], v[88:91]
    s_waitcnt lgkmcnt(6)
    v_mfma_f32_16x16x32_bf16 v[92:95], v[164:167], v[208:211], v[92:95]
    ds_read_b64_tr_b16 v[180:181], v15 offset:16384
    v_mfma_f32_16x16x32_bf16 v[96:99], v[164:167], v[212:215], v[96:99]
    ds_read_b64_tr_b16 v[182:183], v15 offset:20480
    v_mfma_f32_16x16x32_bf16 v[100:103], v[164:167], v[216:219], v[100:103]
    s_waitcnt lgkmcnt(6)
    v_mfma_f32_16x16x32_bf16 v[104:107], v[168:171], v[208:211], v[104:107]
    s_waitcnt vmcnt(14)
    s_barrier
    ds_read_b64_tr_b16 v[152:153], v8 offset:24576
    s_add_u32 m0, s43, 49152
    s_nop 0
    buffer_load_dwordx4 v4, s[12:15], s41 offen offset:0  lds
    v_mfma_f32_16x16x32_bf16 v[108:111], v[168:171], v[212:215], v[108:111]
    ds_read_b64_tr_b16 v[154:155], v8 offset:28672
    v_mfma_f32_16x16x32_bf16 v[112:115], v[168:171], v[216:219], v[112:115]
    s_waitcnt lgkmcnt(6)
    v_mfma_f32_16x16x32_bf16 v[116:119], v[172:175], v[208:211], v[116:119]
    ds_read_b64_tr_b16 v[156:157], v9 offset:24576
    buffer_load_dwordx4 v5, s[12:15], s41 offen offset:1024  lds
    v_mfma_f32_16x16x32_bf16 v[120:123], v[172:175], v[212:215], v[120:123]
    ds_read_b64_tr_b16 v[158:159], v9 offset:28672
    v_mfma_f32_16x16x32_bf16 v[124:127], v[172:175], v[216:219], v[124:127]
    s_waitcnt lgkmcnt(6)
    v_mfma_f32_16x16x32_bf16 v[128:131], v[176:179], v[208:211], v[128:131]
    ds_read_b64_tr_b16 v[160:161], v10 offset:24576
    buffer_load_dwordx4 v6, s[12:15], s41 offen offset:2048  lds
    v_mfma_f32_16x16x32_bf16 v[132:135], v[176:179], v[212:215], v[132:135]
    ds_read_b64_tr_b16 v[162:163], v10 offset:28672
    v_mfma_f32_16x16x32_bf16 v[136:139], v[176:179], v[216:219], v[136:139]
    s_waitcnt lgkmcnt(6)
    v_mfma_f32_16x16x32_bf16 v[140:143], v[180:183], v[208:211], v[140:143]
    ds_read_b64_tr_b16 v[164:165], v11 offset:24576
    buffer_load_dwordx4 v7, s[12:15], s41 offen offset:3072  lds
    s_add_u32 s41, s41, 589824
    v_mfma_f32_16x16x32_bf16 v[144:147], v[180:183], v[212:215], v[144:147]
    ds_read_b64_tr_b16 v[166:167], v11 offset:28672
    v_mfma_f32_16x16x32_bf16 v[148:151], v[180:183], v[216:219], v[148:151]
    s_waitcnt lgkmcnt(6)
    v_mfma_f32_16x16x32_bf16 v[56:59], v[152:155], v[220:223], v[56:59]
    ds_read_b64_tr_b16 v[168:169], v12 offset:24576
    buffer_load_dwordx4 v[184:187], v2, s[16:19], s40 offen offset:0 sc1
    v_mfma_f32_16x16x32_bf16 v[60:63], v[152:155], v[224:227], v[60:63]
    ds_read_b64_tr_b16 v[170:171], v12 offset:28672
    v_mfma_f32_16x16x32_bf16 v[64:67], v[152:155], v[228:231], v[64:67]
    s_waitcnt lgkmcnt(6)
    v_mfma_f32_16x16x32_bf16 v[68:71], v[156:159], v[220:223], v[68:71]
    ds_read_b64_tr_b16 v[172:173], v13 offset:24576
    buffer_load_dwordx4 v[188:191], v2, s[16:19], s40 offen offset:1024 sc1
    v_mfma_f32_16x16x32_bf16 v[72:75], v[156:159], v[224:227], v[72:75]
    ds_read_b64_tr_b16 v[174:175], v13 offset:28672
    v_mfma_f32_16x16x32_bf16 v[76:79], v[156:159], v[228:231], v[76:79]
    s_waitcnt lgkmcnt(6)
    v_mfma_f32_16x16x32_bf16 v[80:83], v[160:163], v[220:223], v[80:83]
    ds_read_b64_tr_b16 v[176:177], v14 offset:24576
    buffer_load_dwordx4 v[192:195], v2, s[16:19], s40 offen offset:2048 sc1
    s_add_u32 s40, s40, 73728
    v_mfma_f32_16x16x32_bf16 v[84:87], v[160:163], v[224:227], v[84:87]
    ds_read_b64_tr_b16 v[178:179], v14 offset:28672
    v_mfma_f32_16x16x32_bf16 v[88:91], v[160:163], v[228:231], v[88:91]
    s_waitcnt lgkmcnt(6)
    v_mfma_f32_16x16x32_bf16 v[92:95], v[164:167], v[220:223], v[92:95]
    ds_read_b64_tr_b16 v[180:181], v15 offset:24576
    v_mfma_f32_16x16x32_bf16 v[96:99], v[164:167], v[224:227], v[96:99]
    ds_read_b64_tr_b16 v[182:183], v15 offset:28672
    v_mfma_f32_16x16x32_bf16 v[100:103], v[164:167], v[228:231], v[100:103]
    s_waitcnt lgkmcnt(6)
    v_mfma_f32_16x16x32_bf16 v[104:107], v[168:171], v[220:223], v[104:107]
    s_waitcnt vmcnt(14)
    s_barrier
    ds_read_b64_tr_b16 v[152:153], v8 offset:32768
    s_add_u32 m0, s43, 57344
    s_nop 0
    buffer_load_dwordx4 v4, s[12:15], s41 offen offset:0  lds
    v_mfma_f32_16x16x32_bf16 v[108:111], v[168:171], v[224:227], v[108:111]
    ds_read_b64_tr_b16 v[154:155], v8 offset:36864
    v_mfma_f32_16x16x32_bf16 v[112:115], v[168:171], v[228:231], v[112:115]
    s_waitcnt lgkmcnt(6)
    v_mfma_f32_16x16x32_bf16 v[116:119], v[172:175], v[220:223], v[116:119]
    ds_read_b64_tr_b16 v[156:157], v9 offset:32768
    buffer_load_dwordx4 v5, s[12:15], s41 offen offset:1024  lds
    v_mfma_f32_16x16x32_bf16 v[120:123], v[172:175], v[224:227], v[120:123]
    ds_read_b64_tr_b16 v[158:159], v9 offset:36864
    v_mfma_f32_16x16x32_bf16 v[124:127], v[172:175], v[228:231], v[124:127]
    s_waitcnt lgkmcnt(6)
    v_mfma_f32_16x16x32_bf16 v[128:131], v[176:179], v[220:223], v[128:131]
    ds_read_b64_tr_b16 v[160:161], v10 offset:32768
    buffer_load_dwordx4 v6, s[12:15], s41 offen offset:2048  lds
    v_mfma_f32_16x16x32_bf16 v[132:135], v[176:179], v[224:227], v[132:135]
    ds_read_b64_tr_b16 v[162:163], v10 offset:36864
    v_mfma_f32_16x16x32_bf16 v[136:139], v[176:179], v[228:231], v[136:139]
    s_waitcnt lgkmcnt(6)
    v_mfma_f32_16x16x32_bf16 v[140:143], v[180:183], v[220:223], v[140:143]
    ds_read_b64_tr_b16 v[164:165], v11 offset:32768
    buffer_load_dwordx4 v7, s[12:15], s41 offen offset:3072  lds
    s_add_u32 s41, s41, 589824
    v_mfma_f32_16x16x32_bf16 v[144:147], v[180:183], v[224:227], v[144:147]
    ds_read_b64_tr_b16 v[166:167], v11 offset:36864
    v_mfma_f32_16x16x32_bf16 v[148:151], v[180:183], v[228:231], v[148:151]
    s_waitcnt lgkmcnt(6)
    v_mfma_f32_16x16x32_bf16 v[56:59], v[152:155], v[232:235], v[56:59]
    ds_read_b64_tr_b16 v[168:169], v12 offset:32768
    buffer_load_dwordx4 v[196:199], v2, s[16:19], s40 offen offset:0 sc1
    v_mfma_f32_16x16x32_bf16 v[60:63], v[152:155], v[236:239], v[60:63]
    ds_read_b64_tr_b16 v[170:171], v12 offset:36864
    v_mfma_f32_16x16x32_bf16 v[64:67], v[152:155], v[240:243], v[64:67]
    s_waitcnt lgkmcnt(6)
    v_mfma_f32_16x16x32_bf16 v[68:71], v[156:159], v[232:235], v[68:71]
    ds_read_b64_tr_b16 v[172:173], v13 offset:32768
    buffer_load_dwordx4 v[200:203], v2, s[16:19], s40 offen offset:1024 sc1
    v_mfma_f32_16x16x32_bf16 v[72:75], v[156:159], v[236:239], v[72:75]
    ds_read_b64_tr_b16 v[174:175], v13 offset:36864
    v_mfma_f32_16x16x32_bf16 v[76:79], v[156:159], v[240:243], v[76:79]
    s_waitcnt lgkmcnt(6)
    v_mfma_f32_16x16x32_bf16 v[80:83], v[160:163], v[232:235], v[80:83]
    ds_read_b64_tr_b16 v[176:177], v14 offset:32768
    buffer_load_dwordx4 v[204:207], v2, s[16:19], s40 offen offset:2048 sc1
    s_add_u32 s40, s40, 73728
    v_mfma_f32_16x16x32_bf16 v[84:87], v[160:163], v[236:239], v[84:87]
    ds_read_b64_tr_b16 v[178:179], v14 offset:36864
    v_mfma_f32_16x16x32_bf16 v[88:91], v[160:163], v[240:243], v[88:91]
    s_waitcnt lgkmcnt(6)
    v_mfma_f32_16x16x32_bf16 v[92:95], v[164:167], v[232:235], v[92:95]
    ds_read_b64_tr_b16 v[180:181], v15 offset:32768
    v_mfma_f32_16x16x32_bf16 v[96:99], v[164:167], v[236:239], v[96:99]
    ds_read_b64_tr_b16 v[182:183], v15 offset:36864
    v_mfma_f32_16x16x32_bf16 v[100:103], v[164:167], v[240:243], v[100:103]
    s_waitcnt lgkmcnt(6)
    v_mfma_f32_16x16x32_bf16 v[104:107], v[168:171], v[232:235], v[104:107]
    s_waitcnt vmcnt(14)
    s_barrier
    ds_read_b64_tr_b16 v[152:153], v8 offset:40960
    v_mfma_f32_16x16x32_bf16 v[108:111], v[168:171], v[236:239], v[108:111]
    ds_read_b64_tr_b16 v[154:155], v8 offset:45056
    v_mfma_f32_16x16x32_bf16 v[112:115], v[168:171], v[240:243], v[112:115]
    s_waitcnt lgkmcnt(6)
    v_mfma_f32_16x16x32_bf16 v[116:119], v[172:175], v[232:235], v[116:119]
    ds_read_b64_tr_b16 v[156:157], v9 offset:40960
    v_mfma_f32_16x16x32_bf16 v[120:123], v[172:175], v[236:239], v[120:123]
    ds_read_b64_tr_b16 v[158:159], v9 offset:45056
    v_mfma_f32_16x16x32_bf16 v[124:127], v[172:175], v[240:243], v[124:127]
    s_waitcnt lgkmcnt(6)
    v_mfma_f32_16x16x32_bf16 v[128:131], v[176:179], v[232:235], v[128:131]
    ds_read_b64_tr_b16 v[160:161], v10 offset:40960
    v_mfma_f32_16x16x32_bf16 v[132:135], v[176:179], v[236:239], v[132:135]
    ds_read_b64_tr_b16 v[162:163], v10 offset:45056
    v_mfma_f32_16x16x32_bf16 v[136:139], v[176:179], v[240:243], v[136:139]
    s_waitcnt lgkmcnt(6)
    v_mfma_f32_16x16x32_bf16 v[140:143], v[180:183], v[232:235], v[140:143]
    ds_read_b64_tr_b16 v[164:165], v11 offset:40960
    v_mfma_f32_16x16x32_bf16 v[144:147], v[180:183], v[236:239], v[144:147]
    ds_read_b64_tr_b16 v[166:167], v11 offset:45056
    v_mfma_f32_16x16x32_bf16 v[148:151], v[180:183], v[240:243], v[148:151]
    s_waitcnt lgkmcnt(6)
    v_mfma_f32_16x16x32_bf16 v[56:59], v[152:155], v[244:247], v[56:59]
    ds_read_b64_tr_b16 v[168:169], v12 offset:40960
    v_mfma_f32_16x16x32_bf16 v[60:63], v[152:155], v[248:251], v[60:63]
    ds_read_b64_tr_b16 v[170:171], v12 offset:45056
    v_mfma_f32_16x16x32_bf16 v[64:67], v[152:155], v[252:255], v[64:67]
    s_waitcnt lgkmcnt(6)
    v_mfma_f32_16x16x32_bf16 v[68:71], v[156:159], v[244:247], v[68:71]
    ds_read_b64_tr_b16 v[172:173], v13 offset:40960
    v_mfma_f32_16x16x32_bf16 v[72:75], v[156:159], v[248:251], v[72:75]
    ds_read_b64_tr_b16 v[174:175], v13 offset:45056
    v_mfma_f32_16x16x32_bf16 v[76:79], v[156:159], v[252:255], v[76:79]
    s_waitcnt lgkmcnt(6)
    v_mfma_f32_16x16x32_bf16 v[80:83], v[160:163], v[244:247], v[80:83]
    ds_read_b64_tr_b16 v[176:177], v14 offset:40960
    v_mfma_f32_16x16x32_bf16 v[84:87], v[160:163], v[248:251], v[84:87]
    ds_read_b64_tr_b16 v[178:179], v14 offset:45056
    v_mfma_f32_16x16x32_bf16 v[88:91], v[160:163], v[252:255], v[88:91]
    s_waitcnt lgkmcnt(6)
    v_mfma_f32_16x16x32_bf16 v[92:95], v[164:167], v[244:247], v[92:95]
    ds_read_b64_tr_b16 v[180:181], v15 offset:40960
    v_mfma_f32_16x16x32_bf16 v[96:99], v[164:167], v[248:251], v[96:99]
    ds_read_b64_tr_b16 v[182:183], v15 offset:45056
    v_mfma_f32_16x16x32_bf16 v[100:103], v[164:167], v[252:255], v[100:103]
    s_waitcnt lgkmcnt(6)
    v_mfma_f32_16x16x32_bf16 v[104:107], v[168:171], v[244:247], v[104:107]
    s_waitcnt vmcnt(7)
    s_barrier
    ds_read_b64_tr_b16 v[152:153], v8 offset:49152
    v_mfma_f32_16x16x32_bf16 v[108:111], v[168:171], v[248:251], v[108:111]
    ds_read_b64_tr_b16 v[154:155], v8 offset:53248
    v_mfma_f32_16x16x32_bf16 v[112:115], v[168:171], v[252:255], v[112:115]
    s_waitcnt lgkmcnt(6)
    v_mfma_f32_16x16x32_bf16 v[116:119], v[172:175], v[244:247], v[116:119]
    ds_read_b64_tr_b16 v[156:157], v9 offset:49152
    v_mfma_f32_16x16x32_bf16 v[120:123], v[172:175], v[248:251], v[120:123]
    ds_read_b64_tr_b16 v[158:159], v9 offset:53248
    v_mfma_f32_16x16x32_bf16 v[124:127], v[172:175], v[252:255], v[124:127]
    s_waitcnt lgkmcnt(6)
    v_mfma_f32_16x16x32_bf16 v[128:131], v[176:179], v[244:247], v[128:131]
    ds_read_b64_tr_b16 v[160:161], v10 offset:49152
    v_mfma_f32_16x16x32_bf16 v[132:135], v[176:179], v[248:251], v[132:135]
    ds_read_b64_tr_b16 v[162:163], v10 offset:53248
    v_mfma_f32_16x16x32_bf16 v[136:139], v[176:179], v[252:255], v[136:139]
    s_waitcnt lgkmcnt(6)
    v_mfma_f32_16x16x32_bf16 v[140:143], v[180:183], v[244:247], v[140:143]
    ds_read_b64_tr_b16 v[164:165], v11 offset:49152
    v_mfma_f32_16x16x32_bf16 v[144:147], v[180:183], v[248:251], v[144:147]
    ds_read_b64_tr_b16 v[166:167], v11 offset:53248
    v_mfma_f32_16x16x32_bf16 v[148:151], v[180:183], v[252:255], v[148:151]
    s_waitcnt lgkmcnt(6)
    v_mfma_f32_16x16x32_bf16 v[56:59], v[152:155], v[184:187], v[56:59]
    ds_read_b64_tr_b16 v[168:169], v12 offset:49152
    v_mfma_f32_16x16x32_bf16 v[60:63], v[152:155], v[188:191], v[60:63]
    ds_read_b64_tr_b16 v[170:171], v12 offset:53248
    v_mfma_f32_16x16x32_bf16 v[64:67], v[152:155], v[192:195], v[64:67]
    s_waitcnt lgkmcnt(6)
    v_mfma_f32_16x16x32_bf16 v[68:71], v[156:159], v[184:187], v[68:71]
    ds_read_b64_tr_b16 v[172:173], v13 offset:49152
    v_mfma_f32_16x16x32_bf16 v[72:75], v[156:159], v[188:191], v[72:75]
    ds_read_b64_tr_b16 v[174:175], v13 offset:53248
    v_mfma_f32_16x16x32_bf16 v[76:79], v[156:159], v[192:195], v[76:79]
    s_waitcnt lgkmcnt(6)
    v_mfma_f32_16x16x32_bf16 v[80:83], v[160:163], v[184:187], v[80:83]
    ds_read_b64_tr_b16 v[176:177], v14 offset:49152
    v_mfma_f32_16x16x32_bf16 v[84:87], v[160:163], v[188:191], v[84:87]
    ds_read_b64_tr_b16 v[178:179], v14 offset:53248
    v_mfma_f32_16x16x32_bf16 v[88:91], v[160:163], v[192:195], v[88:91]
    s_waitcnt lgkmcnt(6)
    v_mfma_f32_16x16x32_bf16 v[92:95], v[164:167], v[184:187], v[92:95]
    ds_read_b64_tr_b16 v[180:181], v15 offset:49152
    v_mfma_f32_16x16x32_bf16 v[96:99], v[164:167], v[188:191], v[96:99]
    ds_read_b64_tr_b16 v[182:183], v15 offset:53248
    v_mfma_f32_16x16x32_bf16 v[100:103], v[164:167], v[192:195], v[100:103]
    s_waitcnt lgkmcnt(6)
    v_mfma_f32_16x16x32_bf16 v[104:107], v[168:171], v[184:187], v[104:107]
    s_waitcnt vmcnt(0)
    s_barrier
    ds_read_b64_tr_b16 v[152:153], v8 offset:57344
    v_mfma_f32_16x16x32_bf16 v[108:111], v[168:171], v[188:191], v[108:111]
    ds_read_b64_tr_b16 v[154:155], v8 offset:61440
    v_mfma_f32_16x16x32_bf16 v[112:115], v[168:171], v[192:195], v[112:115]
    s_waitcnt lgkmcnt(6)
    v_mfma_f32_16x16x32_bf16 v[116:119], v[172:175], v[184:187], v[116:119]
    ds_read_b64_tr_b16 v[156:157], v9 offset:57344
    v_mfma_f32_16x16x32_bf16 v[120:123], v[172:175], v[188:191], v[120:123]
    ds_read_b64_tr_b16 v[158:159], v9 offset:61440
    v_mfma_f32_16x16x32_bf16 v[124:127], v[172:175], v[192:195], v[124:127]
    s_waitcnt lgkmcnt(6)
    v_mfma_f32_16x16x32_bf16 v[128:131], v[176:179], v[184:187], v[128:131]
    ds_read_b64_tr_b16 v[160:161], v10 offset:57344
    v_mfma_f32_16x16x32_bf16 v[132:135], v[176:179], v[188:191], v[132:135]
    ds_read_b64_tr_b16 v[162:163], v10 offset:61440
    v_mfma_f32_16x16x32_bf16 v[136:139], v[176:179], v[192:195], v[136:139]
    s_waitcnt lgkmcnt(6)
    v_mfma_f32_16x16x32_bf16 v[140:143], v[180:183], v[184:187], v[140:143]
    ds_read_b64_tr_b16 v[164:165], v11 offset:57344
    v_mfma_f32_16x16x32_bf16 v[144:147], v[180:183], v[188:191], v[144:147]
    ds_read_b64_tr_b16 v[166:167], v11 offset:61440
    v_mfma_f32_16x16x32_bf16 v[148:151], v[180:183], v[192:195], v[148:151]
    s_waitcnt lgkmcnt(6)
    v_mfma_f32_16x16x32_bf16 v[56:59], v[152:155], v[196:199], v[56:59]
    ds_read_b64_tr_b16 v[168:169], v12 offset:57344
    s_getpc_b64 s[56:57]
Lk3_pc901:
    s_add_u32 s56, s56, Lk4_entry-Lk3_pc901
    s_addc_u32 s57, s57, 0
    s_lshr_b32 s58, s2, 3
    v_mfma_f32_16x16x32_bf16 v[60:63], v[152:155], v[200:203], v[60:63]
    ds_read_b64_tr_b16 v[170:171], v12 offset:61440
    s_lshl_b32 s58, s58, 2
    s_add_u32 s58, s58, s3
    v_mfma_f32_16x16x32_bf16 v[64:67], v[152:155], v[204:207], v[64:67]
    s_movk_i32 s59, 108
    v_mov_b32 v44, s58
    s_waitcnt lgkmcnt(6)
    v_mfma_f32_16x16x32_bf16 v[68:71], v[156:159], v[196:199], v[68:71]
    ds_read_b64_tr_b16 v[172:173], v13 offset:57344
    v_mad_u32_u24 v44, v1, s59, v44
    v_mfma_f32_16x16x32_bf16 v[72:75], v[156:159], v[200:203], v[72:75]
    ds_read_b64_tr_b16 v[174:175], v13 offset:61440
    v_lshlrev_b32 v44, 7, v44
    v_mfma_f32_16x16x32_bf16 v[76:79], v[156:159], v[204:207], v[76:79]
    v_cmp_gt_u32 vcc, Lcode_end-Lk4_entry, v44
    s_waitcnt lgkmcnt(6)
    v_mfma_f32_16x16x32_bf16 v[80:83], v[160:163], v[196:199], v[80:83]
    ds_read_b64_tr_b16 v[176:177], v14 offset:57344
    v_mov_b32 v45, 0
    v_mfma_f32_16x16x32_bf16 v[84:87], v[160:163], v[200:203], v[84:87]
    ds_read_b64_tr_b16 v[178:179], v14 offset:61440
    v_mov_b32 v42, s56
    v_mfma_f32_16x16x32_bf16 v[88:91], v[160:163], v[204:207], v[88:91]
    v_mov_b32 v43, s57
    s_waitcnt lgkmcnt(6)
    v_mfma_f32_16x16x32_bf16 v[92:95], v[164:167], v[196:199], v[92:95]
    ds_read_b64_tr_b16 v[180:181], v15 offset:57344
    v_lshl_add_u64 v[42:43], v[44:45], 0, v[42:43]
    v_mfma_f32_16x16x32_bf16 v[96:99], v[164:167], v[200:203], v[96:99]
    ds_read_b64_tr_b16 v[182:183], v15 offset:61440
    s_and_saveexec_b64 s[58:59], vcc
    global_load_dword v46, v[42:43], off
    s_mov_b64 exec, s[58:59]
    v_mfma_f32_16x16x32_bf16 v[100:103], v[164:167], v[204:207], v[100:103]
    s_waitcnt lgkmcnt(6)
    v_mfma_f32_16x16x32_bf16 v[104:107], v[168:171], v[196:199], v[104:107]
    ds_write_b128 v38, v[56:59] offset:0
    v_mfma_f32_16x16x32_bf16 v[108:111], v[168:171], v[200:203], v[108:111]
    ds_write_b128 v38, v[60:63] offset:1024
    v_mfma_f32_16x16x32_bf16 v[112:115], v[168:171], v[204:207], v[112:115]
    ds_write_b128 v38, v[64:67] offset:2048
    s_waitcnt lgkmcnt(7)
    v_mfma_f32_16x16x32_bf16 v[116:119], v[172:175], v[196:199], v[116:119]
    ds_write_b128 v38, v[68:71] offset:3072
    v_mfma_f32_16x16x32_bf16 v[120:123], v[172:175], v[200:203], v[120:123]
    ds_write_b128 v38, v[72:75] offset:4096
    v_mfma_f32_16x16x32_bf16 v[124:127], v[172:175], v[204:207], v[124:127]
    ds_write_b128 v38, v[76:79] offset:5120
    s_waitcnt lgkmcnt(8)
    v_mfma_f32_16x16x32_bf16 v[128:131], v[176:179], v[196:199], v[128:131]
    ds_write_b128 v38, v[80:83] offset:6144
    v_mfma_f32_16x16x32_bf16 v[132:135], v[176:179], v[200:203], v[132:135]
    ds_write_b128 v38, v[84:87] offset:7168
    v_mfma_f32_16x16x32_bf16 v[136:139], v[176:179], v[204:207], v[136:139]
    ds_write_b128 v38, v[88:91] offset:8192
    s_waitcnt lgkmcnt(9)
    v_mfma_f32_16x16x32_bf16 v[140:143], v[180:183], v[196:199], v[140:143]
    ds_write_b128 v38, v[92:95] offset:9216
    v_mfma_f32_16x16x32_bf16 v[144:147], v[180:183], v[200:203], v[144:147]
    ds_write_b128 v38, v[96:99] offset:10240
    v_mfma_f32_16x16x32_bf16 v[148:151], v[180:183], v[204:207], v[148:151]
    ds_write_b128 v38, v[100:103] offset:11264
    s_waitcnt lgkmcnt(0)
    s_barrier
    ds_read_b128 v[56:59], v39 offset:0
    ds_read_b128 v[60:63], v39 offset:1024
    ds_read_b128 v[64:67], v39 offset:2048
    ds_read_b128 v[68:71], v39 offset:3072
    ds_read_b128 v[72:75], v39 offset:4096
    ds_read_b128 v[76:79], v39 offset:5120
    ds_read_b128 v[80:83], v39 offset:6144
    ds_read_b128 v[84:87], v39 offset:7168
    ds_read_b128 v[88:91], v39 offset:8192
    ds_read_b128 v[92:95], v39 offset:9216
    ds_read_b128 v[96:99], v39 offset:10240
    ds_read_b128 v[100:103], v39 offset:11264
    s_mov_b32 s50, 3222493025
    s_mov_b32 s51, 3222493025
    s_mov_b32 s52, 3184710632
    s_mov_b32 s53, 3184710632
    s_mov_b32 s54, 1.0
    s_mov_b32 s55, 1.0
    v_mov_b32 v40, s50
    v_mov_b32 v41, s50
    s_waitcnt lgkmcnt(8)
    v_pk_add_f32 v[104:105], v[104:105], v[56:57]
    v_pk_add_f32 v[106:107], v[106:107], v[58:59]
    v_pk_add_f32 v[116:117], v[116:117], v[68:69]
    v_pk_add_f32 v[118:119], v[118:119], v[70:71]
    v_pk_mul_f32 v[56:57], v[104:105], v[104:105]
    v_pk_mul_f32 v[58:59], v[106:107], v[106:107]
    v_pk_mul_f32 v[68:69], v[116:117], v[116:117]
    v_pk_mul_f32 v[70:71], v[118:119], v[118:119]
    v_pk_fma_f32 v[56:57], v[56:57], s[52:53], v[40:41]
    v_pk_fma_f32 v[58:59], v[58:59], s[52:53], v[40:41]
    v_pk_fma_f32 v[68:69], v[68:69], s[52:53], v[40:41]
    v_pk_fma_f32 v[70:71], v[70:71], s[52:53], v[40:41]
    v_pk_mul_f32 v[56:57], v[56:57], v[104:105]
    v_pk_mul_f32 v[58:59], v[58:59], v[106:107]
    v_pk_mul_f32 v[68:69], v[68:69], v[116:117]
    v_pk_mul_f32 v[70:71], v[70:71], v[118:119]
    v_exp_f32 v56, v56
    v_exp_f32 v57, v57
    v_exp_f32 v58, v58
    v_exp_f32 v59, v59
    v_exp_f32 v68, v68
    v_exp_f32 v69, v69
    v_exp_f32 v70, v70
    v_exp_f32 v71, v71
    v_pk_add_f32 v[56:57], v[56:57], s[54:55]
    v_pk_add_f32 v[58:59], v[58:59], s[54:55]
    v_pk_add_f32 v[68:69], v[68:69], s[54:55]
    v_pk_add_f32 v[70:71], v[70:71], s[54:55]
    v_rcp_f32 v56, v56
    v_rcp_f32 v57, v57
    v_rcp_f32 v58, v58
    v_rcp_f32 v59, v59
    v_rcp_f32 v68, v68
    v_rcp_f32 v69, v69
    v_rcp_f32 v70, v70
    v_rcp_f32 v71, v71
    v_pk_mul_f32 v[104:105], v[104:105], v[56:57]
    v_pk_mul_f32 v[106:107], v[106:107], v[58:59]
    v_pk_mul_f32 v[116:117], v[116:117], v[68:69]
    v_pk_mul_f32 v[118:119], v[118:119], v[70:71]
    v_cvt_pk_bf16_f32 v56, v104, v105
    v_cvt_pk_bf16_f32 v57, v106, v107
    v_cvt_pk_bf16_f32 v58, v116, v117
    v_cvt_pk_bf16_f32 v59, v118, v119
    buffer_store_dwordx4 v[56:59], v2, s[24:27], s48 offen offset:0 sc1
    s_waitcnt lgkmcnt(7)
    v_pk_add_f32 v[108:109], v[108:109], v[60:61]
    v_pk_add_f32 v[110:111], v[110:111], v[62:63]
    v_pk_add_f32 v[120:121], v[120:121], v[72:73]
    v_pk_add_f32 v[122:123], v[122:123], v[74:75]
    v_pk_mul_f32 v[60:61], v[108:109], v[108:109]
    v_pk_mul_f32 v[62:63], v[110:111], v[110:111]
    v_pk_mul_f32 v[72:73], v[120:121], v[120:121]
    v_pk_mul_f32 v[74:75], v[122:123], v[122:123]
    v_pk_fma_f32 v[60:61], v[60:61], s[52:53], v[40:41]
    v_pk_fma_f32 v[62:63], v[62:63], s[52:53], v[40:41]
    v_pk_fma_f32 v[72:73], v[72:73], s[52:53], v[40:41]
    v_pk_fma_f32 v[74:75], v[74:75], s[52:53], v[40:41]
    v_pk_mul_f32 v[60:61], v[60:61], v[108:109]
    v_pk_mul_f32 v[62:63], v[62:63], v[110:111]
    v_pk_mul_f32 v[72:73], v[72:73], v[120:121]
    v_pk_mul_f32 v[74:75], v[74:75], v[122:123]
    v_exp_f32 v60, v60
    v_exp_f32 v61, v61
    v_exp_f32 v62, v62
    v_exp_f32 v63, v63
    v_exp_f32 v72, v72
    v_exp_f32 v73, v73
    v_exp_f32 v74, v74
    v_exp_f32 v75, v75
    v_pk_add_f32 v[60:61], v[60:61], s[54:55]
    v_pk_add_f32 v[62:63], v[62:63], s[54:55]
    v_pk_add_f32 v[72:73], v[72:73], s[54:55]
    v_pk_add_f32 v[74:75], v[74:75], s[54:55]
    v_rcp_f32 v60, v60
    v_rcp_f32 v61, v61
    v_rcp_f32 v62, v62
    v_rcp_f32 v63, v63
    v_rcp_f32 v72, v72
    v_rcp_f32 v73, v73
    v_rcp_f32 v74, v74
    v_rcp_f32 v75, v75
    v_pk_mul_f32 v[108:109], v[108:109], v[60:61]
    v_pk_mul_f32 v[110:111], v[110:111], v[62:63]
    v_pk_mul_f32 v[120:121], v[120:121], v[72:73]
    v_pk_mul_f32 v[122:123], v[122:123], v[74:75]
    v_cvt_pk_bf16_f32 v60, v108, v109
    v_cvt_pk_bf16_f32 v61, v110, v111
    v_cvt_pk_bf16_f32 v62, v120, v121
    v_cvt_pk_bf16_f32 v63, v122, v123
    buffer_store_dwordx4 v[60:63], v2, s[24:27], s48 offen offset:1024 sc1
    s_waitcnt lgkmcnt(6)
    v_pk_add_f32 v[112:113], v[112:113], v[64:65]
    v_pk_add_f32 v[114:115], v[114:115], v[66:67]
    v_pk_add_f32 v[124:125], v[124:125], v[76:77]
    v_pk_add_f32 v[126:127], v[126:127], v[78:79]
    v_pk_mul_f32 v[64:65], v[112:113], v[112:113]
    v_pk_mul_f32 v[66:67], v[114:115], v[114:115]
    v_pk_mul_f32 v[76:77], v[124:125], v[124:125]
    v_pk_mul_f32 v[78:79], v[126:127], v[126:127]
    v_pk_fma_f32 v[64:65], v[64:65], s[52:53], v[40:41]
    v_pk_fma_f32 v[66:67], v[66:67], s[52:53], v[40:41]
    v_pk_fma_f32 v[76:77], v[76:77], s[52:53], v[40:41]
    v_pk_fma_f32 v[78:79], v[78:79], s[52:53], v[40:41]
    v_pk_mul_f32 v[64:65], v[64:65], v[112:113]
    v_pk_mul_f32 v[66:67], v[66:67], v[114:115]
    v_pk_mul_f32 v[76:77], v[76:77], v[124:125]
    v_pk_mul_f32 v[78:79], v[78:79], v[126:127]
    v_exp_f32 v64, v64
    v_exp_f32 v65, v65
    v_exp_f32 v66, v66
    v_exp_f32 v67, v67
    v_exp_f32 v76, v76
    v_exp_f32 v77, v77
    v_exp_f32 v78, v78
    v_exp_f32 v79, v79
    v_pk_add_f32 v[64:65], v[64:65], s[54:55]
    v_pk_add_f32 v[66:67], v[66:67], s[54:55]
    v_pk_add_f32 v[76:77], v[76:77], s[54:55]
    v_pk_add_f32 v[78:79], v[78:79], s[54:55]
    v_rcp_f32 v64, v64
    v_rcp_f32 v65, v65
    v_rcp_f32 v66, v66
    v_rcp_f32 v67, v67
    v_rcp_f32 v76, v76
    v_rcp_f32 v77, v77
    v_rcp_f32 v78, v78
    v_rcp_f32 v79, v79
    v_pk_mul_f32 v[112:113], v[112:113], v[64:65]
    v_pk_mul_f32 v[114:115], v[114:115], v[66:67]
    v_pk_mul_f32 v[124:125], v[124:125], v[76:77]
    v_pk_mul_f32 v[126:127], v[126:127], v[78:79]
    v_cvt_pk_bf16_f32 v64, v112, v113
    v_cvt_pk_bf16_f32 v65, v114, v115
    v_cvt_pk_bf16_f32 v66, v124, v125
    v_cvt_pk_bf16_f32 v67, v126, v127
    buffer_store_dwordx4 v[64:67], v2, s[24:27], s48 offen offset:2048 sc1
    s_waitcnt lgkmcnt(2)
    v_pk_add_f32 v[128:129], v[128:129], v[80:81]
    v_pk_add_f32 v[130:131], v[130:131], v[82:83]
    v_pk_add_f32 v[140:141], v[140:141], v[92:93]
    v_pk_add_f32 v[142:143], v[142:143], v[94:95]
    v_pk_mul_f32 v[80:81], v[128:129], v[128:129]
    v_pk_mul_f32 v[82:83], v[130:131], v[130:131]
    v_pk_mul_f32 v[92:93], v[140:141], v[140:141]
    v_pk_mul_f32 v[94:95], v[142:143], v[142:143]
    v_pk_fma_f32 v[80:81], v[80:81], s[52:53], v[40:41]
    v_pk_fma_f32 v[82:83], v[82:83], s[52:53], v[40:41]
    v_pk_fma_f32 v[92:93], v[92:93], s[52:53], v[40:41]
    v_pk_fma_f32 v[94:95], v[94:95], s[52:53], v[40:41]
    v_pk_mul_f32 v[80:81], v[80:81], v[128:129]
    v_pk_mul_f32 v[82:83], v[82:83], v[130:131]
    v_pk_mul_f32 v[92:93], v[92:93], v[140:141]
    v_pk_mul_f32 v[94:95], v[94:95], v[142:143]
    v_exp_f32 v80, v80
    v_exp_f32 v81, v81
    v_exp_f32 v82, v82
    v_exp_f32 v83, v83
    v_exp_f32 v92, v92
    v_exp_f32 v93, v93
    v_exp_f32 v94, v94
    v_exp_f32 v95, v95
    v_pk_add_f32 v[80:81], v[80:81], s[54:55]
    v_pk_add_f32 v[82:83], v[82:83], s[54:55]
    v_pk_add_f32 v[92:93], v[92:93], s[54:55]
    v_pk_add_f32 v[94:95], v[94:95], s[54:55]
    v_rcp_f32 v80, v80
    v_rcp_f32 v81, v81
    v_rcp_f32 v82, v82
    v_rcp_f32 v83, v83
    v_rcp_f32 v92, v92
    v_rcp_f32 v93, v93
    v_rcp_f32 v94, v94
    v_rcp_f32 v95, v95
    v_pk_mul_f32 v[128:129], v[128:129], v[80:81]
    v_pk_mul_f32 v[130:131], v[130:131], v[82:83]
    v_pk_mul_f32 v[140:141], v[140:141], v[92:93]
    v_pk_mul_f32 v[142:143], v[142:143], v[94:95]
    v_cvt_pk_bf16_f32 v80, v128, v129
    v_cvt_pk_bf16_f32 v81, v130, v131
    v_cvt_pk_bf16_f32 v82, v140, v141
    v_cvt_pk_bf16_f32 v83, v142, v143
    buffer_store_dwordx4 v[80:83], v2, s[24:27], s49 offen offset:0 sc1
    s_waitcnt lgkmcnt(1)
    v_pk_add_f32 v[132:133], v[132:133], v[84:85]
    v_pk_add_f32 v[134:135], v[134:135], v[86:87]
    v_pk_add_f32 v[144:145], v[144:145], v[96:97]
    v_pk_add_f32 v[146:147], v[146:147], v[98:99]
    v_pk_mul_f32 v[84:85], v[132:133], v[132:133]
    v_pk_mul_f32 v[86:87], v[134:135], v[134:135]
    v_pk_mul_f32 v[96:97], v[144:145], v[144:145]
    v_pk_mul_f32 v[98:99], v[146:147], v[146:147]
    v_pk_fma_f32 v[84:85], v[84:85], s[52:53], v[40:41]
    v_pk_fma_f32 v[86:87], v[86:87], s[52:53], v[40:41]
    v_pk_fma_f32 v[96:97], v[96:97], s[52:53], v[40:41]
    v_pk_fma_f32 v[98:99], v[98:99], s[52:53], v[40:41]
    v_pk_mul_f32 v[84:85], v[84:85], v[132:133]
    v_pk_mul_f32 v[86:87], v[86:87], v[134:135]
    v_pk_mul_f32 v[96:97], v[96:97], v[144:145]
    v_pk_mul_f32 v[98:99], v[98:99], v[146:147]
    v_exp_f32 v84, v84
    v_exp_f32 v85, v85
    v_exp_f32 v86, v86
    v_exp_f32 v87, v87
    v_exp_f32 v96, v96
    v_exp_f32 v97, v97
    v_exp_f32 v98, v98
    v_exp_f32 v99, v99
    v_pk_add_f32 v[84:85], v[84:85], s[54:55]
    v_pk_add_f32 v[86:87], v[86:87], s[54:55]
    v_pk_add_f32 v[96:97], v[96:97], s[54:55]
    v_pk_add_f32 v[98:99], v[98:99], s[54:55]
    v_rcp_f32 v84, v84
    v_rcp_f32 v85, v85
    v_rcp_f32 v86, v86
    v_rcp_f32 v87, v87
    v_rcp_f32 v96, v96
    v_rcp_f32 v97, v97
    v_rcp_f32 v98, v98
    v_rcp_f32 v99, v99
    v_pk_mul_f32 v[132:133], v[132:133], v[84:85]
    v_pk_mul_f32 v[134:135], v[134:135], v[86:87]
    v_pk_mul_f32 v[144:145], v[144:145], v[96:97]
    v_pk_mul_f32 v[146:147], v[146:147], v[98:99]
    v_cvt_pk_bf16_f32 v84, v132, v133
    v_cvt_pk_bf16_f32 v85, v134, v135
    v_cvt_pk_bf16_f32 v86, v144, v145
    v_cvt_pk_bf16_f32 v87, v146, v147
    buffer_store_dwordx4 v[84:87], v2, s[24:27], s49 offen offset:1024 sc1
    s_waitcnt lgkmcnt(0)
    v_pk_add_f32 v[136:137], v[136:137], v[88:89]
    v_pk_add_f32 v[138:139], v[138:139], v[90:91]
    v_pk_add_f32 v[148:149], v[148:149], v[100:101]
    v_pk_add_f32 v[150:151], v[150:151], v[102:103]
    v_pk_mul_f32 v[88:89], v[136:137], v[136:137]
    v_pk_mul_f32 v[90:91], v[138:139], v[138:139]
    v_pk_mul_f32 v[100:101], v[148:149], v[148:149]
    v_pk_mul_f32 v[102:103], v[150:151], v[150:151]
    v_pk_fma_f32 v[88:89], v[88:89], s[52:53], v[40:41]
    v_pk_fma_f32 v[90:91], v[90:91], s[52:53], v[40:41]
    v_pk_fma_f32 v[100:101], v[100:101], s[52:53], v[40:41]
    v_pk_fma_f32 v[102:103], v[102:103], s[52:53], v[40:41]
    v_pk_mul_f32 v[88:89], v[88:89], v[136:137]
    v_pk_mul_f32 v[90:91], v[90:91], v[138:139]
    v_pk_mul_f32 v[100:101], v[100:101], v[148:149]
    v_pk_mul_f32 v[102:103], v[102:103], v[150:151]
    v_exp_f32 v88, v88
    v_exp_f32 v89, v89
    v_exp_f32 v90, v90
    v_exp_f32 v91, v91
    v_exp_f32 v100, v100
    v_exp_f32 v101, v101
    v_exp_f32 v102, v102
    v_exp_f32 v103, v103
    v_pk_add_f32 v[88:89], v[88:89], s[54:55]
    v_pk_add_f32 v[90:91], v[90:91], s[54:55]
    v_pk_add_f32 v[100:101], v[100:101], s[54:55]
    v_pk_add_f32 v[102:103], v[102:103], s[54:55]
    v_rcp_f32 v88, v88
    v_rcp_f32 v89, v89
    v_rcp_f32 v90, v90
    v_rcp_f32 v91, v91
    v_rcp_f32 v100, v100
    v_rcp_f32 v101, v101
    v_rcp_f32 v102, v102
    v_rcp_f32 v103, v103
    v_pk_mul_f32 v[136:137], v[136:137], v[88:89]
    v_pk_mul_f32 v[138:139], v[138:139], v[90:91]
    v_pk_mul_f32 v[148:149], v[148:149], v[100:101]
    v_pk_mul_f32 v[150:151], v[150:151], v[102:103]
    v_cvt_pk_bf16_f32 v88, v136, v137
    v_cvt_pk_bf16_f32 v89, v138, v139
    v_cvt_pk_bf16_f32 v90, v148, v149
    v_cvt_pk_bf16_f32 v91, v150, v151
    buffer_store_dwordx4 v[88:91], v2, s[24:27], s49 offen offset:2048 sc1
    s_mul_i32 s56, s33, 128
    s_add_u32 s56, s56, 7585792
    s_cmp_eq_u32 s3, 0
    s_cselect_b32 s57, 0, 0x40000000
    v_or_b32 v250, s57, v2
    v_mov_b32 v252, 0
    v_mov_b32 v253, 0
    v_mov_b32 v254, 0
    v_mov_b32 v255, 0
    s_mov_b64 exec, 1
    s_waitcnt vmcnt(0)
    s_barrier
    buffer_store_dword v252, v250, s[24:27], s56 offen sc1
    s_mov_b64 exec, -1
    s_branch Lk4_entry
Lk1_hr68:
    s_add_u32 s63, s62, 0
    s_add_u32 s51, s51, 1
    buffer_load_dwordx4 v[184:187], v2, s[16:19], s63 offen offset:0 sc1
    buffer_load_dwordx4 v[188:191], v2, s[16:19], s63 offen offset:1024 sc1
    buffer_load_dwordx4 v[192:195], v2, s[16:19], s63 offen offset:2048 sc1
    s_waitcnt vmcnt(0)
    v_max3_u32 v40, v184, v185, v186
    v_max3_u32 v41, v187, v188, v189
    v_max3_u32 v45, v190, v191, v192
    v_max3_u32 v47, v193, v194, v195
    v_max3_u32 v40, v40, v41, v45
    v_max_u32 v40, v40, v47
    v_cmp_eq_u32 vcc, -1, v40
    s_cmp_ge_u32 s51, 0x40000
    s_cbranch_scc1 Lk1_hk69
    s_cbranch_vccnz Lk1_hr68
    s_branch Lk1_hk69
Lk1_hr70:
    s_add_u32 s63, s62, 73728
    s_add_u32 s51, s51, 1
    buffer_load_dwordx4 v[196:199], v2, s[16:19], s63 offen offset:0 sc1
    buffer_load_dwordx4 v[200:203], v2, s[16:19], s63 offen offset:1024 sc1
    buffer_load_dwordx4 v[204:207], v2, s[16:19], s63 offen offset:2048 sc1
    s_waitcnt vmcnt(0)
    v_max3_u32 v40, v196, v197, v198
    v_max3_u32 v41, v199, v200, v201
    v_max3_u32 v45, v202, v203, v204
    v_max3_u32 v47, v205, v206, v207
    v_max3_u32 v40, v40, v41, v45
    v_max_u32 v40, v40, v47
    v_cmp_eq_u32 vcc, -1, v40
    s_cmp_ge_u32 s51, 0x40000
    s_cbranch_scc1 Lk1_hk71
    s_cbranch_vccnz Lk1_hr70
    s_branch Lk1_hk71
Lk1_hr73:
    s_add_u32 s63, s62, 147456
    s_add_u32 s51, s51, 1
    buffer_load_dwordx4 v[208:211], v2, s[16:19], s63 offen offset:0 sc1
    buffer_load_dwordx4 v[212:215], v2, s[16:19], s63 offen offset:1024 sc1
    buffer_load_dwordx4 v[216:219], v2, s[16:19], s63 offen offset:2048 sc1
    s_waitcnt vmcnt(0)
    v_max3_u32 v40, v208, v209, v210
    v_max3_u32 v41, v211, v212, v213
    v_max3_u32 v45, v214, v215, v216
    v_max3_u32 v47, v217, v218, v219
    v_max3_u32 v40, v40, v41, v45
    v_max_u32 v40, v40, v47
    v_cmp_eq_u32 vcc, -1, v40
    s_cmp_ge_u32 s51, 0x40000
    s_cbranch_scc1 Lk1_hk74
    s_cbranch_vccnz Lk1_hr73
    s_branch Lk1_hk74
Lk1_hr75:
    s_add_u32 s63, s62, 221184
    s_add_u32 s51, s51, 1
    buffer_load_dwordx4 v[220:223], v2, s[16:19], s63 offen offset:0 sc1
    buffer_load_dwordx4 v[224:227], v2, s[16:19], s63 offen offset:1024 sc1
    buffer_load_dwordx4 v[228:231], v2, s[16:19], s63 offen offset:2048 sc1
    s_waitcnt vmcnt(0)
    v_max3_u32 v40, v220, v221, v222
    v_max3_u32 v41, v223, v224, v225
    v_max3_u32 v45, v226, v227, v228
    v_max3_u32 v47, v229, v230, v231
    v_max3_u32 v40, v40, v41, v45
    v_max_u32 v40, v40, v47
    v_cmp_eq_u32 vcc, -1, v40
    s_cmp_ge_u32 s51, 0x40000
    s_cbranch_scc1 Lk1_hk76
    s_cbranch_vccnz Lk1_hr75
    s_branch Lk1_hk76
Lk1_hr77:
    s_add_u32 s63, s62, 294912
    s_add_u32 s51, s51, 1
    buffer_load_dwordx4 v[232:235], v2, s[16:19], s63 offen offset:0 sc1
    buffer_load_dwordx4 v[236:239], v2, s[16:19], s63 offen offset:1024 sc1
    buffer_load_dwordx4 v[240:243], v2, s[16:19], s63 offen offset:2048 sc1
    s_waitcnt vmcnt(0)
    v_max3_u32 v40, v232, v233, v234
    v_max3_u32 v41, v235, v236, v237
    v_max3_u32 v45, v238, v239, v240
    v_max3_u32 v47, v241, v242, v243
    v_max3_u32 v40, v40, v41, v45
    v_max_u32 v40, v40, v47
    v_cmp_eq_u32 vcc, -1, v40
    s_cmp_ge_u32 s51, 0x40000
    s_cbranch_scc1 Lk1_hk78
    s_cbranch_vccnz Lk1_hr77
    s_branch Lk1_hk78
Lk1_hr81:
    s_add_u32 s63, s62, 368640
    s_add_u32 s51, s51, 1
    buffer_load_dwordx4 v[244:247], v2, s[16:19], s63 offen offset:0 sc1
    buffer_load_dwordx4 v[248:251], v2, s[16:19], s63 offen offset:1024 sc1
    buffer_load_dwordx4 v[252:255], v2, s[16:19], s63 offen offset:2048 sc1
    s_waitcnt vmcnt(0)
    v_max3_u32 v40, v244, v245, v246
    v_max3_u32 v41, v247, v248, v249
    v_max3_u32 v45, v250, v251, v252
    v_max3_u32 v47, v253, v254, v255
    v_max3_u32 v40, v40, v41, v45
    v_max_u32 v40, v40, v47
    v_cmp_eq_u32 vcc, -1, v40
    s_cmp_ge_u32 s51, 0x40000
    s_cbranch_scc1 Lk1_hk82
    s_cbranch_vccnz Lk1_hr81
    s_branch Lk1_hk82
Lk1_hr83:
    s_add_u32 s63, s62, 442368
    s_add_u32 s51, s51, 1
    buffer_load_dwordx4 v[184:187], v2, s[16:19], s63 offen offset:0 sc1
    buffer_load_dwordx4 v[188:191], v2, s[16:19], s63 offen offset:1024 sc1
    buffer_load_dwordx4 v[192:195], v2, s[16:19], s63 offen offset:2048 sc1
    s_waitcnt vmcnt(0)
    v_max3_u32 v40, v184, v185, v186
    v_max3_u32 v41, v187, v188, v189
    v_max3_u32 v45, v190, v191, v192
    v_max3_u32 v47, v193, v194, v195
    v_max3_u32 v40, v40, v41, v45
    v_max_u32 v40, v40, v47
    v_cmp_eq_u32 vcc, -1, v40
    s_cmp_ge_u32 s51, 0x40000
    s_cbranch_scc1 Lk1_hk84
    s_cbranch_vccnz Lk1_hr83
    s_branch Lk1_hk84
Lk1_hr85:
    s_add_u32 s63, s62, 516096
    s_add_u32 s51, s51, 1
    buffer_load_dwordx4 v[196:199], v2, s[16:19], s63 offen offset:0 sc1
    buffer_load_dwordx4 v[200:203], v2, s[16:19], s63 offen offset:1024 sc1
    buffer_load_dwordx4 v[204:207], v2, s[16:19], s63 offen offset:2048 sc1
    s_waitcnt vmcnt(0)
    v_max3_u32 v40, v196, v197, v198
    v_max3_u32 v41, v199, v200, v201
    v_max3_u32 v45, v202, v203, v204
    v_max3_u32 v47, v205, v206, v207
    v_max3_u32 v40, v40, v41, v45
    v_max_u32 v40, v40, v47
    v_cmp_eq_u32 vcc, -1, v40
    s_cmp_ge_u32 s51, 0x40000
    s_cbranch_scc1 Lk1_hk86
    s_cbranch_vccnz Lk1_hr85
    s_branch Lk1_hk86
Lk1_hw61:
    s_waitcnt lgkmcnt(0)
    s_branch Lk4_entry
Lk1_end62:
    s_endpgm
Lk1_help63:
    s_cmp_ge_u32 s2, 256
    s_cbranch_scc1 Lk1_end62
    s_load_dwordx2 s[4:5], s[0:1], 48
    s_load_dwordx2 s[6:7], s[0:1], 32
    s_load_dwordx2 s[10:11], s[0:1], 80
    v_lshrrev_b32 v2, 6, v0
    v_and_b32 v1, 63, v0
    s_and_b32 s33, s2, 7
    v_readfirstlane_b32 s3, v2
    s_sub_u32 s34, s2, 216
    s_lshr_b32 s34, s34, 3
    s_mul_i32 s34, s34, 4
    s_add_u32 s34, s34, s3
    s_cmp_ge_u32 s3, 4
    s_cbranch_scc1 Lk1_hw61
    s_mov_b32 s38, s34
    s_mov_b32 s39, s33
    s_add_u32 s34, s34, 236
    v_lshrrev_b32 v2, 4, v1
    v_and_b32 v3, 15, v1
    v_lshlrev_b32 v3, 7, v3
    v_lshl_add_u32 v3, v2, 12, v3
    s_lshr_b32 s35, s33, 1
    s_mul_i32 s35, s35, 4718592
    s_and_b32 s33, s33, 1
    s_lshl_b32 s33, s33, 11
    s_add_u32 s33, s33, s35
    s_lshl_b32 s37, s38, 18
    s_add_u32 s37, s37, s33
    s_lshl_b32 s35, s34, 14
    s_add_u32 s33, s33, s35
    s_waitcnt lgkmcnt(0)
    s_mov_b32 s12, s4
    s_mov_b32 s13, s5
    s_mov_b32 s14, 18874368
    s_mov_b32 s15, 0x20000
    s_mov_b32 s16, s6
    s_mov_b32 s17, s7
    s_mov_b32 s18, 18874368
    s_mov_b32 s19, 0x20000
    s_mov_b32 s98, 429496730
    s_movk_i32 s99, 7936
    s_and_b32 s97, s39, 1
    s_mul_i32 s42, s39, 9
    s_sub_u32 s42, s42, s97
    s_lshl_b32 s42, s42, 7
    s_add_u32 s40, s38, 120
    s_lshl_b32 s40, s40, 6
    s_add_u32 s24, s10, 7094272
    s_addc_u32 s25, s11, 0
    s_mov_b32 s26, 7127040
    s_mov_b32 s27, 0x20000
    s_sub_u32 s53, s2, 216
    s_lshl_b32 s50, s53, 2
    s_add_u32 s50, s50, s3
    v_mov_b32 v12, -1
    v_mov_b32 v13, -1
    v_mov_b32 v14, -1
    v_mov_b32 v15, -1
    v_lshlrev_b32 v16, 4, v1
    v_mov_b32 v17, 0
    s_mul_i32 s51, s50, 3641
    s_lshr_b32 s51, s51, 20
    s_mul_i32 s51, s51, 1032320
    s_lshl_b32 s55, s50, 10
    s_add_u32 s51, s51, s55
    s_cmp_lt_u32 s50, 1152
    s_cselect_b32 s51, s51, 0x40000000
    s_add_u32 s50, s50, 160
    buffer_store_dwordx4 v[12:15], v16, s[24:27], s51 offen sc1
    s_mul_i32 s51, s50, 3641
    s_lshr_b32 s51, s51, 20
    s_mul_i32 s51, s51, 1032320
    s_lshl_b32 s55, s50, 10
    s_add_u32 s51, s51, s55
    s_cmp_lt_u32 s50, 1152
    s_cselect_b32 s51, s51, 0x40000000
    s_add_u32 s50, s50, 160
    buffer_store_dwordx4 v[12:15], v16, s[24:27], s51 offen sc1
    s_mul_i32 s51, s50, 3641
    s_lshr_b32 s51, s51, 20
    s_mul_i32 s51, s51, 1032320
    s_lshl_b32 s55, s50, 10
    s_add_u32 s51, s51, s55
    s_cmp_lt_u32 s50, 1152
    s_cselect_b32 s51, s51, 0x40000000
    s_add_u32 s50, s50, 160
    buffer_store_dwordx4 v[12:15], v16, s[24:27], s51 offen sc1
    s_mul_i32 s51, s50, 3641
    s_lshr_b32 s51, s51, 20
    s_mul_i32 s51, s51, 1032320
    s_lshl_b32 s55, s50, 10
    s_add_u32 s51, s51, s55
    s_cmp_lt_u32 s50, 1152
    s_cselect_b32 s51, s51, 0x40000000
    s_add_u32 s50, s50, 160
    buffer_store_dwordx4 v[12:15], v16, s[24:27], s51 offen sc1
    s_mul_i32 s51, s50, 3641
    s_lshr_b32 s51, s51, 20
    s_mul_i32 s51, s51, 1032320
    s_lshl_b32 s55, s50, 10
    s_add_u32 s51, s51, s55
    s_cmp_lt_u32 s50, 1152
    s_cselect_b32 s51, s51, 0x40000000
    s_add_u32 s50, s50, 160
    buffer_store_dwordx4 v[12:15], v16, s[24:27], s51 offen sc1
    s_mul_i32 s51, s50, 3641
    s_lshr_b32 s51, s51, 20
    s_mul_i32 s51, s51, 1032320
    s_lshl_b32 s55, s50, 10
    s_add_u32 s51, s51, s55
    s_cmp_lt_u32 s50, 1152
    s_cselect_b32 s51, s51, 0x40000000
    s_add_u32 s50, s50, 160
    buffer_store_dwordx4 v[12:15], v16, s[24:27], s51 offen sc1
    s_mul_i32 s51, s50, 3641
    s_lshr_b32 s51, s51, 20
    s_mul_i32 s51, s51, 1032320
    s_lshl_b32 s55, s50, 10
    s_add_u32 s51, s51, s55
    s_cmp_lt_u32 s50, 1152
    s_cselect_b32 s51, s51, 0x40000000
    s_add_u32 s50, s50, 160
    buffer_store_dwordx4 v[12:15], v16, s[24:27], s51 offen sc1
    s_mul_i32 s51, s50, 3641
    s_lshr_b32 s51, s51, 20
    s_mul_i32 s51, s51, 1032320
    s_lshl_b32 s55, s50, 10
    s_add_u32 s51, s51, s55
    s_cmp_lt_u32 s50, 1152
    s_cselect_b32 s51, s51, 0x40000000
    s_add_u32 s50, s50, 160
    buffer_store_dwordx4 v[12:15], v16, s[24:27], s51 offen sc1
    s_lshl_b32 s53, s53, 7
    s_lshl_b32 s52, s3, 2
    s_add_u32 s52, s52, s53
    s_add_u32 s52, s52, 7118848
    s_mov_b64 exec, 1
    s_waitcnt vmcnt(0)
    buffer_store_dword v17, v17, s[24:27], s52 offen sc1
    s_mov_b64 exec, -1
    s_add_u32 s20, s10, 14155776
    s_addc_u32 s21, s11, 0
    s_mov_b32 s22, 32768
    s_mov_b32 s23, 0x20000
    s_sub_u32 s50, s2, 216
    s_lshl_b32 s50, s50, 2
    s_add_u32 s50, s50, s3
    s_lshl_b32 s50, s50, 7
    s_mov_b32 s51, 0
    v_mov_b32 v12, 0
    s_mov_b64 exec, 1
Lk1_gs89:
    buffer_load_dword v13, v12, s[20:23], s50 offen sc1
    s_add_u32 s51, s51, 1
    s_waitcnt vmcnt(0)
    v_cmp_ne_u32 vcc, 0, v13
    s_cmp_ge_u32 s51, 0x40000
    s_cbranch_scc1 Lk1_gg90
    s_cbranch_vccnz Lk1_gs89
Lk1_gg90:
    s_mov_b64 exec, -1
Lk1_w188:
    v_add_u32 v4, s40, v1
    v_mul_hi_u32 v5, v4, s98
    v_mul_u32_u24 v5, s99, v5
    v_lshl_add_u32 v6, v4, 7, v5
    buffer_load_dword v8, v6, s[16:19], s42 offen
    s_add_u32 s40, s40, 1280
    s_waitcnt vmcnt(1)
    s_cmp_lt_u32 s40, 20480
    s_cbranch_scc1 Lk1_w188
    s_lshr_b32 s40, s40, 6
    s_sub_u32 s40, s40, 320
    s_sub_u32 s40, s40, s38
    s_add_u32 s34, s34, s40
    s_lshl_b32 s40, s40, 14
    s_add_u32 s33, s33, s40
Lk1_pf87:
    buffer_load_dword v8, v3, s[12:15], s33 offen
    s_add_u32 s33, s33, 327680
    s_add_u32 s34, s34, 20
    s_waitcnt vmcnt(1)
    s_cmp_lt_u32 s34, 288
    s_cbranch_scc1 Lk1_pf87
    s_waitcnt vmcnt(0)
    s_barrier
    s_branch Lk4_entry
    .p2align 6
Lk4_entry:
    s_load_dwordx4 s[4:7], s[0:1], 48
    s_load_dwordx2 s[10:11], s[0:1], 80
    s_load_dwordx2 s[8:9], s[0:1], 64
    v_lshrrev_b32 v20, 6, v0
    v_and_b32 v1, 63, v0
    s_bfe_u32 s32, s2, 0x20001
    v_readfirstlane_b32 s3, v20
    s_bfe_u32 s33, s2, 0x20003
    s_and_b32 s34, s2, 1
    s_lshl_b32 s34, s34, 3
    s_lshr_b32 s35, s2, 5
    s_add_u32 s34, s34, s35
    s_lshr_b32 s64, s3, 2
    s_and_b32 s3, s3, 3
    v_lshrrev_b32 v20, 4, v1
    v_and_b32 v21, 15, v1
    v_lshlrev_b32 v22, 1, v20
    v_xor_b32 v22, v22, v21
    v_lshlrev_b32 v23, 12, v20
    v_lshl_add_u32 v3, v22, 4, v23
    v_xor_b32 v4, 0x80, v3
    v_add_u32 v4, 15360, v4
    v_lshlrev_b32 v2, 4, v1
    s_mul_i32 s36, s32, 144
    s_add_u32 s36, s36, s3
    s_lshl_b32 s36, s36, 15
    s_lshl_b32 s37, s34, 8
    s_add_u32 s36, s36, s37
    s_mul_i32 s37, s32, 1296
    s_mul_i32 s38, s33, 9
    s_add_u32 s37, s37, s38
    s_mul_i32 s39, s3, 36
    s_add_u32 s39, s39, s37
    s_add_u32 s39, s39, 10
    s_lshl_b32 s39, s39, 10
    s_add_u32 s38, s3, s32
    s_and_b32 s38, s38, 3
    s_lshl_b32 s38, s38, 1
    s_add_u32 s37, s37, s38
    s_lshl_b32 s37, s37, 10
    s_mul_i32 s38, s32, 128
    s_add_u32 s37, s37, s38
    s_add_u32 s39, s39, s38
    s_lshl_b32 s40, s3, 12
    s_lshl_b32 s41, s3, 10
    s_add_u32 s41, s41, 131072
    s_mov_b32 m0, s40
    s_mov_b32 s14, 18874368
    s_mov_b32 s15, 0x20000
    s_mov_b32 s18, 9160704
    s_mov_b32 s19, 0x20000
    s_waitcnt lgkmcnt(0)
    s_mov_b32 s12, s4
    s_mov_b32 s13, s5
    s_add_u32 s16, s10, 7092224
    s_addc_u32 s17, s11, 0
    s_cmp_eq_u32 s64, 0
    s_cbranch_scc1 Lk1_comp92
    s_mul_i32 s60, s32, 54
    s_mul_i32 s61, s33, 3
    s_lshr_b32 s61, s61, 1
    s_add_u32 s60, s60, s61
    s_mul_i32 s60, s60, 128
    s_movk_i32 s62, 128
    s_add_u32 s60, s60, 7587840
    v_mul_u32_u24 v21, 6, v21
    v_add_u32 v20, v20, v21
    v_mul_u32_u24 v20, s62, v20
    s_mov_b32 s61, 0
    s_mov_b32 s56, 7120896
    v_lshlrev_b32 v44, 7, v1
    s_cmp_ge_u32 s2, 216
    s_cbranch_scc1 Lk1_bd94
    s_movk_i32 s65, 33
    s_barrier
    s_barrier
    s_barrier
    s_barrier
    s_barrier
    s_barrier
    s_cmp_lg_u32 s3, 0
    s_cbranch_scc1 Lk1_c197
    s_mov_b32 exec_hi, 0xff
    buffer_load_dwordx4 v[40:43], v44, s[16:19], s56 offen sc1
    s_mov_b32 exec_hi, -1
Lk1_c197:
    s_barrier
    s_barrier
    s_barrier
    s_barrier
    s_cmp_lg_u32 s3, 0
    s_cbranch_scc1 Lk1_c298
    s_mov_b32 exec_hi, 0xff
    s_waitcnt vmcnt(0)
    v_or3_b32 v40, v40, v41, v42
    v_or_b32 v40, v40, v43
    v_cmp_ne_u32 vcc, 0, v40
    s_cbranch_vccz Lk1_cg102
Lk1_cs101:
    buffer_load_dwordx4 v[40:43], v44, s[16:19], s56 offen sc1
    s_add_u32 s61, s61, 1
    s_waitcnt vmcnt(0)
    v_or3_b32 v40, v40, v41, v42
    v_or_b32 v40, v40, v43
    v_cmp_ne_u32 vcc, 0, v40
    s_cmp_ge_u32 s61, 0x40000
    s_cbranch_scc1 Lk1_cg102
    s_cbranch_vccnz Lk1_cs101
Lk1_cg102:
    s_mov_b32 exec_hi, -1
Lk1_c298:
    s_sub_u32 s65, s65, 10
Lk1_bl93:
    s_sub_u32 s65, s65, 1
    s_cmp_lg_u32 s65, 0
    s_barrier
    s_cbranch_scc1 Lk1_bl93
Lk1_bd94:
    s_add_u32 m0, s40, 32768
    s_nop 0
    buffer_load_dwordx4 v3, s[12:15], s36 offen  lds
    buffer_load_dwordx4 v4, s[12:15], s36 offen offset:1024  lds
    s_add_u32 s36, s36, 131072
    s_add_u32 m0, s40, 98304
    s_nop 0
    buffer_load_dwordx4 v3, s[12:15], s36 offen  lds
    buffer_load_dwordx4 v4, s[12:15], s36 offen offset:1024  lds
    s_add_u32 s36, s36, 131072
    s_add_u32 m0, s40, 49152
    s_nop 0
    buffer_load_dwordx4 v3, s[12:15], s36 offen  lds
    buffer_load_dwordx4 v4, s[12:15], s36 offen offset:1024  lds
    s_add_u32 s36, s36, 131072
    s_cmp_lg_u32 s3, 0
    s_barrier
    s_mov_b32 s52, s37
    s_mov_b32 s53, s39
    v_add_u32 v8, s40, v2
    v_add_u32 v9, 0x10000, v8
    v_add_u32 v10, s41, v2
    s_cmp_lt_u32 s2, 216
    s_cbranch_scc1 Lk1_gg104
    s_mov_b32 exec_hi, 0xff
Lk1_cs105:
    buffer_load_dwordx4 v[40:43], v44, s[16:19], s56 offen sc1
    s_add_u32 s61, s61, 1
    s_waitcnt vmcnt(0)
    v_or3_b32 v40, v40, v41, v42
    v_or_b32 v40, v40, v43
    v_cmp_ne_u32 vcc, 0, v40
    s_cmp_ge_u32 s61, 0x40000
    s_cbranch_scc1 Lk1_cg106
    s_cbranch_vccnz Lk1_cs105
Lk1_cg106:
    s_mov_b32 exec_hi, -1
    s_add_u32 s56, s37, 262128
    v_mov_b32 v22, 0
    s_mov_b64 exec, 1
Lk1_gs103:
    buffer_load_dword v23, v22, s[16:19], s56 offen sc1
    s_add_u32 s61, s61, 1
    s_waitcnt vmcnt(0)
    v_cmp_eq_u32 vcc, -1, v23
    s_cmp_ge_u32 s61, 0x40000
    s_cbranch_scc1 Lk1_gg104
    s_cbranch_vccnz Lk1_gs103
Lk1_gg104:
    s_mov_b64 exec, -1
    s_add_u32 m0, s40, 32768
    s_nop 0
    buffer_load_dwordx4 v2, s[16:19], s37 offen offset:2048 sc1 lds
    buffer_load_dwordx4 v2, s[16:19], s37 offen offset:3072 sc1 lds
    s_add_u32 s37, s37, 36864
    s_add_u32 m0, s41, 0
    s_nop 0
    buffer_load_dwordx4 v2, s[16:19], s39 offen sc1 lds
    s_add_u32 s39, s39, 147456
    s_add_u32 m0, s40, 98304
    s_nop 0
    buffer_load_dwordx4 v2, s[16:19], s37 offen offset:2048 sc1 lds
    buffer_load_dwordx4 v2, s[16:19], s37 offen offset:3072 sc1 lds
    s_add_u32 s37, s37, 36864
    s_add_u32 m0, s40, 49152
    s_nop 0
    buffer_load_dwordx4 v2, s[16:19], s37 offen offset:2048 sc1 lds
    buffer_load_dwordx4 v2, s[16:19], s37 offen offset:3072 sc1 lds
    s_add_u32 s37, s37, 36864
    s_add_u32 m0, s40, 114688
    s_nop 0
    buffer_load_dwordx4 v3, s[12:15], s36 offen  lds
    buffer_load_dwordx4 v4, s[12:15], s36 offen offset:1024  lds
    s_add_u32 s36, s36, 131072
    buffer_load_dwordx4 v2, s[16:19], s37 offen offset:2048 sc1 lds
    buffer_load_dwordx4 v2, s[16:19], s37 offen offset:3072 sc1 lds
    s_add_u32 s37, s37, 36864
    s_waitcnt vmcnt(8)
    ds_read_b128 v[24:27], v8 offset:34816
    ds_read_b128 v[28:31], v8 offset:35840
    ds_read_b128 v[32:35], v10 offset:0
    s_waitcnt lgkmcnt(0)
    v_max3_u32 v24, v24, v25, v26
    v_max3_u32 v27, v27, v28, v29
    v_max3_u32 v24, v24, v30, v31
    v_max3_u32 v32, v32, v33, v34
    v_max3_u32 v27, v27, v32, v35
    v_max_u32 v24, v24, v27
    v_cmp_eq_u32 vcc, -1, v24
    s_cbranch_vccnz Lk1_ur107
Lk1_uk108:
    s_barrier
    s_add_u32 m0, s40, 0
    s_nop 0
    buffer_load_dwordx4 v3, s[12:15], s36 offen  lds
    buffer_load_dwordx4 v4, s[12:15], s36 offen offset:1024  lds
    s_add_u32 s36, s36, 131072
    buffer_load_dwordx4 v2, s[16:19], s37 offen offset:2048 sc1 lds
    buffer_load_dwordx4 v2, s[16:19], s37 offen offset:3072 sc1 lds
    s_add_u32 s37, s37, 36864
    s_add_u32 m0, s41, 4096
    s_nop 0
    buffer_load_dwordx4 v2, s[16:19], s39 offen sc1 lds
    s_add_u32 s39, s39, 147456
    s_waitcnt vmcnt(11)
    ds_read_b128 v[24:27], v9 offset:34816
    ds_read_b128 v[28:31], v9 offset:35840
    s_waitcnt lgkmcnt(0)
    v_max3_u32 v24, v24, v25, v26
    v_max3_u32 v27, v27, v28, v29
    v_max3_u32 v24, v24, v30, v31
    v_max_u32 v24, v24, v27
    v_cmp_eq_u32 vcc, -1, v24
    s_cbranch_vccnz Lk1_ur109
Lk1_uk110:
    s_barrier
    s_add_u32 m0, s40, 16384
    s_nop 0
    buffer_load_dwordx4 v3, s[12:15], s36 offen  lds
    buffer_load_dwordx4 v4, s[12:15], s36 offen offset:1024  lds
    s_add_u32 s36, s36, 131072
    buffer_load_dwordx4 v2, s[16:19], s37 offen offset:2048 sc1 lds
    buffer_load_dwordx4 v2, s[16:19], s37 offen offset:3072 sc1 lds
    s_add_u32 s37, s37, 36864
    s_waitcnt vmcnt(13)
    ds_read_b128 v[24:27], v8 offset:51200
    ds_read_b128 v[28:31], v8 offset:52224
    s_waitcnt lgkmcnt(0)
    v_max3_u32 v24, v24, v25, v26
    v_max3_u32 v27, v27, v28, v29
    v_max3_u32 v24, v24, v30, v31
    v_max_u32 v24, v24, v27
    v_cmp_eq_u32 vcc, -1, v24
    s_cbranch_vccnz Lk1_ur111
Lk1_uk112:
    s_barrier
    s_add_u32 m0, s40, 65536
    s_nop 0
    buffer_load_dwordx4 v3, s[12:15], s36 offen  lds
    buffer_load_dwordx4 v4, s[12:15], s36 offen offset:1024  lds
    s_add_u32 s36, s36, 131072
    buffer_load_dwordx4 v2, s[16:19], s37 offen offset:2048 sc1 lds
    buffer_load_dwordx4 v2, s[16:19], s37 offen offset:3072 sc1 lds
    s_add_u32 s37, s37, 36864
    s_waitcnt vmcnt(13)
    ds_read_b128 v[24:27], v9 offset:51200
    ds_read_b128 v[28:31], v9 offset:52224
    s_waitcnt lgkmcnt(0)
    v_max3_u32 v24, v24, v25, v26
    v_max3_u32 v27, v27, v28, v29
    v_max3_u32 v24, v24, v30, v31
    v_max_u32 v24, v24, v27
    v_cmp_eq_u32 vcc, -1, v24
    s_cbranch_vccnz Lk1_ur113
Lk1_uk114:
    s_barrier
    s_cmp_lg_u32 s3, 0
    s_cbranch_scc1 Lk1_na115
    s_mov_b32 exec_lo, 0x01ff01ff
    s_mov_b32 exec_hi, 0
    buffer_load_dword v21, v20, s[16:19], s60 offen sc1
    s_mov_b64 exec, -1
Lk1_na115:
    s_add_u32 m0, s40, 81920
    s_nop 0
    buffer_load_dwordx4 v3, s[12:15], s36 offen  lds
    buffer_load_dwordx4 v4, s[12:15], s36 offen offset:1024  lds
    s_add_u32 s36, s36, 131072
    buffer_load_dwordx4 v2, s[16:19], s37 offen offset:2048 sc1 lds
    buffer_load_dwordx4 v2, s[16:19], s37 offen offset:3072 sc1 lds
    s_add_u32 s37, s37, 36864
    s_waitcnt vmcnt(12)
    ds_read_b128 v[24:27], v8 offset:2048
    ds_read_b128 v[28:31], v8 offset:3072
    ds_read_b128 v[32:35], v10 offset:4096
    s_waitcnt lgkmcnt(0)
    v_max3_u32 v24, v24, v25, v26
    v_max3_u32 v27, v27, v28, v29
    v_max3_u32 v24, v24, v30, v31
    v_max3_u32 v32, v32, v33, v34
    v_max3_u32 v27, v27, v32, v35
    v_max_u32 v24, v24, v27
    v_cmp_eq_u32 vcc, -1, v24
    s_cbranch_vccnz Lk1_ur116
Lk1_uk117:
    s_cmp_lg_u32 s3, 0
    s_cbranch_scc1 Lk1_ug96
    s_mov_b32 exec_lo, 0x01ff01ff
    s_mov_b32 exec_hi, 0
    s_waitcnt vmcnt(4)
    v_cmp_ne_u32 vcc, 0, v21
    s_and_b64 exec, exec, vcc
    s_cbranch_scc0 Lk1_ug96
Lk1_us95:
    buffer_load_dword v21, v20, s[16:19], s60 offen sc1
    s_add_u32 s61, s61, 1
    s_waitcnt vmcnt(0)
    v_cmp_ne_u32 vcc, 0, v21
    s_cmp_ge_u32 s61, 0x40000
    s_cbranch_scc1 Lk1_ug96
    s_and_b64 exec, exec, vcc
    s_cbranch_scc1 Lk1_us95
Lk1_ug96:
    s_mov_b64 exec, -1
    s_barrier
    s_add_u32 m0, s40, 32768
    s_nop 0
    buffer_load_dwordx4 v3, s[12:15], s36 offen  lds
    buffer_load_dwordx4 v4, s[12:15], s36 offen offset:1024  lds
    s_add_u32 s36, s36, 131072
    buffer_load_dwordx4 v2, s[16:19], s37 offen offset:2048 sc1 lds
    buffer_load_dwordx4 v2, s[16:19], s37 offen offset:3072 sc1 lds
    s_add_u32 s37, s37, 36864
    s_add_u32 m0, s41, 8192
    s_nop 0
    buffer_load_dwordx4 v2, s[16:19], s39 offen sc1 lds
    s_add_u32 s39, s39, 147456
    s_waitcnt vmcnt(13)
    ds_read_b128 v[24:27], v8 offset:18432
    ds_read_b128 v[28:31], v8 offset:19456
    s_waitcnt lgkmcnt(0)
    v_max3_u32 v24, v24, v25, v26
    v_max3_u32 v27, v27, v28, v29
    v_max3_u32 v24, v24, v30, v31
    v_max_u32 v24, v24, v27
    v_cmp_eq_u32 vcc, -1, v24
    s_cbranch_vccnz Lk1_ur118
Lk1_uk119:
    s_barrier
    s_add_u32 m0, s40, 98304
    s_nop 0
    buffer_load_dwordx4 v3, s[12:15], s36 offen  lds
    buffer_load_dwordx4 v4, s[12:15], s36 offen offset:1024  lds
    s_add_u32 s36, s36, 131072
    buffer_load_dwordx4 v2, s[16:19], s37 offen offset:2048 sc1 lds
    buffer_load_dwordx4 v2, s[16:19], s37 offen offset:3072 sc1 lds
    s_add_u32 s37, s37, 36864
    s_waitcnt vmcnt(13)
    ds_read_b128 v[24:27], v9 offset:2048
    ds_read_b128 v[28:31], v9 offset:3072
    s_waitcnt lgkmcnt(0)
    v_max3_u32 v24, v24, v25, v26
    v_max3_u32 v27, v27, v28, v29
    v_max3_u32 v24, v24, v30, v31
    v_max_u32 v24, v24, v27
    v_cmp_eq_u32 vcc, -1, v24
    s_cbranch_vccnz Lk1_ur120
Lk1_uk121:
    s_barrier
    s_add_u32 m0, s40, 49152
    s_nop 0
    buffer_load_dwordx4 v3, s[12:15], s36 offen  lds
    buffer_load_dwordx4 v4, s[12:15], s36 offen offset:1024  lds
    s_add_u32 s36, s36, 131072
    buffer_load_dwordx4 v2, s[16:19], s37 offen offset:2048 sc1 lds
    buffer_load_dwordx4 v2, s[16:19], s37 offen offset:3072 sc1 lds
    s_add_u32 s37, s37, 36864
    s_waitcnt vmcnt(13)
    ds_read_b128 v[24:27], v9 offset:18432
    ds_read_b128 v[28:31], v9 offset:19456
    s_waitcnt lgkmcnt(0)
    v_max3_u32 v24, v24, v25, v26
    v_max3_u32 v27, v27, v28, v29
    v_max3_u32 v24, v24, v30, v31
    v_max_u32 v24, v24, v27
    v_cmp_eq_u32 vcc, -1, v24
    s_cbranch_vccnz Lk1_ur122
Lk1_uk123:
    s_barrier
    s_add_u32 m0, s40, 114688
    s_nop 0
    buffer_load_dwordx4 v3, s[12:15], s36 offen  lds
    buffer_load_dwordx4 v4, s[12:15], s36 offen offset:1024  lds
    s_add_u32 s36, s36, 131072
    buffer_load_dwordx4 v2, s[16:19], s37 offen offset:2048 sc1 lds
    buffer_load_dwordx4 v2, s[16:19], s37 offen offset:3072 sc1 lds
    s_add_u32 s37, s37, 36864
    s_waitcnt vmcnt(12)
    s_barrier
    s_add_u32 m0, s40, 0
    s_nop 0
    buffer_load_dwordx4 v3, s[12:15], s36 offen  lds
    buffer_load_dwordx4 v4, s[12:15], s36 offen offset:1024  lds
    s_add_u32 s36, s36, 131072
    buffer_load_dwordx4 v2, s[16:19], s37 offen offset:2048 sc1 lds
    buffer_load_dwordx4 v2, s[16:19], s37 offen offset:3072 sc1 lds
    s_add_u32 s37, s37, 36864
    s_add_u32 m0, s41, 0
    s_nop 0
    buffer_load_dwordx4 v2, s[16:19], s39 offen sc1 lds
    s_add_u32 s39, s39, 147456
    s_waitcnt vmcnt(13)
    s_barrier
    s_add_u32 m0, s40, 16384
    s_nop 0
    buffer_load_dwordx4 v3, s[12:15], s36 offen  lds
    buffer_load_dwordx4 v4, s[12:15], s36 offen offset:1024  lds
    s_add_u32 s36, s36, 131072
    buffer_load_dwordx4 v2, s[16:19], s37 offen offset:2048 sc1 lds
    buffer_load_dwordx4 v2, s[16:19], s37 offen offset:3072 sc1 lds
    s_add_u32 s37, s37, 36864
    s_waitcnt vmcnt(13)
    s_barrier
    s_add_u32 m0, s40, 65536
    s_nop 0
    buffer_load_dwordx4 v3, s[12:15], s36 offen  lds
    buffer_load_dwordx4 v4, s[12:15], s36 offen offset:1024  lds
    s_add_u32 s36, s36, 131072
    buffer_load_dwordx4 v2, s[16:19], s37 offen offset:2048 sc1 lds
    buffer_load_dwordx4 v2, s[16:19], s37 offen offset:3072 sc1 lds
    s_add_u32 s37, s37, 36864
    s_waitcnt vmcnt(13)
    s_barrier
    s_add_u32 m0, s40, 81920
    s_nop 0
    buffer_load_dwordx4 v3, s[12:15], s36 offen  lds
    buffer_load_dwordx4 v4, s[12:15], s36 offen offset:1024  lds
    s_add_u32 s36, s36, 131072
    buffer_load_dwordx4 v2, s[16:19], s37 offen offset:2048 sc1 lds
    buffer_load_dwordx4 v2, s[16:19], s37 offen offset:3072 sc1 lds
    s_add_u32 s37, s37, 36864
    s_waitcnt vmcnt(12)
    s_barrier
    s_add_u32 m0, s40, 32768
    s_nop 0
    buffer_load_dwordx4 v3, s[12:15], s36 offen  lds
    buffer_load_dwordx4 v4, s[12:15], s36 offen offset:1024  lds
    s_add_u32 s36, s36, 131072
    buffer_load_dwordx4 v2, s[16:19], s37 offen offset:2048 sc1 lds
    buffer_load_dwordx4 v2, s[16:19], s37 offen offset:3072 sc1 lds
    s_add_u32 s37, s37, 36864
    s_add_u32 m0, s41, 4096
    s_nop 0
    buffer_load_dwordx4 v2, s[16:19], s39 offen sc1 lds
    s_add_u32 s39, s39, 147456
    s_waitcnt vmcnt(13)
    s_barrier
    s_add_u32 m0, s40, 98304
    s_nop 0
    buffer_load_dwordx4 v3, s[12:15], s36 offen  lds
    buffer_load_dwordx4 v4, s[12:15], s36 offen offset:1024  lds
    s_add_u32 s36, s36, 131072
    buffer_load_dwordx4 v2, s[16:19], s37 offen offset:2048 sc1 lds
    buffer_load_dwordx4 v2, s[16:19], s37 offen offset:3072 sc1 lds
    s_add_u32 s37, s37, 36864
    s_waitcnt vmcnt(13)
    s_barrier
    s_add_u32 m0, s40, 49152
    s_nop 0
    buffer_load_dwordx4 v3, s[12:15], s36 offen  lds
    buffer_load_dwordx4 v4, s[12:15], s36 offen offset:1024  lds
    s_add_u32 s36, s36, 131072
    buffer_load_dwordx4 v2, s[16:19], s37 offen offset:2048 sc1 lds
    buffer_load_dwordx4 v2, s[16:19], s37 offen offset:3072 sc1 lds
    s_add_u32 s37, s37, 36864
    s_waitcnt vmcnt(13)
    s_barrier
    s_add_u32 m0, s40, 114688
    s_nop 0
    buffer_load_dwordx4 v3, s[12:15], s36 offen  lds
    buffer_load_dwordx4 v4, s[12:15], s36 offen offset:1024  lds
    s_add_u32 s36, s36, 131072
    buffer_load_dwordx4 v2, s[16:19], s37 offen offset:2048 sc1 lds
    buffer_load_dwordx4 v2, s[16:19], s37 offen offset:3072 sc1 lds
    s_add_u32 s37, s37, 36864
    s_waitcnt vmcnt(12)
    s_barrier
    s_add_u32 m0, s40, 0
    s_nop 0
    buffer_load_dwordx4 v3, s[12:15], s36 offen  lds
    buffer_load_dwordx4 v4, s[12:15], s36 offen offset:1024  lds
    s_add_u32 s36, s36, 131072
    buffer_load_dwordx4 v2, s[16:19], s37 offen offset:2048 sc1 lds
    buffer_load_dwordx4 v2, s[16:19], s37 offen offset:3072 sc1 lds
    s_add_u32 s37, s37, 36864
    s_add_u32 m0, s41, 8192
    s_nop 0
    buffer_load_dwordx4 v2, s[16:19], s39 offen sc1 lds
    s_add_u32 s39, s39, 147456
    s_waitcnt vmcnt(13)
    s_barrier
    s_add_u32 m0, s40, 16384
    s_nop 0
    buffer_load_dwordx4 v3, s[12:15], s36 offen  lds
    buffer_load_dwordx4 v4, s[12:15], s36 offen offset:1024  lds
    s_add_u32 s36, s36, 131072
    buffer_load_dwordx4 v2, s[16:19], s37 offen offset:2048 sc1 lds
    buffer_load_dwordx4 v2, s[16:19], s37 offen offset:3072 sc1 lds
    s_add_u32 s37, s37, 36864
    s_waitcnt vmcnt(13)
    s_barrier
    s_add_u32 m0, s40, 65536
    s_nop 0
    buffer_load_dwordx4 v3, s[12:15], s36 offen  lds
    buffer_load_dwordx4 v4, s[12:15], s36 offen offset:1024  lds
    s_add_u32 s36, s36, 131072
    buffer_load_dwordx4 v2, s[16:19], s37 offen offset:2048 sc1 lds
    buffer_load_dwordx4 v2, s[16:19], s37 offen offset:3072 sc1 lds
    s_add_u32 s37, s37, 36864
    s_waitcnt vmcnt(13)
    s_barrier
    s_add_u32 m0, s40, 81920
    s_nop 0
    buffer_load_dwordx4 v3, s[12:15], s36 offen  lds
    buffer_load_dwordx4 v4, s[12:15], s36 offen offset:1024  lds
    s_add_u32 s36, s36, 131072
    buffer_load_dwordx4 v2, s[16:19], s37 offen offset:2048 sc1 lds
    buffer_load_dwordx4 v2, s[16:19], s37 offen offset:3072 sc1 lds
    s_add_u32 s37, s37, 36864
    s_waitcnt vmcnt(12)
    s_barrier
    s_add_u32 m0, s40, 32768
    s_nop 0
    buffer_load_dwordx4 v3, s[12:15], s36 offen  lds
    buffer_load_dwordx4 v4, s[12:15], s36 offen offset:1024  lds
    s_add_u32 s36, s36, 131072
    buffer_load_dwordx4 v2, s[16:19], s37 offen offset:2048 sc1 lds
    buffer_load_dwordx4 v2, s[16:19], s37 offen offset:3072 sc1 lds
    s_add_u32 s37, s37, 36864
    s_add_u32 m0, s41, 0
    s_nop 0
    buffer_load_dwordx4 v2, s[16:19], s39 offen sc1 lds
    s_add_u32 s39, s39, 147456
    s_waitcnt vmcnt(13)
    s_barrier
    s_add_u32 m0, s40, 98304
    s_nop 0
    buffer_load_dwordx4 v3, s[12:15], s36 offen  lds
    buffer_load_dwordx4 v4, s[12:15], s36 offen offset:1024  lds
    s_add_u32 s36, s36, 131072
    buffer_load_dwordx4 v2, s[16:19], s37 offen offset:2048 sc1 lds
    buffer_load_dwordx4 v2, s[16:19], s37 offen offset:3072 sc1 lds
    s_add_u32 s37, s37, 36864
    s_waitcnt vmcnt(13)
    s_barrier
    s_add_u32 m0, s40, 49152
    s_nop 0
    buffer_load_dwordx4 v3, s[12:15], s36 offen  lds
    buffer_load_dwordx4 v4, s[12:15], s36 offen offset:1024  lds
    s_add_u32 s36, s36, 131072
    buffer_load_dwordx4 v2, s[16:19], s37 offen offset:2048 sc1 lds
    buffer_load_dwordx4 v2, s[16:19], s37 offen offset:3072 sc1 lds
    s_add_u32 s37, s37, 36864
    s_waitcnt vmcnt(13)
    s_barrier
    s_add_u32 m0, s40, 114688
    s_nop 0
    buffer_load_dwordx4 v3, s[12:15], s36 offen  lds
    buffer_load_dwordx4 v4, s[12:15], s36 offen offset:1024  lds
    s_add_u32 s36, s36, 131072
    buffer_load_dwordx4 v2, s[16:19], s37 offen offset:2048 sc1 lds
    buffer_load_dwordx4 v2, s[16:19], s37 offen offset:3072 sc1 lds
    s_add_u32 s37, s37, 36864
    s_waitcnt vmcnt(12)
    s_barrier
    s_add_u32 m0, s40, 0
    s_nop 0
    buffer_load_dwordx4 v3, s[12:15], s36 offen  lds
    buffer_load_dwordx4 v4, s[12:15], s36 offen offset:1024  lds
    s_add_u32 s36, s36, 131072
    buffer_load_dwordx4 v2, s[16:19], s37 offen offset:2048 sc1 lds
    buffer_load_dwordx4 v2, s[16:19], s37 offen offset:3072 sc1 lds
    s_add_u32 s37, s37, 36864
    s_add_u32 m0, s41, 4096
    s_nop 0
    buffer_load_dwordx4 v2, s[16:19], s39 offen sc1 lds
    s_add_u32 s39, s39, 147456
    s_waitcnt vmcnt(13)
    s_barrier
    s_add_u32 m0, s40, 16384
    s_nop 0
    buffer_load_dwordx4 v3, s[12:15], s36 offen  lds
    buffer_load_dwordx4 v4, s[12:15], s36 offen offset:1024  lds
    s_add_u32 s36, s36, 131072
    buffer_load_dwordx4 v2, s[16:19], s37 offen offset:2048 sc1 lds
    buffer_load_dwordx4 v2, s[16:19], s37 offen offset:3072 sc1 lds
    s_add_u32 s37, s37, 36864
    s_waitcnt vmcnt(13)
    s_barrier
    s_add_u32 m0, s40, 65536
    s_nop 0
    buffer_load_dwordx4 v3, s[12:15], s36 offen  lds
    buffer_load_dwordx4 v4, s[12:15], s36 offen offset:1024  lds
    s_add_u32 s36, s36, 131072
    buffer_load_dwordx4 v2, s[16:19], s37 offen offset:2048 sc1 lds
    buffer_load_dwordx4 v2, s[16:19], s37 offen offset:3072 sc1 lds
    s_add_u32 s37, s37, 36864
    s_waitcnt vmcnt(13)
    s_barrier
    s_add_u32 m0, s40, 81920
    s_nop 0
    buffer_load_dwordx4 v3, s[12:15], s36 offen  lds
    buffer_load_dwordx4 v4, s[12:15], s36 offen offset:1024  lds
    s_add_u32 s36, s36, 131072
    buffer_load_dwordx4 v2, s[16:19], s37 offen offset:2048 sc1 lds
    buffer_load_dwordx4 v2, s[16:19], s37 offen offset:3072 sc1 lds
    s_add_u32 s37, s37, 36864
    s_waitcnt vmcnt(12)
    s_barrier
    s_add_u32 m0, s40, 32768
    s_nop 0
    buffer_load_dwordx4 v3, s[12:15], s36 offen  lds
    buffer_load_dwordx4 v4, s[12:15], s36 offen offset:1024  lds
    s_add_u32 s36, s36, 131072
    buffer_load_dwordx4 v2, s[16:19], s37 offen offset:2048 sc1 lds
    buffer_load_dwordx4 v2, s[16:19], s37 offen offset:3072 sc1 lds
    s_add_u32 s37, s37, 36864
    s_add_u32 m0, s41, 8192
    s_nop 0
    buffer_load_dwordx4 v2, s[16:19], s39 offen sc1 lds
    s_add_u32 s39, s39, 147456
    s_waitcnt vmcnt(13)
    s_barrier
    s_add_u32 m0, s40, 98304
    s_nop 0
    buffer_load_dwordx4 v3, s[12:15], s36 offen  lds
    buffer_load_dwordx4 v4, s[12:15], s36 offen offset:1024  lds
    s_add_u32 s36, s36, 131072
    buffer_load_dwordx4 v2, s[16:19], s37 offen offset:2048 sc1 lds
    buffer_load_dwordx4 v2, s[16:19], s37 offen offset:3072 sc1 lds
    s_add_u32 s37, s37, 36864
    s_waitcnt vmcnt(13)
    s_barrier
    s_add_u32 m0, s40, 49152
    s_nop 0
    buffer_load_dwordx4 v3, s[12:15], s36 offen  lds
    buffer_load_dwordx4 v4, s[12:15], s36 offen offset:1024  lds
    s_add_u32 s36, s36, 131072
    buffer_load_dwordx4 v2, s[16:19], s37 offen offset:2048 sc1 lds
    buffer_load_dwordx4 v2, s[16:19], s37 offen offset:3072 sc1 lds
    s_add_u32 s37, s37, 36864
    s_waitcnt vmcnt(13)
    s_barrier
    s_add_u32 m0, s40, 114688
    s_nop 0
    buffer_load_dwordx4 v3, s[12:15], s36 offen  lds
    buffer_load_dwordx4 v4, s[12:15], s36 offen offset:1024  lds
    s_add_u32 s36, s36, 131072
    buffer_load_dwordx4 v2, s[16:19], s37 offen offset:2048 sc1 lds
    buffer_load_dwordx4 v2, s[16:19], s37 offen offset:3072 sc1 lds
    s_add_u32 s37, s37, 36864
    s_waitcnt vmcnt(12)
    s_barrier
    s_waitcnt vmcnt(8)
    s_barrier
    s_waitcnt vmcnt(0)
    s_barrier
    s_endpgm
Lk1_ur107:
    s_add_u32 m0, s40, 32768
    s_add_u32 s56, s52, 0
    s_add_u32 s61, s61, 1
    buffer_load_dwordx4 v2, s[16:19], s56 offen offset:2048 sc1 lds
    buffer_load_dwordx4 v2, s[16:19], s56 offen offset:3072 sc1 lds
    s_add_u32 m0, s41, 0
    s_add_u32 s56, s53, 0
    buffer_load_dwordx4 v2, s[16:19], s56 offen sc1 lds
    s_waitcnt vmcnt(0)
    ds_read_b128 v[24:27], v8 offset:34816
    ds_read_b128 v[28:31], v8 offset:35840
    ds_read_b128 v[32:35], v10 offset:0
    s_waitcnt lgkmcnt(0)
    v_max3_u32 v24, v24, v25, v26
    v_max3_u32 v27, v27, v28, v29
    v_max3_u32 v24, v24, v30, v31
    v_max3_u32 v32, v32, v33, v34
    v_max3_u32 v27, v27, v32, v35
    v_max_u32 v24, v24, v27
    v_cmp_eq_u32 vcc, -1, v24
    s_cmp_ge_u32 s61, 0x40000
    s_cbranch_scc1 Lk1_uk108
    s_cbranch_vccnz Lk1_ur107
    s_branch Lk1_uk108
Lk1_ur109:
    s_add_u32 m0, s40, 98304
    s_add_u32 s56, s52, 36864
    s_add_u32 s61, s61, 1
    buffer_load_dwordx4 v2, s[16:19], s56 offen offset:2048 sc1 lds
    buffer_load_dwordx4 v2, s[16:19], s56 offen offset:3072 sc1 lds
    s_waitcnt vmcnt(0)
    ds_read_b128 v[24:27], v9 offset:34816
    ds_read_b128 v[28:31], v9 offset:35840
    s_waitcnt lgkmcnt(0)
    v_max3_u32 v24, v24, v25, v26
    v_max3_u32 v27, v27, v28, v29
    v_max3_u32 v24, v24, v30, v31
    v_max_u32 v24, v24, v27
    v_cmp_eq_u32 vcc, -1, v24
    s_cmp_ge_u32 s61, 0x40000
    s_cbranch_scc1 Lk1_uk110
    s_cbranch_vccnz Lk1_ur109
    s_branch Lk1_uk110
Lk1_ur111:
    s_add_u32 m0, s40, 49152
    s_add_u32 s56, s52, 73728
    s_add_u32 s61, s61, 1
    buffer_load_dwordx4 v2, s[16:19], s56 offen offset:2048 sc1 lds
    buffer_load_dwordx4 v2, s[16:19], s56 offen offset:3072 sc1 lds
    s_waitcnt vmcnt(0)
    ds_read_b128 v[24:27], v8 offset:51200
    ds_read_b128 v[28:31], v8 offset:52224
    s_waitcnt lgkmcnt(0)
    v_max3_u32 v24, v24, v25, v26
    v_max3_u32 v27, v27, v28, v29
    v_max3_u32 v24, v24, v30, v31
    v_max_u32 v24, v24, v27
    v_cmp_eq_u32 vcc, -1, v24
    s_cmp_ge_u32 s61, 0x40000
    s_cbranch_scc1 Lk1_uk112
    s_cbranch_vccnz Lk1_ur111
    s_branch Lk1_uk112
Lk1_ur113:
    s_add_u32 m0, s40, 114688
    s_add_u32 s56, s52, 110592
    s_add_u32 s61, s61, 1
    buffer_load_dwordx4 v2, s[16:19], s56 offen offset:2048 sc1 lds
    buffer_load_dwordx4 v2, s[16:19], s56 offen offset:3072 sc1 lds
    s_waitcnt vmcnt(0)
    ds_read_b128 v[24:27], v9 offset:51200
    ds_read_b128 v[28:31], v9 offset:52224
    s_waitcnt lgkmcnt(0)
    v_max3_u32 v24, v24, v25, v26
    v_max3_u32 v27, v27, v28, v29
    v_max3_u32 v24, v24, v30, v31
    v_max_u32 v24, v24, v27
    v_cmp_eq_u32 vcc, -1, v24
    s_cmp_ge_u32 s61, 0x40000
    s_cbranch_scc1 Lk1_uk114
    s_cbranch_vccnz Lk1_ur113
    s_branch Lk1_uk114
Lk1_ur116:
    s_add_u32 m0, s40, 0
    s_add_u32 s56, s52, 147456
    s_add_u32 s61, s61, 1
    buffer_load_dwordx4 v2, s[16:19], s56 offen offset:2048 sc1 lds
    buffer_load_dwordx4 v2, s[16:19], s56 offen offset:3072 sc1 lds
    s_add_u32 m0, s41, 4096
    s_add_u32 s56, s53, 147456
    buffer_load_dwordx4 v2, s[16:19], s56 offen sc1 lds
    s_waitcnt vmcnt(0)
    ds_read_b128 v[24:27], v8 offset:2048
    ds_read_b128 v[28:31], v8 offset:3072
    ds_read_b128 v[32:35], v10 offset:4096
    s_waitcnt lgkmcnt(0)
    v_max3_u32 v24, v24, v25, v26
    v_max3_u32 v27, v27, v28, v29
    v_max3_u32 v24, v24, v30, v31
    v_max3_u32 v32, v32, v33, v34
    v_max3_u32 v27, v27, v32, v35
    v_max_u32 v24, v24, v27
    v_cmp_eq_u32 vcc, -1, v24
    s_cmp_ge_u32 s61, 0x40000
    s_cbranch_scc1 Lk1_uk117
    s_cbranch_vccnz Lk1_ur116
    s_branch Lk1_uk117
Lk1_ur118:
    s_add_u32 m0, s40, 16384
    s_add_u32 s56, s52, 184320
    s_add_u32 s61, s61, 1
    buffer_load_dwordx4 v2, s[16:19], s56 offen offset:2048 sc1 lds
    buffer_load_dwordx4 v2, s[16:19], s56 offen offset:3072 sc1 lds
    s_waitcnt vmcnt(0)
    ds_read_b128 v[24:27], v8 offset:18432
    ds_read_b128 v[28:31], v8 offset:19456
    s_waitcnt lgkmcnt(0)
    v_max3_u32 v24, v24, v25, v26
    v_max3_u32 v27, v27, v28, v29
    v_max3_u32 v24, v24, v30, v31
    v_max_u32 v24, v24, v27
    v_cmp_eq_u32 vcc, -1, v24
    s_cmp_ge_u32 s61, 0x40000
    s_cbranch_scc1 Lk1_uk119
    s_cbranch_vccnz Lk1_ur118
    s_branch Lk1_uk119
Lk1_ur120:
    s_add_u32 m0, s40, 65536
    s_add_u32 s56, s52, 221184
    s_add_u32 s61, s61, 1
    buffer_load_dwordx4 v2, s[16:19], s56 offen offset:2048 sc1 lds
    buffer_load_dwordx4 v2, s[16:19], s56 offen offset:3072 sc1 lds
    s_waitcnt vmcnt(0)
    ds_read_b128 v[24:27], v9 offset:2048
    ds_read_b128 v[28:31], v9 offset:3072
    s_waitcnt lgkmcnt(0)
    v_max3_u32 v24, v24, v25, v26
    v_max3_u32 v27, v27, v28, v29
    v_max3_u32 v24, v24, v30, v31
    v_max_u32 v24, v24, v27
    v_cmp_eq_u32 vcc, -1, v24
    s_cmp_ge_u32 s61, 0x40000
    s_cbranch_scc1 Lk1_uk121
    s_cbranch_vccnz Lk1_ur120
    s_branch Lk1_uk121
Lk1_ur122:
    s_add_u32 m0, s40, 81920
    s_add_u32 s56, s52, 258048
    s_add_u32 s61, s61, 1
    buffer_load_dwordx4 v2, s[16:19], s56 offen offset:2048 sc1 lds
    buffer_load_dwordx4 v2, s[16:19], s56 offen offset:3072 sc1 lds
    s_waitcnt vmcnt(0)
    ds_read_b128 v[24:27], v9 offset:18432
    ds_read_b128 v[28:31], v9 offset:19456
    s_waitcnt lgkmcnt(0)
    v_max3_u32 v24, v24, v25, v26
    v_max3_u32 v27, v27, v28, v29
    v_max3_u32 v24, v24, v30, v31
    v_max_u32 v24, v24, v27
    v_cmp_eq_u32 vcc, -1, v24
    s_cmp_ge_u32 s61, 0x40000
    s_cbranch_scc1 Lk1_uk123
    s_cbranch_vccnz Lk1_ur122
    s_branch Lk1_uk123
Lk1_comp92:
    v_add_u32 v5, 0x10000, v2
    v_add_u32 v6, 131072, v2
    v_bfe_u32 v22, v1, 2, 3
    v_lshrrev_b32 v23, 5, v1
    v_lshlrev_b32 v23, 12, v23
    v_lshl_add_u32 v23, v22, 8, v23
    v_and_b32 v24, 3, v1
    v_lshl_add_u32 v23, v24, 3, v23
    s_lshl_b32 s42, s3, 1
    v_xor_b32 v22, s42, v22
    v_lshl_add_u32 v8, v22, 5, v23
    v_xor_b32 v10, 32, v8
    v_add_u32 v9, 0x10000, v8
    v_add_u32 v11, 0x10000, v10
    s_add_u32 s20, s10, 4730880
    s_addc_u32 s21, s11, 0
    s_mov_b32 s22, 19124224
    s_mov_b32 s23, 0x20000
    s_mov_b32 s24, s6
    s_mov_b32 s25, s7
    s_mov_b32 s26, 4096
    s_mov_b32 s27, 0x20000
    s_mov_b32 s28, s8
    s_mov_b32 s29, s9
    s_mov_b32 s30, 2359296
    s_mov_b32 s31, 0x20000
    s_lshl_b32 s42, s34, 2
    s_add_u32 s42, s42, s3
    s_lshl_b32 s43, s42, 6
    s_mul_i32 s44, s42, 36864
    s_mul_i32 s45, s33, 288
    s_add_u32 s44, s44, s45
    s_add_u32 s45, s44, 256
    s_lshl_b32 s46, s32, 6
    s_add_u32 s44, s44, s46
    s_mul_i32 s42, s42, 36
    s_mul_i32 s46, s33, 9
    s_add_u32 s42, s42, s46
    s_add_u32 s46, s42, 8
    s_lshl_b32 s46, s46, 10
    s_lshl_b32 s47, s32, 1
    s_add_u32 s42, s42, s47
    s_lshl_b32 s42, s42, 10
    s_lshr_b32 s47, s2, 3
    s_lshl_b32 s47, s47, 1
    s_and_b32 s48, s2, 1
    s_add_u32 s47, s47, s48
    s_lshl_b32 s48, s47, 2
    s_add_u32 s48, s48, s3
    s_lshl_b32 s48, s48, 7
    s_add_u32 s48, s48, 8900608
    s_lshl_b32 s49, s32, 2
    s_add_u32 s49, s49, s48
    s_mul_i32 s47, s47, 110592
    s_add_u32 s47, s47, 12046336
    s_lshl_b32 s54, s3, 11
    s_add_u32 s55, s32, 1
    s_and_b32 s55, s55, 3
    s_mul_i32 s55, s55, 27648
    s_add_u32 s55, s55, s47
    s_add_u32 s55, s55, s54
    s_add_u32 s50, s55, 0
    s_add_u32 s55, s32, 2
    s_and_b32 s55, s55, 3
    s_mul_i32 s55, s55, 27648
    s_add_u32 s55, s55, s47
    s_add_u32 s55, s55, s54
    s_add_u32 s51, s55, 9216
    s_add_u32 s55, s32, 3
    s_and_b32 s55, s55, 3
    s_mul_i32 s55, s55, 27648
    s_add_u32 s55, s55, s47
    s_add_u32 s55, s55, s54
    s_add_u32 s52, s55, 18432
    s_sub_u32 s55, s3, s32
    s_add_u32 s55, s55, 3
    s_and_b32 s55, s55, 3
    s_mul_i32 s56, s3, 3
    s_add_u32 s55, s55, s56
    s_mul_i32 s55, s55, 9216
    s_add_u32 s55, s55, s47
    s_add_u32 s53, s55, 8192
    s_mul_i32 s55, s32, 27648
    s_add_u32 s55, s55, s47
    s_add_u32 s56, s55, s54
    s_add_u32 s57, s56, 9216
    s_add_u32 s58, s56, 18432
    s_add_u32 s59, s55, 8192
    s_add_u32 s60, s59, 9216
    s_add_u32 s61, s59, 18432
    s_cmp_eq_u32 s3, s32
    s_cselect_b32 s62, 0x40000000, 0
    v_or_b32 v12, s62, v2
    v_mov_b32 v17, 0
    s_movk_i32 s63, 1152
    v_mul_u32_u24 v22, s63, v21
    v_lshrrev_b32 v23, 1, v20
    v_lshl_add_u32 v22, v23, 4, v22
    v_and_b32 v23, 1, v20
    v_lshl_add_u32 v13, v23, 5, v22
    v_add_u32 v14, 18432, v13
    v_mul_u32_u24 v23, 18432, v23
    v_add_u32 v15, v23, v22
    v_cmp_gt_u32 vcc, 16, v1
    v_lshlrev_b32 v22, 1, v1
    v_mov_b32 v23, 0x40000000
    v_mov_b32 v195, 0
    v_cndmask_b32 v16, v23, v22, vcc
    v_mov_b32 v196, 0
    v_mov_b32 v197, 0
    v_mov_b32 v198, 0
    v_mov_b32 v200, 0x3f803f80
    v_mov_b32 v201, 0x3f803f80
    v_mov_b32 v202, 0x3f803f80
    v_mov_b32 v203, 0x3f803f80
    v_lshrrev_b32 v22, 2, v21
    v_cmp_eq_u32 vcc, v22, v20
    v_and_b32 v23, 1, v21
    v_lshlrev_b32 v23, 4, v23
    v_mov_b32 v24, 0x3f80
    v_lshlrev_b32 v24, v23, v24
    v_cndmask_b32 v24, 0, v24, vcc
    v_and_b32 v23, 2, v21
    v_cmp_eq_u32 vcc, 0, v23
    v_mov_b32 v190, 0
    v_mov_b32 v191, 0
    v_cndmask_b32 v188, 0, v24, vcc
    v_cndmask_b32 v189, v24, 0, vcc
    v_mov_b32 v192, v188
    v_mov_b32 v193, v189
    s_barrier
    ds_read_b64_tr_b16 v[144:145], v8 offset:32768
    ds_read_b64_tr_b16 v[146:147], v8 offset:40960
    ds_read_b64_tr_b16 v[148:149], v10 offset:32768
    ds_read_b64_tr_b16 v[150:151], v10 offset:40960
    ds_read_b128 v[112:115], v2 offset:34816
    ds_read_b128 v[116:119], v2 offset:35840
    ds_read_b128 v[120:123], v2 offset:38912
    ds_read_b128 v[124:127], v2 offset:39936
    ds_read_b128 v[128:131], v2 offset:43008
    s_waitcnt lgkmcnt(4)
    v_mfma_f32_16x16x32_bf16 v[40:43], v[112:115], v[144:147], 0
    ds_read_b128 v[132:135], v2 offset:44032
    v_mfma_f32_16x16x32_bf16 v[44:47], v[112:115], v[148:151], 0
    s_waitcnt lgkmcnt(4)
    v_mfma_f32_16x16x32_bf16 v[48:51], v[116:119], v[144:147], 0
    ds_read_b128 v[136:139], v2 offset:47104
    v_mfma_f32_16x16x32_bf16 v[52:55], v[116:119], v[148:151], 0
    s_waitcnt lgkmcnt(4)
    v_mfma_f32_16x16x32_bf16 v[56:59], v[120:123], v[144:147], 0
    ds_read_b128 v[140:143], v2 offset:48128
    v_mfma_f32_16x16x32_bf16 v[60:63], v[120:123], v[148:151], 0
    s_waitcnt lgkmcnt(4)
    v_mfma_f32_16x16x32_bf16 v[64:67], v[124:127], v[144:147], 0
    ds_read_b128 v[112:115], v6 offset:0
    v_mfma_f32_16x16x32_bf16 v[68:71], v[124:127], v[148:151], 0
    s_waitcnt lgkmcnt(4)
    v_mfma_f32_16x16x32_bf16 v[72:75], v[128:131], v[144:147], 0
    s_barrier
    ds_read_b128 v[116:119], v5 offset:34816
    v_mfma_f32_16x16x32_bf16 v[76:79], v[128:131], v[148:151], 0
    ds_read_b64_tr_b16 v[152:153], v9 offset:32768
    ds_read_b64_tr_b16 v[154:155], v9 offset:40960
    s_waitcnt lgkmcnt(6)
    v_mfma_f32_16x16x32_bf16 v[80:83], v[132:135], v[144:147], 0
    ds_read_b128 v[120:123], v5 offset:35840
    v_mfma_f32_16x16x32_bf16 v[84:87], v[132:135], v[148:151], 0
    ds_read_b64_tr_b16 v[156:157], v11 offset:32768
    ds_read_b64_tr_b16 v[158:159], v11 offset:40960
    s_waitcnt lgkmcnt(8)
    v_mfma_f32_16x16x32_bf16 v[88:91], v[136:139], v[144:147], 0
    ds_read_b128 v[124:127], v5 offset:38912
    v_mfma_f32_16x16x32_bf16 v[92:95], v[136:139], v[148:151], 0
    s_waitcnt lgkmcnt(8)
    v_mfma_f32_16x16x32_bf16 v[96:99], v[140:143], v[144:147], 0
    ds_read_b128 v[128:131], v5 offset:39936
    v_mfma_f32_16x16x32_bf16 v[100:103], v[140:143], v[148:151], 0
    s_waitcnt lgkmcnt(8)
    v_mfma_f32_16x16x32_bf16 v[104:107], v[112:115], v[144:147], 0
    ds_read_b128 v[132:135], v5 offset:43008
    v_mfma_f32_16x16x32_bf16 v[108:111], v[112:115], v[148:151], 0
    s_waitcnt lgkmcnt(3)
    v_mfma_f32_16x16x32_bf16 v[40:43], v[116:119], v[152:155], v[40:43]
    ds_read_b128 v[136:139], v5 offset:44032
    v_mfma_f32_16x16x32_bf16 v[44:47], v[116:119], v[156:159], v[44:47]
    v_mfma_f32_16x16x32_bf16 v[48:51], v[120:123], v[152:155], v[48:51]
    ds_read_b128 v[140:143], v5 offset:47104
    v_mfma_f32_16x16x32_bf16 v[52:55], v[120:123], v[156:159], v[52:55]
    s_waitcnt lgkmcnt(4)
    v_mfma_f32_16x16x32_bf16 v[56:59], v[124:127], v[152:155], v[56:59]
    ds_read_b128 v[112:115], v5 offset:48128
    v_mfma_f32_16x16x32_bf16 v[60:63], v[124:127], v[156:159], v[60:63]
    s_waitcnt lgkmcnt(4)
    v_mfma_f32_16x16x32_bf16 v[64:67], v[128:131], v[152:155], v[64:67]
    ds_read_b128 v[116:119], v6 offset:1024
    v_mfma_f32_16x16x32_bf16 v[68:71], v[128:131], v[156:159], v[68:71]
    s_waitcnt lgkmcnt(4)
    v_mfma_f32_16x16x32_bf16 v[72:75], v[132:135], v[152:155], v[72:75]
    s_barrier
    ds_read_b128 v[120:123], v2 offset:51200
    v_mfma_f32_16x16x32_bf16 v[76:79], v[132:135], v[156:159], v[76:79]
    ds_read_b64_tr_b16 v[160:161], v8 offset:49152
    ds_read_b64_tr_b16 v[162:163], v8 offset:57344
    s_waitcnt lgkmcnt(6)
    v_mfma_f32_16x16x32_bf16 v[80:83], v[136:139], v[152:155], v[80:83]
    ds_read_b128 v[124:127], v2 offset:52224
    v_mfma_f32_16x16x32_bf16 v[84:87], v[136:139], v[156:159], v[84:87]
    ds_read_b64_tr_b16 v[164:165], v10 offset:49152
    ds_read_b64_tr_b16 v[166:167], v10 offset:57344
    s_waitcnt lgkmcnt(8)
    v_mfma_f32_16x16x32_bf16 v[88:91], v[140:143], v[152:155], v[88:91]
    ds_read_b128 v[128:131], v2 offset:55296
    v_mfma_f32_16x16x32_bf16 v[92:95], v[140:143], v[156:159], v[92:95]
    s_waitcnt lgkmcnt(8)
    v_mfma_f32_16x16x32_bf16 v[96:99], v[112:115], v[152:155], v[96:99]
    ds_read_b128 v[132:135], v2 offset:56320
    v_mfma_f32_16x16x32_bf16 v[100:103], v[112:115], v[156:159], v[100:103]
    s_waitcnt lgkmcnt(8)
    v_mfma_f32_16x16x32_bf16 v[104:107], v[116:119], v[152:155], v[104:107]
    ds_read_b128 v[136:139], v2 offset:59392
    v_mfma_f32_16x16x32_bf16 v[108:111], v[116:119], v[156:159], v[108:111]
    s_waitcnt lgkmcnt(3)
    v_mfma_f32_16x16x32_bf16 v[40:43], v[120:123], v[160:163], v[40:43]
    ds_read_b128 v[140:143], v2 offset:60416
    v_mfma_f32_16x16x32_bf16 v[44:47], v[120:123], v[164:167], v[44:47]
    v_mfma_f32_16x16x32_bf16 v[48:51], v[124:127], v[160:163], v[48:51]
    ds_read_b128 v[112:115], v2 offset:63488
    v_mfma_f32_16x16x32_bf16 v[52:55], v[124:127], v[164:167], v[52:55]
    s_waitcnt lgkmcnt(4)
    v_mfma_f32_16x16x32_bf16 v[56:59], v[128:131], v[160:163], v[56:59]
    ds_read_b128 v[116:119], v2 offset:64512
    v_mfma_f32_16x16x32_bf16 v[60:63], v[128:131], v[164:167], v[60:63]
    s_waitcnt lgkmcnt(4)
    v_mfma_f32_16x16x32_bf16 v[64:67], v[132:135], v[160:163], v[64:67]
    ds_read_b128 v[120:123], v6 offset:2048
    v_mfma_f32_16x16x32_bf16 v[68:71], v[132:135], v[164:167], v[68:71]
    s_waitcnt lgkmcnt(4)
    v_mfma_f32_16x16x32_bf16 v[72:75], v[136:139], v[160:163], v[72:75]
    s_barrier
    ds_read_b128 v[124:127], v5 offset:51200
    v_mfma_f32_16x16x32_bf16 v[76:79], v[136:139], v[164:167], v[76:79]
    ds_read_b64_tr_b16 v[168:169], v9 offset:49152
    ds_read_b64_tr_b16 v[170:171], v9 offset:57344
    s_waitcnt lgkmcnt(6)
    v_mfma_f32_16x16x32_bf16 v[80:83], v[140:143], v[160:163], v[80:83]
    ds_read_b128 v[128:131], v5 offset:52224
    v_mfma_f32_16x16x32_bf16 v[84:87], v[140:143], v[164:167], v[84:87]
    ds_read_b64_tr_b16 v[172:173], v11 offset:49152
    ds_read_b64_tr_b16 v[174:175], v11 offset:57344
    s_waitcnt lgkmcnt(8)
    v_mfma_f32_16x16x32_bf16 v[88:91], v[112:115], v[160:163], v[88:91]
    ds_read_b128 v[132:135], v5 offset:55296
    v_mfma_f32_16x16x32_bf16 v[92:95], v[112:115], v[164:167], v[92:95]
    s_waitcnt lgkmcnt(8)
    v_mfma_f32_16x16x32_bf16 v[96:99], v[116:119], v[160:163], v[96:99]
    ds_read_b128 v[136:139], v5 offset:56320
    v_mfma_f32_16x16x32_bf16 v[100:103], v[116:119], v[164:167], v[100:103]
    s_waitcnt lgkmcnt(8)
    v_mfma_f32_16x16x32_bf16 v[104:107], v[120:123], v[160:163], v[104:107]
    ds_read_b128 v[140:143], v5 offset:59392
    v_mfma_f32_16x16x32_bf16 v[108:111], v[120:123], v[164:167], v[108:111]
    s_waitcnt lgkmcnt(3)
    v_mfma_f32_16x16x32_bf16 v[40:43], v[124:127], v[168:171], v[40:43]
    ds_read_b128 v[112:115], v5 offset:60416
    v_mfma_f32_16x16x32_bf16 v[44:47], v[124:127], v[172:175], v[44:47]
    v_mfma_f32_16x16x32_bf16 v[48:51], v[128:131], v[168:171], v[48:51]
    ds_read_b128 v[116:119], v5 offset:63488
    v_mfma_f32_16x16x32_bf16 v[52:55], v[128:131], v[172:175], v[52:55]
    s_waitcnt lgkmcnt(4)
    v_mfma_f32_16x16x32_bf16 v[56:59], v[132:135], v[168:171], v[56:59]
    ds_read_b128 v[120:123], v5 offset:64512
    v_mfma_f32_16x16x32_bf16 v[60:63], v[132:135], v[172:175], v[60:63]
    s_waitcnt lgkmcnt(4)
    v_mfma_f32_16x16x32_bf16 v[64:67], v[136:139], v[168:171], v[64:67]
    ds_read_b128 v[124:127], v6 offset:3072
    v_mfma_f32_16x16x32_bf16 v[68:71], v[136:139], v[172:175], v[68:71]
    s_waitcnt lgkmcnt(4)
    v_mfma_f32_16x16x32_bf16 v[72:75], v[140:143], v[168:171], v[72:75]
    s_barrier
    ds_read_b128 v[128:131], v2 offset:2048
    v_mfma_f32_16x16x32_bf16 v[76:79], v[140:143], v[172:175], v[76:79]
    ds_read_b64_tr_b16 v[144:145], v8 offset:0
    ds_read_b64_tr_b16 v[146:147], v8 offset:8192
    s_waitcnt lgkmcnt(6)
    v_mfma_f32_16x16x32_bf16 v[80:83], v[112:115], v[168:171], v[80:83]
    ds_read_b128 v[132:135], v2 offset:3072
    v_mfma_f32_16x16x32_bf16 v[84:87], v[112:115], v[172:175], v[84:87]
    ds_read_b64_tr_b16 v[148:149], v10 offset:0
    ds_read_b64_tr_b16 v[150:151], v10 offset:8192
    s_waitcnt lgkmcnt(8)
    v_mfma_f32_16x16x32_bf16 v[88:91], v[116:119], v[168:171], v[88:91]
    ds_read_b128 v[136:139], v2 offset:6144
    v_mfma_f32_16x16x32_bf16 v[92:95], v[116:119], v[172:175], v[92:95]
    s_waitcnt lgkmcnt(8)
    v_mfma_f32_16x16x32_bf16 v[96:99], v[120:123], v[168:171], v[96:99]
    ds_read_b128 v[140:143], v2 offset:7168
    v_mfma_f32_16x16x32_bf16 v[100:103], v[120:123], v[172:175], v[100:103]
    s_waitcnt lgkmcnt(8)
    v_mfma_f32_16x16x32_bf16 v[104:107], v[124:127], v[168:171], v[104:107]
    ds_read_b128 v[112:115], v2 offset:10240
    v_mfma_f32_16x16x32_bf16 v[108:111], v[124:127], v[172:175], v[108:111]
    s_waitcnt lgkmcnt(3)
    v_mfma_f32_16x16x32_bf16 v[40:43], v[128:131], v[144:147], v[40:43]
    ds_read_b128 v[116:119], v2 offset:11264
    v_mfma_f32_16x16x32_bf16 v[44:47], v[128:131], v[148:151], v[44:47]
    v_mfma_f32_16x16x32_bf16 v[48:51], v[132:135], v[144:147], v[48:51]
    ds_read_b128 v[120:123], v2 offset:14336
    v_mfma_f32_16x16x32_bf16 v[52:55], v[132:135], v[148:151], v[52:55]
    s_waitcnt lgkmcnt(4)
    v_mfma_f32_16x16x32_bf16 v[56:59], v[136:139], v[144:147], v[56:59]
    ds_read_b128 v[124:127], v2 offset:15360
    v_mfma_f32_16x16x32_bf16 v[60:63], v[136:139], v[148:151], v[60:63]
    s_waitcnt lgkmcnt(4)
    v_mfma_f32_16x16x32_bf16 v[64:67], v[140:143], v[144:147], v[64:67]
    ds_read_b128 v[128:131], v6 offset:4096
    v_mfma_f32_16x16x32_bf16 v[68:71], v[140:143], v[148:151], v[68:71]
    s_waitcnt lgkmcnt(4)
    v_mfma_f32_16x16x32_bf16 v[72:75], v[112:115], v[144:147], v[72:75]
    s_barrier
    ds_read_b128 v[132:135], v2 offset:18432
    v_mfma_f32_16x16x32_bf16 v[76:79], v[112:115], v[148:151], v[76:79]
    ds_read_b64_tr_b16 v[152:153], v8 offset:16384
    ds_read_b64_tr_b16 v[154:155], v8 offset:24576
    s_waitcnt lgkmcnt(6)
    v_mfma_f32_16x16x32_bf16 v[80:83], v[116:119], v[144:147], v[80:83]
    ds_read_b128 v[136:139], v2 offset:19456
    v_mfma_f32_16x16x32_bf16 v[84:87], v[116:119], v[148:151], v[84:87]
    ds_read_b64_tr_b16 v[156:157], v10 offset:16384
    ds_read_b64_tr_b16 v[158:159], v10 offset:24576
    s_waitcnt lgkmcnt(8)
    v_mfma_f32_16x16x32_bf16 v[88:91], v[120:123], v[144:147], v[88:91]
    ds_read_b128 v[140:143], v2 offset:22528
    v_mfma_f32_16x16x32_bf16 v[92:95], v[120:123], v[148:151], v[92:95]
    s_waitcnt lgkmcnt(8)
    v_mfma_f32_16x16x32_bf16 v[96:99], v[124:127], v[144:147], v[96:99]
    ds_read_b128 v[112:115], v2 offset:23552
    v_mfma_f32_16x16x32_bf16 v[100:103], v[124:127], v[148:151], v[100:103]
    s_waitcnt lgkmcnt(8)
    v_mfma_f32_16x16x32_bf16 v[104:107], v[128:131], v[144:147], v[104:107]
    ds_read_b128 v[116:119], v2 offset:26624
    v_mfma_f32_16x16x32_bf16 v[108:111], v[128:131], v[148:151], v[108:111]
    s_waitcnt lgkmcnt(3)
    v_mfma_f32_16x16x32_bf16 v[40:43], v[132:135], v[152:155], v[40:43]
    ds_read_b128 v[120:123], v2 offset:27648
    v_mfma_f32_16x16x32_bf16 v[44:47], v[132:135], v[156:159], v[44:47]
    v_mfma_f32_16x16x32_bf16 v[48:51], v[136:139], v[152:155], v[48:51]
    ds_read_b128 v[124:127], v2 offset:30720
    v_mfma_f32_16x16x32_bf16 v[52:55], v[136:139], v[156:159], v[52:55]
    s_waitcnt lgkmcnt(4)
    v_mfma_f32_16x16x32_bf16 v[56:59], v[140:143], v[152:155], v[56:59]
    ds_read_b128 v[128:131], v2 offset:31744
    v_mfma_f32_16x16x32_bf16 v[60:63], v[140:143], v[156:159], v[60:63]
    s_waitcnt lgkmcnt(4)
    v_mfma_f32_16x16x32_bf16 v[64:67], v[112:115], v[152:155], v[64:67]
    ds_read_b128 v[132:135], v6 offset:5120
    v_mfma_f32_16x16x32_bf16 v[68:71], v[112:115], v[156:159], v[68:71]
    s_waitcnt lgkmcnt(4)
    v_mfma_f32_16x16x32_bf16 v[72:75], v[116:119], v[152:155], v[72:75]
    s_barrier
    ds_read_b128 v[136:139], v5 offset:2048
    v_mfma_f32_16x16x32_bf16 v[76:79], v[116:119], v[156:159], v[76:79]
    ds_read_b64_tr_b16 v[160:161], v9 offset:0
    ds_read_b64_tr_b16 v[162:163], v9 offset:8192
    s_waitcnt lgkmcnt(6)
    v_mfma_f32_16x16x32_bf16 v[80:83], v[120:123], v[152:155], v[80:83]
    ds_read_b128 v[140:143], v5 offset:3072
    v_mfma_f32_16x16x32_bf16 v[84:87], v[120:123], v[156:159], v[84:87]
    ds_read_b64_tr_b16 v[164:165], v11 offset:0
    ds_read_b64_tr_b16 v[166:167], v11 offset:8192
    s_waitcnt lgkmcnt(8)
    v_mfma_f32_16x16x32_bf16 v[88:91], v[124:127], v[152:155], v[88:91]
    ds_read_b128 v[112:115], v5 offset:6144
    v_mfma_f32_16x16x32_bf16 v[92:95], v[124:127], v[156:159], v[92:95]
    s_waitcnt lgkmcnt(8)
    v_mfma_f32_16x16x32_bf16 v[96:99], v[128:131], v[152:155], v[96:99]
    ds_read_b128 v[116:119], v5 offset:7168
    v_mfma_f32_16x16x32_bf16 v[100:103], v[128:131], v[156:159], v[100:103]
    s_waitcnt lgkmcnt(8)
    v_mfma_f32_16x16x32_bf16 v[104:107], v[132:135], v[152:155], v[104:107]
    ds_read_b128 v[120:123], v5 offset:10240
    v_mfma_f32_16x16x32_bf16 v[108:111], v[132:135], v[156:159], v[108:111]
    s_waitcnt lgkmcnt(3)
    v_mfma_f32_16x16x32_bf16 v[40:43], v[136:139], v[160:163], v[40:43]
    ds_read_b128 v[124:127], v5 offset:11264
    v_mfma_f32_16x16x32_bf16 v[44:47], v[136:139], v[164:167], v[44:47]
    v_mfma_f32_16x16x32_bf16 v[48:51], v[140:143], v[160:163], v[48:51]
    ds_read_b128 v[128:131], v5 offset:14336
    v_mfma_f32_16x16x32_bf16 v[52:55], v[140:143], v[164:167], v[52:55]
    s_waitcnt lgkmcnt(4)
    v_mfma_f32_16x16x32_bf16 v[56:59], v[112:115], v[160:163], v[56:59]
    ds_read_b128 v[132:135], v5 offset:15360
    v_mfma_f32_16x16x32_bf16 v[60:63], v[112:115], v[164:167], v[60:63]
    s_waitcnt lgkmcnt(4)
    v_mfma_f32_16x16x32_bf16 v[64:67], v[116:119], v[160:163], v[64:67]
    ds_read_b128 v[136:139], v6 offset:6144
    v_mfma_f32_16x16x32_bf16 v[68:71], v[116:119], v[164:167], v[68:71]
    s_waitcnt lgkmcnt(4)
    v_mfma_f32_16x16x32_bf16 v[72:75], v[120:123], v[160:163], v[72:75]
    s_barrier
    ds_read_b128 v[140:143], v5 offset:18432
    v_mfma_f32_16x16x32_bf16 v[76:79], v[120:123], v[164:167], v[76:79]
    ds_read_b64_tr_b16 v[168:169], v9 offset:16384
    ds_read_b64_tr_b16 v[170:171], v9 offset:24576
    s_waitcnt lgkmcnt(6)
    v_mfma_f32_16x16x32_bf16 v[80:83], v[124:127], v[160:163], v[80:83]
    ds_read_b128 v[112:115], v5 offset:19456
    v_mfma_f32_16x16x32_bf16 v[84:87], v[124:127], v[164:167], v[84:87]
    ds_read_b64_tr_b16 v[172:173], v11 offset:16384
    ds_read_b64_tr_b16 v[174:175], v11 offset:24576
    s_waitcnt lgkmcnt(8)
    v_mfma_f32_16x16x32_bf16 v[88:91], v[128:131], v[160:163], v[88:91]
    ds_read_b128 v[116:119], v5 offset:22528
    v_mfma_f32_16x16x32_bf16 v[92:95], v[128:131], v[164:167], v[92:95]
    s_waitcnt lgkmcnt(8)
    v_mfma_f32_16x16x32_bf16 v[96:99], v[132:135], v[160:163], v[96:99]
    ds_read_b128 v[120:123], v5 offset:23552
    v_mfma_f32_16x16x32_bf16 v[100:103], v[132:135], v[164:167], v[100:103]
    s_waitcnt lgkmcnt(8)
    v_mfma_f32_16x16x32_bf16 v[104:107], v[136:139], v[160:163], v[104:107]
    ds_read_b128 v[124:127], v5 offset:26624
    v_mfma_f32_16x16x32_bf16 v[108:111], v[136:139], v[164:167], v[108:111]
    s_waitcnt lgkmcnt(3)
    v_mfma_f32_16x16x32_bf16 v[40:43], v[140:143], v[168:171], v[40:43]
    ds_read_b128 v[128:131], v5 offset:27648
    v_mfma_f32_16x16x32_bf16 v[44:47], v[140:143], v[172:175], v[44:47]
    v_mfma_f32_16x16x32_bf16 v[48:51], v[112:115], v[168:171], v[48:51]
    ds_read_b128 v[132:135], v5 offset:30720
    v_mfma_f32_16x16x32_bf16 v[52:55], v[112:115], v[172:175], v[52:55]
    s_waitcnt lgkmcnt(4)
    v_mfma_f32_16x16x32_bf16 v[56:59], v[116:119], v[168:171], v[56:59]
    ds_read_b128 v[136:139], v5 offset:31744
    v_mfma_f32_16x16x32_bf16 v[60:63], v[116:119], v[172:175], v[60:63]
    s_waitcnt lgkmcnt(4)
    v_mfma_f32_16x16x32_bf16 v[64:67], v[120:123], v[168:171], v[64:67]
    ds_read_b128 v[140:143], v6 offset:7168
    v_mfma_f32_16x16x32_bf16 v[68:71], v[120:123], v[172:175], v[68:71]
    s_waitcnt lgkmcnt(4)
    v_mfma_f32_16x16x32_bf16 v[72:75], v[124:127], v[168:171], v[72:75]
    s_barrier
    ds_read_b128 v[112:115], v2 offset:34816
    v_mfma_f32_16x16x32_bf16 v[76:79], v[124:127], v[172:175], v[76:79]
    ds_read_b64_tr_b16 v[144:145], v8 offset:32768
    ds_read_b64_tr_b16 v[146:147], v8 offset:40960
    s_waitcnt lgkmcnt(6)
    v_mfma_f32_16x16x32_bf16 v[80:83], v[128:131], v[168:171], v[80:83]
    ds_read_b128 v[116:119], v2 offset:35840
    v_mfma_f32_16x16x32_bf16 v[84:87], v[128:131], v[172:175], v[84:87]
    ds_read_b64_tr_b16 v[148:149], v10 offset:32768
    ds_read_b64_tr_b16 v[150:151], v10 offset:40960
    s_waitcnt lgkmcnt(8)
    v_mfma_f32_16x16x32_bf16 v[88:91], v[132:135], v[168:171], v[88:91]
    ds_read_b128 v[120:123], v2 offset:38912
    v_mfma_f32_16x16x32_bf16 v[92:95], v[132:135], v[172:175], v[92:95]
    s_waitcnt lgkmcnt(8)
    v_mfma_f32_16x16x32_bf16 v[96:99], v[136:139], v[168:171], v[96:99]
    ds_read_b128 v[124:127], v2 offset:39936
    v_mfma_f32_16x16x32_bf16 v[100:103], v[136:139], v[172:175], v[100:103]
    s_waitcnt lgkmcnt(8)
    v_mfma_f32_16x16x32_bf16 v[104:107], v[140:143], v[168:171], v[104:107]
    ds_read_b128 v[128:131], v2 offset:43008
    v_mfma_f32_16x16x32_bf16 v[108:111], v[140:143], v[172:175], v[108:111]
    s_waitcnt lgkmcnt(3)
    v_mfma_f32_16x16x32_bf16 v[40:43], v[112:115], v[144:147], v[40:43]
    ds_read_b128 v[132:135], v2 offset:44032
    v_mfma_f32_16x16x32_bf16 v[44:47], v[112:115], v[148:151], v[44:47]
    v_mfma_f32_16x16x32_bf16 v[48:51], v[116:119], v[144:147], v[48:51]
    ds_read_b128 v[136:139], v2 offset:47104
    v_mfma_f32_16x16x32_bf16 v[52:55], v[116:119], v[148:151], v[52:55]
    s_waitcnt lgkmcnt(4)
    v_mfma_f32_16x16x32_bf16 v[56:59], v[120:123], v[144:147], v[56:59]
    ds_read_b128 v[140:143], v2 offset:48128
    buffer_load_dwordx4 v[176:179], v2, s[20:23], s42 offen sc1
    v_mfma_f32_16x16x32_bf16 v[60:63], v[120:123], v[148:151], v[60:63]
    s_waitcnt lgkmcnt(4)
    v_mfma_f32_16x16x32_bf16 v[64:67], v[124:127], v[144:147], v[64:67]
    ds_read_b128 v[112:115], v6 offset:8192
    buffer_load_dwordx4 v[180:183], v2, s[20:23], s42 offen offset:1024 sc1
    v_mfma_f32_16x16x32_bf16 v[68:71], v[124:127], v[148:151], v[68:71]
    s_waitcnt lgkmcnt(4)
    v_mfma_f32_16x16x32_bf16 v[72:75], v[128:131], v[144:147], v[72:75]
    s_barrier
    ds_read_b128 v[116:119], v5 offset:34816
    buffer_load_dwordx4 v[184:187], v2, s[20:23], s46 offen sc1
    v_mfma_f32_16x16x32_bf16 v[76:79], v[128:131], v[148:151], v[76:79]
    ds_read_b64_tr_b16 v[152:153], v9 offset:32768
    ds_read_b64_tr_b16 v[154:155], v9 offset:40960
    s_waitcnt lgkmcnt(6)
    v_mfma_f32_16x16x32_bf16 v[80:83], v[132:135], v[144:147], v[80:83]
    ds_read_b128 v[120:123], v5 offset:35840
    buffer_load_ushort v194, v16, s[24:27], s43 offen
    v_mfma_f32_16x16x32_bf16 v[84:87], v[132:135], v[148:151], v[84:87]
    ds_read_b64_tr_b16 v[156:157], v11 offset:32768
    ds_read_b64_tr_b16 v[158:159], v11 offset:40960
    s_waitcnt lgkmcnt(8)
    v_mfma_f32_16x16x32_bf16 v[88:91], v[136:139], v[144:147], v[88:91]
    ds_read_b128 v[124:127], v5 offset:38912
    buffer_load_ushort v199, v16, s[24:27], s43 offen offset:32
    v_mfma_f32_16x16x32_bf16 v[92:95], v[136:139], v[148:151], v[92:95]
    s_waitcnt lgkmcnt(8)
    v_mfma_f32_16x16x32_bf16 v[96:99], v[140:143], v[144:147], v[96:99]
    ds_read_b128 v[128:131], v5 offset:39936
    v_mfma_f32_16x16x32_bf16 v[100:103], v[140:143], v[148:151], v[100:103]
    s_waitcnt lgkmcnt(8)
    v_mfma_f32_16x16x32_bf16 v[104:107], v[112:115], v[144:147], v[104:107]
    ds_read_b128 v[132:135], v5 offset:43008
    v_mfma_f32_16x16x32_bf16 v[108:111], v[112:115], v[148:151], v[108:111]
    s_waitcnt lgkmcnt(3)
    v_mfma_f32_16x16x32_bf16 v[40:43], v[116:119], v[152:155], v[40:43]
    ds_read_b128 v[136:139], v5 offset:44032
    v_mfma_f32_16x16x32_bf16 v[44:47], v[116:119], v[156:159], v[44:47]
    v_mfma_f32_16x16x32_bf16 v[48:51], v[120:123], v[152:155], v[48:51]
    ds_read_b128 v[140:143], v5 offset:47104
    v_mfma_f32_16x16x32_bf16 v[52:55], v[120:123], v[156:159], v[52:55]
    s_waitcnt lgkmcnt(4)
    v_mfma_f32_16x16x32_bf16 v[56:59], v[124:127], v[152:155], v[56:59]
    ds_read_b128 v[112:115], v5 offset:48128
    v_mfma_f32_16x16x32_bf16 v[60:63], v[124:127], v[156:159], v[60:63]
    s_waitcnt lgkmcnt(4)
    v_mfma_f32_16x16x32_bf16 v[64:67], v[128:131], v[152:155], v[64:67]
    ds_read_b128 v[116:119], v6 offset:9216
    v_mfma_f32_16x16x32_bf16 v[68:71], v[128:131], v[156:159], v[68:71]
    s_waitcnt lgkmcnt(4)
    v_mfma_f32_16x16x32_bf16 v[72:75], v[132:135], v[152:155], v[72:75]
    s_barrier
    ds_read_b128 v[120:123], v2 offset:51200
    v_mfma_f32_16x16x32_bf16 v[76:79], v[132:135], v[156:159], v[76:79]
    ds_read_b64_tr_b16 v[160:161], v8 offset:49152
    ds_read_b64_tr_b16 v[162:163], v8 offset:57344
    s_waitcnt lgkmcnt(6)
    v_mfma_f32_16x16x32_bf16 v[80:83], v[136:139], v[152:155], v[80:83]
    ds_read_b128 v[124:127], v2 offset:52224
    v_mfma_f32_16x16x32_bf16 v[84:87], v[136:139], v[156:159], v[84:87]
    ds_read_b64_tr_b16 v[164:165], v10 offset:49152
    ds_read_b64_tr_b16 v[166:167], v10 offset:57344
    s_waitcnt lgkmcnt(8)
    v_mfma_f32_16x16x32_bf16 v[88:91], v[140:143], v[152:155], v[88:91]
    ds_read_b128 v[128:131], v2 offset:55296
    v_mfma_f32_16x16x32_bf16 v[92:95], v[140:143], v[156:159], v[92:95]
    s_waitcnt lgkmcnt(8)
    v_mfma_f32_16x16x32_bf16 v[96:99], v[112:115], v[152:155], v[96:99]
    ds_read_b128 v[132:135], v2 offset:56320
    v_mfma_f32_16x16x32_bf16 v[100:103], v[112:115], v[156:159], v[100:103]
    s_waitcnt lgkmcnt(8)
    v_mfma_f32_16x16x32_bf16 v[104:107], v[116:119], v[152:155], v[104:107]
    ds_read_b128 v[136:139], v2 offset:59392
    v_mfma_f32_16x16x32_bf16 v[108:111], v[116:119], v[156:159], v[108:111]
    s_waitcnt lgkmcnt(3)
    v_mfma_f32_16x16x32_bf16 v[40:43], v[120:123], v[160:163], v[40:43]
    ds_read_b128 v[140:143], v2 offset:60416
    v_mfma_f32_16x16x32_bf16 v[44:47], v[120:123], v[164:167], v[44:47]
    v_mfma_f32_16x16x32_bf16 v[48:51], v[124:127], v[160:163], v[48:51]
    ds_read_b128 v[112:115], v2 offset:63488
    v_mfma_f32_16x16x32_bf16 v[52:55], v[124:127], v[164:167], v[52:55]
    s_waitcnt lgkmcnt(4)
    v_mfma_f32_16x16x32_bf16 v[56:59], v[128:131], v[160:163], v[56:59]
    ds_read_b128 v[116:119], v2 offset:64512
    v_mfma_f32_16x16x32_bf16 v[60:63], v[128:131], v[164:167], v[60:63]
    s_waitcnt lgkmcnt(4)
    v_mfma_f32_16x16x32_bf16 v[64:67], v[132:135], v[160:163], v[64:67]
    ds_read_b128 v[120:123], v6 offset:10240
    v_mfma_f32_16x16x32_bf16 v[68:71], v[132:135], v[164:167], v[68:71]
    s_waitcnt lgkmcnt(4)
    v_mfma_f32_16x16x32_bf16 v[72:75], v[136:139], v[160:163], v[72:75]
    s_barrier
    ds_read_b128 v[124:127], v5 offset:51200
    v_mfma_f32_16x16x32_bf16 v[76:79], v[136:139], v[164:167], v[76:79]
    ds_read_b64_tr_b16 v[168:169], v9 offset:49152
    ds_read_b64_tr_b16 v[170:171], v9 offset:57344
    s_waitcnt lgkmcnt(6)
    v_mfma_f32_16x16x32_bf16 v[80:83], v[140:143], v[160:163], v[80:83]
    ds_read_b128 v[128:131], v5 offset:52224
    v_mfma_f32_16x16x32_bf16 v[84:87], v[140:143], v[164:167], v[84:87]
    ds_read_b64_tr_b16 v[172:173], v11 offset:49152
    ds_read_b64_tr_b16 v[174:175], v11 offset:57344
    s_waitcnt lgkmcnt(8)
    v_mfma_f32_16x16x32_bf16 v[88:91], v[112:115], v[160:163], v[88:91]
    ds_read_b128 v[132:135], v5 offset:55296
    v_mfma_f32_16x16x32_bf16 v[92:95], v[112:115], v[164:167], v[92:95]
    s_waitcnt lgkmcnt(8)
    v_mfma_f32_16x16x32_bf16 v[96:99], v[116:119], v[160:163], v[96:99]
    ds_read_b128 v[136:139], v5 offset:56320
    v_mfma_f32_16x16x32_bf16 v[100:103], v[116:119], v[164:167], v[100:103]
    s_waitcnt lgkmcnt(8)
    v_mfma_f32_16x16x32_bf16 v[104:107], v[120:123], v[160:163], v[104:107]
    ds_read_b128 v[140:143], v5 offset:59392
    v_mfma_f32_16x16x32_bf16 v[108:111], v[120:123], v[164:167], v[108:111]
    s_waitcnt lgkmcnt(3)
    v_mfma_f32_16x16x32_bf16 v[40:43], v[124:127], v[168:171], v[40:43]
    ds_read_b128 v[112:115], v5 offset:60416
    v_mfma_f32_16x16x32_bf16 v[44:47], v[124:127], v[172:175], v[44:47]
    v_mfma_f32_16x16x32_bf16 v[48:51], v[128:131], v[168:171], v[48:51]
    ds_read_b128 v[116:119], v5 offset:63488
    v_mfma_f32_16x16x32_bf16 v[52:55], v[128:131], v[172:175], v[52:55]
    s_waitcnt lgkmcnt(4)
    v_mfma_f32_16x16x32_bf16 v[56:59], v[132:135], v[168:171], v[56:59]
    ds_read_b128 v[120:123], v5 offset:64512
    v_mfma_f32_16x16x32_bf16 v[60:63], v[132:135], v[172:175], v[60:63]
    s_waitcnt lgkmcnt(4)
    v_mfma_f32_16x16x32_bf16 v[64:67], v[136:139], v[168:171], v[64:67]
    ds_read_b128 v[124:127], v6 offset:11264
    v_mfma_f32_16x16x32_bf16 v[68:71], v[136:139], v[172:175], v[68:71]
    s_waitcnt lgkmcnt(4)
    v_mfma_f32_16x16x32_bf16 v[72:75], v[140:143], v[168:171], v[72:75]
    s_barrier
    ds_read_b128 v[128:131], v2 offset:2048
    v_mfma_f32_16x16x32_bf16 v[76:79], v[140:143], v[172:175], v[76:79]
    ds_read_b64_tr_b16 v[144:145], v8 offset:0
    ds_read_b64_tr_b16 v[146:147], v8 offset:8192
    s_waitcnt lgkmcnt(6)
    v_mfma_f32_16x16x32_bf16 v[80:83], v[112:115], v[168:171], v[80:83]
    ds_read_b128 v[132:135], v2 offset:3072
    v_mfma_f32_16x16x32_bf16 v[84:87], v[112:115], v[172:175], v[84:87]
    ds_read_b64_tr_b16 v[148:149], v10 offset:0
    ds_read_b64_tr_b16 v[150:151], v10 offset:8192
    s_waitcnt lgkmcnt(8)
    v_mfma_f32_16x16x32_bf16 v[88:91], v[116:119], v[168:171], v[88:91]
    ds_read_b128 v[136:139], v2 offset:6144
    v_mfma_f32_16x16x32_bf16 v[92:95], v[116:119], v[172:175], v[92:95]
    s_waitcnt lgkmcnt(8)
    v_mfma_f32_16x16x32_bf16 v[96:99], v[120:123], v[168:171], v[96:99]
    ds_read_b128 v[140:143], v2 offset:7168
    v_mfma_f32_16x16x32_bf16 v[100:103], v[120:123], v[172:175], v[100:103]
    s_waitcnt lgkmcnt(8)
    v_mfma_f32_16x16x32_bf16 v[104:107], v[124:127], v[168:171], v[104:107]
    ds_read_b128 v[112:115], v2 offset:10240
    v_mfma_f32_16x16x32_bf16 v[108:111], v[124:127], v[172:175], v[108:111]
    s_waitcnt lgkmcnt(3)
    v_mfma_f32_16x16x32_bf16 v[40:43], v[128:131], v[144:147], v[40:43]
    ds_read_b128 v[116:119], v2 offset:11264
    v_mfma_f32_16x16x32_bf16 v[44:47], v[128:131], v[148:151], v[44:47]
    v_mfma_f32_16x16x32_bf16 v[48:51], v[132:135], v[144:147], v[48:51]
    ds_read_b128 v[120:123], v2 offset:14336
    v_mfma_f32_16x16x32_bf16 v[52:55], v[132:135], v[148:151], v[52:55]
    s_waitcnt lgkmcnt(4)
    v_mfma_f32_16x16x32_bf16 v[56:59], v[136:139], v[144:147], v[56:59]
    ds_read_b128 v[124:127], v2 offset:15360
    v_mfma_f32_16x16x32_bf16 v[60:63], v[136:139], v[148:151], v[60:63]
    s_waitcnt lgkmcnt(4)
    v_mfma_f32_16x16x32_bf16 v[64:67], v[140:143], v[144:147], v[64:67]
    ds_read_b128 v[128:131], v6 offset:0
    v_mfma_f32_16x16x32_bf16 v[68:71], v[140:143], v[148:151], v[68:71]
    s_waitcnt lgkmcnt(4)
    v_mfma_f32_16x16x32_bf16 v[72:75], v[112:115], v[144:147], v[72:75]
    s_barrier
    ds_read_b128 v[132:135], v2 offset:18432
    v_mfma_f32_16x16x32_bf16 v[76:79], v[112:115], v[148:151], v[76:79]
    ds_read_b64_tr_b16 v[152:153], v8 offset:16384
    ds_read_b64_tr_b16 v[154:155], v8 offset:24576
    s_waitcnt lgkmcnt(6)
    v_mfma_f32_16x16x32_bf16 v[80:83], v[116:119], v[144:147], v[80:83]
    ds_read_b128 v[136:139], v2 offset:19456
    v_mfma_f32_16x16x32_bf16 v[84:87], v[116:119], v[148:151], v[84:87]
    ds_read_b64_tr_b16 v[156:157], v10 offset:16384
    ds_read_b64_tr_b16 v[158:159], v10 offset:24576
    s_waitcnt lgkmcnt(8)
    v_mfma_f32_16x16x32_bf16 v[88:91], v[120:123], v[144:147], v[88:91]
    ds_read_b128 v[140:143], v2 offset:22528
    v_mfma_f32_16x16x32_bf16 v[92:95], v[120:123], v[148:151], v[92:95]
    s_waitcnt lgkmcnt(8)
    v_mfma_f32_16x16x32_bf16 v[96:99], v[124:127], v[144:147], v[96:99]
    ds_read_b128 v[112:115], v2 offset:23552
    v_mfma_f32_16x16x32_bf16 v[100:103], v[124:127], v[148:151], v[100:103]
    s_waitcnt lgkmcnt(8)
    v_mfma_f32_16x16x32_bf16 v[104:107], v[128:131], v[144:147], v[104:107]
    ds_read_b128 v[116:119], v2 offset:26624
    v_mfma_f32_16x16x32_bf16 v[108:111], v[128:131], v[148:151], v[108:111]
    s_waitcnt lgkmcnt(3)
    v_mfma_f32_16x16x32_bf16 v[40:43], v[132:135], v[152:155], v[40:43]
    ds_read_b128 v[120:123], v2 offset:27648
    v_mfma_f32_16x16x32_bf16 v[44:47], v[132:135], v[156:159], v[44:47]
    v_mfma_f32_16x16x32_bf16 v[48:51], v[136:139], v[152:155], v[48:51]
    ds_read_b128 v[124:127], v2 offset:30720
    v_mfma_f32_16x16x32_bf16 v[52:55], v[136:139], v[156:159], v[52:55]
    s_waitcnt lgkmcnt(4)
    v_mfma_f32_16x16x32_bf16 v[56:59], v[140:143], v[152:155], v[56:59]
    ds_read_b128 v[128:131], v2 offset:31744
    v_mfma_f32_16x16x32_bf16 v[60:63], v[140:143], v[156:159], v[60:63]
    s_waitcnt lgkmcnt(4)
    v_mfma_f32_16x16x32_bf16 v[64:67], v[112:115], v[152:155], v[64:67]
    ds_read_b128 v[132:135], v6 offset:1024
    v_mfma_f32_16x16x32_bf16 v[68:71], v[112:115], v[156:159], v[68:71]
    s_waitcnt lgkmcnt(4)
    v_mfma_f32_16x16x32_bf16 v[72:75], v[116:119], v[152:155], v[72:75]
    s_barrier
    ds_read_b128 v[136:139], v5 offset:2048
    v_mfma_f32_16x16x32_bf16 v[76:79], v[116:119], v[156:159], v[76:79]
    ds_read_b64_tr_b16 v[160:161], v9 offset:0
    ds_read_b64_tr_b16 v[162:163], v9 offset:8192
    s_waitcnt lgkmcnt(6)
    v_mfma_f32_16x16x32_bf16 v[80:83], v[120:123], v[152:155], v[80:83]
    ds_read_b128 v[140:143], v5 offset:3072
    v_mfma_f32_16x16x32_bf16 v[84:87], v[120:123], v[156:159], v[84:87]
    ds_read_b64_tr_b16 v[164:165], v11 offset:0
    ds_read_b64_tr_b16 v[166:167], v11 offset:8192
    s_waitcnt lgkmcnt(8)
    v_mfma_f32_16x16x32_bf16 v[88:91], v[124:127], v[152:155], v[88:91]
    ds_read_b128 v[112:115], v5 offset:6144
    v_mfma_f32_16x16x32_bf16 v[92:95], v[124:127], v[156:159], v[92:95]
    s_waitcnt lgkmcnt(8)
    v_mfma_f32_16x16x32_bf16 v[96:99], v[128:131], v[152:155], v[96:99]
    ds_read_b128 v[116:119], v5 offset:7168
    v_mfma_f32_16x16x32_bf16 v[100:103], v[128:131], v[156:159], v[100:103]
    s_waitcnt lgkmcnt(8)
    v_mfma_f32_16x16x32_bf16 v[104:107], v[132:135], v[152:155], v[104:107]
    ds_read_b128 v[120:123], v5 offset:10240
    v_mfma_f32_16x16x32_bf16 v[108:111], v[132:135], v[156:159], v[108:111]
    s_waitcnt lgkmcnt(3)
    v_mfma_f32_16x16x32_bf16 v[40:43], v[136:139], v[160:163], v[40:43]
    ds_read_b128 v[124:127], v5 offset:11264
    v_mfma_f32_16x16x32_bf16 v[44:47], v[136:139], v[164:167], v[44:47]
    v_mfma_f32_16x16x32_bf16 v[48:51], v[140:143], v[160:163], v[48:51]
    ds_read_b128 v[128:131], v5 offset:14336
    v_mfma_f32_16x16x32_bf16 v[52:55], v[140:143], v[164:167], v[52:55]
    s_waitcnt lgkmcnt(4)
    v_mfma_f32_16x16x32_bf16 v[56:59], v[112:115], v[160:163], v[56:59]
    ds_read_b128 v[132:135], v5 offset:15360
    v_mfma_f32_16x16x32_bf16 v[60:63], v[112:115], v[164:167], v[60:63]
    s_waitcnt lgkmcnt(4)
    v_mfma_f32_16x16x32_bf16 v[64:67], v[116:119], v[160:163], v[64:67]
    ds_read_b128 v[136:139], v6 offset:2048
    v_mfma_f32_16x16x32_bf16 v[68:71], v[116:119], v[164:167], v[68:71]
    s_waitcnt lgkmcnt(4)
    v_mfma_f32_16x16x32_bf16 v[72:75], v[120:123], v[160:163], v[72:75]
    s_barrier
    ds_read_b128 v[140:143], v5 offset:18432
    v_mfma_f32_16x16x32_bf16 v[76:79], v[120:123], v[164:167], v[76:79]
    ds_read_b64_tr_b16 v[168:169], v9 offset:16384
    ds_read_b64_tr_b16 v[170:171], v9 offset:24576
    s_waitcnt lgkmcnt(6)
    v_mfma_f32_16x16x32_bf16 v[80:83], v[124:127], v[160:163], v[80:83]
    ds_read_b128 v[112:115], v5 offset:19456
    v_mfma_f32_16x16x32_bf16 v[84:87], v[124:127], v[164:167], v[84:87]
    ds_read_b64_tr_b16 v[172:173], v11 offset:16384
    ds_read_b64_tr_b16 v[174:175], v11 offset:24576
    s_waitcnt lgkmcnt(8)
    v_mfma_f32_16x16x32_bf16 v[88:91], v[128:131], v[160:163], v[88:91]
    ds_read_b128 v[116:119], v5 offset:22528
    v_mfma_f32_16x16x32_bf16 v[92:95], v[128:131], v[164:167], v[92:95]
    s_waitcnt lgkmcnt(8)
    v_mfma_f32_16x16x32_bf16 v[96:99], v[132:135], v[160:163], v[96:99]
    ds_read_b128 v[120:123], v5 offset:23552
    v_mfma_f32_16x16x32_bf16 v[100:103], v[132:135], v[164:167], v[100:103]
    s_waitcnt lgkmcnt(8)
    v_mfma_f32_16x16x32_bf16 v[104:107], v[136:139], v[160:163], v[104:107]
    ds_read_b128 v[124:127], v5 offset:26624
    v_mfma_f32_16x16x32_bf16 v[108:111], v[136:139], v[164:167], v[108:111]
    s_waitcnt lgkmcnt(3)
    v_mfma_f32_16x16x32_bf16 v[40:43], v[140:143], v[168:171], v[40:43]
    ds_read_b128 v[128:131], v5 offset:27648
    v_mfma_f32_16x16x32_bf16 v[44:47], v[140:143], v[172:175], v[44:47]
    v_mfma_f32_16x16x32_bf16 v[48:51], v[112:115], v[168:171], v[48:51]
    ds_read_b128 v[132:135], v5 offset:30720
    v_mfma_f32_16x16x32_bf16 v[52:55], v[112:115], v[172:175], v[52:55]
    s_waitcnt lgkmcnt(4)
    v_mfma_f32_16x16x32_bf16 v[56:59], v[116:119], v[168:171], v[56:59]
    ds_read_b128 v[136:139], v5 offset:31744
    v_mfma_f32_16x16x32_bf16 v[60:63], v[116:119], v[172:175], v[60:63]
    s_waitcnt lgkmcnt(4)
    v_mfma_f32_16x16x32_bf16 v[64:67], v[120:123], v[168:171], v[64:67]
    ds_read_b128 v[140:143], v6 offset:3072
    v_mfma_f32_16x16x32_bf16 v[68:71], v[120:123], v[172:175], v[68:71]
    s_waitcnt lgkmcnt(4)
    v_mfma_f32_16x16x32_bf16 v[72:75], v[124:127], v[168:171], v[72:75]
    s_barrier
    ds_read_b128 v[112:115], v2 offset:34816
    v_mfma_f32_16x16x32_bf16 v[76:79], v[124:127], v[172:175], v[76:79]
    ds_read_b64_tr_b16 v[144:145], v8 offset:32768
    ds_read_b64_tr_b16 v[146:147], v8 offset:40960
    s_waitcnt lgkmcnt(6)
    v_mfma_f32_16x16x32_bf16 v[80:83], v[128:131], v[168:171], v[80:83]
    ds_read_b128 v[116:119], v2 offset:35840
    v_mfma_f32_16x16x32_bf16 v[84:87], v[128:131], v[172:175], v[84:87]
    ds_read_b64_tr_b16 v[148:149], v10 offset:32768
    ds_read_b64_tr_b16 v[150:151], v10 offset:40960
    s_waitcnt lgkmcnt(8)
    v_mfma_f32_16x16x32_bf16 v[88:91], v[132:135], v[168:171], v[88:91]
    ds_read_b128 v[120:123], v2 offset:38912
    v_mfma_f32_16x16x32_bf16 v[92:95], v[132:135], v[172:175], v[92:95]
    s_waitcnt lgkmcnt(8)
    v_mfma_f32_16x16x32_bf16 v[96:99], v[136:139], v[168:171], v[96:99]
    ds_read_b128 v[124:127], v2 offset:39936
    v_mfma_f32_16x16x32_bf16 v[100:103], v[136:139], v[172:175], v[100:103]
    s_waitcnt lgkmcnt(8)
    v_mfma_f32_16x16x32_bf16 v[104:107], v[140:143], v[168:171], v[104:107]
    ds_read_b128 v[128:131], v2 offset:43008
    v_mfma_f32_16x16x32_bf16 v[108:111], v[140:143], v[172:175], v[108:111]
    s_waitcnt lgkmcnt(3)
    v_mfma_f32_16x16x32_bf16 v[40:43], v[112:115], v[144:147], v[40:43]
    ds_read_b128 v[132:135], v2 offset:44032
    v_mfma_f32_16x16x32_bf16 v[44:47], v[112:115], v[148:151], v[44:47]
    v_mfma_f32_16x16x32_bf16 v[48:51], v[116:119], v[144:147], v[48:51]
    ds_read_b128 v[136:139], v2 offset:47104
    v_mfma_f32_16x16x32_bf16 v[52:55], v[116:119], v[148:151], v[52:55]
    s_waitcnt lgkmcnt(4)
    v_mfma_f32_16x16x32_bf16 v[56:59], v[120:123], v[144:147], v[56:59]
    ds_read_b128 v[140:143], v2 offset:48128
    v_mfma_f32_16x16x32_bf16 v[60:63], v[120:123], v[148:151], v[60:63]
    s_waitcnt lgkmcnt(4)
    v_mfma_f32_16x16x32_bf16 v[64:67], v[124:127], v[144:147], v[64:67]
    ds_read_b128 v[112:115], v6 offset:4096
    v_mfma_f32_16x16x32_bf16 v[68:71], v[124:127], v[148:151], v[68:71]
    s_waitcnt lgkmcnt(4)
    v_mfma_f32_16x16x32_bf16 v[72:75], v[128:131], v[144:147], v[72:75]
    s_barrier
    ds_read_b128 v[116:119], v5 offset:34816
    v_mfma_f32_16x16x32_bf16 v[76:79], v[128:131], v[148:151], v[76:79]
    ds_read_b64_tr_b16 v[152:153], v9 offset:32768
    ds_read_b64_tr_b16 v[154:155], v9 offset:40960
    s_waitcnt lgkmcnt(6)
    v_mfma_f32_16x16x32_bf16 v[80:83], v[132:135], v[144:147], v[80:83]
    ds_read_b128 v[120:123], v5 offset:35840
    v_mfma_f32_16x16x32_bf16 v[84:87], v[132:135], v[148:151], v[84:87]
    ds_read_b64_tr_b16 v[156:157], v11 offset:32768
    ds_read_b64_tr_b16 v[158:159], v11 offset:40960
    s_waitcnt lgkmcnt(8)
    v_mfma_f32_16x16x32_bf16 v[88:91], v[136:139], v[144:147], v[88:91]
    ds_read_b128 v[124:127], v5 offset:38912
    v_mfma_f32_16x16x32_bf16 v[92:95], v[136:139], v[148:151], v[92:95]
    s_waitcnt lgkmcnt(8)
    v_mfma_f32_16x16x32_bf16 v[96:99], v[140:143], v[144:147], v[96:99]
    ds_read_b128 v[128:131], v5 offset:39936
    v_mfma_f32_16x16x32_bf16 v[100:103], v[140:143], v[148:151], v[100:103]
    s_waitcnt lgkmcnt(8)
    v_mfma_f32_16x16x32_bf16 v[104:107], v[112:115], v[144:147], v[104:107]
    ds_read_b128 v[132:135], v5 offset:43008
    v_mfma_f32_16x16x32_bf16 v[108:111], v[112:115], v[148:151], v[108:111]
    s_waitcnt lgkmcnt(3)
    v_mfma_f32_16x16x32_bf16 v[40:43], v[116:119], v[152:155], v[40:43]
    ds_read_b128 v[136:139], v5 offset:44032
    v_mfma_f32_16x16x32_bf16 v[44:47], v[116:119], v[156:159], v[44:47]
    v_mfma_f32_16x16x32_bf16 v[48:51], v[120:123], v[152:155], v[48:51]
    ds_read_b128 v[140:143], v5 offset:47104
    v_mfma_f32_16x16x32_bf16 v[52:55], v[120:123], v[156:159], v[52:55]
    s_waitcnt lgkmcnt(4)
    v_mfma_f32_16x16x32_bf16 v[56:59], v[124:127], v[152:155], v[56:59]
    ds_read_b128 v[112:115], v5 offset:48128
    v_mfma_f32_16x16x32_bf16 v[60:63], v[124:127], v[156:159], v[60:63]
    s_waitcnt lgkmcnt(4)
    v_mfma_f32_16x16x32_bf16 v[64:67], v[128:131], v[152:155], v[64:67]
    ds_read_b128 v[116:119], v6 offset:5120
    v_mfma_f32_16x16x32_bf16 v[68:71], v[128:131], v[156:159], v[68:71]
    s_waitcnt lgkmcnt(4)
    v_mfma_f32_16x16x32_bf16 v[72:75], v[132:135], v[152:155], v[72:75]
    s_barrier
    ds_read_b128 v[120:123], v2 offset:51200
    v_mfma_f32_16x16x32_bf16 v[76:79], v[132:135], v[156:159], v[76:79]
    ds_read_b64_tr_b16 v[160:161], v8 offset:49152
    ds_read_b64_tr_b16 v[162:163], v8 offset:57344
    s_waitcnt lgkmcnt(6)
    v_mfma_f32_16x16x32_bf16 v[80:83], v[136:139], v[152:155], v[80:83]
    ds_read_b128 v[124:127], v2 offset:52224
    v_mfma_f32_16x16x32_bf16 v[84:87], v[136:139], v[156:159], v[84:87]
    ds_read_b64_tr_b16 v[164:165], v10 offset:49152
    ds_read_b64_tr_b16 v[166:167], v10 offset:57344
    s_waitcnt lgkmcnt(8)
    v_mfma_f32_16x16x32_bf16 v[88:91], v[140:143], v[152:155], v[88:91]
    ds_read_b128 v[128:131], v2 offset:55296
    v_mfma_f32_16x16x32_bf16 v[92:95], v[140:143], v[156:159], v[92:95]
    s_waitcnt lgkmcnt(8)
    v_mfma_f32_16x16x32_bf16 v[96:99], v[112:115], v[152:155], v[96:99]
    ds_read_b128 v[132:135], v2 offset:56320
    v_mfma_f32_16x16x32_bf16 v[100:103], v[112:115], v[156:159], v[100:103]
    s_waitcnt lgkmcnt(8)
    v_mfma_f32_16x16x32_bf16 v[104:107], v[116:119], v[152:155], v[104:107]
    ds_read_b128 v[136:139], v2 offset:59392
    v_mfma_f32_16x16x32_bf16 v[108:111], v[116:119], v[156:159], v[108:111]
    s_waitcnt lgkmcnt(3)
    v_mfma_f32_16x16x32_bf16 v[40:43], v[120:123], v[160:163], v[40:43]
    ds_read_b128 v[140:143], v2 offset:60416
    v_mfma_f32_16x16x32_bf16 v[44:47], v[120:123], v[164:167], v[44:47]
    v_mfma_f32_16x16x32_bf16 v[48:51], v[124:127], v[160:163], v[48:51]
    ds_read_b128 v[112:115], v2 offset:63488
    v_mfma_f32_16x16x32_bf16 v[52:55], v[124:127], v[164:167], v[52:55]
    s_waitcnt lgkmcnt(4)
    v_mfma_f32_16x16x32_bf16 v[56:59], v[128:131], v[160:163], v[56:59]
    ds_read_b128 v[116:119], v2 offset:64512
    v_mfma_f32_16x16x32_bf16 v[60:63], v[128:131], v[164:167], v[60:63]
    s_waitcnt lgkmcnt(4)
    v_mfma_f32_16x16x32_bf16 v[64:67], v[132:135], v[160:163], v[64:67]
    ds_read_b128 v[120:123], v6 offset:6144
    v_mfma_f32_16x16x32_bf16 v[68:71], v[132:135], v[164:167], v[68:71]
    s_waitcnt lgkmcnt(4)
    v_mfma_f32_16x16x32_bf16 v[72:75], v[136:139], v[160:163], v[72:75]
    s_barrier
    ds_read_b128 v[124:127], v5 offset:51200
    v_mfma_f32_16x16x32_bf16 v[76:79], v[136:139], v[164:167], v[76:79]
    ds_read_b64_tr_b16 v[168:169], v9 offset:49152
    ds_read_b64_tr_b16 v[170:171], v9 offset:57344
    s_waitcnt lgkmcnt(6)
    v_mfma_f32_16x16x32_bf16 v[80:83], v[140:143], v[160:163], v[80:83]
    ds_read_b128 v[128:131], v5 offset:52224
    v_mfma_f32_16x16x32_bf16 v[84:87], v[140:143], v[164:167], v[84:87]
    ds_read_b64_tr_b16 v[172:173], v11 offset:49152
    ds_read_b64_tr_b16 v[174:175], v11 offset:57344
    s_waitcnt lgkmcnt(8)
    v_mfma_f32_16x16x32_bf16 v[88:91], v[112:115], v[160:163], v[88:91]
    ds_read_b128 v[132:135], v5 offset:55296
    v_mfma_f32_16x16x32_bf16 v[92:95], v[112:115], v[164:167], v[92:95]
    s_waitcnt lgkmcnt(8)
    v_mfma_f32_16x16x32_bf16 v[96:99], v[116:119], v[160:163], v[96:99]
    ds_read_b128 v[136:139], v5 offset:56320
    v_mfma_f32_16x16x32_bf16 v[100:103], v[116:119], v[164:167], v[100:103]
    s_waitcnt lgkmcnt(8)
    v_mfma_f32_16x16x32_bf16 v[104:107], v[120:123], v[160:163], v[104:107]
    ds_read_b128 v[140:143], v5 offset:59392
    v_mfma_f32_16x16x32_bf16 v[108:111], v[120:123], v[164:167], v[108:111]
    s_waitcnt lgkmcnt(3)
    v_mfma_f32_16x16x32_bf16 v[40:43], v[124:127], v[168:171], v[40:43]
    ds_read_b128 v[112:115], v5 offset:60416
    v_mfma_f32_16x16x32_bf16 v[44:47], v[124:127], v[172:175], v[44:47]
    v_mfma_f32_16x16x32_bf16 v[48:51], v[128:131], v[168:171], v[48:51]
    ds_read_b128 v[116:119], v5 offset:63488
    v_mfma_f32_16x16x32_bf16 v[52:55], v[128:131], v[172:175], v[52:55]
    s_waitcnt lgkmcnt(4)
    v_mfma_f32_16x16x32_bf16 v[56:59], v[132:135], v[168:171], v[56:59]
    ds_read_b128 v[120:123], v5 offset:64512
    v_mfma_f32_16x16x32_bf16 v[60:63], v[132:135], v[172:175], v[60:63]
    s_waitcnt lgkmcnt(4)
    v_mfma_f32_16x16x32_bf16 v[64:67], v[136:139], v[168:171], v[64:67]
    ds_read_b128 v[124:127], v6 offset:7168
    v_mfma_f32_16x16x32_bf16 v[68:71], v[136:139], v[172:175], v[68:71]
    s_waitcnt lgkmcnt(4)
    v_mfma_f32_16x16x32_bf16 v[72:75], v[140:143], v[168:171], v[72:75]
    s_barrier
    ds_read_b128 v[128:131], v2 offset:2048
    v_mfma_f32_16x16x32_bf16 v[76:79], v[140:143], v[172:175], v[76:79]
    ds_read_b64_tr_b16 v[144:145], v8 offset:0
    ds_read_b64_tr_b16 v[146:147], v8 offset:8192
    s_waitcnt lgkmcnt(6)
    v_mfma_f32_16x16x32_bf16 v[80:83], v[112:115], v[168:171], v[80:83]
    ds_read_b128 v[132:135], v2 offset:3072
    v_mfma_f32_16x16x32_bf16 v[84:87], v[112:115], v[172:175], v[84:87]
    ds_read_b64_tr_b16 v[148:149], v10 offset:0
    ds_read_b64_tr_b16 v[150:151], v10 offset:8192
    s_waitcnt lgkmcnt(8)
    v_mfma_f32_16x16x32_bf16 v[88:91], v[116:119], v[168:171], v[88:91]
    ds_read_b128 v[136:139], v2 offset:6144
    v_mfma_f32_16x16x32_bf16 v[92:95], v[116:119], v[172:175], v[92:95]
    s_waitcnt lgkmcnt(8)
    v_mfma_f32_16x16x32_bf16 v[96:99], v[120:123], v[168:171], v[96:99]
    ds_read_b128 v[140:143], v2 offset:7168
    v_mfma_f32_16x16x32_bf16 v[100:103], v[120:123], v[172:175], v[100:103]
    s_waitcnt lgkmcnt(8)
    v_mfma_f32_16x16x32_bf16 v[104:107], v[124:127], v[168:171], v[104:107]
    ds_read_b128 v[112:115], v2 offset:10240
    v_mfma_f32_16x16x32_bf16 v[108:111], v[124:127], v[172:175], v[108:111]
    s_waitcnt lgkmcnt(3)
    v_mfma_f32_16x16x32_bf16 v[40:43], v[128:131], v[144:147], v[40:43]
    ds_read_b128 v[116:119], v2 offset:11264
    v_mfma_f32_16x16x32_bf16 v[44:47], v[128:131], v[148:151], v[44:47]
    v_mfma_f32_16x16x32_bf16 v[48:51], v[132:135], v[144:147], v[48:51]
    ds_read_b128 v[120:123], v2 offset:14336
    v_mfma_f32_16x16x32_bf16 v[52:55], v[132:135], v[148:151], v[52:55]
    s_waitcnt lgkmcnt(4)
    v_mfma_f32_16x16x32_bf16 v[56:59], v[136:139], v[144:147], v[56:59]
    ds_read_b128 v[124:127], v2 offset:15360
    v_mfma_f32_16x16x32_bf16 v[60:63], v[136:139], v[148:151], v[60:63]
    s_waitcnt lgkmcnt(4)
    v_mfma_f32_16x16x32_bf16 v[64:67], v[140:143], v[144:147], v[64:67]
    ds_read_b128 v[128:131], v6 offset:8192
    v_mfma_f32_16x16x32_bf16 v[68:71], v[140:143], v[148:151], v[68:71]
    s_waitcnt lgkmcnt(4)
    v_mfma_f32_16x16x32_bf16 v[72:75], v[112:115], v[144:147], v[72:75]
    s_barrier
    ds_read_b128 v[132:135], v2 offset:18432
    v_mfma_f32_16x16x32_bf16 v[76:79], v[112:115], v[148:151], v[76:79]
    ds_read_b64_tr_b16 v[152:153], v8 offset:16384
    ds_read_b64_tr_b16 v[154:155], v8 offset:24576
    s_waitcnt lgkmcnt(6)
    v_mfma_f32_16x16x32_bf16 v[80:83], v[116:119], v[144:147], v[80:83]
    ds_read_b128 v[136:139], v2 offset:19456
    v_mfma_f32_16x16x32_bf16 v[84:87], v[116:119], v[148:151], v[84:87]
    ds_read_b64_tr_b16 v[156:157], v10 offset:16384
    ds_read_b64_tr_b16 v[158:159], v10 offset:24576
    s_waitcnt lgkmcnt(8)
    v_mfma_f32_16x16x32_bf16 v[88:91], v[120:123], v[144:147], v[88:91]
    ds_read_b128 v[140:143], v2 offset:22528
    v_mfma_f32_16x16x32_bf16 v[92:95], v[120:123], v[148:151], v[92:95]
    s_waitcnt lgkmcnt(8)
    v_mfma_f32_16x16x32_bf16 v[96:99], v[124:127], v[144:147], v[96:99]
    ds_read_b128 v[112:115], v2 offset:23552
    v_mfma_f32_16x16x32_bf16 v[100:103], v[124:127], v[148:151], v[100:103]
    s_waitcnt lgkmcnt(8)
    v_mfma_f32_16x16x32_bf16 v[104:107], v[128:131], v[144:147], v[104:107]
    ds_read_b128 v[116:119], v2 offset:26624
    v_mfma_f32_16x16x32_bf16 v[108:111], v[128:131], v[148:151], v[108:111]
    s_waitcnt lgkmcnt(3)
    v_mfma_f32_16x16x32_bf16 v[40:43], v[132:135], v[152:155], v[40:43]
    ds_read_b128 v[120:123], v2 offset:27648
    v_mfma_f32_16x16x32_bf16 v[44:47], v[132:135], v[156:159], v[44:47]
    v_mfma_f32_16x16x32_bf16 v[48:51], v[136:139], v[152:155], v[48:51]
    ds_read_b128 v[124:127], v2 offset:30720
    v_mfma_f32_16x16x32_bf16 v[52:55], v[136:139], v[156:159], v[52:55]
    s_waitcnt lgkmcnt(4)
    v_mfma_f32_16x16x32_bf16 v[56:59], v[140:143], v[152:155], v[56:59]
    ds_read_b128 v[128:131], v2 offset:31744
    v_mfma_f32_16x16x32_bf16 v[60:63], v[140:143], v[156:159], v[60:63]
    s_waitcnt lgkmcnt(4)
    v_mfma_f32_16x16x32_bf16 v[64:67], v[112:115], v[152:155], v[64:67]
    ds_read_b128 v[132:135], v6 offset:9216
    v_mfma_f32_16x16x32_bf16 v[68:71], v[112:115], v[156:159], v[68:71]
    s_waitcnt lgkmcnt(4)
    v_mfma_f32_16x16x32_bf16 v[72:75], v[116:119], v[152:155], v[72:75]
    s_barrier
    ds_read_b128 v[136:139], v5 offset:2048
    v_mfma_f32_16x16x32_bf16 v[76:79], v[116:119], v[156:159], v[76:79]
    ds_read_b64_tr_b16 v[160:161], v9 offset:0
    ds_read_b64_tr_b16 v[162:163], v9 offset:8192
    s_waitcnt lgkmcnt(6)
    v_mfma_f32_16x16x32_bf16 v[80:83], v[120:123], v[152:155], v[80:83]
    ds_read_b128 v[140:143], v5 offset:3072
    v_mfma_f32_16x16x32_bf16 v[84:87], v[120:123], v[156:159], v[84:87]
    ds_read_b64_tr_b16 v[164:165], v11 offset:0
    ds_read_b64_tr_b16 v[166:167], v11 offset:8192
    s_waitcnt lgkmcnt(8)
    v_mfma_f32_16x16x32_bf16 v[88:91], v[124:127], v[152:155], v[88:91]
    ds_read_b128 v[112:115], v5 offset:6144
    v_mfma_f32_16x16x32_bf16 v[92:95], v[124:127], v[156:159], v[92:95]
    s_waitcnt lgkmcnt(8)
    v_mfma_f32_16x16x32_bf16 v[96:99], v[128:131], v[152:155], v[96:99]
    ds_read_b128 v[116:119], v5 offset:7168
    v_mfma_f32_16x16x32_bf16 v[100:103], v[128:131], v[156:159], v[100:103]
    s_waitcnt lgkmcnt(8)
    v_mfma_f32_16x16x32_bf16 v[104:107], v[132:135], v[152:155], v[104:107]
    ds_read_b128 v[120:123], v5 offset:10240
    v_mfma_f32_16x16x32_bf16 v[108:111], v[132:135], v[156:159], v[108:111]
    s_waitcnt lgkmcnt(3)
    v_mfma_f32_16x16x32_bf16 v[40:43], v[136:139], v[160:163], v[40:43]
    ds_read_b128 v[124:127], v5 offset:11264
    v_mfma_f32_16x16x32_bf16 v[44:47], v[136:139], v[164:167], v[44:47]
    v_mfma_f32_16x16x32_bf16 v[48:51], v[140:143], v[160:163], v[48:51]
    ds_read_b128 v[128:131], v5 offset:14336
    v_mfma_f32_16x16x32_bf16 v[52:55], v[140:143], v[164:167], v[52:55]
    s_waitcnt lgkmcnt(4)
    v_mfma_f32_16x16x32_bf16 v[56:59], v[112:115], v[160:163], v[56:59]
    ds_read_b128 v[132:135], v5 offset:15360
    v_mfma_f32_16x16x32_bf16 v[60:63], v[112:115], v[164:167], v[60:63]
    s_waitcnt lgkmcnt(4)
    v_mfma_f32_16x16x32_bf16 v[64:67], v[116:119], v[160:163], v[64:67]
    ds_read_b128 v[136:139], v6 offset:10240
    v_mfma_f32_16x16x32_bf16 v[68:71], v[116:119], v[164:167], v[68:71]
    s_waitcnt lgkmcnt(4)
    v_mfma_f32_16x16x32_bf16 v[72:75], v[120:123], v[160:163], v[72:75]
    s_barrier
    ds_read_b128 v[140:143], v5 offset:18432
    v_mfma_f32_16x16x32_bf16 v[76:79], v[120:123], v[164:167], v[76:79]
    ds_read_b64_tr_b16 v[168:169], v9 offset:16384
    ds_read_b64_tr_b16 v[170:171], v9 offset:24576
    s_waitcnt lgkmcnt(6)
    v_mfma_f32_16x16x32_bf16 v[80:83], v[124:127], v[160:163], v[80:83]
    ds_read_b128 v[112:115], v5 offset:19456
    v_mfma_f32_16x16x32_bf16 v[84:87], v[124:127], v[164:167], v[84:87]
    ds_read_b64_tr_b16 v[172:173], v11 offset:16384
    ds_read_b64_tr_b16 v[174:175], v11 offset:24576
    s_waitcnt lgkmcnt(8)
    v_mfma_f32_16x16x32_bf16 v[88:91], v[128:131], v[160:163], v[88:91]
    ds_read_b128 v[116:119], v5 offset:22528
    v_mfma_f32_16x16x32_bf16 v[92:95], v[128:131], v[164:167], v[92:95]
    s_waitcnt lgkmcnt(8)
    v_mfma_f32_16x16x32_bf16 v[96:99], v[132:135], v[160:163], v[96:99]
    ds_read_b128 v[120:123], v5 offset:23552
    v_mfma_f32_16x16x32_bf16 v[100:103], v[132:135], v[164:167], v[100:103]
    s_waitcnt lgkmcnt(8)
    v_mfma_f32_16x16x32_bf16 v[104:107], v[136:139], v[160:163], v[104:107]
    ds_read_b128 v[124:127], v5 offset:26624
    v_mfma_f32_16x16x32_bf16 v[108:111], v[136:139], v[164:167], v[108:111]
    s_waitcnt lgkmcnt(3)
    v_mfma_f32_16x16x32_bf16 v[40:43], v[140:143], v[168:171], v[40:43]
    ds_read_b128 v[128:131], v5 offset:27648
    v_mfma_f32_16x16x32_bf16 v[44:47], v[140:143], v[172:175], v[44:47]
    v_mfma_f32_16x16x32_bf16 v[48:51], v[112:115], v[168:171], v[48:51]
    ds_read_b128 v[132:135], v5 offset:30720
    v_mfma_f32_16x16x32_bf16 v[52:55], v[112:115], v[172:175], v[52:55]
    s_waitcnt lgkmcnt(4)
    v_mfma_f32_16x16x32_bf16 v[56:59], v[116:119], v[168:171], v[56:59]
    ds_read_b128 v[136:139], v5 offset:31744
    v_mfma_f32_16x16x32_bf16 v[60:63], v[116:119], v[172:175], v[60:63]
    s_waitcnt lgkmcnt(4)
    v_mfma_f32_16x16x32_bf16 v[64:67], v[120:123], v[168:171], v[64:67]
    ds_read_b128 v[140:143], v6 offset:11264
    v_mfma_f32_16x16x32_bf16 v[68:71], v[120:123], v[172:175], v[68:71]
    s_waitcnt lgkmcnt(4)
    v_mfma_f32_16x16x32_bf16 v[72:75], v[124:127], v[168:171], v[72:75]
    s_barrier
    ds_read_b128 v[112:115], v2 offset:34816
    v_mfma_f32_16x16x32_bf16 v[76:79], v[124:127], v[172:175], v[76:79]
    ds_read_b64_tr_b16 v[144:145], v8 offset:32768
    ds_read_b64_tr_b16 v[146:147], v8 offset:40960
    s_waitcnt lgkmcnt(6)
    v_mfma_f32_16x16x32_bf16 v[80:83], v[128:131], v[168:171], v[80:83]
    ds_read_b128 v[116:119], v2 offset:35840
    v_mfma_f32_16x16x32_bf16 v[84:87], v[128:131], v[172:175], v[84:87]
    ds_read_b64_tr_b16 v[148:149], v10 offset:32768
    ds_read_b64_tr_b16 v[150:151], v10 offset:40960
    s_waitcnt lgkmcnt(8)
    v_mfma_f32_16x16x32_bf16 v[88:91], v[132:135], v[168:171], v[88:91]
    ds_read_b128 v[120:123], v2 offset:38912
    v_mfma_f32_16x16x32_bf16 v[92:95], v[132:135], v[172:175], v[92:95]
    s_waitcnt lgkmcnt(8)
    v_mfma_f32_16x16x32_bf16 v[96:99], v[136:139], v[168:171], v[96:99]
    ds_read_b128 v[124:127], v2 offset:39936
    v_mfma_f32_16x16x32_bf16 v[100:103], v[136:139], v[172:175], v[100:103]
    s_waitcnt lgkmcnt(8)
    v_mfma_f32_16x16x32_bf16 v[104:107], v[140:143], v[168:171], v[104:107]
    ds_read_b128 v[128:131], v2 offset:43008
    v_mfma_f32_16x16x32_bf16 v[108:111], v[140:143], v[172:175], v[108:111]
    s_waitcnt lgkmcnt(3)
    v_mfma_f32_16x16x32_bf16 v[40:43], v[112:115], v[144:147], v[40:43]
    ds_read_b128 v[132:135], v2 offset:44032
    v_mfma_f32_16x16x32_bf16 v[44:47], v[112:115], v[148:151], v[44:47]
    v_mfma_f32_16x16x32_bf16 v[48:51], v[116:119], v[144:147], v[48:51]
    ds_read_b128 v[136:139], v2 offset:47104
    v_mfma_f32_16x16x32_bf16 v[52:55], v[116:119], v[148:151], v[52:55]
    s_waitcnt lgkmcnt(4)
    v_mfma_f32_16x16x32_bf16 v[56:59], v[120:123], v[144:147], v[56:59]
    ds_read_b128 v[140:143], v2 offset:48128
    v_mfma_f32_16x16x32_bf16 v[60:63], v[120:123], v[148:151], v[60:63]
    s_waitcnt lgkmcnt(4)
    v_mfma_f32_16x16x32_bf16 v[64:67], v[124:127], v[144:147], v[64:67]
    ds_read_b128 v[112:115], v6 offset:0
    v_mfma_f32_16x16x32_bf16 v[68:71], v[124:127], v[148:151], v[68:71]
    s_waitcnt lgkmcnt(4)
    v_mfma_f32_16x16x32_bf16 v[72:75], v[128:131], v[144:147], v[72:75]
    s_barrier
    ds_read_b128 v[116:119], v5 offset:34816
    v_mfma_f32_16x16x32_bf16 v[76:79], v[128:131], v[148:151], v[76:79]
    ds_read_b64_tr_b16 v[152:153], v9 offset:32768
    ds_read_b64_tr_b16 v[154:155], v9 offset:40960
    s_waitcnt lgkmcnt(6)
    v_mfma_f32_16x16x32_bf16 v[80:83], v[132:135], v[144:147], v[80:83]
    ds_read_b128 v[120:123], v5 offset:35840
    v_mfma_f32_16x16x32_bf16 v[84:87], v[132:135], v[148:151], v[84:87]
    ds_read_b64_tr_b16 v[156:157], v11 offset:32768
    ds_read_b64_tr_b16 v[158:159], v11 offset:40960
    s_waitcnt lgkmcnt(8)
    v_mfma_f32_16x16x32_bf16 v[88:91], v[136:139], v[144:147], v[88:91]
    ds_read_b128 v[124:127], v5 offset:38912
    v_mfma_f32_16x16x32_bf16 v[92:95], v[136:139], v[148:151], v[92:95]
    s_waitcnt lgkmcnt(8)
    v_mfma_f32_16x16x32_bf16 v[96:99], v[140:143], v[144:147], v[96:99]
    ds_read_b128 v[128:131], v5 offset:39936
    v_mfma_f32_16x16x32_bf16 v[100:103], v[140:143], v[148:151], v[100:103]
    s_waitcnt lgkmcnt(8)
    v_mfma_f32_16x16x32_bf16 v[104:107], v[112:115], v[144:147], v[104:107]
    ds_read_b128 v[132:135], v5 offset:43008
    v_mfma_f32_16x16x32_bf16 v[108:111], v[112:115], v[148:151], v[108:111]
    s_waitcnt lgkmcnt(3)
    v_mfma_f32_16x16x32_bf16 v[40:43], v[116:119], v[152:155], v[40:43]
    ds_read_b128 v[136:139], v5 offset:44032
    v_mfma_f32_16x16x32_bf16 v[44:47], v[116:119], v[156:159], v[44:47]
    v_mfma_f32_16x16x32_bf16 v[48:51], v[120:123], v[152:155], v[48:51]
    ds_read_b128 v[140:143], v5 offset:47104
    v_mfma_f32_16x16x32_bf16 v[52:55], v[120:123], v[156:159], v[52:55]
    s_waitcnt lgkmcnt(4)
    v_mfma_f32_16x16x32_bf16 v[56:59], v[124:127], v[152:155], v[56:59]
    ds_read_b128 v[112:115], v5 offset:48128
    v_mfma_f32_16x16x32_bf16 v[60:63], v[124:127], v[156:159], v[60:63]
    s_waitcnt lgkmcnt(4)
    v_mfma_f32_16x16x32_bf16 v[64:67], v[128:131], v[152:155], v[64:67]
    ds_read_b128 v[116:119], v6 offset:1024
    v_mfma_f32_16x16x32_bf16 v[68:71], v[128:131], v[156:159], v[68:71]
    s_waitcnt lgkmcnt(4)
    v_mfma_f32_16x16x32_bf16 v[72:75], v[132:135], v[152:155], v[72:75]
    s_barrier
    ds_read_b128 v[120:123], v2 offset:51200
    v_mfma_f32_16x16x32_bf16 v[76:79], v[132:135], v[156:159], v[76:79]
    ds_read_b64_tr_b16 v[160:161], v8 offset:49152
    ds_read_b64_tr_b16 v[162:163], v8 offset:57344
    s_waitcnt lgkmcnt(6)
    v_mfma_f32_16x16x32_bf16 v[80:83], v[136:139], v[152:155], v[80:83]
    ds_read_b128 v[124:127], v2 offset:52224
    v_mfma_f32_16x16x32_bf16 v[84:87], v[136:139], v[156:159], v[84:87]
    ds_read_b64_tr_b16 v[164:165], v10 offset:49152
    ds_read_b64_tr_b16 v[166:167], v10 offset:57344
    s_waitcnt lgkmcnt(8)
    v_mfma_f32_16x16x32_bf16 v[88:91], v[140:143], v[152:155], v[88:91]
    ds_read_b128 v[128:131], v2 offset:55296
    v_mfma_f32_16x16x32_bf16 v[92:95], v[140:143], v[156:159], v[92:95]
    s_waitcnt lgkmcnt(8)
    v_mfma_f32_16x16x32_bf16 v[96:99], v[112:115], v[152:155], v[96:99]
    ds_read_b128 v[132:135], v2 offset:56320
    v_mfma_f32_16x16x32_bf16 v[100:103], v[112:115], v[156:159], v[100:103]
    s_waitcnt lgkmcnt(8)
    v_mfma_f32_16x16x32_bf16 v[104:107], v[116:119], v[152:155], v[104:107]
    ds_read_b128 v[136:139], v2 offset:59392
    v_mfma_f32_16x16x32_bf16 v[108:111], v[116:119], v[156:159], v[108:111]
    s_waitcnt lgkmcnt(3)
    v_mfma_f32_16x16x32_bf16 v[40:43], v[120:123], v[160:163], v[40:43]
    ds_read_b128 v[140:143], v2 offset:60416
    v_mfma_f32_16x16x32_bf16 v[44:47], v[120:123], v[164:167], v[44:47]
    v_mfma_f32_16x16x32_bf16 v[48:51], v[124:127], v[160:163], v[48:51]
    ds_read_b128 v[112:115], v2 offset:63488
    v_mfma_f32_16x16x32_bf16 v[52:55], v[124:127], v[164:167], v[52:55]
    s_waitcnt lgkmcnt(4)
    v_mfma_f32_16x16x32_bf16 v[56:59], v[128:131], v[160:163], v[56:59]
    ds_read_b128 v[116:119], v2 offset:64512
    v_mfma_f32_16x16x32_bf16 v[60:63], v[128:131], v[164:167], v[60:63]
    s_waitcnt lgkmcnt(4)
    v_mfma_f32_16x16x32_bf16 v[64:67], v[132:135], v[160:163], v[64:67]
    ds_read_b128 v[120:123], v6 offset:2048
    v_mfma_f32_16x16x32_bf16 v[68:71], v[132:135], v[164:167], v[68:71]
    s_waitcnt lgkmcnt(4)
    v_mfma_f32_16x16x32_bf16 v[72:75], v[136:139], v[160:163], v[72:75]
    s_barrier
    ds_read_b128 v[124:127], v5 offset:51200
    v_mfma_f32_16x16x32_bf16 v[76:79], v[136:139], v[164:167], v[76:79]
    ds_read_b64_tr_b16 v[168:169], v9 offset:49152
    ds_read_b64_tr_b16 v[170:171], v9 offset:57344
    s_waitcnt lgkmcnt(6)
    v_mfma_f32_16x16x32_bf16 v[80:83], v[140:143], v[160:163], v[80:83]
    ds_read_b128 v[128:131], v5 offset:52224
    v_mfma_f32_16x16x32_bf16 v[84:87], v[140:143], v[164:167], v[84:87]
    ds_read_b64_tr_b16 v[172:173], v11 offset:49152
    ds_read_b64_tr_b16 v[174:175], v11 offset:57344
    s_waitcnt lgkmcnt(8)
    v_mfma_f32_16x16x32_bf16 v[88:91], v[112:115], v[160:163], v[88:91]
    ds_read_b128 v[132:135], v5 offset:55296
    v_mfma_f32_16x16x32_bf16 v[92:95], v[112:115], v[164:167], v[92:95]
    s_waitcnt lgkmcnt(8)
    v_mfma_f32_16x16x32_bf16 v[96:99], v[116:119], v[160:163], v[96:99]
    ds_read_b128 v[136:139], v5 offset:56320
    v_mfma_f32_16x16x32_bf16 v[100:103], v[116:119], v[164:167], v[100:103]
    s_waitcnt lgkmcnt(8)
    v_mfma_f32_16x16x32_bf16 v[104:107], v[120:123], v[160:163], v[104:107]
    ds_read_b128 v[140:143], v5 offset:59392
    v_mfma_f32_16x16x32_bf16 v[108:111], v[120:123], v[164:167], v[108:111]
    s_waitcnt lgkmcnt(3)
    v_mfma_f32_16x16x32_bf16 v[40:43], v[124:127], v[168:171], v[40:43]
    ds_read_b128 v[112:115], v5 offset:60416
    v_mfma_f32_16x16x32_bf16 v[44:47], v[124:127], v[172:175], v[44:47]
    v_mfma_f32_16x16x32_bf16 v[48:51], v[128:131], v[168:171], v[48:51]
    ds_read_b128 v[116:119], v5 offset:63488
    v_mfma_f32_16x16x32_bf16 v[52:55], v[128:131], v[172:175], v[52:55]
    s_waitcnt lgkmcnt(4)
    v_mfma_f32_16x16x32_bf16 v[56:59], v[132:135], v[168:171], v[56:59]
    ds_read_b128 v[120:123], v5 offset:64512
    v_mfma_f32_16x16x32_bf16 v[60:63], v[132:135], v[172:175], v[60:63]
    s_waitcnt lgkmcnt(4)
    v_mfma_f32_16x16x32_bf16 v[64:67], v[136:139], v[168:171], v[64:67]
    ds_read_b128 v[124:127], v6 offset:3072
    v_mfma_f32_16x16x32_bf16 v[68:71], v[136:139], v[172:175], v[68:71]
    s_waitcnt lgkmcnt(4)
    v_mfma_f32_16x16x32_bf16 v[72:75], v[140:143], v[168:171], v[72:75]
    s_barrier
    ds_read_b128 v[128:131], v2 offset:2048
    v_mfma_f32_16x16x32_bf16 v[76:79], v[140:143], v[172:175], v[76:79]
    ds_read_b64_tr_b16 v[144:145], v8 offset:0
    ds_read_b64_tr_b16 v[146:147], v8 offset:8192
    s_waitcnt lgkmcnt(6)
    v_mfma_f32_16x16x32_bf16 v[80:83], v[112:115], v[168:171], v[80:83]
    ds_read_b128 v[132:135], v2 offset:3072
    v_mfma_f32_16x16x32_bf16 v[84:87], v[112:115], v[172:175], v[84:87]
    ds_read_b64_tr_b16 v[148:149], v10 offset:0
    ds_read_b64_tr_b16 v[150:151], v10 offset:8192
    s_waitcnt lgkmcnt(8)
    v_mfma_f32_16x16x32_bf16 v[88:91], v[116:119], v[168:171], v[88:91]
    ds_read_b128 v[136:139], v2 offset:6144
    v_mfma_f32_16x16x32_bf16 v[92:95], v[116:119], v[172:175], v[92:95]
    s_waitcnt lgkmcnt(8)
    v_mfma_f32_16x16x32_bf16 v[96:99], v[120:123], v[168:171], v[96:99]
    ds_read_b128 v[140:143], v2 offset:7168
    v_mfma_f32_16x16x32_bf16 v[100:103], v[120:123], v[172:175], v[100:103]
    s_waitcnt lgkmcnt(8)
    v_mfma_f32_16x16x32_bf16 v[104:107], v[124:127], v[168:171], v[104:107]
    ds_read_b128 v[112:115], v2 offset:10240
    v_mfma_f32_16x16x32_bf16 v[108:111], v[124:127], v[172:175], v[108:111]
    s_waitcnt lgkmcnt(3)
    v_mfma_f32_16x16x32_bf16 v[40:43], v[128:131], v[144:147], v[40:43]
    ds_read_b128 v[116:119], v2 offset:11264
    v_mfma_f32_16x16x32_bf16 v[44:47], v[128:131], v[148:151], v[44:47]
    v_mfma_f32_16x16x32_bf16 v[48:51], v[132:135], v[144:147], v[48:51]
    ds_read_b128 v[120:123], v2 offset:14336
    v_mfma_f32_16x16x32_bf16 v[52:55], v[132:135], v[148:151], v[52:55]
    s_waitcnt lgkmcnt(4)
    v_mfma_f32_16x16x32_bf16 v[56:59], v[136:139], v[144:147], v[56:59]
    ds_read_b128 v[124:127], v2 offset:15360
    v_mfma_f32_16x16x32_bf16 v[60:63], v[136:139], v[148:151], v[60:63]
    s_waitcnt lgkmcnt(4)
    v_mfma_f32_16x16x32_bf16 v[64:67], v[140:143], v[144:147], v[64:67]
    ds_read_b128 v[128:131], v6 offset:4096
    v_mfma_f32_16x16x32_bf16 v[68:71], v[140:143], v[148:151], v[68:71]
    s_waitcnt lgkmcnt(4)
    v_mfma_f32_16x16x32_bf16 v[72:75], v[112:115], v[144:147], v[72:75]
    s_barrier
    ds_read_b128 v[132:135], v2 offset:18432
    v_mfma_f32_16x16x32_bf16 v[76:79], v[112:115], v[148:151], v[76:79]
    ds_read_b64_tr_b16 v[152:153], v8 offset:16384
    ds_read_b64_tr_b16 v[154:155], v8 offset:24576
    s_waitcnt lgkmcnt(6)
    v_mfma_f32_16x16x32_bf16 v[80:83], v[116:119], v[144:147], v[80:83]
    ds_read_b128 v[136:139], v2 offset:19456
    v_mfma_f32_16x16x32_bf16 v[84:87], v[116:119], v[148:151], v[84:87]
    ds_read_b64_tr_b16 v[156:157], v10 offset:16384
    ds_read_b64_tr_b16 v[158:159], v10 offset:24576
    s_waitcnt lgkmcnt(8)
    v_mfma_f32_16x16x32_bf16 v[88:91], v[120:123], v[144:147], v[88:91]
    ds_read_b128 v[140:143], v2 offset:22528
    v_mfma_f32_16x16x32_bf16 v[92:95], v[120:123], v[148:151], v[92:95]
    s_waitcnt lgkmcnt(8)
    v_mfma_f32_16x16x32_bf16 v[96:99], v[124:127], v[144:147], v[96:99]
    ds_read_b128 v[112:115], v2 offset:23552
    v_mfma_f32_16x16x32_bf16 v[100:103], v[124:127], v[148:151], v[100:103]
    s_waitcnt lgkmcnt(8)
    v_mfma_f32_16x16x32_bf16 v[104:107], v[128:131], v[144:147], v[104:107]
    ds_read_b128 v[116:119], v2 offset:26624
    v_mfma_f32_16x16x32_bf16 v[108:111], v[128:131], v[148:151], v[108:111]
    s_waitcnt lgkmcnt(3)
    v_mfma_f32_16x16x32_bf16 v[40:43], v[132:135], v[152:155], v[40:43]
    ds_read_b128 v[120:123], v2 offset:27648
    v_mfma_f32_16x16x32_bf16 v[44:47], v[132:135], v[156:159], v[44:47]
    v_mfma_f32_16x16x32_bf16 v[48:51], v[136:139], v[152:155], v[48:51]
    ds_read_b128 v[124:127], v2 offset:30720
    v_mfma_f32_16x16x32_bf16 v[52:55], v[136:139], v[156:159], v[52:55]
    s_waitcnt lgkmcnt(4)
    v_mfma_f32_16x16x32_bf16 v[56:59], v[140:143], v[152:155], v[56:59]
    ds_read_b128 v[128:131], v2 offset:31744
    v_mfma_f32_16x16x32_bf16 v[60:63], v[140:143], v[156:159], v[60:63]
    s_waitcnt lgkmcnt(4)
    v_mfma_f32_16x16x32_bf16 v[64:67], v[112:115], v[152:155], v[64:67]
    ds_read_b128 v[132:135], v6 offset:5120
    v_mfma_f32_16x16x32_bf16 v[68:71], v[112:115], v[156:159], v[68:71]
    s_waitcnt lgkmcnt(4)
    v_mfma_f32_16x16x32_bf16 v[72:75], v[116:119], v[152:155], v[72:75]
    s_barrier
    ds_read_b128 v[136:139], v5 offset:2048
    v_mfma_f32_16x16x32_bf16 v[76:79], v[116:119], v[156:159], v[76:79]
    ds_read_b64_tr_b16 v[160:161], v9 offset:0
    ds_read_b64_tr_b16 v[162:163], v9 offset:8192
    s_waitcnt lgkmcnt(6)
    v_mfma_f32_16x16x32_bf16 v[80:83], v[120:123], v[152:155], v[80:83]
    ds_read_b128 v[140:143], v5 offset:3072
    v_mfma_f32_16x16x32_bf16 v[84:87], v[120:123], v[156:159], v[84:87]
    ds_read_b64_tr_b16 v[164:165], v11 offset:0
    ds_read_b64_tr_b16 v[166:167], v11 offset:8192
    s_waitcnt lgkmcnt(8)
    v_mfma_f32_16x16x32_bf16 v[88:91], v[124:127], v[152:155], v[88:91]
    ds_read_b128 v[112:115], v5 offset:6144
    v_mfma_f32_16x16x32_bf16 v[92:95], v[124:127], v[156:159], v[92:95]
    s_waitcnt lgkmcnt(8)
    v_mfma_f32_16x16x32_bf16 v[96:99], v[128:131], v[152:155], v[96:99]
    ds_read_b128 v[116:119], v5 offset:7168
    v_mfma_f32_16x16x32_bf16 v[100:103], v[128:131], v[156:159], v[100:103]
    s_waitcnt lgkmcnt(8)
    v_mfma_f32_16x16x32_bf16 v[104:107], v[132:135], v[152:155], v[104:107]
    ds_read_b128 v[120:123], v5 offset:10240
    v_mfma_f32_16x16x32_bf16 v[108:111], v[132:135], v[156:159], v[108:111]
    s_waitcnt lgkmcnt(3)
    v_mfma_f32_16x16x32_bf16 v[40:43], v[136:139], v[160:163], v[40:43]
    ds_read_b128 v[124:127], v5 offset:11264
    v_mfma_f32_16x16x32_bf16 v[44:47], v[136:139], v[164:167], v[44:47]
    v_mfma_f32_16x16x32_bf16 v[48:51], v[140:143], v[160:163], v[48:51]
    ds_read_b128 v[128:131], v5 offset:14336
    v_mfma_f32_16x16x32_bf16 v[52:55], v[140:143], v[164:167], v[52:55]
    s_waitcnt lgkmcnt(4)
    v_mfma_f32_16x16x32_bf16 v[56:59], v[112:115], v[160:163], v[56:59]
    ds_read_b128 v[132:135], v5 offset:15360
    v_mfma_f32_16x16x32_bf16 v[60:63], v[112:115], v[164:167], v[60:63]
    s_waitcnt lgkmcnt(4)
    v_mfma_f32_16x16x32_bf16 v[64:67], v[116:119], v[160:163], v[64:67]
    ds_read_b128 v[136:139], v6 offset:6144
    v_mfma_f32_16x16x32_bf16 v[68:71], v[116:119], v[164:167], v[68:71]
    s_waitcnt lgkmcnt(4)
    v_mfma_f32_16x16x32_bf16 v[72:75], v[120:123], v[160:163], v[72:75]
    s_barrier
    ds_read_b128 v[140:143], v5 offset:18432
    v_mfma_f32_16x16x32_bf16 v[76:79], v[120:123], v[164:167], v[76:79]
    ds_read_b64_tr_b16 v[168:169], v9 offset:16384
    ds_read_b64_tr_b16 v[170:171], v9 offset:24576
    s_waitcnt lgkmcnt(6)
    v_mfma_f32_16x16x32_bf16 v[80:83], v[124:127], v[160:163], v[80:83]
    ds_read_b128 v[112:115], v5 offset:19456
    v_mfma_f32_16x16x32_bf16 v[84:87], v[124:127], v[164:167], v[84:87]
    ds_read_b64_tr_b16 v[172:173], v11 offset:16384
    ds_read_b64_tr_b16 v[174:175], v11 offset:24576
    s_waitcnt lgkmcnt(8)
    v_mfma_f32_16x16x32_bf16 v[88:91], v[128:131], v[160:163], v[88:91]
    ds_read_b128 v[116:119], v5 offset:22528
    v_mfma_f32_16x16x32_bf16 v[92:95], v[128:131], v[164:167], v[92:95]
    s_waitcnt lgkmcnt(8)
    v_mfma_f32_16x16x32_bf16 v[96:99], v[132:135], v[160:163], v[96:99]
    ds_read_b128 v[120:123], v5 offset:23552
    v_mfma_f32_16x16x32_bf16 v[100:103], v[132:135], v[164:167], v[100:103]
    s_waitcnt lgkmcnt(8)
    v_mfma_f32_16x16x32_bf16 v[104:107], v[136:139], v[160:163], v[104:107]
    ds_read_b128 v[124:127], v5 offset:26624
    v_mfma_f32_16x16x32_bf16 v[108:111], v[136:139], v[164:167], v[108:111]
    s_waitcnt lgkmcnt(3)
    v_mfma_f32_16x16x32_bf16 v[40:43], v[140:143], v[168:171], v[40:43]
    ds_read_b128 v[128:131], v5 offset:27648
    v_mfma_f32_16x16x32_bf16 v[44:47], v[140:143], v[172:175], v[44:47]
    v_mfma_f32_16x16x32_bf16 v[48:51], v[112:115], v[168:171], v[48:51]
    ds_read_b128 v[132:135], v5 offset:30720
    v_mfma_f32_16x16x32_bf16 v[52:55], v[112:115], v[172:175], v[52:55]
    s_waitcnt lgkmcnt(4)
    v_mfma_f32_16x16x32_bf16 v[56:59], v[116:119], v[168:171], v[56:59]
    ds_read_b128 v[136:139], v5 offset:31744
    v_mfma_f32_16x16x32_bf16 v[60:63], v[116:119], v[172:175], v[60:63]
    s_waitcnt lgkmcnt(4)
    v_mfma_f32_16x16x32_bf16 v[64:67], v[120:123], v[168:171], v[64:67]
    ds_read_b128 v[140:143], v6 offset:7168
    v_mfma_f32_16x16x32_bf16 v[68:71], v[120:123], v[172:175], v[68:71]
    s_waitcnt lgkmcnt(4)
    v_mfma_f32_16x16x32_bf16 v[72:75], v[124:127], v[168:171], v[72:75]
    s_barrier
    ds_read_b128 v[112:115], v2 offset:34816
    v_mfma_f32_16x16x32_bf16 v[76:79], v[124:127], v[172:175], v[76:79]
    ds_read_b64_tr_b16 v[144:145], v8 offset:32768
    ds_read_b64_tr_b16 v[146:147], v8 offset:40960
    s_waitcnt lgkmcnt(6)
    v_mfma_f32_16x16x32_bf16 v[80:83], v[128:131], v[168:171], v[80:83]
    ds_read_b128 v[116:119], v2 offset:35840
    v_mfma_f32_16x16x32_bf16 v[84:87], v[128:131], v[172:175], v[84:87]
    ds_read_b64_tr_b16 v[148:149], v10 offset:32768
    ds_read_b64_tr_b16 v[150:151], v10 offset:40960
    s_waitcnt lgkmcnt(8)
    v_mfma_f32_16x16x32_bf16 v[88:91], v[132:135], v[168:171], v[88:91]
    ds_read_b128 v[120:123], v2 offset:38912
    v_mfma_f32_16x16x32_bf16 v[92:95], v[132:135], v[172:175], v[92:95]
    s_waitcnt lgkmcnt(8)
    v_mfma_f32_16x16x32_bf16 v[96:99], v[136:139], v[168:171], v[96:99]
    ds_read_b128 v[124:127], v2 offset:39936
    v_mfma_f32_16x16x32_bf16 v[100:103], v[136:139], v[172:175], v[100:103]
    s_waitcnt lgkmcnt(8)
    v_mfma_f32_16x16x32_bf16 v[104:107], v[140:143], v[168:171], v[104:107]
    ds_read_b128 v[128:131], v2 offset:43008
    v_mfma_f32_16x16x32_bf16 v[108:111], v[140:143], v[172:175], v[108:111]
    s_waitcnt lgkmcnt(3)
    v_mfma_f32_16x16x32_bf16 v[40:43], v[112:115], v[144:147], v[40:43]
    ds_read_b128 v[132:135], v2 offset:44032
    v_mfma_f32_16x16x32_bf16 v[44:47], v[112:115], v[148:151], v[44:47]
    v_mfma_f32_16x16x32_bf16 v[48:51], v[116:119], v[144:147], v[48:51]
    ds_read_b128 v[136:139], v2 offset:47104
    v_mfma_f32_16x16x32_bf16 v[52:55], v[116:119], v[148:151], v[52:55]
    s_waitcnt lgkmcnt(4)
    v_mfma_f32_16x16x32_bf16 v[56:59], v[120:123], v[144:147], v[56:59]
    ds_read_b128 v[140:143], v2 offset:48128
    v_mfma_f32_16x16x32_bf16 v[60:63], v[120:123], v[148:151], v[60:63]
    s_waitcnt lgkmcnt(4)
    v_mfma_f32_16x16x32_bf16 v[64:67], v[124:127], v[144:147], v[64:67]
    ds_read_b128 v[112:115], v6 offset:8192
    v_mfma_f32_16x16x32_bf16 v[68:71], v[124:127], v[148:151], v[68:71]
    s_waitcnt lgkmcnt(4)
    v_mfma_f32_16x16x32_bf16 v[72:75], v[128:131], v[144:147], v[72:75]
    s_barrier
    ds_read_b128 v[116:119], v5 offset:34816
    v_mfma_f32_16x16x32_bf16 v[76:79], v[128:131], v[148:151], v[76:79]
    ds_read_b64_tr_b16 v[152:153], v9 offset:32768
    ds_read_b64_tr_b16 v[154:155], v9 offset:40960
    s_waitcnt lgkmcnt(6)
    v_mfma_f32_16x16x32_bf16 v[80:83], v[132:135], v[144:147], v[80:83]
    ds_read_b128 v[120:123], v5 offset:35840
    v_mfma_f32_16x16x32_bf16 v[84:87], v[132:135], v[148:151], v[84:87]
    ds_read_b64_tr_b16 v[156:157], v11 offset:32768
    ds_read_b64_tr_b16 v[158:159], v11 offset:40960
    s_waitcnt lgkmcnt(8)
    v_mfma_f32_16x16x32_bf16 v[88:91], v[136:139], v[144:147], v[88:91]
    ds_read_b128 v[124:127], v5 offset:38912
    v_mfma_f32_16x16x32_bf16 v[92:95], v[136:139], v[148:151], v[92:95]
    s_waitcnt lgkmcnt(8)
    v_mfma_f32_16x16x32_bf16 v[96:99], v[140:143], v[144:147], v[96:99]
    ds_read_b128 v[128:131], v5 offset:39936
    v_mfma_f32_16x16x32_bf16 v[100:103], v[140:143], v[148:151], v[100:103]
    s_waitcnt lgkmcnt(8)
    v_mfma_f32_16x16x32_bf16 v[104:107], v[112:115], v[144:147], v[104:107]
    ds_read_b128 v[132:135], v5 offset:43008
    v_mfma_f32_16x16x32_bf16 v[108:111], v[112:115], v[148:151], v[108:111]
    s_waitcnt lgkmcnt(3)
    v_mfma_f32_16x16x32_bf16 v[40:43], v[116:119], v[152:155], v[40:43]
    ds_read_b128 v[136:139], v5 offset:44032
    v_mfma_f32_16x16x32_bf16 v[44:47], v[116:119], v[156:159], v[44:47]
    v_mfma_f32_16x16x32_bf16 v[48:51], v[120:123], v[152:155], v[48:51]
    ds_read_b128 v[140:143], v5 offset:47104
    v_mfma_f32_16x16x32_bf16 v[52:55], v[120:123], v[156:159], v[52:55]
    s_waitcnt lgkmcnt(4)
    v_mfma_f32_16x16x32_bf16 v[56:59], v[124:127], v[152:155], v[56:59]
    ds_read_b128 v[112:115], v5 offset:48128
    v_mfma_f32_16x16x32_bf16 v[60:63], v[124:127], v[156:159], v[60:63]
    s_waitcnt lgkmcnt(4)
    v_mfma_f32_16x16x32_bf16 v[64:67], v[128:131], v[152:155], v[64:67]
    ds_read_b128 v[116:119], v6 offset:9216
    v_mfma_f32_16x16x32_bf16 v[68:71], v[128:131], v[156:159], v[68:71]
    s_waitcnt lgkmcnt(4)
    v_mfma_f32_16x16x32_bf16 v[72:75], v[132:135], v[152:155], v[72:75]
    s_barrier
    ds_read_b128 v[120:123], v2 offset:55296
    v_mfma_f32_16x16x32_bf16 v[76:79], v[132:135], v[156:159], v[76:79]
    ds_read_b64_tr_b16 v[160:161], v8 offset:49152
    ds_read_b64_tr_b16 v[162:163], v8 offset:57344
    s_waitcnt lgkmcnt(6)
    v_mfma_f32_16x16x32_bf16 v[80:83], v[136:139], v[152:155], v[80:83]
    ds_read_b128 v[124:127], v5 offset:55296
    v_mfma_f32_16x16x32_bf16 v[84:87], v[136:139], v[156:159], v[84:87]
    ds_read_b64_tr_b16 v[164:165], v10 offset:49152
    ds_read_b64_tr_b16 v[166:167], v10 offset:57344
    s_waitcnt lgkmcnt(8)
    v_mfma_f32_16x16x32_bf16 v[88:91], v[140:143], v[152:155], v[88:91]
    ds_read_b128 v[128:131], v2 offset:56320
    v_mfma_f32_16x16x32_bf16 v[92:95], v[140:143], v[156:159], v[92:95]
    ds_read_b64_tr_b16 v[168:169], v9 offset:49152
    ds_read_b64_tr_b16 v[170:171], v9 offset:57344
    s_waitcnt lgkmcnt(10)
    v_mfma_f32_16x16x32_bf16 v[96:99], v[112:115], v[152:155], v[96:99]
    ds_read_b128 v[132:135], v5 offset:56320
    v_mfma_f32_16x16x32_bf16 v[100:103], v[112:115], v[156:159], v[100:103]
    ds_read_b64_tr_b16 v[172:173], v11 offset:49152
    ds_read_b64_tr_b16 v[174:175], v11 offset:57344
    s_waitcnt lgkmcnt(12)
    v_mfma_f32_16x16x32_bf16 v[104:107], v[116:119], v[152:155], v[104:107]
    ds_read_b128 v[136:139], v2 offset:59392
    v_mfma_f32_16x16x32_bf16 v[108:111], v[116:119], v[156:159], v[108:111]
    s_waitcnt lgkmcnt(7)
    v_mfma_f32_16x16x32_bf16 v[56:59], v[120:123], v[160:163], v[56:59]
    ds_read_b128 v[140:143], v5 offset:59392
    v_mfma_f32_16x16x32_bf16 v[60:63], v[120:123], v[164:167], v[60:63]
    s_waitcnt lgkmcnt(2)
    v_mfma_f32_16x16x32_bf16 v[56:59], v[124:127], v[168:171], v[56:59]
    ds_read_b128 v[112:115], v2 offset:60416
    v_mfma_f32_16x16x32_bf16 v[60:63], v[124:127], v[172:175], v[60:63]
    v_mfma_f32_16x16x32_bf16 v[64:67], v[128:131], v[160:163], v[64:67]
    ds_read_b128 v[116:119], v5 offset:60416
    v_mfma_f32_16x16x32_bf16 v[68:71], v[128:131], v[164:167], v[68:71]
    v_mfma_f32_16x16x32_bf16 v[64:67], v[132:135], v[168:171], v[64:67]
    ds_read_b128 v[120:123], v2 offset:63488
    v_mfma_f32_16x16x32_bf16 v[68:71], v[132:135], v[172:175], v[68:71]
    s_waitcnt lgkmcnt(4)
    v_mfma_f32_16x16x32_bf16 v[72:75], v[136:139], v[160:163], v[72:75]
    ds_read_b128 v[124:127], v5 offset:63488
    v_cvt_pk_bf16_f32 v204, v56, v57
    v_cvt_pk_bf16_f32 v205, v58, v59
    v_mfma_f32_16x16x32_bf16 v[76:79], v[136:139], v[164:167], v[76:79]
    v_cvt_pk_bf16_f32 v206, v60, v61
    v_cvt_pk_bf16_f32 v207, v62, v63
    s_waitcnt lgkmcnt(4)
    v_mfma_f32_16x16x32_bf16 v[72:75], v[140:143], v[168:171], v[72:75]
    ds_read_b128 v[128:131], v2 offset:64512
    buffer_store_dwordx4 v[204:207], v2, s[20:23], s50 offen offset:0 sc1
    v_cvt_pk_bf16_f32 v208, v64, v65
    v_mfma_f32_16x16x32_bf16 v[76:79], v[140:143], v[172:175], v[76:79]
    v_cvt_pk_bf16_f32 v209, v66, v67
    v_cvt_pk_bf16_f32 v210, v68, v69
    s_waitcnt lgkmcnt(4)
    v_mfma_f32_16x16x32_bf16 v[80:83], v[112:115], v[160:163], v[80:83]
    ds_read_b128 v[132:135], v5 offset:64512
    v_cvt_pk_bf16_f32 v211, v70, v71
    buffer_store_dwordx4 v[208:211], v2, s[20:23], s50 offen offset:1024 sc1
    v_mfma_f32_16x16x32_bf16 v[84:87], v[112:115], v[164:167], v[84:87]
    v_cvt_pk_bf16_f32 v212, v72, v73
    v_cvt_pk_bf16_f32 v213, v74, v75
    s_waitcnt lgkmcnt(4)
    v_mfma_f32_16x16x32_bf16 v[80:83], v[116:119], v[168:171], v[80:83]
    ds_read_b128 v[136:139], v6 offset:10240
    v_cvt_pk_bf16_f32 v214, v76, v77
    v_cvt_pk_bf16_f32 v215, v78, v79
    v_mfma_f32_16x16x32_bf16 v[84:87], v[116:119], v[172:175], v[84:87]
    buffer_store_dwordx4 v[212:215], v2, s[20:23], s51 offen offset:0 sc1
    s_waitcnt lgkmcnt(4)
    v_mfma_f32_16x16x32_bf16 v[88:91], v[120:123], v[160:163], v[88:91]
    ds_read_b128 v[140:143], v6 offset:11264
    v_mfma_f32_16x16x32_bf16 v[92:95], v[120:123], v[164:167], v[92:95]
    s_waitcnt lgkmcnt(4)
    v_mfma_f32_16x16x32_bf16 v[88:91], v[124:127], v[168:171], v[88:91]
    ds_read_b128 v[112:115], v2 offset:51200
    v_cvt_pk_bf16_f32 v216, v80, v81
    v_cvt_pk_bf16_f32 v217, v82, v83
    v_mfma_f32_16x16x32_bf16 v[92:95], v[124:127], v[172:175], v[92:95]
    v_cvt_pk_bf16_f32 v218, v84, v85
    v_cvt_pk_bf16_f32 v219, v86, v87
    s_waitcnt lgkmcnt(4)
    v_mfma_f32_16x16x32_bf16 v[96:99], v[128:131], v[160:163], v[96:99]
    ds_read_b128 v[116:119], v5 offset:51200
    buffer_store_dwordx4 v[216:219], v2, s[20:23], s51 offen offset:1024 sc1
    v_mfma_f32_16x16x32_bf16 v[100:103], v[128:131], v[164:167], v[100:103]
    s_waitcnt lgkmcnt(4)
    v_mfma_f32_16x16x32_bf16 v[96:99], v[132:135], v[168:171], v[96:99]
    ds_read_b128 v[120:123], v2 offset:52224
    v_cvt_pk_bf16_f32 v220, v88, v89
    v_cvt_pk_bf16_f32 v221, v90, v91
    v_mfma_f32_16x16x32_bf16 v[100:103], v[132:135], v[172:175], v[100:103]
    v_cvt_pk_bf16_f32 v222, v92, v93
    v_cvt_pk_bf16_f32 v223, v94, v95
    s_waitcnt lgkmcnt(4)
    v_mfma_f32_16x16x32_bf16 v[104:107], v[136:139], v[160:163], v[104:107]
    ds_read_b128 v[124:127], v5 offset:52224
    buffer_store_dwordx4 v[220:223], v2, s[20:23], s52 offen offset:0 sc1
    v_mfma_f32_16x16x32_bf16 v[108:111], v[136:139], v[164:167], v[108:111]
    s_waitcnt lgkmcnt(4)
    v_mfma_f32_16x16x32_bf16 v[104:107], v[140:143], v[168:171], v[104:107]
    v_cvt_pk_bf16_f32 v224, v96, v97
    v_cvt_pk_bf16_f32 v225, v98, v99
    v_mfma_f32_16x16x32_bf16 v[108:111], v[140:143], v[172:175], v[108:111]
    v_cvt_pk_bf16_f32 v226, v100, v101
    v_cvt_pk_bf16_f32 v227, v102, v103
    s_waitcnt lgkmcnt(3)
    v_mfma_f32_16x16x32_bf16 v[40:43], v[112:115], v[160:163], v[40:43]
    buffer_store_dwordx4 v[224:227], v2, s[20:23], s52 offen offset:1024 sc1
    v_mfma_f32_16x16x32_bf16 v[44:47], v[112:115], v[164:167], v[44:47]
    s_waitcnt lgkmcnt(2)
    v_mfma_f32_16x16x32_bf16 v[40:43], v[116:119], v[168:171], v[40:43]
    v_cvt_pk_bf16_f32 v228, v104, v105
    v_cvt_pk_bf16_f32 v229, v106, v107
    v_mfma_f32_16x16x32_bf16 v[44:47], v[116:119], v[172:175], v[44:47]
    v_cvt_pk_bf16_f32 v230, v108, v109
    v_cvt_pk_bf16_f32 v231, v110, v111
    s_waitcnt lgkmcnt(1)
    v_mfma_f32_16x16x32_bf16 v[48:51], v[120:123], v[160:163], v[48:51]
    buffer_store_dwordx4 v[228:231], v12, s[20:23], s53 offen sc1
    v_mfma_f32_16x16x32_bf16 v[52:55], v[120:123], v[164:167], v[52:55]
    s_waitcnt lgkmcnt(0)
    v_mfma_f32_16x16x32_bf16 v[48:51], v[124:127], v[168:171], v[48:51]
    v_mfma_f32_16x16x32_bf16 v[52:55], v[124:127], v[172:175], v[52:55]
    s_waitcnt vmcnt(7)
    v_mfma_f32_16x16x32_bf16 v[40:43], v[176:179], v[188:191], v[40:43]
    v_mfma_f32_16x16x32_bf16 v[44:47], v[176:179], v[190:193], v[44:47]
    v_mfma_f32_16x16x32_bf16 v[48:51], v[180:183], v[188:191], v[48:51]
    v_mfma_f32_16x16x32_bf16 v[52:55], v[180:183], v[190:193], v[52:55]
    v_mfma_f32_16x16x32_bf16 v[40:43], v[200:203], v[194:197], v[40:43]
    v_mfma_f32_16x16x32_bf16 v[44:47], v[200:203], v[196:199], v[44:47]
    v_mfma_f32_16x16x32_bf16 v[48:51], v[200:203], v[194:197], v[48:51]
    v_mfma_f32_16x16x32_bf16 v[52:55], v[200:203], v[196:199], v[52:55]
Lk1_join124:
    s_waitcnt vmcnt(0)
    buffer_store_dword v17, v17, s[20:23], s49 offen sc1
    v_mfma_f32_16x16x32_bf16 v[104:107], v[184:187], v[188:191], v[104:107]
    v_mfma_f32_16x16x32_bf16 v[108:111], v[184:187], v[190:193], v[108:111]
    v_mfma_f32_16x16x32_bf16 v[104:107], v[200:203], v[194:197], v[104:107]
    v_mfma_f32_16x16x32_bf16 v[108:111], v[200:203], v[196:199], v[108:111]
    s_mov_b32 s63, 0
Lk1_spin126:
    buffer_load_dwordx4 v[20:23], v17, s[20:23], s48 offen sc1
    s_add_u32 s63, s63, 1
    s_waitcnt vmcnt(0)
    v_or3_b32 v20, v20, v21, v22
    v_or_b32 v20, v20, v23
    s_cmp_ge_u32 s63, 262144
    v_cmp_ne_u32 vcc, 0, v20
    s_cbranch_scc1 Lk1_go127
    s_cbranch_vccnz Lk1_spin126
Lk1_go127:
    buffer_load_dwordx4 v[56:59], v2, s[20:23], s56 offen offset:0 sc1
    buffer_load_dwordx4 v[60:63], v2, s[20:23], s57 offen offset:0 sc1
    buffer_load_dwordx4 v[64:67], v2, s[20:23], s58 offen offset:0 sc1
    buffer_load_dwordx4 v[68:71], v2, s[20:23], s56 offen offset:1024 sc1
    buffer_load_dwordx4 v[72:75], v2, s[20:23], s57 offen offset:1024 sc1
    buffer_load_dwordx4 v[76:79], v2, s[20:23], s58 offen offset:1024 sc1
    s_cmp_lg_u32 s3, s32
    s_cbranch_scc1 Lk1_no8128
    buffer_load_dwordx4 v[80:83], v2, s[20:23], s59 offen offset:0 sc1
    buffer_load_dwordx4 v[84:87], v2, s[20:23], s60 offen offset:0 sc1
    buffer_load_dwordx4 v[88:91], v2, s[20:23], s61 offen offset:0 sc1
    s_waitcnt vmcnt(8)
    v_mfma_f32_16x16x32_bf16 v[40:43], v[188:191], v[56:59], v[40:43]
    v_mfma_f32_16x16x32_bf16 v[44:47], v[190:193], v[56:59], v[44:47]
    s_waitcnt vmcnt(7)
    v_mfma_f32_16x16x32_bf16 v[40:43], v[188:191], v[60:63], v[40:43]
    v_mfma_f32_16x16x32_bf16 v[44:47], v[190:193], v[60:63], v[44:47]
    s_waitcnt vmcnt(6)
    v_mfma_f32_16x16x32_bf16 v[40:43], v[188:191], v[64:67], v[40:43]
    v_mfma_f32_16x16x32_bf16 v[44:47], v[190:193], v[64:67], v[44:47]
    s_waitcnt vmcnt(5)
    v_mfma_f32_16x16x32_bf16 v[48:51], v[188:191], v[68:71], v[48:51]
    v_mfma_f32_16x16x32_bf16 v[52:55], v[190:193], v[68:71], v[52:55]
    s_waitcnt vmcnt(4)
    v_mfma_f32_16x16x32_bf16 v[48:51], v[188:191], v[72:75], v[48:51]
    v_mfma_f32_16x16x32_bf16 v[52:55], v[190:193], v[72:75], v[52:55]
    s_waitcnt vmcnt(3)
    v_mfma_f32_16x16x32_bf16 v[48:51], v[188:191], v[76:79], v[48:51]
    v_mfma_f32_16x16x32_bf16 v[52:55], v[190:193], v[76:79], v[52:55]
    s_waitcnt vmcnt(2)
    v_mfma_f32_16x16x32_bf16 v[104:107], v[188:191], v[80:83], v[104:107]
    v_mfma_f32_16x16x32_bf16 v[108:111], v[190:193], v[80:83], v[108:111]
    s_waitcnt vmcnt(1)
    v_mfma_f32_16x16x32_bf16 v[104:107], v[188:191], v[84:87], v[104:107]
    v_mfma_f32_16x16x32_bf16 v[108:111], v[190:193], v[84:87], v[108:111]
    s_waitcnt vmcnt(0)
    v_mfma_f32_16x16x32_bf16 v[104:107], v[188:191], v[88:91], v[104:107]
    v_mfma_f32_16x16x32_bf16 v[108:111], v[190:193], v[88:91], v[108:111]
    s_nop 1
    v_cvt_pk_bf16_f32 v144, v40, v41
    v_cvt_pk_bf16_f32 v146, v48, v49
    v_cvt_pk_bf16_f32 v145, v42, v43
    v_cvt_pk_bf16_f32 v147, v50, v51
    s_nop 0
    v_permlane16_swap_b32 v144, v146
    v_permlane16_swap_b32 v145, v147
    buffer_store_dwordx4 v[144:147], v13, s[28:31], s44 offen sc1
    v_cvt_pk_bf16_f32 v148, v44, v45
    v_cvt_pk_bf16_f32 v150, v52, v53
    v_cvt_pk_bf16_f32 v149, v46, v47
    v_cvt_pk_bf16_f32 v151, v54, v55
    s_nop 0
    v_permlane16_swap_b32 v148, v150
    v_permlane16_swap_b32 v149, v151
    buffer_store_dwordx4 v[148:151], v14, s[28:31], s44 offen sc1
    v_cvt_pk_bf16_f32 v152, v104, v105
    v_cvt_pk_bf16_f32 v154, v108, v109
    v_cvt_pk_bf16_f32 v153, v106, v107
    v_cvt_pk_bf16_f32 v155, v110, v111
    s_nop 0
    v_permlane16_swap_b32 v152, v154
    v_permlane16_swap_b32 v153, v155
    buffer_store_dwordx4 v[152:155], v15, s[28:31], s45 offen sc1
    s_endpgm
Lk1_no8128:
    s_waitcnt vmcnt(5)
    v_mfma_f32_16x16x32_bf16 v[40:43], v[188:191], v[56:59], v[40:43]
    v_mfma_f32_16x16x32_bf16 v[44:47], v[190:193], v[56:59], v[44:47]
    s_waitcnt vmcnt(4)
    v_mfma_f32_16x16x32_bf16 v[40:43], v[188:191], v[60:63], v[40:43]
    v_mfma_f32_16x16x32_bf16 v[44:47], v[190:193], v[60:63], v[44:47]
    s_waitcnt vmcnt(3)
    v_mfma_f32_16x16x32_bf16 v[40:43], v[188:191], v[64:67], v[40:43]
    v_mfma_f32_16x16x32_bf16 v[44:47], v[190:193], v[64:67], v[44:47]
    s_waitcnt vmcnt(2)
    v_mfma_f32_16x16x32_bf16 v[48:51], v[188:191], v[68:71], v[48:51]
    v_mfma_f32_16x16x32_bf16 v[52:55], v[190:193], v[68:71], v[52:55]
    s_waitcnt vmcnt(1)
    v_mfma_f32_16x16x32_bf16 v[48:51], v[188:191], v[72:75], v[48:51]
    v_mfma_f32_16x16x32_bf16 v[52:55], v[190:193], v[72:75], v[52:55]
    s_waitcnt vmcnt(0)
    v_mfma_f32_16x16x32_bf16 v[48:51], v[188:191], v[76:79], v[48:51]
    v_mfma_f32_16x16x32_bf16 v[52:55], v[190:193], v[76:79], v[52:55]
    s_nop 7
    v_cvt_pk_bf16_f32 v144, v40, v41
    v_cvt_pk_bf16_f32 v146, v48, v49
    v_cvt_pk_bf16_f32 v145, v42, v43
    v_cvt_pk_bf16_f32 v147, v50, v51
    s_nop 0
    v_permlane16_swap_b32 v144, v146
    v_permlane16_swap_b32 v145, v147
    buffer_store_dwordx4 v[144:147], v13, s[28:31], s44 offen sc1
    v_cvt_pk_bf16_f32 v148, v44, v45
    v_cvt_pk_bf16_f32 v150, v52, v53
    v_cvt_pk_bf16_f32 v149, v46, v47
    v_cvt_pk_bf16_f32 v151, v54, v55
    s_nop 0
    v_permlane16_swap_b32 v148, v150
    v_permlane16_swap_b32 v149, v151
    buffer_store_dwordx4 v[148:151], v14, s[28:31], s44 offen sc1
Lk1_end91:
    s_endpgm
Lcode_end:
.section .rodata,"a"
.p2align 6
.amdhsa_kernel sequential_preLN__linear_attn_block__mixer_token_mlp__prompt_kernel
  .amdhsa_next_free_vgpr 256
  .amdhsa_next_free_sgpr 102
  .amdhsa_accum_offset 256
  .amdhsa_group_segment_fixed_size 0
  .amdhsa_kernarg_size 88
  .amdhsa_user_sgpr_count 2
  .amdhsa_user_sgpr_kernarg_segment_ptr 1
  .amdhsa_system_sgpr_workgroup_id_x 1
  .amdhsa_float_denorm_mode_32 3
.end_amdhsa_kernel
```
